```python
import torch

def _softmax(x, axis=-1):
    return torch.softmax(x, dim=axis)
def _gelu(x):
    return torch.nn.functional.gelu(x, approximate="tanh")
def _silu(x):
    return torch.nn.functional.silu(x)
def _sigmoid(x):
    return torch.sigmoid(x)
def _layernorm(x, axis=-1, eps=1e-5):
    m = x.mean(dim=axis, keepdim=True)
    v = x.var(dim=axis, keepdim=True, unbiased=False)
    return (x - m) / torch.sqrt(v + eps)
def _scatter_add(tgt, idx, src, axis=0):
    return tgt.clone().index_add_(axis, idx, src)
def _segment_sum(src, seg, n):
    out = torch.zeros((n,) + src.shape[1:], dtype=src.dtype)
    return out.index_add_(0, seg, src)
def _pad(x, pw):
    flat = tuple(v for pair in reversed(pw) for v in pair)
    return torch.nn.functional.pad(x, flat)

kernel_name = 'recurrent_scan__ssm_conv_s4d__geglu_ffn__prompt'

def setup_inputs():

    _w = (lambda a: (lambda t: t.to(torch.bfloat16) if t.is_floating_point() else t)(torch.as_tensor(a)))
    def _A_setup():
        Bsz, L, D, N = 1, 2048, 576, 128
        return {
            "u": _w((lambda *s: torch.randn(*s, dtype=torch.bfloat16) * 0.05)(Bsz, L, D)),
            "log_A_real": _w((lambda *s: torch.randn(*s, dtype=torch.bfloat16) * 6.4)(D, N) * 0.5),
            "A_imag": _w((lambda *s: torch.randn(*s, dtype=torch.bfloat16) * 0.05)(D, N) * 3.14),
            "C_real": _w((lambda *s: torch.randn(*s, dtype=torch.bfloat16) * 0.05)(D, N) / N ** 0.5),
            "C_imag": _w((lambda *s: torch.randn(*s, dtype=torch.bfloat16) * 0.05)(D, N) / N ** 0.5),
            "log_dt": _w((lambda *s: torch.randn(*s, dtype=torch.bfloat16) * 0.05)(D) * 0.5 - 4.0),
            "D_skip": _w((lambda *s: torch.randn(*s, dtype=torch.bfloat16) * 0.05)(D)),
        }
    _A_in = _A_setup()

    def _B_setup():
        B, S, D, F = 1, 2048, 576, 4608
        return {
            "x": _w((lambda *s: torch.randn(*s, dtype=torch.bfloat16) * 0.05)(B, S, D)),
            "w_gate": _w((lambda *s: torch.randn(*s, dtype=torch.bfloat16) * 0.05)(D, F)),
            "w_up": _w((lambda *s: torch.randn(*s, dtype=torch.bfloat16) * 0.05)(D, F)),
            "w_down": _w((lambda *s: torch.randn(*s, dtype=torch.bfloat16) * 0.05)(F, D)),
        }
    _B_in = _B_setup()

    return {
        "A_u": _A_in["u"],
        "A_log_A_real": _A_in["log_A_real"],
        "A_A_imag": _A_in["A_imag"],
        "A_C_real": _A_in["C_real"],
        "A_C_imag": _A_in["C_imag"],
        "A_log_dt": _A_in["log_dt"],
        "A_D_skip": _A_in["D_skip"],
        "B_x": _B_in["x"],
        "B_w_gate": _B_in["w_gate"],
        "B_w_up": _B_in["w_up"],
        "B_w_down": _B_in["w_down"],
    }

def reference(A_u, A_log_A_real, A_A_imag, A_C_real, A_C_imag, A_log_dt, A_D_skip, B_x, B_w_gate, B_w_up, B_w_down):
    def _A_ref(u, log_A_real, A_imag, C_real, C_imag, log_dt, D_skip):
        L = u.shape[1]
        dt = torch.exp(log_dt)
        A = -torch.exp(log_A_real) + 1j * A_imag
        C = (C_real + 1j * C_imag) * dt[:, None]
        pos = (lambda x, dt: x.to(dt))(torch.arange(L), log_dt.dtype)
        P = torch.exp((A * dt[:, None])[:, :, None] * pos[None, None, :])
        K = 2.0 * torch.einsum("dn,dnl->dl", C, P).real
        L2 = 2 * L
        u_t = (lambda x, *d: x.permute(*d))(u, 0, 2, 1)
        Kf = (lambda x, *a, **k: torch.fft.rfft(x.float(), *a, **k))(K, L2)
        Uf = (lambda x, *a, **k: torch.fft.rfft(x.float(), *a, **k))(u_t, L2)
        y = (lambda x, *a, **k: torch.fft.irfft(x, *a, **k).to(torch.bfloat16))(Uf * Kf[None, :, :], L2)[:, :, :L]
        y = (lambda x, *d: x.permute(*d))(y, 0, 2, 1)
        return y + u * D_skip[None, None, :]

    def _B_ref(x, w_gate, w_up, w_down):
        return (_gelu(x @ w_gate) * (x @ w_up)) @ w_down

    x = A_u
    xn = _layernorm(x, axis=-1)
    s = _A_ref(xn, A_log_A_real, A_A_imag, A_C_real, A_C_imag, A_log_dt, A_D_skip)
    g = _silu(_B_ref(xn, B_w_gate, B_w_up, B_w_down))
    return x + s * g
```

```asm
; @launch grid=(256,1,1) block=(256,1,1) lds=163840
.amdgcn_target "amdgcn-amd-amdhsa--gfx950"
.text
.globl recurrent_scan__ssm_conv_s4d__geglu_ffn__prompt_kernel
.p2align 8
.type recurrent_scan__ssm_conv_s4d__geglu_ffn__prompt_kernel,@function
recurrent_scan__ssm_conv_s4d__geglu_ffn__prompt_kernel:
    s_cmp_ge_u32 s2, 256
    s_cbranch_scc1 Lend
    s_load_dwordx2 s[4:5], s[0:1], 0
    s_load_dwordx8 s[60:67], s[0:1], 8
    s_load_dwordx2 s[68:69], s[0:1], 40
    s_load_dwordx2 s[28:29], s[0:1], 48
    s_load_dwordx2 s[8:9], s[0:1], 104
    s_load_dwordx2 s[12:13], s[0:1], 64
    s_load_dwordx2 s[20:21], s[0:1], 72
    s_getpc_b64 s[82:83]
Lpc:
    s_lshr_b32 s80, s2, 3
    s_mul_i32 s80, s80, 2168
    v_lshl_add_u32 v13, v0, 7, s80
    v_cmp_gt_u32 vcc, 17, v0
    v_lshrrev_b32 v1, 6, v0
    s_and_saveexec_b64 s[80:81], vcc
    s_cbranch_execz Lnotouch
    global_load_dword v61, v13, s[82:83]
Lnotouch:
    s_mov_b64 exec, -1
    v_readfirstlane_b32 s3, v1
    v_and_b32 v0, 63, v0
    v_mov_b32 v64, v0
    s_cmp_eq_u32 s3, 3
    s_cbranch_scc1 Lw3
    s_mul_hi_u32 s80, s2, 1431655766
    s_mul_i32 s81, s80, 3
    s_sub_u32 s81, s2, s81
    s_mul_i32 s81, s81, 3
    s_add_u32 s81, s81, s3
    s_lshl_b32 s83, s80, 3
    s_add_u32 s83, s83, s81
    s_add_u32 s82, s80, 512
    s_cmp_eq_u32 s81, 8
    s_cselect_b32 s83, s82, s83
    s_lshl_b32 s84, s80, 7
    s_lshl_b32 s81, s81, 3
    s_add_u32 s84, s84, s81
    s_add_u32 s84, s84, 37814272
    s_lshl_b32 s59, s83, 12
    s_add_u32 s59, s59, 2621440
    s_cmp_lt_u32 s2, 192
    s_cselect_b32 s81, s3, 3
    s_cmp_lt_u32 s81, 3
    s_cselect_b32 s84, s84, 2146435072
    s_cselect_b32 s59, s59, 0
    s_cselect_b32 s83, s83, 0
    s_lshl_b32 s80, s83, 8
    v_lshl_add_u32 v71, v0, 2, s80
    s_lshl_b32 s80, s83, 1
    v_mov_b32 v72, s80
    s_waitcnt lgkmcnt(0)
    global_load_dword v120, v71, s[60:61]
    global_load_ushort v124, v72, s[68:69]
    global_load_dword v121, v71, s[62:63]
    global_load_dword v122, v71, s[64:65]
    global_load_dword v123, v71, s[66:67]
    global_load_ushort v127, v72, s[28:29]
    s_branch Lcommon
Lw3:
    v_and_b32 v66, 7, v0
    v_lshrrev_b32 v67, 3, v0
    v_mul_u32_u24 v68, 1152, v66
    v_lshl_add_u32 v68, v67, 4, v68
    s_mul_i32 s80, s2, 9216
    v_add_u32 v68, s80, v68
    s_mov_b32 s84, 2146435072
    s_mov_b32 s59, 0
    s_waitcnt lgkmcnt(0)
    global_load_dwordx4 v[80:83], v68, s[4:5] offset:0
    global_load_dwordx4 v[84:87], v68, s[4:5] offset:128
    global_load_dwordx4 v[88:91], v68, s[4:5] offset:256
    global_load_dwordx4 v[92:95], v68, s[4:5] offset:384
    global_load_dwordx4 v[96:99], v68, s[4:5] offset:512
    global_load_dwordx4 v[100:103], v68, s[4:5] offset:640
    global_load_dwordx4 v[104:107], v68, s[4:5] offset:768
    global_load_dwordx4 v[108:111], v68, s[4:5] offset:896
    global_load_dwordx4 v[112:115], v68, s[4:5] offset:1024
    s_add_u32 s80, s8, 37748736
    s_addc_u32 s81, s9, 0
    s_load_dword s30, s[80:81], 0
Lcommon:
    v_mov_b32 v14, 163824
    s_load_dwordx2 s[24:25], s[0:1], 80
    s_load_dwordx2 s[6:7], s[0:1], 88
    s_mov_b32 s14, 5308416
    s_mov_b32 s15, 0x20000
    s_sub_u32 s16, s20, 1024
    s_subb_u32 s17, s21, 0
    s_mov_b32 s18, 5309440
    s_mov_b32 s19, 0x20000
    s_and_b32 s80, s2, 7
    s_mul_i32 s80, s80, 1152
    s_lshr_b32 s81, s2, 6
    s_lshl_b32 s81, s81, 8
    s_add_u32 s80, s80, s81
    s_mul_i32 s81, s3, 73728
    s_add_u32 s80, s80, s81
    s_and_b32 s81, s3, 1
    s_lshl_b32 s81, s81, 1
    s_lshl_b32 s50, s3, 11
    v_lshrrev_b32 v10, 3, v0
    v_bfe_u32 v11, v0, 4, 1
    v_or_b32 v11, s81, v11
    v_bfe_u32 v12, v0, 1, 2
    v_xor_b32 v11, v11, v12
    v_lshlrev_b32 v1, 4, v0
    v_and_b32 v12, 16, v1
    v_mul_u32_u24 v2, 9216, v10
    v_lshl_add_u32 v2, v11, 5, v2
    v_add3_u32 v2, v2, v12, s80
    s_bfe_u32 s83, s2, 0x30003
    s_mul_i32 s81, s3, 73728
    s_sub_u32 s80, s80, s81
    s_lshl_b32 s81, s83, 1
    s_lshr_b32 s82, s3, 1
    s_add_u32 s81, s81, s82
    s_mul_i32 s81, s81, 184320
    s_add_u32 s80, s80, s81
    s_add_u32 s80, s80, 2359296
    v_min_u32 v62, 19, v0
    v_mul_u32_u24 v62, 9216, v62
    v_add_u32 v62, s80, v62
    s_bitcmp1_b32 s3, 0
    s_cselect_b32 s20, s20, s12
    s_cselect_b32 s21, s21, s13
    s_mul_i32 s81, s83, 294912
    s_lshl_b32 s82, s83, 13
    s_add_u32 m0, s82, s50
    s_add_u32 s83, s83, 1
    s_mov_b32 s10, 100663296
    s_mov_b32 s11, 0x20000
    s_bfe_u32 s80, s2, 0x30003
    s_lshl_b32 s80, s80, 2
    s_add_u32 s80, s80, s3
    s_lshl_b32 s31, s80, 7
    s_add_u32 s31, s31, 37912576
    s_mul_i32 s52, s80, 73728
    v_lshrrev_b32 v10, 4, v0
    v_bfe_u32 v11, v0, 2, 2
    v_and_b32 v12, 3, v0
    v_lshlrev_b32 v12, 3, v12
    v_lshl_add_u32 v4, v10, 11, v12
    v_lshl_add_u32 v4, v11, 7, v4
    v_bfe_u32 v13, v0, 3, 2
    v_lshl_add_u32 v4, v13, 5, v4
    v_xor_b32 v5, 32, v4
    v_xor_b32 v6, 64, v4
    v_xor_b32 v7, 96, v4
    v_and_b32 v13, 31, v0
    v_lshlrev_b32 v13, 4, v13
    s_cmp_lg_u32 s3, 3
    s_cbranch_scc1 Lkg
    v_subrev_u32 v117, 147456, v2
    v_xor_b32 v118, 64, v2
    v_subrev_u32 v118, 73728, v118
    v_subrev_u32 v116, 147456, v118
    v_mov_b32 v119, v2
    s_lshl_b32 s80, s2, 4
    s_add_u32 s80, s80, 37912576
    v_mov_b32 v120, 2146435072
    v_writelane_b32 v120, s80, 0
    v_lshrrev_b32 v73, 2, v67
    v_lshlrev_b32 v73, 12, v73
    v_and_b32 v67, 3, v67
    v_lshl_add_u32 v73, v67, 8, v73
    v_lshl_add_u32 v73, v66, 4, v73
    s_lshr_b32 s60, s2, 3
    s_mul_i32 s60, s60, 73728
    s_bfe_u32 s61, s2, 0x20001
    s_lshl_b32 s61, s61, 10
    s_add_u32 s60, s60, s61
    s_and_b32 s61, s2, 1
    s_lshl_b32 s61, s61, 7
    s_add_u32 s60, s60, s61
    s_mov_b32 s63, 0x3f803f80
    s_mov_b32 s64, 0x3ae38e39
    s_mov_b32 s65, 0xffff0000
    v_mov_b32 v74, 0
    v_mov_b32 v75, 0
    v_mov_b32 v76, 0
    v_mov_b32 v77, 0
    s_waitcnt vmcnt(6)
    buffer_load_dwordx4 v2, s[12:15], s81 offen  lds
    buffer_load_dwordx4 v2, s[16:19], s81 offen offset:1024  lds
    global_load_dword v63, v62, s[20:21]
    v_dot2c_f32_bf16 v74, s63, v80
    v_dot2c_f32_bf16 v76, v80, v80
    v_dot2c_f32_bf16 v75, s63, v81
    v_dot2c_f32_bf16 v77, v81, v81
    v_dot2c_f32_bf16 v74, s63, v82
    v_dot2c_f32_bf16 v76, v82, v82
    v_dot2c_f32_bf16 v75, s63, v83
    v_dot2c_f32_bf16 v77, v83, v83
    v_dot2c_f32_bf16 v74, s63, v84
    v_dot2c_f32_bf16 v76, v84, v84
    v_dot2c_f32_bf16 v75, s63, v85
    v_dot2c_f32_bf16 v77, v85, v85
    v_dot2c_f32_bf16 v74, s63, v86
    v_dot2c_f32_bf16 v76, v86, v86
    v_dot2c_f32_bf16 v75, s63, v87
    v_dot2c_f32_bf16 v77, v87, v87
    v_dot2c_f32_bf16 v74, s63, v88
    v_dot2c_f32_bf16 v76, v88, v88
    v_dot2c_f32_bf16 v75, s63, v89
    v_dot2c_f32_bf16 v77, v89, v89
    v_dot2c_f32_bf16 v74, s63, v90
    v_dot2c_f32_bf16 v76, v90, v90
    v_dot2c_f32_bf16 v75, s63, v91
    v_dot2c_f32_bf16 v77, v91, v91
    s_waitcnt vmcnt(6)
    v_dot2c_f32_bf16 v74, s63, v92
    v_dot2c_f32_bf16 v76, v92, v92
    v_dot2c_f32_bf16 v75, s63, v93
    v_dot2c_f32_bf16 v77, v93, v93
    v_dot2c_f32_bf16 v74, s63, v94
    v_dot2c_f32_bf16 v76, v94, v94
    v_dot2c_f32_bf16 v75, s63, v95
    v_dot2c_f32_bf16 v77, v95, v95
    v_dot2c_f32_bf16 v74, s63, v96
    v_dot2c_f32_bf16 v76, v96, v96
    v_dot2c_f32_bf16 v75, s63, v97
    v_dot2c_f32_bf16 v77, v97, v97
    v_dot2c_f32_bf16 v74, s63, v98
    v_dot2c_f32_bf16 v76, v98, v98
    v_dot2c_f32_bf16 v75, s63, v99
    v_dot2c_f32_bf16 v77, v99, v99
    v_dot2c_f32_bf16 v74, s63, v100
    v_dot2c_f32_bf16 v76, v100, v100
    v_dot2c_f32_bf16 v75, s63, v101
    v_dot2c_f32_bf16 v77, v101, v101
    v_dot2c_f32_bf16 v74, s63, v102
    v_dot2c_f32_bf16 v76, v102, v102
    v_dot2c_f32_bf16 v75, s63, v103
    v_dot2c_f32_bf16 v77, v103, v103
    s_waitcnt vmcnt(5)
    v_dot2c_f32_bf16 v74, s63, v104
    v_dot2c_f32_bf16 v76, v104, v104
    v_dot2c_f32_bf16 v75, s63, v105
    v_dot2c_f32_bf16 v77, v105, v105
    v_dot2c_f32_bf16 v74, s63, v106
    v_dot2c_f32_bf16 v76, v106, v106
    v_dot2c_f32_bf16 v75, s63, v107
    v_dot2c_f32_bf16 v77, v107, v107
    s_waitcnt vmcnt(4)
    v_dot2c_f32_bf16 v74, s63, v108
    v_dot2c_f32_bf16 v76, v108, v108
    v_dot2c_f32_bf16 v75, s63, v109
    v_dot2c_f32_bf16 v77, v109, v109
    v_dot2c_f32_bf16 v74, s63, v110
    v_dot2c_f32_bf16 v76, v110, v110
    v_dot2c_f32_bf16 v75, s63, v111
    v_dot2c_f32_bf16 v77, v111, v111
    s_waitcnt vmcnt(3)
    v_dot2c_f32_bf16 v74, s63, v112
    v_dot2c_f32_bf16 v76, v112, v112
    v_dot2c_f32_bf16 v75, s63, v113
    v_dot2c_f32_bf16 v77, v113, v113
    v_dot2c_f32_bf16 v74, s63, v114
    v_dot2c_f32_bf16 v76, v114, v114
    v_dot2c_f32_bf16 v75, s63, v115
    v_dot2c_f32_bf16 v77, v115, v115
    s_nop 1
    v_add_f32 v74, v74, v75
    v_add_f32 v76, v76, v77
    s_nop 0
    v_add_f32_dpp v74, v74, v74 row_ror:8 row_mask:0xf bank_mask:0xf
    v_add_f32_dpp v76, v76, v76 row_ror:8 row_mask:0xf bank_mask:0xf
    v_mov_b32 v75, v74
    v_mov_b32 v77, v76
    s_nop 0
    v_permlane16_swap_b32 v75, v74
    v_permlane16_swap_b32 v77, v76
    v_add_f32 v74, v74, v75
    v_add_f32 v76, v76, v77
    v_mov_b32 v75, v74
    v_mov_b32 v77, v76
    s_nop 0
    v_permlane32_swap_b32 v75, v74
    v_permlane32_swap_b32 v77, v76
    v_add_f32 v74, v74, v75
    v_add_f32 v76, v76, v77
    v_mul_f32 v74, s64, v74
    v_mul_f32 v76, s64, v76
    v_cvt_pk_bf16_f32 v78, 0, -v74
    v_fma_f32 v76, -v74, v74, v76
    v_max_f32 v76, 0, v76
    v_cvt_pk_bf16_f32 v76, 0, v76
    v_add_f32 v76, 0x3727c5ac, v76
    v_cvt_pk_bf16_f32 v76, 0, v76
    v_sqrt_f32 v76, v76
    v_lshlrev_b32 v128, 16, v80
    v_and_b32 v129, s65, v80
    v_cvt_pk_bf16_f32 v76, 0, v76
    v_rcp_f32 v74, v76
    v_lshlrev_b32 v130, 16, v81
    v_and_b32 v131, s65, v81
    v_mul_f32 v74, 0x3eeff558, v74
    v_mul_f32 v78, v78, v74
    v_lshlrev_b32 v132, 16, v82
    v_and_b32 v133, s65, v82
    v_lshlrev_b32 v134, 16, v83
    v_and_b32 v135, s65, v83
    v_pk_fma_f32 v[128:129], v[128:129], v[74:75], v[78:79] op_sel_hi:[1,0,0]
    v_pk_fma_f32 v[130:131], v[130:131], v[74:75], v[78:79] op_sel_hi:[1,0,0]
    v_pk_fma_f32 v[132:133], v[132:133], v[74:75], v[78:79] op_sel_hi:[1,0,0]
    v_pk_fma_f32 v[134:135], v[134:135], v[74:75], v[78:79] op_sel_hi:[1,0,0]
    v_cvt_pk_bf16_f32 v80, v128, v129
    v_cvt_pk_bf16_f32 v81, v130, v131
    v_cvt_pk_bf16_f32 v82, v132, v133
    v_cvt_pk_bf16_f32 v83, v134, v135
    buffer_store_dwordx4 v[80:83], v73, s[8:11], s60 offen sc1
    s_add_u32 s60, s60, 8192
    v_lshlrev_b32 v128, 16, v84
    v_and_b32 v129, s65, v84
    v_lshlrev_b32 v130, 16, v85
    v_and_b32 v131, s65, v85
    v_lshlrev_b32 v132, 16, v86
    v_and_b32 v133, s65, v86
    v_lshlrev_b32 v134, 16, v87
    v_and_b32 v135, s65, v87
    v_pk_fma_f32 v[128:129], v[128:129], v[74:75], v[78:79] op_sel_hi:[1,0,0]
    v_pk_fma_f32 v[130:131], v[130:131], v[74:75], v[78:79] op_sel_hi:[1,0,0]
    v_pk_fma_f32 v[132:133], v[132:133], v[74:75], v[78:79] op_sel_hi:[1,0,0]
    v_pk_fma_f32 v[134:135], v[134:135], v[74:75], v[78:79] op_sel_hi:[1,0,0]
    v_cvt_pk_bf16_f32 v84, v128, v129
    v_cvt_pk_bf16_f32 v85, v130, v131
    v_cvt_pk_bf16_f32 v86, v132, v133
    v_cvt_pk_bf16_f32 v87, v134, v135
    buffer_store_dwordx4 v[84:87], v73, s[8:11], s60 offen sc1
    s_add_u32 s60, s60, 8192
    v_lshlrev_b32 v128, 16, v88
    v_and_b32 v129, s65, v88
    v_lshlrev_b32 v130, 16, v89
    v_and_b32 v131, s65, v89
    v_lshlrev_b32 v132, 16, v90
    v_and_b32 v133, s65, v90
    v_lshlrev_b32 v134, 16, v91
    v_and_b32 v135, s65, v91
    v_pk_fma_f32 v[128:129], v[128:129], v[74:75], v[78:79] op_sel_hi:[1,0,0]
    v_pk_fma_f32 v[130:131], v[130:131], v[74:75], v[78:79] op_sel_hi:[1,0,0]
    v_pk_fma_f32 v[132:133], v[132:133], v[74:75], v[78:79] op_sel_hi:[1,0,0]
    v_pk_fma_f32 v[134:135], v[134:135], v[74:75], v[78:79] op_sel_hi:[1,0,0]
    v_cvt_pk_bf16_f32 v88, v128, v129
    v_cvt_pk_bf16_f32 v89, v130, v131
    v_cvt_pk_bf16_f32 v90, v132, v133
    v_cvt_pk_bf16_f32 v91, v134, v135
    buffer_store_dwordx4 v[88:91], v73, s[8:11], s60 offen sc1
    s_add_u32 s60, s60, 8192
    v_lshlrev_b32 v128, 16, v92
    v_and_b32 v129, s65, v92
    v_lshlrev_b32 v130, 16, v93
    v_and_b32 v131, s65, v93
    v_lshlrev_b32 v132, 16, v94
    v_and_b32 v133, s65, v94
    v_lshlrev_b32 v134, 16, v95
    v_and_b32 v135, s65, v95
    v_pk_fma_f32 v[128:129], v[128:129], v[74:75], v[78:79] op_sel_hi:[1,0,0]
    v_pk_fma_f32 v[130:131], v[130:131], v[74:75], v[78:79] op_sel_hi:[1,0,0]
    v_pk_fma_f32 v[132:133], v[132:133], v[74:75], v[78:79] op_sel_hi:[1,0,0]
    v_pk_fma_f32 v[134:135], v[134:135], v[74:75], v[78:79] op_sel_hi:[1,0,0]
    v_cvt_pk_bf16_f32 v92, v128, v129
    v_cvt_pk_bf16_f32 v93, v130, v131
    v_cvt_pk_bf16_f32 v94, v132, v133
    v_cvt_pk_bf16_f32 v95, v134, v135
    buffer_store_dwordx4 v[92:95], v73, s[8:11], s60 offen sc1
    s_add_u32 s60, s60, 8192
    v_lshlrev_b32 v128, 16, v96
    v_and_b32 v129, s65, v96
    v_lshlrev_b32 v130, 16, v97
    v_and_b32 v131, s65, v97
    v_lshlrev_b32 v132, 16, v98
    v_and_b32 v133, s65, v98
    v_lshlrev_b32 v134, 16, v99
    v_and_b32 v135, s65, v99
    v_pk_fma_f32 v[128:129], v[128:129], v[74:75], v[78:79] op_sel_hi:[1,0,0]
    v_pk_fma_f32 v[130:131], v[130:131], v[74:75], v[78:79] op_sel_hi:[1,0,0]
    v_pk_fma_f32 v[132:133], v[132:133], v[74:75], v[78:79] op_sel_hi:[1,0,0]
    v_pk_fma_f32 v[134:135], v[134:135], v[74:75], v[78:79] op_sel_hi:[1,0,0]
    v_cvt_pk_bf16_f32 v96, v128, v129
    v_cvt_pk_bf16_f32 v97, v130, v131
    v_cvt_pk_bf16_f32 v98, v132, v133
    v_cvt_pk_bf16_f32 v99, v134, v135
    buffer_store_dwordx4 v[96:99], v73, s[8:11], s60 offen sc1
    s_add_u32 s60, s60, 8192
    v_lshlrev_b32 v128, 16, v100
    v_and_b32 v129, s65, v100
    v_lshlrev_b32 v130, 16, v101
    v_and_b32 v131, s65, v101
    v_lshlrev_b32 v132, 16, v102
    v_and_b32 v133, s65, v102
    v_lshlrev_b32 v134, 16, v103
    v_and_b32 v135, s65, v103
    v_pk_fma_f32 v[128:129], v[128:129], v[74:75], v[78:79] op_sel_hi:[1,0,0]
    v_pk_fma_f32 v[130:131], v[130:131], v[74:75], v[78:79] op_sel_hi:[1,0,0]
    v_pk_fma_f32 v[132:133], v[132:133], v[74:75], v[78:79] op_sel_hi:[1,0,0]
    v_pk_fma_f32 v[134:135], v[134:135], v[74:75], v[78:79] op_sel_hi:[1,0,0]
    v_cvt_pk_bf16_f32 v100, v128, v129
    v_cvt_pk_bf16_f32 v101, v130, v131
    v_cvt_pk_bf16_f32 v102, v132, v133
    v_cvt_pk_bf16_f32 v103, v134, v135
    buffer_store_dwordx4 v[100:103], v73, s[8:11], s60 offen sc1
    s_add_u32 s60, s60, 8192
    v_lshlrev_b32 v128, 16, v104
    v_and_b32 v129, s65, v104
    v_lshlrev_b32 v130, 16, v105
    v_and_b32 v131, s65, v105
    v_lshlrev_b32 v132, 16, v106
    v_and_b32 v133, s65, v106
    v_lshlrev_b32 v134, 16, v107
    v_and_b32 v135, s65, v107
    v_pk_fma_f32 v[128:129], v[128:129], v[74:75], v[78:79] op_sel_hi:[1,0,0]
    v_pk_fma_f32 v[130:131], v[130:131], v[74:75], v[78:79] op_sel_hi:[1,0,0]
    v_pk_fma_f32 v[132:133], v[132:133], v[74:75], v[78:79] op_sel_hi:[1,0,0]
    v_pk_fma_f32 v[134:135], v[134:135], v[74:75], v[78:79] op_sel_hi:[1,0,0]
    v_cvt_pk_bf16_f32 v104, v128, v129
    v_cvt_pk_bf16_f32 v105, v130, v131
    v_cvt_pk_bf16_f32 v106, v132, v133
    v_cvt_pk_bf16_f32 v107, v134, v135
    buffer_store_dwordx4 v[104:107], v73, s[8:11], s60 offen sc1
    s_add_u32 s60, s60, 8192
    v_lshlrev_b32 v128, 16, v108
    v_and_b32 v129, s65, v108
    v_lshlrev_b32 v130, 16, v109
    v_and_b32 v131, s65, v109
    v_lshlrev_b32 v132, 16, v110
    v_and_b32 v133, s65, v110
    v_lshlrev_b32 v134, 16, v111
    v_and_b32 v135, s65, v111
    v_pk_fma_f32 v[128:129], v[128:129], v[74:75], v[78:79] op_sel_hi:[1,0,0]
    v_pk_fma_f32 v[130:131], v[130:131], v[74:75], v[78:79] op_sel_hi:[1,0,0]
    v_pk_fma_f32 v[132:133], v[132:133], v[74:75], v[78:79] op_sel_hi:[1,0,0]
    v_pk_fma_f32 v[134:135], v[134:135], v[74:75], v[78:79] op_sel_hi:[1,0,0]
    v_cvt_pk_bf16_f32 v108, v128, v129
    v_cvt_pk_bf16_f32 v109, v130, v131
    v_cvt_pk_bf16_f32 v110, v132, v133
    v_cvt_pk_bf16_f32 v111, v134, v135
    buffer_store_dwordx4 v[108:111], v73, s[8:11], s60 offen sc1
    s_add_u32 s60, s60, 8192
    v_lshlrev_b32 v128, 16, v112
    v_and_b32 v129, s65, v112
    v_lshlrev_b32 v130, 16, v113
    v_and_b32 v131, s65, v113
    v_lshlrev_b32 v132, 16, v114
    v_and_b32 v133, s65, v114
    v_lshlrev_b32 v134, 16, v115
    v_and_b32 v135, s65, v115
    v_pk_fma_f32 v[128:129], v[128:129], v[74:75], v[78:79] op_sel_hi:[1,0,0]
    v_pk_fma_f32 v[130:131], v[130:131], v[74:75], v[78:79] op_sel_hi:[1,0,0]
    v_pk_fma_f32 v[132:133], v[132:133], v[74:75], v[78:79] op_sel_hi:[1,0,0]
    v_pk_fma_f32 v[134:135], v[134:135], v[74:75], v[78:79] op_sel_hi:[1,0,0]
    v_cvt_pk_bf16_f32 v112, v128, v129
    v_cvt_pk_bf16_f32 v113, v130, v131
    v_cvt_pk_bf16_f32 v114, v132, v133
    v_cvt_pk_bf16_f32 v115, v134, v135
    buffer_store_dwordx4 v[112:115], v73, s[8:11], s60 offen sc1
    s_waitcnt lgkmcnt(0)
    s_mul_i32 s30, s30, 1664525
    s_add_u32 s30, s30, 1013904223
    v_mov_b32 v15, s30
    ds_write_b32 v14, v15
    s_mov_b32 s80, 0
Lsvc1:
    s_and_b32 s83, s83, 7
    s_mul_i32 s81, s83, 294912
    s_lshl_b32 s82, s83, 13
    s_add_u32 m0, s82, 0
    s_add_u32 s83, s83, 1
    buffer_load_dwordx4 v116, s[12:15], s81 offen  lds
    buffer_load_dwordx4 v116, s[16:19], s81 offen offset:1024  lds
    s_add_u32 m0, s82, 2048
    s_add_u32 s80, s80, 1
    buffer_load_dwordx4 v117, s[12:15], s81 offen  lds
    buffer_load_dwordx4 v117, s[16:19], s81 offen offset:1024  lds
    s_add_u32 m0, s82, 4096
    s_nop 0
    buffer_load_dwordx4 v118, s[12:15], s81 offen  lds
    buffer_load_dwordx4 v118, s[16:19], s81 offen offset:1024  lds
    s_add_u32 m0, s82, 6144
    s_nop 0
    buffer_load_dwordx4 v119, s[12:15], s81 offen  lds
    buffer_load_dwordx4 v119, s[16:19], s81 offen offset:1024  lds
    s_cmp_lt_u32 s80, 2
    s_cbranch_scc1 Lsvc1
    s_mov_b64 exec, 0
    s_branch Lpad0
Lwd2_0:
    s_cmp_ge_u32 s2, 192
    s_cbranch_scc1 Lpad13
    s_branch Lpad7
Lwret2:
    s_mov_b64 exec, -1
    s_waitcnt vmcnt(16)
    buffer_store_dword v15, v120, s[8:11], 0 offen sc1
    s_mov_b64 exec, 0
    s_branch Lwd6_0
Lwd6_0:
    s_cmp_ge_u32 s2, 192
    s_cbranch_scc1 Lpad14
    s_branch Lpad8
Lwret6:
    s_mov_b64 exec, -1
    s_mov_b32 s80, 0
Lsvc2:
    s_and_b32 s83, s83, 7
    s_mul_i32 s81, s83, 294912
    s_lshl_b32 s82, s83, 13
    s_add_u32 m0, s82, 0
    s_add_u32 s83, s83, 1
    buffer_load_dwordx4 v116, s[12:15], s81 offen  lds
    buffer_load_dwordx4 v116, s[16:19], s81 offen offset:1024  lds
    s_add_u32 m0, s82, 2048
    s_add_u32 s80, s80, 1
    buffer_load_dwordx4 v117, s[12:15], s81 offen  lds
    buffer_load_dwordx4 v117, s[16:19], s81 offen offset:1024  lds
    s_add_u32 m0, s82, 4096
    s_nop 0
    buffer_load_dwordx4 v118, s[12:15], s81 offen  lds
    buffer_load_dwordx4 v118, s[16:19], s81 offen offset:1024  lds
    s_add_u32 m0, s82, 6144
    s_nop 0
    buffer_load_dwordx4 v119, s[12:15], s81 offen  lds
    buffer_load_dwordx4 v119, s[16:19], s81 offen offset:1024  lds
    s_waitcnt vmcnt(14)
    s_cmp_lt_u32 s80, 5
    s_cbranch_scc1 Lsvc2
    s_mov_b64 exec, 0
    s_branch Lwd4_0
Lwd4_0:
    s_cmp_ge_u32 s2, 192
    s_cbranch_scc1 Lpad16
    s_branch Lpad10
Lwret4:
    s_mov_b64 exec, -1
    s_mov_b32 s83, 8
    s_mov_b32 s80, 0
Lsvc3:
    s_and_b32 s83, s83, 15
    s_mul_i32 s81, s83, 294912
    s_lshl_b32 s82, s83, 13
    s_add_u32 m0, s82, 0
    s_add_u32 s83, s83, 1
    buffer_load_dwordx4 v116, s[12:15], s81 offen  lds
    buffer_load_dwordx4 v116, s[16:19], s81 offen offset:1024  lds
    s_add_u32 m0, s82, 2048
    s_add_u32 s80, s80, 1
    buffer_load_dwordx4 v117, s[12:15], s81 offen  lds
    buffer_load_dwordx4 v117, s[16:19], s81 offen offset:1024  lds
    s_add_u32 m0, s82, 4096
    s_nop 0
    buffer_load_dwordx4 v118, s[12:15], s81 offen  lds
    buffer_load_dwordx4 v118, s[16:19], s81 offen offset:1024  lds
    s_add_u32 m0, s82, 6144
    s_nop 0
    buffer_load_dwordx4 v119, s[12:15], s81 offen  lds
    buffer_load_dwordx4 v119, s[16:19], s81 offen offset:1024  lds
    s_waitcnt vmcnt(14)
    s_cmp_lt_u32 s80, 4
    s_cbranch_scc1 Lsvc3
    s_sub_u32 s80, s31, 384
    buffer_load_dword v12, v13, s[8:11], s80 offen offset:0 sc1
    s_mov_b64 exec, 0
    s_branch Lwd5_0
Lwd5_0:
    s_cmp_ge_u32 s2, 192
    s_cbranch_scc1 Lwret5
    s_branch Lpad11
Lwret5:
    s_mov_b64 exec, -1
    s_waitcnt vmcnt(0)
    v_cmp_ne_u32 vcc, v12, v15
    s_cbranch_vccnz Lspin1
Lback1:
    s_waitcnt lgkmcnt(0)
    s_branch Lmid
Lkg:
    s_mov_b64 exec, 0
    s_cmp_eq_u32 s3, 0
    s_cbranch_scc1 Lpad1
    s_cmp_eq_u32 s3, 1
    s_cbranch_scc1 Lpad2
    s_branch Lpad3
Lwd1_2:
    s_cmp_ge_u32 s2, 192
    s_cbranch_scc1 Lpad12
    s_branch Lpad6
Lwret1:
    s_mov_b64 exec, -1
    s_branch Lmain
    .p2alignl 12, 0xbf810000
Lmain:
    s_cmp_ge_u32 s2, 192
    s_cbranch_scc1 Lnok
    s_mul_i32 s63, s3, 8704
    s_add_u32 s63, s63, 131072
    v_lshl_add_u32 v68, v64, 3, s63
    v_and_b32 v66, 15, v64
    v_lshrrev_b32 v67, 4, v64
    v_lshl_add_u32 v76, v67, 4, s63
    v_mov_b32 v77, 544
    v_mad_u32_u24 v69, v66, v77, v76
    v_lshrrev_b32 v78, 2, v66
    v_and_b32 v79, 3, v66
    v_subrev_u32 v70, 1, v79
    v_max_i32 v70, 0, v70
    v_lshl_add_u32 v70, v78, 1, v70
    v_mad_u32_u24 v70, v70, v77, v76
    v_min_u32 v79, 2, v79
    v_and_b32 v71, 1, v78
    v_mad_u32_u24 v71, v71, 5, v79
    v_and_b32 v73, 2, v78
    v_add_u32 v71, v71, v73
    v_mad_u32_u24 v71, v71, v77, v76
    v_mad_u32_u24 v72, v78, 3, v79
    v_mad_u32_u24 v72, v72, v77, v76
    s_mov_b32 s64, 0x3fb8aa3b
    s_mov_b32 s65, 0x32a57060
    s_mov_b32 s66, 0x3f317218
    s_waitcnt vmcnt(0)
    buffer_load_dwordx4 v2, s[12:15], s81 offen  lds
    buffer_load_dwordx4 v2, s[16:19], s81 offen offset:1024  lds
    global_load_dword v63, v62, s[20:21]
    s_waitcnt lgkmcnt(0)
    v_lshlrev_b32 v86, 16, v120
    v_and_b32 v87, 0xffff0000, v120
    v_lshlrev_b32 v88, 16, v124
    v_cmp_eq_u32 vcc, 0, v64
    v_lshlrev_b32 v127, 16, v127
    v_mul_f32 v90, s64, v86
    v_mul_f32 v91, s64, v87
    v_mul_f32 v92, s64, v88
    v_cndmask_b32 v66, 0, v127, vcc
    v_fma_f32 v94, v86, s64, -v90
    v_fma_f32 v95, v87, s64, -v91
    v_fma_f32 v96, v88, s64, -v92
    v_exp_f32 v90, v90
    v_exp_f32 v91, v91
    v_exp_f32 v92, v92
    v_fmac_f32 v94, s65, v86
    v_fmac_f32 v95, s65, v87
    v_fmac_f32 v96, s65, v88
    v_mul_f32 v94, s66, v94
    v_mul_f32 v95, s66, v95
    v_mul_f32 v96, s66, v96
    v_fmac_f32 v90, v90, v94
    v_fmac_f32 v91, v91, v95
    v_fmac_f32 v92, v92, v96
    v_cvt_pk_bf16_f32 v90, v90, v91
    v_cvt_pk_bf16_f32 v92, v92, v92
    v_and_b32 v88, 0xffff0000, v92
    v_lshlrev_b32 v86, 16, v90
    v_and_b32 v87, 0xffff0000, v90
    v_lshlrev_b32 v90, 16, v121
    v_and_b32 v91, 0xffff0000, v121
    v_pk_mul_f32 v[86:87], v[86:87], v[88:89] op_sel_hi:[1,0]
    v_pk_mul_f32 v[90:91], v[90:91], v[88:89] op_sel_hi:[1,0]
    v_mul_f32 v86, 0xbfb8aa3b, v86
    v_mul_f32 v87, 0xbfb8aa3b, v87
    v_mul_f32 v90, 0.15915494, v90
    v_mul_f32 v91, 0.15915494, v91
    v_mul_f32 v88, 0x419b6ceb, v88
    v_lshlrev_b32 v92, 16, v122
    v_and_b32 v93, 0xffff0000, v122
    v_lshlrev_b32 v94, 16, v123
    v_and_b32 v95, 0xffff0000, v123
    v_pk_mul_f32 v[92:93], v[92:93], v[88:89] op_sel_hi:[1,0]
    v_pk_mul_f32 v[94:95], v[94:95], v[88:89] op_sel_hi:[1,0]
    v_mul_f32 v76, 0x41800000, v86
    v_mul_f32 v77, 0x41800000, v87
    v_mul_f32 v78, 0x41800000, v90
    v_mul_f32 v79, 0x41800000, v91
    v_exp_f32 v76, v76
    v_exp_f32 v77, v77
    v_fract_f32 v78, v78
    v_fract_f32 v79, v79
    v_cos_f32 v100, v78
    v_cos_f32 v101, v79
    v_sin_f32 v102, v78
    v_sin_f32 v103, v79
    v_pk_mul_f32 v[100:101], v[100:101], v[76:77]
    v_pk_mul_f32 v[102:103], v[102:103], v[76:77]
    v_exp_f32 v76, v86
    v_exp_f32 v77, v87
    v_fract_f32 v78, v90
    v_fract_f32 v79, v91
    v_cos_f32 v96, v78
    v_cos_f32 v97, v79
    v_sin_f32 v98, v78
    v_sin_f32 v99, v79
    v_pk_mul_f32 v[96:97], v[96:97], v[76:77]
    v_pk_mul_f32 v[98:99], v[98:99], v[76:77]
    v_mul_f32 v76, 0x43800000, v86
    v_mul_f32 v77, 0x43800000, v87
    v_mul_f32 v78, 0x43800000, v90
    v_mul_f32 v79, 0x43800000, v91
    v_exp_f32 v76, v76
    v_exp_f32 v77, v77
    v_fract_f32 v78, v78
    v_fract_f32 v79, v79
    v_cos_f32 v104, v78
    v_cos_f32 v105, v79
    v_sin_f32 v106, v78
    v_sin_f32 v107, v79
    v_pk_mul_f32 v[104:105], v[104:105], v[76:77]
    v_pk_mul_f32 v[106:107], v[106:107], v[76:77]
    v_cvt_pk_bf16_f32 v80, v92, v93
    v_cvt_pk_bf16_f32 v81, -v94, -v95
    ds_write_b64 v68, v[80:81] offset:0
    v_pk_mul_f32 v[112:113], v[92:93], v[100:101]
    v_pk_mul_f32 v[114:115], v[92:93], v[102:103]
    v_pk_fma_f32 v[112:113], v[94:95], v[102:103], v[112:113] neg_lo:[1,0,0] neg_hi:[1,0,0]
    v_pk_fma_f32 v[114:115], v[94:95], v[100:101], v[114:115]
    v_cvt_pk_bf16_f32 v82, v112, v113
    v_cvt_pk_bf16_f32 v83, -v114, -v115
    ds_write_b64 v68, v[82:83] offset:544
    v_pk_mul_f32 v[108:109], v[112:113], v[100:101]
    v_pk_mul_f32 v[110:111], v[112:113], v[102:103]
    v_pk_fma_f32 v[108:109], v[114:115], v[102:103], v[108:109] neg_lo:[1,0,0] neg_hi:[1,0,0]
    v_pk_fma_f32 v[110:111], v[114:115], v[100:101], v[110:111]
    v_cvt_pk_bf16_f32 v84, v108, v109
    v_cvt_pk_bf16_f32 v85, -v110, -v111
    ds_write_b64 v68, v[84:85] offset:1088
    v_pk_mul_f32 v[112:113], v[108:109], v[100:101]
    v_pk_mul_f32 v[114:115], v[108:109], v[102:103]
    v_pk_fma_f32 v[112:113], v[110:111], v[102:103], v[112:113] neg_lo:[1,0,0] neg_hi:[1,0,0]
    v_pk_fma_f32 v[114:115], v[110:111], v[100:101], v[114:115]
    v_cvt_pk_bf16_f32 v80, v112, v113
    v_cvt_pk_bf16_f32 v81, -v114, -v115
    ds_write_b64 v68, v[80:81] offset:1632
    v_pk_mul_f32 v[108:109], v[112:113], v[100:101]
    v_pk_mul_f32 v[110:111], v[112:113], v[102:103]
    v_pk_fma_f32 v[108:109], v[114:115], v[102:103], v[108:109] neg_lo:[1,0,0] neg_hi:[1,0,0]
    v_pk_fma_f32 v[110:111], v[114:115], v[100:101], v[110:111]
    v_cvt_pk_bf16_f32 v82, v108, v109
    v_cvt_pk_bf16_f32 v83, -v110, -v111
    ds_write_b64 v68, v[82:83] offset:2176
    v_pk_mul_f32 v[112:113], v[108:109], v[100:101]
    v_pk_mul_f32 v[114:115], v[108:109], v[102:103]
    v_pk_fma_f32 v[112:113], v[110:111], v[102:103], v[112:113] neg_lo:[1,0,0] neg_hi:[1,0,0]
    v_pk_fma_f32 v[114:115], v[110:111], v[100:101], v[114:115]
    v_cvt_pk_bf16_f32 v84, v112, v113
    v_cvt_pk_bf16_f32 v85, -v114, -v115
    ds_write_b64 v68, v[84:85] offset:2720
    v_pk_mul_f32 v[108:109], v[112:113], v[100:101]
    v_pk_mul_f32 v[110:111], v[112:113], v[102:103]
    v_pk_fma_f32 v[108:109], v[114:115], v[102:103], v[108:109] neg_lo:[1,0,0] neg_hi:[1,0,0]
    v_pk_fma_f32 v[110:111], v[114:115], v[100:101], v[110:111]
    v_cvt_pk_bf16_f32 v80, v108, v109
    v_cvt_pk_bf16_f32 v81, -v110, -v111
    ds_write_b64 v68, v[80:81] offset:3264
    v_pk_mul_f32 v[112:113], v[108:109], v[100:101]
    v_pk_mul_f32 v[114:115], v[108:109], v[102:103]
    v_pk_fma_f32 v[112:113], v[110:111], v[102:103], v[112:113] neg_lo:[1,0,0] neg_hi:[1,0,0]
    v_pk_fma_f32 v[114:115], v[110:111], v[100:101], v[114:115]
    v_cvt_pk_bf16_f32 v82, v112, v113
    v_cvt_pk_bf16_f32 v83, -v114, -v115
    ds_write_b64 v68, v[82:83] offset:3808
    v_pk_mul_f32 v[108:109], v[112:113], v[100:101]
    v_pk_mul_f32 v[110:111], v[112:113], v[102:103]
    v_pk_fma_f32 v[108:109], v[114:115], v[102:103], v[108:109] neg_lo:[1,0,0] neg_hi:[1,0,0]
    v_pk_fma_f32 v[110:111], v[114:115], v[100:101], v[110:111]
    v_cvt_pk_bf16_f32 v84, v108, v109
    v_cvt_pk_bf16_f32 v85, -v110, -v111
    ds_write_b64 v68, v[84:85] offset:4352
    v_pk_mul_f32 v[112:113], v[108:109], v[100:101]
    v_pk_mul_f32 v[114:115], v[108:109], v[102:103]
    v_pk_fma_f32 v[112:113], v[110:111], v[102:103], v[112:113] neg_lo:[1,0,0] neg_hi:[1,0,0]
    v_pk_fma_f32 v[114:115], v[110:111], v[100:101], v[114:115]
    v_cvt_pk_bf16_f32 v80, v112, v113
    v_cvt_pk_bf16_f32 v81, -v114, -v115
    ds_write_b64 v68, v[80:81] offset:4896
    v_pk_mul_f32 v[108:109], v[112:113], v[100:101]
    v_pk_mul_f32 v[110:111], v[112:113], v[102:103]
    v_pk_fma_f32 v[108:109], v[114:115], v[102:103], v[108:109] neg_lo:[1,0,0] neg_hi:[1,0,0]
    v_pk_fma_f32 v[110:111], v[114:115], v[100:101], v[110:111]
    v_cvt_pk_bf16_f32 v82, v108, v109
    v_cvt_pk_bf16_f32 v83, -v110, -v111
    ds_write_b64 v68, v[82:83] offset:5440
    v_pk_mul_f32 v[112:113], v[108:109], v[100:101]
    v_pk_mul_f32 v[114:115], v[108:109], v[102:103]
    v_pk_fma_f32 v[112:113], v[110:111], v[102:103], v[112:113] neg_lo:[1,0,0] neg_hi:[1,0,0]
    v_pk_fma_f32 v[114:115], v[110:111], v[100:101], v[114:115]
    v_cvt_pk_bf16_f32 v84, v112, v113
    v_cvt_pk_bf16_f32 v85, -v114, -v115
    ds_write_b64 v68, v[84:85] offset:5984
    v_pk_mul_f32 v[108:109], v[112:113], v[100:101]
    v_pk_mul_f32 v[110:111], v[112:113], v[102:103]
    v_pk_fma_f32 v[108:109], v[114:115], v[102:103], v[108:109] neg_lo:[1,0,0] neg_hi:[1,0,0]
    v_pk_fma_f32 v[110:111], v[114:115], v[100:101], v[110:111]
    v_cvt_pk_bf16_f32 v80, v108, v109
    v_cvt_pk_bf16_f32 v81, -v110, -v111
    ds_write_b64 v68, v[80:81] offset:6528
    v_pk_mul_f32 v[112:113], v[108:109], v[100:101]
    v_pk_mul_f32 v[114:115], v[108:109], v[102:103]
    v_pk_fma_f32 v[112:113], v[110:111], v[102:103], v[112:113] neg_lo:[1,0,0] neg_hi:[1,0,0]
    v_pk_fma_f32 v[114:115], v[110:111], v[100:101], v[114:115]
    v_cvt_pk_bf16_f32 v82, v112, v113
    v_cvt_pk_bf16_f32 v83, -v114, -v115
    ds_write_b64 v68, v[82:83] offset:7072
    v_pk_mul_f32 v[108:109], v[112:113], v[100:101]
    v_pk_mul_f32 v[110:111], v[112:113], v[102:103]
    v_pk_fma_f32 v[108:109], v[114:115], v[102:103], v[108:109] neg_lo:[1,0,0] neg_hi:[1,0,0]
    v_pk_fma_f32 v[110:111], v[114:115], v[100:101], v[110:111]
    v_cvt_pk_bf16_f32 v84, v108, v109
    v_cvt_pk_bf16_f32 v85, -v110, -v111
    ds_write_b64 v68, v[84:85] offset:7616
    v_pk_mul_f32 v[112:113], v[108:109], v[100:101]
    v_pk_mul_f32 v[114:115], v[108:109], v[102:103]
    v_pk_fma_f32 v[112:113], v[110:111], v[102:103], v[112:113] neg_lo:[1,0,0] neg_hi:[1,0,0]
    v_pk_fma_f32 v[114:115], v[110:111], v[100:101], v[114:115]
    v_cvt_pk_bf16_f32 v80, v112, v113
    v_cvt_pk_bf16_f32 v81, -v114, -v115
    ds_write_b64 v68, v[80:81] offset:8160
    ds_read_b128 v[128:131], v69 offset:0
    ds_read_b128 v[132:135], v69 offset:64
    ds_read_b128 v[136:139], v69 offset:128
    ds_read_b128 v[140:143], v69 offset:192
    ds_read_b128 v[144:147], v69 offset:256
    ds_read_b128 v[148:151], v69 offset:320
    ds_read_b128 v[152:155], v69 offset:384
    ds_read_b128 v[156:159], v69 offset:448
    v_mov_b32 v86, 0x3f803f80
    v_mov_b32 v87, 0
    ds_write_b64 v68, v[86:87]
    v_cvt_pk_bf16_f32 v82, v96, v97
    v_cvt_pk_bf16_f32 v83, v98, v99
    ds_write_b64 v68, v[82:83] offset:544
    v_pk_mul_f32 v[116:117], v[96:97], v[96:97]
    v_pk_mul_f32 v[118:119], v[96:97], v[98:99]
    v_pk_fma_f32 v[116:117], v[98:99], v[98:99], v[116:117] neg_lo:[1,0,0] neg_hi:[1,0,0]
    v_pk_fma_f32 v[118:119], v[98:99], v[96:97], v[118:119]
    v_cvt_pk_bf16_f32 v84, v116, v117
    v_cvt_pk_bf16_f32 v85, v118, v119
    ds_write_b64 v68, v[84:85] offset:1088
    v_pk_mul_f32 v[112:113], v[116:117], v[96:97]
    v_pk_mul_f32 v[114:115], v[116:117], v[98:99]
    v_pk_fma_f32 v[112:113], v[118:119], v[98:99], v[112:113] neg_lo:[1,0,0] neg_hi:[1,0,0]
    v_pk_fma_f32 v[114:115], v[118:119], v[96:97], v[114:115]
    v_cvt_pk_bf16_f32 v80, v112, v113
    v_cvt_pk_bf16_f32 v81, v114, v115
    ds_write_b64 v68, v[80:81] offset:1632
    v_pk_mul_f32 v[120:121], v[112:113], v[96:97]
    v_pk_mul_f32 v[122:123], v[112:113], v[98:99]
    v_pk_fma_f32 v[120:121], v[114:115], v[98:99], v[120:121] neg_lo:[1,0,0] neg_hi:[1,0,0]
    v_pk_fma_f32 v[122:123], v[114:115], v[96:97], v[122:123]
    v_cvt_pk_bf16_f32 v82, v120, v121
    v_cvt_pk_bf16_f32 v83, v122, v123
    ds_write_b64 v68, v[82:83] offset:2176
    v_pk_mul_f32 v[112:113], v[120:121], v[96:97]
    v_pk_mul_f32 v[114:115], v[120:121], v[98:99]
    v_pk_fma_f32 v[112:113], v[122:123], v[98:99], v[112:113] neg_lo:[1,0,0] neg_hi:[1,0,0]
    v_pk_fma_f32 v[114:115], v[122:123], v[96:97], v[114:115]
    v_cvt_pk_bf16_f32 v84, v112, v113
    v_cvt_pk_bf16_f32 v85, v114, v115
    ds_write_b64 v68, v[84:85] offset:2720
    v_pk_mul_f32 v[108:109], v[112:113], v[96:97]
    v_pk_mul_f32 v[110:111], v[112:113], v[98:99]
    v_pk_fma_f32 v[108:109], v[114:115], v[98:99], v[108:109] neg_lo:[1,0,0] neg_hi:[1,0,0]
    v_pk_fma_f32 v[110:111], v[114:115], v[96:97], v[110:111]
    v_cvt_pk_bf16_f32 v80, v108, v109
    v_cvt_pk_bf16_f32 v81, v110, v111
    ds_write_b64 v68, v[80:81] offset:3264
    v_pk_mul_f32 v[112:113], v[108:109], v[96:97]
    v_pk_mul_f32 v[114:115], v[108:109], v[98:99]
    v_pk_fma_f32 v[112:113], v[110:111], v[98:99], v[112:113] neg_lo:[1,0,0] neg_hi:[1,0,0]
    v_pk_fma_f32 v[114:115], v[110:111], v[96:97], v[114:115]
    v_cvt_pk_bf16_f32 v82, v112, v113
    v_cvt_pk_bf16_f32 v83, v114, v115
    ds_write_b64 v68, v[82:83] offset:3808
    v_pk_mul_f32 v[124:125], v[112:113], v[96:97]
    v_pk_mul_f32 v[126:127], v[112:113], v[98:99]
    v_pk_fma_f32 v[124:125], v[114:115], v[98:99], v[124:125] neg_lo:[1,0,0] neg_hi:[1,0,0]
    v_pk_fma_f32 v[126:127], v[114:115], v[96:97], v[126:127]
    v_cvt_pk_bf16_f32 v84, v124, v125
    v_cvt_pk_bf16_f32 v85, v126, v127
    ds_write_b64 v68, v[84:85] offset:4352
    v_pk_mul_f32 v[112:113], v[124:125], v[96:97]
    v_pk_mul_f32 v[114:115], v[124:125], v[98:99]
    v_pk_fma_f32 v[112:113], v[126:127], v[98:99], v[112:113] neg_lo:[1,0,0] neg_hi:[1,0,0]
    v_pk_fma_f32 v[114:115], v[126:127], v[96:97], v[114:115]
    v_cvt_pk_bf16_f32 v80, v112, v113
    v_cvt_pk_bf16_f32 v81, v114, v115
    ds_write_b64 v68, v[80:81] offset:4896
    v_pk_mul_f32 v[108:109], v[112:113], v[96:97]
    v_pk_mul_f32 v[110:111], v[112:113], v[98:99]
    v_pk_fma_f32 v[108:109], v[114:115], v[98:99], v[108:109] neg_lo:[1,0,0] neg_hi:[1,0,0]
    v_pk_fma_f32 v[110:111], v[114:115], v[96:97], v[110:111]
    v_cvt_pk_bf16_f32 v82, v108, v109
    v_cvt_pk_bf16_f32 v83, v110, v111
    ds_write_b64 v68, v[82:83] offset:5440
    v_pk_mul_f32 v[112:113], v[108:109], v[96:97]
    v_pk_mul_f32 v[114:115], v[108:109], v[98:99]
    v_pk_fma_f32 v[112:113], v[110:111], v[98:99], v[112:113] neg_lo:[1,0,0] neg_hi:[1,0,0]
    v_pk_fma_f32 v[114:115], v[110:111], v[96:97], v[114:115]
    v_cvt_pk_bf16_f32 v84, v112, v113
    v_cvt_pk_bf16_f32 v85, v114, v115
    ds_write_b64 v68, v[84:85] offset:5984
    v_pk_mul_f32 v[108:109], v[112:113], v[96:97]
    v_pk_mul_f32 v[110:111], v[112:113], v[98:99]
    v_pk_fma_f32 v[108:109], v[114:115], v[98:99], v[108:109] neg_lo:[1,0,0] neg_hi:[1,0,0]
    v_pk_fma_f32 v[110:111], v[114:115], v[96:97], v[110:111]
    v_cvt_pk_bf16_f32 v80, v108, v109
    v_cvt_pk_bf16_f32 v81, v110, v111
    ds_write_b64 v68, v[80:81] offset:6528
    v_pk_mul_f32 v[112:113], v[108:109], v[96:97]
    v_pk_mul_f32 v[114:115], v[108:109], v[98:99]
    v_pk_fma_f32 v[112:113], v[110:111], v[98:99], v[112:113] neg_lo:[1,0,0] neg_hi:[1,0,0]
    v_pk_fma_f32 v[114:115], v[110:111], v[96:97], v[114:115]
    v_cvt_pk_bf16_f32 v82, v112, v113
    v_cvt_pk_bf16_f32 v83, v114, v115
    ds_write_b64 v68, v[82:83] offset:7072
    v_pk_mul_f32 v[108:109], v[112:113], v[96:97]
    v_pk_mul_f32 v[110:111], v[112:113], v[98:99]
    v_pk_fma_f32 v[108:109], v[114:115], v[98:99], v[108:109] neg_lo:[1,0,0] neg_hi:[1,0,0]
    v_pk_fma_f32 v[110:111], v[114:115], v[96:97], v[110:111]
    v_cvt_pk_bf16_f32 v84, v108, v109
    v_cvt_pk_bf16_f32 v85, v110, v111
    ds_write_b64 v68, v[84:85] offset:7616
    v_pk_mul_f32 v[112:113], v[108:109], v[96:97]
    v_pk_mul_f32 v[114:115], v[108:109], v[98:99]
    v_pk_fma_f32 v[112:113], v[110:111], v[98:99], v[112:113] neg_lo:[1,0,0] neg_hi:[1,0,0]
    v_pk_fma_f32 v[114:115], v[110:111], v[96:97], v[114:115]
    v_cvt_pk_bf16_f32 v80, v112, v113
    v_cvt_pk_bf16_f32 v81, v114, v115
    ds_write_b64 v68, v[80:81] offset:8160
    ds_read_b128 v[160:163], v69 offset:0
    ds_read_b128 v[164:167], v69 offset:64
    ds_read_b128 v[168:171], v69 offset:128
    ds_read_b128 v[172:175], v69 offset:192
    ds_read_b128 v[176:179], v69 offset:256
    ds_read_b128 v[180:183], v69 offset:320
    ds_read_b128 v[184:187], v69 offset:384
    ds_read_b128 v[188:191], v69 offset:448
    v_cvt_pk_bf16_f32 v82, v104, v105
    v_cvt_pk_bf16_f32 v83, v106, v107
    ds_write_b64 v68, v[82:83] offset:0
    v_pk_mul_f32 v[112:113], v[104:105], v[116:117]
    v_pk_mul_f32 v[114:115], v[104:105], v[118:119]
    v_pk_fma_f32 v[112:113], v[106:107], v[118:119], v[112:113] neg_lo:[1,0,0] neg_hi:[1,0,0]
    v_pk_fma_f32 v[114:115], v[106:107], v[116:117], v[114:115]
    v_cvt_pk_bf16_f32 v84, v112, v113
    v_cvt_pk_bf16_f32 v85, v114, v115
    ds_write_b64 v68, v[84:85] offset:544
    v_pk_mul_f32 v[108:109], v[112:113], v[116:117]
    v_pk_mul_f32 v[110:111], v[112:113], v[118:119]
    v_pk_fma_f32 v[108:109], v[114:115], v[118:119], v[108:109] neg_lo:[1,0,0] neg_hi:[1,0,0]
    v_pk_fma_f32 v[110:111], v[114:115], v[116:117], v[110:111]
    v_cvt_pk_bf16_f32 v80, v108, v109
    v_cvt_pk_bf16_f32 v81, v110, v111
    ds_write_b64 v68, v[80:81] offset:1088
    s_waitcnt lgkmcnt(3)
    v_pk_mul_f32 v[112:113], v[108:109], v[116:117]
    v_pk_mul_f32 v[114:115], v[108:109], v[118:119]
    v_pk_fma_f32 v[112:113], v[110:111], v[118:119], v[112:113] neg_lo:[1,0,0] neg_hi:[1,0,0]
    v_pk_fma_f32 v[114:115], v[110:111], v[116:117], v[114:115]
    v_mfma_f32_16x16x32_bf16 v[224:227], v[160:163], v[128:131], 0
    v_cvt_pk_bf16_f32 v82, v112, v113
    v_cvt_pk_bf16_f32 v83, v114, v115
    v_mfma_f32_16x16x32_bf16 v[224:227], v[164:167], v[132:135], v[224:227]
    ds_write_b64 v68, v[82:83] offset:1632
    v_pk_mul_f32 v[108:109], v[112:113], v[116:117]
    v_pk_mul_f32 v[110:111], v[112:113], v[118:119]
    v_pk_fma_f32 v[108:109], v[114:115], v[118:119], v[108:109] neg_lo:[1,0,0] neg_hi:[1,0,0]
    v_pk_fma_f32 v[110:111], v[114:115], v[116:117], v[110:111]
    v_mfma_f32_16x16x32_bf16 v[224:227], v[168:171], v[136:139], v[224:227]
    v_cvt_pk_bf16_f32 v84, v108, v109
    v_cvt_pk_bf16_f32 v85, v110, v111
    v_mfma_f32_16x16x32_bf16 v[224:227], v[172:175], v[140:143], v[224:227]
    ds_write_b64 v68, v[84:85] offset:2176
    v_pk_mul_f32 v[112:113], v[108:109], v[116:117]
    v_pk_mul_f32 v[114:115], v[108:109], v[118:119]
    v_pk_fma_f32 v[112:113], v[110:111], v[118:119], v[112:113] neg_lo:[1,0,0] neg_hi:[1,0,0]
    v_pk_fma_f32 v[114:115], v[110:111], v[116:117], v[114:115]
    v_mfma_f32_16x16x32_bf16 v[224:227], v[176:179], v[144:147], v[224:227]
    v_cvt_pk_bf16_f32 v80, v112, v113
    v_cvt_pk_bf16_f32 v81, v114, v115
    v_mfma_f32_16x16x32_bf16 v[224:227], v[180:183], v[148:151], v[224:227]
    ds_write_b64 v68, v[80:81] offset:2720
    v_pk_mul_f32 v[108:109], v[112:113], v[116:117]
    v_pk_mul_f32 v[110:111], v[112:113], v[118:119]
    v_pk_fma_f32 v[108:109], v[114:115], v[118:119], v[108:109] neg_lo:[1,0,0] neg_hi:[1,0,0]
    v_pk_fma_f32 v[110:111], v[114:115], v[116:117], v[110:111]
    v_mfma_f32_16x16x32_bf16 v[224:227], v[184:187], v[152:155], v[224:227]
    v_cvt_pk_bf16_f32 v82, v108, v109
    v_cvt_pk_bf16_f32 v83, v110, v111
    v_mfma_f32_16x16x32_bf16 v[224:227], v[188:191], v[156:159], v[224:227]
    ds_write_b64 v68, v[82:83] offset:3264
    v_pk_mul_f32 v[112:113], v[108:109], v[116:117]
    v_pk_mul_f32 v[114:115], v[108:109], v[118:119]
    v_pk_fma_f32 v[112:113], v[110:111], v[118:119], v[112:113] neg_lo:[1,0,0] neg_hi:[1,0,0]
    v_pk_fma_f32 v[114:115], v[110:111], v[116:117], v[114:115]
    v_cvt_pk_bf16_f32 v84, v112, v113
    v_cvt_pk_bf16_f32 v85, v114, v115
    ds_write_b64 v68, v[84:85] offset:3808
    v_pk_mul_f32 v[108:109], v[112:113], v[116:117]
    v_pk_mul_f32 v[110:111], v[112:113], v[118:119]
    v_pk_fma_f32 v[108:109], v[114:115], v[118:119], v[108:109] neg_lo:[1,0,0] neg_hi:[1,0,0]
    v_pk_fma_f32 v[110:111], v[114:115], v[116:117], v[110:111]
    v_cvt_pk_bf16_f32 v80, v108, v109
    v_cvt_pk_bf16_f32 v81, v110, v111
    ds_write_b64 v68, v[80:81] offset:4352
    ds_read_b128 v[192:195], v70 offset:0
    ds_read_b128 v[196:199], v70 offset:64
    ds_read_b128 v[200:203], v70 offset:128
    ds_read_b128 v[204:207], v70 offset:192
    ds_read_b128 v[208:211], v70 offset:256
    ds_read_b128 v[212:215], v70 offset:320
    ds_read_b128 v[216:219], v70 offset:384
    ds_read_b128 v[220:223], v70 offset:448
    v_pk_mul_f32 v[88:89], v[104:105], v[104:105]
    v_pk_mul_f32 v[90:91], v[104:105], v[106:107]
    v_pk_fma_f32 v[88:89], v[106:107], v[106:107], v[88:89] neg_lo:[1,0,0] neg_hi:[1,0,0]
    v_pk_fma_f32 v[90:91], v[106:107], v[104:105], v[90:91]
    v_cvt_pk_bf16_f32 v82, v88, v89
    v_cvt_pk_bf16_f32 v83, v90, v91
    ds_write_b64 v68, v[82:83] offset:0
    v_pk_mul_f32 v[112:113], v[88:89], v[120:121]
    v_pk_mul_f32 v[114:115], v[88:89], v[122:123]
    v_pk_fma_f32 v[112:113], v[90:91], v[122:123], v[112:113] neg_lo:[1,0,0] neg_hi:[1,0,0]
    v_pk_fma_f32 v[114:115], v[90:91], v[120:121], v[114:115]
    v_cvt_pk_bf16_f32 v84, v112, v113
    v_cvt_pk_bf16_f32 v85, v114, v115
    ds_write_b64 v68, v[84:85] offset:544
    v_pk_mul_f32 v[108:109], v[112:113], v[120:121]
    v_pk_mul_f32 v[110:111], v[112:113], v[122:123]
    v_pk_fma_f32 v[108:109], v[114:115], v[122:123], v[108:109] neg_lo:[1,0,0] neg_hi:[1,0,0]
    v_pk_fma_f32 v[110:111], v[114:115], v[120:121], v[110:111]
    v_cvt_pk_bf16_f32 v80, v108, v109
    v_cvt_pk_bf16_f32 v81, v110, v111
    ds_write_b64 v68, v[80:81] offset:1088
    s_waitcnt lgkmcnt(3)
    v_pk_mul_f32 v[112:113], v[108:109], v[120:121]
    v_pk_mul_f32 v[114:115], v[108:109], v[122:123]
    v_pk_fma_f32 v[112:113], v[110:111], v[122:123], v[112:113] neg_lo:[1,0,0] neg_hi:[1,0,0]
    v_pk_fma_f32 v[114:115], v[110:111], v[120:121], v[114:115]
    v_mfma_f32_16x16x32_bf16 v[228:231], v[192:195], v[128:131], 0
    v_cvt_pk_bf16_f32 v82, v112, v113
    v_cvt_pk_bf16_f32 v83, v114, v115
    v_mfma_f32_16x16x32_bf16 v[228:231], v[196:199], v[132:135], v[228:231]
    ds_write_b64 v68, v[82:83] offset:1632
    v_pk_mul_f32 v[108:109], v[112:113], v[120:121]
    v_pk_mul_f32 v[110:111], v[112:113], v[122:123]
    v_pk_fma_f32 v[108:109], v[114:115], v[122:123], v[108:109] neg_lo:[1,0,0] neg_hi:[1,0,0]
    v_pk_fma_f32 v[110:111], v[114:115], v[120:121], v[110:111]
    v_mfma_f32_16x16x32_bf16 v[228:231], v[200:203], v[136:139], v[228:231]
    v_cvt_pk_bf16_f32 v84, v108, v109
    v_cvt_pk_bf16_f32 v85, v110, v111
    v_mfma_f32_16x16x32_bf16 v[228:231], v[204:207], v[140:143], v[228:231]
    ds_write_b64 v68, v[84:85] offset:2176
    v_pk_mul_f32 v[92:93], v[88:89], v[104:105]
    v_pk_mul_f32 v[94:95], v[88:89], v[106:107]
    v_pk_fma_f32 v[92:93], v[90:91], v[106:107], v[92:93] neg_lo:[1,0,0] neg_hi:[1,0,0]
    v_pk_fma_f32 v[94:95], v[90:91], v[104:105], v[94:95]
    v_mfma_f32_16x16x32_bf16 v[228:231], v[208:211], v[144:147], v[228:231]
    v_cvt_pk_bf16_f32 v80, v92, v93
    v_cvt_pk_bf16_f32 v81, v94, v95
    v_mfma_f32_16x16x32_bf16 v[228:231], v[212:215], v[148:151], v[228:231]
    ds_write_b64 v68, v[80:81] offset:2720
    v_pk_mul_f32 v[112:113], v[92:93], v[120:121]
    v_pk_mul_f32 v[114:115], v[92:93], v[122:123]
    v_pk_fma_f32 v[112:113], v[94:95], v[122:123], v[112:113] neg_lo:[1,0,0] neg_hi:[1,0,0]
    v_pk_fma_f32 v[114:115], v[94:95], v[120:121], v[114:115]
    v_mfma_f32_16x16x32_bf16 v[228:231], v[216:219], v[152:155], v[228:231]
    v_cvt_pk_bf16_f32 v82, v112, v113
    v_cvt_pk_bf16_f32 v83, v114, v115
    v_mfma_f32_16x16x32_bf16 v[228:231], v[220:223], v[156:159], v[228:231]
    ds_write_b64 v68, v[82:83] offset:3264
    v_pk_mul_f32 v[108:109], v[112:113], v[120:121]
    v_pk_mul_f32 v[110:111], v[112:113], v[122:123]
    v_pk_fma_f32 v[108:109], v[114:115], v[122:123], v[108:109] neg_lo:[1,0,0] neg_hi:[1,0,0]
    v_pk_fma_f32 v[110:111], v[114:115], v[120:121], v[110:111]
    v_cvt_pk_bf16_f32 v84, v108, v109
    v_cvt_pk_bf16_f32 v85, v110, v111
    ds_write_b64 v68, v[84:85] offset:3808
    v_pk_mul_f32 v[112:113], v[108:109], v[120:121]
    v_pk_mul_f32 v[114:115], v[108:109], v[122:123]
    v_pk_fma_f32 v[112:113], v[110:111], v[122:123], v[112:113] neg_lo:[1,0,0] neg_hi:[1,0,0]
    v_pk_fma_f32 v[114:115], v[110:111], v[120:121], v[114:115]
    v_cvt_pk_bf16_f32 v80, v112, v113
    v_cvt_pk_bf16_f32 v81, v114, v115
    ds_write_b64 v68, v[80:81] offset:4352
    v_pk_mul_f32 v[108:109], v[112:113], v[120:121]
    v_pk_mul_f32 v[110:111], v[112:113], v[122:123]
    v_pk_fma_f32 v[108:109], v[114:115], v[122:123], v[108:109] neg_lo:[1,0,0] neg_hi:[1,0,0]
    v_pk_fma_f32 v[110:111], v[114:115], v[120:121], v[110:111]
    v_cvt_pk_bf16_f32 v82, v108, v109
    v_cvt_pk_bf16_f32 v83, v110, v111
    ds_write_b64 v68, v[82:83] offset:4896
    ds_read_b128 v[160:163], v71 offset:0
    ds_read_b128 v[164:167], v71 offset:64
    ds_read_b128 v[168:171], v71 offset:128
    ds_read_b128 v[172:175], v71 offset:192
    ds_read_b128 v[176:179], v71 offset:256
    ds_read_b128 v[180:183], v71 offset:320
    ds_read_b128 v[184:187], v71 offset:384
    ds_read_b128 v[188:191], v71 offset:448
    v_fmamk_f32 v224, v66, 0x411b6ceb, v224
    v_pk_mul_f32 v[88:89], v[92:93], v[104:105]
    v_pk_mul_f32 v[90:91], v[92:93], v[106:107]
    v_pk_fma_f32 v[88:89], v[94:95], v[106:107], v[88:89] neg_lo:[1,0,0] neg_hi:[1,0,0]
    v_pk_fma_f32 v[90:91], v[94:95], v[104:105], v[90:91]
    v_cvt_pk_bf16_f32 v84, v88, v89
    v_cvt_pk_bf16_f32 v85, v90, v91
    ds_write_b64 v68, v[84:85] offset:0
    v_pk_mul_f32 v[108:109], v[88:89], v[124:125]
    v_pk_mul_f32 v[110:111], v[88:89], v[126:127]
    v_pk_fma_f32 v[108:109], v[90:91], v[126:127], v[108:109] neg_lo:[1,0,0] neg_hi:[1,0,0]
    v_pk_fma_f32 v[110:111], v[90:91], v[124:125], v[110:111]
    v_cvt_pk_bf16_f32 v80, v108, v109
    v_cvt_pk_bf16_f32 v81, v110, v111
    ds_write_b64 v68, v[80:81] offset:544
    v_pk_mul_f32 v[112:113], v[88:89], v[100:101]
    v_pk_mul_f32 v[114:115], v[88:89], v[102:103]
    v_pk_fma_f32 v[112:113], v[90:91], v[102:103], v[112:113] neg_lo:[1,0,0] neg_hi:[1,0,0]
    v_pk_fma_f32 v[114:115], v[90:91], v[100:101], v[114:115]
    v_cvt_pk_bf16_f32 v82, v112, v113
    v_cvt_pk_bf16_f32 v83, v114, v115
    ds_write_b64 v68, v[82:83] offset:1088
    s_waitcnt lgkmcnt(3)
    v_pk_mul_f32 v[92:93], v[88:89], v[104:105]
    v_pk_mul_f32 v[94:95], v[88:89], v[106:107]
    v_pk_fma_f32 v[92:93], v[90:91], v[106:107], v[92:93] neg_lo:[1,0,0] neg_hi:[1,0,0]
    v_pk_fma_f32 v[94:95], v[90:91], v[104:105], v[94:95]
    v_mfma_f32_16x16x32_bf16 v[232:235], v[160:163], v[128:131], 0
    v_cvt_pk_bf16_f32 v84, v92, v93
    v_cvt_pk_bf16_f32 v85, v94, v95
    v_mfma_f32_16x16x32_bf16 v[232:235], v[164:167], v[132:135], v[232:235]
    ds_write_b64 v68, v[84:85] offset:1632
    v_pk_mul_f32 v[108:109], v[92:93], v[124:125]
    v_pk_mul_f32 v[110:111], v[92:93], v[126:127]
    v_pk_fma_f32 v[108:109], v[94:95], v[126:127], v[108:109] neg_lo:[1,0,0] neg_hi:[1,0,0]
    v_pk_fma_f32 v[110:111], v[94:95], v[124:125], v[110:111]
    v_mfma_f32_16x16x32_bf16 v[232:235], v[168:171], v[136:139], v[232:235]
    v_cvt_pk_bf16_f32 v80, v108, v109
    v_cvt_pk_bf16_f32 v81, v110, v111
    v_mfma_f32_16x16x32_bf16 v[232:235], v[172:175], v[140:143], v[232:235]
    ds_write_b64 v68, v[80:81] offset:2176
Lpad0:
    s_cbranch_execz Lwd2_0
    v_pk_mul_f32 v[112:113], v[92:93], v[100:101]
    v_pk_mul_f32 v[114:115], v[92:93], v[102:103]
    v_pk_fma_f32 v[112:113], v[94:95], v[102:103], v[112:113] neg_lo:[1,0,0] neg_hi:[1,0,0]
    v_pk_fma_f32 v[114:115], v[94:95], v[100:101], v[114:115]
    v_mfma_f32_16x16x32_bf16 v[232:235], v[176:179], v[144:147], v[232:235]
    v_cvt_pk_bf16_f32 v82, v112, v113
    v_cvt_pk_bf16_f32 v83, v114, v115
    v_mfma_f32_16x16x32_bf16 v[232:235], v[180:183], v[148:151], v[232:235]
    ds_write_b64 v68, v[82:83] offset:2720
    s_waitcnt vmcnt(0)
    s_barrier
    buffer_load_dwordx4 a[0:3], v1, s[8:11], s52 offen offset:0 sc1
    buffer_load_dwordx4 a[4:7], v1, s[8:11], s52 offen offset:1024 sc1
    buffer_load_dwordx4 a[8:11], v1, s[8:11], s52 offen offset:2048 sc1
    buffer_load_dwordx4 a[12:15], v1, s[8:11], s52 offen offset:3072 sc1
    s_add_u32 s52, s52, 4096
    buffer_load_dwordx4 a[16:19], v1, s[8:11], s52 offen offset:0 sc1
    buffer_load_dwordx4 a[20:23], v1, s[8:11], s52 offen offset:1024 sc1
    buffer_load_dwordx4 a[24:27], v1, s[8:11], s52 offen offset:2048 sc1
    buffer_load_dwordx4 a[28:31], v1, s[8:11], s52 offen offset:3072 sc1
    s_add_u32 s52, s52, 4096
    ds_read_b32 v15, v14
    v_pk_mul_f32 v[88:89], v[92:93], v[104:105]
    v_pk_mul_f32 v[90:91], v[92:93], v[106:107]
    v_pk_fma_f32 v[88:89], v[94:95], v[106:107], v[88:89] neg_lo:[1,0,0] neg_hi:[1,0,0]
    v_pk_fma_f32 v[90:91], v[94:95], v[104:105], v[90:91]
    v_mfma_f32_16x16x32_bf16 v[232:235], v[184:187], v[152:155], v[232:235]
    v_cvt_pk_bf16_f32 v84, v88, v89
    v_cvt_pk_bf16_f32 v85, v90, v91
    v_mfma_f32_16x16x32_bf16 v[232:235], v[188:191], v[156:159], v[232:235]
    ds_write_b64 v68, v[84:85] offset:3264
    v_pk_mul_f32 v[108:109], v[88:89], v[124:125]
    v_pk_mul_f32 v[110:111], v[88:89], v[126:127]
    v_pk_fma_f32 v[108:109], v[90:91], v[126:127], v[108:109] neg_lo:[1,0,0] neg_hi:[1,0,0]
    v_pk_fma_f32 v[110:111], v[90:91], v[124:125], v[110:111]
    v_cvt_pk_bf16_f32 v80, v108, v109
    v_cvt_pk_bf16_f32 v81, v110, v111
    ds_write_b64 v68, v[80:81] offset:3808
    v_pk_mul_f32 v[112:113], v[88:89], v[100:101]
    v_pk_mul_f32 v[114:115], v[88:89], v[102:103]
    v_pk_fma_f32 v[112:113], v[90:91], v[102:103], v[112:113] neg_lo:[1,0,0] neg_hi:[1,0,0]
    v_pk_fma_f32 v[114:115], v[90:91], v[100:101], v[114:115]
    v_cvt_pk_bf16_f32 v82, v112, v113
    v_cvt_pk_bf16_f32 v83, v114, v115
    ds_write_b64 v68, v[82:83] offset:4352
    v_pk_mul_f32 v[92:93], v[88:89], v[104:105]
    v_pk_mul_f32 v[94:95], v[88:89], v[106:107]
    v_pk_fma_f32 v[92:93], v[90:91], v[106:107], v[92:93] neg_lo:[1,0,0] neg_hi:[1,0,0]
    v_pk_fma_f32 v[94:95], v[90:91], v[104:105], v[94:95]
    v_cvt_pk_bf16_f32 v84, v92, v93
    v_cvt_pk_bf16_f32 v85, v94, v95
    ds_write_b64 v68, v[84:85] offset:4896
    v_pk_mul_f32 v[108:109], v[92:93], v[124:125]
    v_pk_mul_f32 v[110:111], v[92:93], v[126:127]
    v_pk_fma_f32 v[108:109], v[94:95], v[126:127], v[108:109] neg_lo:[1,0,0] neg_hi:[1,0,0]
    v_pk_fma_f32 v[110:111], v[94:95], v[124:125], v[110:111]
    v_cvt_pk_bf16_f32 v80, v108, v109
    v_cvt_pk_bf16_f32 v81, v110, v111
    ds_write_b64 v68, v[80:81] offset:5440
    v_pk_mul_f32 v[112:113], v[92:93], v[100:101]
    v_pk_mul_f32 v[114:115], v[92:93], v[102:103]
    v_pk_fma_f32 v[112:113], v[94:95], v[102:103], v[112:113] neg_lo:[1,0,0] neg_hi:[1,0,0]
    v_pk_fma_f32 v[114:115], v[94:95], v[100:101], v[114:115]
    v_cvt_pk_bf16_f32 v82, v112, v113
    v_cvt_pk_bf16_f32 v83, v114, v115
    ds_write_b64 v68, v[82:83] offset:5984
    ds_read_b128 v[192:195], v72 offset:0
    ds_read_b128 v[196:199], v72 offset:64
    ds_read_b128 v[200:203], v72 offset:128
    ds_read_b128 v[204:207], v72 offset:192
    ds_read_b128 v[208:211], v72 offset:256
    ds_read_b128 v[212:215], v72 offset:320
    ds_read_b128 v[216:219], v72 offset:384
    ds_read_b128 v[220:223], v72 offset:448
    buffer_load_dwordx4 a[32:35], v1, s[8:11], s52 offen offset:0 sc1
    buffer_load_dwordx4 a[36:39], v1, s[8:11], s52 offen offset:1024 sc1
    buffer_load_dwordx4 a[40:43], v1, s[8:11], s52 offen offset:2048 sc1
    buffer_load_dwordx4 a[44:47], v1, s[8:11], s52 offen offset:3072 sc1
    s_add_u32 s52, s52, 4096
    buffer_load_dwordx4 a[48:51], v1, s[8:11], s52 offen offset:0 sc1
    buffer_load_dwordx4 a[52:55], v1, s[8:11], s52 offen offset:1024 sc1
    buffer_load_dwordx4 a[56:59], v1, s[8:11], s52 offen offset:2048 sc1
    buffer_load_dwordx4 a[60:63], v1, s[8:11], s52 offen offset:3072 sc1
    s_add_u32 s52, s52, 4096
    s_waitcnt lgkmcnt(0)
    v_mfma_f32_16x16x32_bf16 v[236:239], v[192:195], v[128:131], 0
    v_mfma_f32_16x16x32_bf16 v[236:239], v[196:199], v[132:135], v[236:239]
    v_mfma_f32_16x16x32_bf16 v[236:239], v[200:203], v[136:139], v[236:239]
    v_mfma_f32_16x16x32_bf16 v[236:239], v[204:207], v[140:143], v[236:239]
    v_mfma_f32_16x16x32_bf16 v[236:239], v[208:211], v[144:147], v[236:239]
    v_mfma_f32_16x16x32_bf16 v[236:239], v[212:215], v[148:151], v[236:239]
    v_mfma_f32_16x16x32_bf16 v[236:239], v[216:219], v[152:155], v[236:239]
    v_mfma_f32_16x16x32_bf16 v[236:239], v[220:223], v[156:159], v[236:239]
    v_add_u32 v194, s59, v1
    s_branch Ljoin
Lnok:
    s_waitcnt vmcnt(0)
    buffer_load_dwordx4 v2, s[12:15], s81 offen  lds
    buffer_load_dwordx4 v2, s[16:19], s81 offen offset:1024  lds
    global_load_dword v63, v62, s[20:21]
    s_waitcnt lgkmcnt(0)
    s_waitcnt vmcnt(0)
Lmid:
    s_barrier
    buffer_load_dwordx4 a[0:3], v1, s[8:11], s52 offen offset:0 sc1
    buffer_load_dwordx4 a[4:7], v1, s[8:11], s52 offen offset:1024 sc1
    buffer_load_dwordx4 a[8:11], v1, s[8:11], s52 offen offset:2048 sc1
    buffer_load_dwordx4 a[12:15], v1, s[8:11], s52 offen offset:3072 sc1
    s_add_u32 s52, s52, 4096
    buffer_load_dwordx4 a[16:19], v1, s[8:11], s52 offen offset:0 sc1
    buffer_load_dwordx4 a[20:23], v1, s[8:11], s52 offen offset:1024 sc1
    buffer_load_dwordx4 a[24:27], v1, s[8:11], s52 offen offset:2048 sc1
    buffer_load_dwordx4 a[28:31], v1, s[8:11], s52 offen offset:3072 sc1
    s_add_u32 s52, s52, 4096
    ds_read_b32 v15, v14
    buffer_load_dwordx4 a[32:35], v1, s[8:11], s52 offen offset:0 sc1
    buffer_load_dwordx4 a[36:39], v1, s[8:11], s52 offen offset:1024 sc1
    buffer_load_dwordx4 a[40:43], v1, s[8:11], s52 offen offset:2048 sc1
    buffer_load_dwordx4 a[44:47], v1, s[8:11], s52 offen offset:3072 sc1
    s_add_u32 s52, s52, 4096
    buffer_load_dwordx4 a[48:51], v1, s[8:11], s52 offen offset:0 sc1
    buffer_load_dwordx4 a[52:55], v1, s[8:11], s52 offen offset:1024 sc1
    buffer_load_dwordx4 a[56:59], v1, s[8:11], s52 offen offset:2048 sc1
    buffer_load_dwordx4 a[60:63], v1, s[8:11], s52 offen offset:3072 sc1
    s_add_u32 s52, s52, 4096
    v_mov_b32 v194, 2146435072
Ljoin:
    s_waitcnt lgkmcnt(0)
    ds_read_b64_tr_b16 v[16:17], v4 offset:0
    ds_read_b64_tr_b16 v[18:19], v4 offset:512
    ds_read_b64_tr_b16 v[20:21], v4 offset:1024
    ds_read_b64_tr_b16 v[22:23], v4 offset:1536
    ds_read_b64_tr_b16 v[24:25], v5 offset:0
    ds_read_b64_tr_b16 v[26:27], v5 offset:512
    ds_read_b64_tr_b16 v[28:29], v5 offset:1024
    ds_read_b64_tr_b16 v[30:31], v5 offset:1536
    s_barrier
    s_waitcnt vmcnt(12)
    s_waitcnt lgkmcnt(4)
    v_mfma_f32_16x16x32_bf16 v[64:67], v[16:19], a[0:3], 0
    ds_read_b64_tr_b16 v[32:33], v6 offset:0
    ds_read_b64_tr_b16 v[34:35], v6 offset:512
    v_mfma_f32_16x16x32_bf16 v[80:83], v[20:23], a[0:3], 0
    v_cvt_pk_bf16_f32 v208, v224, v225
    v_cvt_pk_bf16_f32 v209, v226, v227
    v_mfma_f32_16x16x32_bf16 v[68:71], v[16:19], a[4:7], 0
    v_cvt_pk_bf16_f32 v210, v228, v229
    v_cvt_pk_bf16_f32 v211, v230, v231
    v_mfma_f32_16x16x32_bf16 v[84:87], v[20:23], a[4:7], 0
    v_cvt_pk_bf16_f32 v212, v232, v232
    v_cvt_pk_bf16_f32 v213, v232, v233
    v_mfma_f32_16x16x32_bf16 v[72:75], v[16:19], a[8:11], 0
    ds_read_b64_tr_b16 v[36:37], v6 offset:1024
    ds_read_b64_tr_b16 v[38:39], v6 offset:1536
    v_mfma_f32_16x16x32_bf16 v[88:91], v[20:23], a[8:11], 0
    v_cvt_pk_bf16_f32 v214, v233, v233
    v_cvt_pk_bf16_f32 v215, v234, v234
    v_mfma_f32_16x16x32_bf16 v[76:79], v[16:19], a[12:15], 0
    v_permlane16_swap_b32 v208, v210
    v_permlane16_swap_b32 v209, v211
    v_mfma_f32_16x16x32_bf16 v[92:95], v[20:23], a[12:15], 0
    v_cvt_pk_bf16_f32 v216, v236, v236
    s_waitcnt lgkmcnt(4)
    v_mfma_f32_16x16x32_bf16 v[96:99], v[24:27], a[0:3], 0
    ds_read_b64_tr_b16 v[16:17], v7 offset:0
    ds_read_b64_tr_b16 v[18:19], v7 offset:512
    v_mfma_f32_16x16x32_bf16 v[112:115], v[28:31], a[0:3], 0
    v_cvt_pk_bf16_f32 v217, v236, v236
    v_cvt_pk_bf16_f32 v218, v236, v237
    v_mfma_f32_16x16x32_bf16 v[100:103], v[24:27], a[4:7], 0
    v_cvt_pk_bf16_f32 v219, v237, v237
    v_cvt_pk_bf16_f32 v220, v237, v237
    v_mfma_f32_16x16x32_bf16 v[116:119], v[28:31], a[4:7], 0
    v_cvt_pk_bf16_f32 v221, v237, v237
    v_cvt_pk_bf16_f32 v222, v238, v238
    v_mfma_f32_16x16x32_bf16 v[104:107], v[24:27], a[8:11], 0
    ds_read_b64_tr_b16 v[20:21], v7 offset:1024
    ds_read_b64_tr_b16 v[22:23], v7 offset:1536
    v_mfma_f32_16x16x32_bf16 v[120:123], v[28:31], a[8:11], 0
    v_cvt_pk_bf16_f32 v223, v238, v238
    v_permlane32_swap_b32 v216, v220
    v_mfma_f32_16x16x32_bf16 v[108:111], v[24:27], a[12:15], 0
    v_permlane32_swap_b32 v217, v221
    v_permlane32_swap_b32 v218, v222
    v_mfma_f32_16x16x32_bf16 v[124:127], v[28:31], a[12:15], 0
    v_permlane32_swap_b32 v219, v223
    s_waitcnt lgkmcnt(4)
    v_mfma_f32_16x16x32_bf16 v[128:131], v[32:35], a[0:3], 0
    ds_read_b64_tr_b16 v[24:25], v4 offset:8192
    ds_read_b64_tr_b16 v[26:27], v4 offset:8704
    v_mfma_f32_16x16x32_bf16 v[144:147], v[36:39], a[0:3], 0
    s_mov_b32 s40, 2359296
    s_mov_b32 s41, 2654208
    v_mfma_f32_16x16x32_bf16 v[132:135], v[32:35], a[4:7], 0
    s_mov_b32 s42, 2949120
    s_mov_b32 s43, 3244032
    v_mfma_f32_16x16x32_bf16 v[148:151], v[36:39], a[4:7], 0
    s_mov_b32 s44, 3538944
    s_mov_b32 s45, 3833856
    v_mfma_f32_16x16x32_bf16 v[136:139], v[32:35], a[8:11], 0
    ds_read_b64_tr_b16 v[28:29], v4 offset:9216
    ds_read_b64_tr_b16 v[30:31], v4 offset:9728
    v_mfma_f32_16x16x32_bf16 v[152:155], v[36:39], a[8:11], 0
    s_mov_b32 s46, 4128768
    s_mov_b32 s47, 4423680
    v_mfma_f32_16x16x32_bf16 v[140:143], v[32:35], a[12:15], 0
    s_mov_b32 s48, 4718592
    s_mov_b32 s49, 5013504
    v_mfma_f32_16x16x32_bf16 v[156:159], v[36:39], a[12:15], 0
    s_and_b32 s60, s2, 7
    s_waitcnt lgkmcnt(4)
    v_mfma_f32_16x16x32_bf16 v[160:163], v[16:19], a[0:3], 0
    ds_read_b64_tr_b16 v[32:33], v5 offset:8192
    ds_read_b64_tr_b16 v[34:35], v5 offset:8704
    v_mfma_f32_16x16x32_bf16 v[176:179], v[20:23], a[0:3], 0
    s_lshr_b32 s61, s2, 3
    s_lshr_b32 s67, s60, 1
    v_mfma_f32_16x16x32_bf16 v[164:167], v[16:19], a[4:7], 0
    s_lshr_b32 s69, s2, 6
    s_mul_i32 s63, s60, 1152
    v_mfma_f32_16x16x32_bf16 v[180:183], v[20:23], a[4:7], 0
    s_lshl_b32 s64, s69, 8
    s_add_u32 s64, s64, s63
    v_mfma_f32_16x16x32_bf16 v[168:171], v[16:19], a[8:11], 0
    ds_read_b64_tr_b16 v[36:37], v5 offset:9216
    ds_read_b64_tr_b16 v[38:39], v5 offset:9728
    v_mfma_f32_16x16x32_bf16 v[184:187], v[20:23], a[8:11], 0
    s_and_b32 s65, s61, 7
    s_lshl_b32 s65, s65, 1
    v_mfma_f32_16x16x32_bf16 v[172:175], v[16:19], a[12:15], 0
    s_lshr_b32 s66, s3, 1
    s_add_u32 s65, s65, s66
    v_mfma_f32_16x16x32_bf16 v[188:191], v[20:23], a[12:15], 0
    s_waitcnt vmcnt(8) lgkmcnt(4)
    v_mfma_f32_16x16x32_bf16 v[64:67], v[24:27], a[16:19], v[64:67]
    ds_read_b64_tr_b16 v[16:17], v6 offset:8192
    ds_read_b64_tr_b16 v[18:19], v6 offset:8704
    v_mfma_f32_16x16x32_bf16 v[80:83], v[28:31], a[16:19], v[80:83]
    s_mul_i32 s68, s65, 36
    v_add_u32 v57, s68, v0
    v_mfma_f32_16x16x32_bf16 v[68:71], v[24:27], a[20:23], v[68:71]
    v_mul_u32_u24 v57, 9216, v57
    s_add_u32 s68, s64, 128
    v_mfma_f32_16x16x32_bf16 v[84:87], v[28:31], a[20:23], v[84:87]
    v_add_u32 v57, s68, v57
    v_cmp_gt_u32 vcc, 36, v0
    v_mfma_f32_16x16x32_bf16 v[72:75], v[24:27], a[24:27], v[72:75]
    ds_read_b64_tr_b16 v[20:21], v6 offset:9216
    ds_read_b64_tr_b16 v[22:23], v6 offset:9728
    v_mfma_f32_16x16x32_bf16 v[88:91], v[28:31], a[24:27], v[88:91]
    v_mov_b32 v60, 2146435072
    s_lshl_b32 s68, s69, 4
    v_mfma_f32_16x16x32_bf16 v[76:79], v[24:27], a[28:31], v[76:79]
    s_add_u32 s68, s68, s65
    s_mul_i32 s68, s68, 9
    v_mfma_f32_16x16x32_bf16 v[92:95], v[28:31], a[28:31], v[92:95]
    v_cndmask_b32 v57, v60, v57, vcc
    s_waitcnt lgkmcnt(4)
    v_mfma_f32_16x16x32_bf16 v[96:99], v[32:35], a[16:19], v[96:99]
    ds_read_b64_tr_b16 v[24:25], v7 offset:8192
    ds_read_b64_tr_b16 v[26:27], v7 offset:8704
    v_mfma_f32_16x16x32_bf16 v[112:115], v[36:39], a[16:19], v[112:115]
    buffer_load_dwordx4 a[64:67], v1, s[8:11], s52 offen offset:0 sc1
    v_mfma_f32_16x16x32_bf16 v[100:103], v[32:35], a[20:23], v[100:103]
    v_add_u32 v59, s68, v0
    v_mul_u32_u24 v59, 9216, v59
    v_mfma_f32_16x16x32_bf16 v[116:119], v[36:39], a[20:23], v[116:119]
    buffer_load_dwordx4 a[68:71], v1, s[8:11], s52 offen offset:1024 sc1
    v_mfma_f32_16x16x32_bf16 v[104:107], v[32:35], a[24:27], v[104:107]
    ds_read_b64_tr_b16 v[28:29], v7 offset:9216
    ds_read_b64_tr_b16 v[30:31], v7 offset:9728
    v_mfma_f32_16x16x32_bf16 v[120:123], v[36:39], a[24:27], v[120:123]
    s_add_u32 s68, s63, 1024
    v_add_u32 v59, s68, v59
    v_mfma_f32_16x16x32_bf16 v[108:111], v[32:35], a[28:31], v[108:111]
    v_cmp_gt_u32 vcc, 9, v0
    s_lshl_b32 s65, s69, 5
    v_mfma_f32_16x16x32_bf16 v[124:127], v[36:39], a[28:31], v[124:127]
    s_add_u32 s65, s65, s63
    s_waitcnt lgkmcnt(4)
    v_mfma_f32_16x16x32_bf16 v[128:131], v[16:19], a[16:19], v[128:131]
    ds_read_b64_tr_b16 v[32:33], v4 offset:16384
    ds_read_b64_tr_b16 v[34:35], v4 offset:16896
    v_mfma_f32_16x16x32_bf16 v[144:147], v[20:23], a[16:19], v[144:147]
    buffer_load_dwordx4 a[72:75], v1, s[8:11], s52 offen offset:2048 sc1
    v_mfma_f32_16x16x32_bf16 v[132:135], v[16:19], a[20:23], v[132:135]
    v_cndmask_b32 v59, v60, v59, vcc
    v_cmp_gt_u32 vcc, 41, v0
    v_mfma_f32_16x16x32_bf16 v[148:151], v[20:23], a[20:23], v[148:151]
    v_lshlrev_b32 v58, 7, v0
    s_nop 0
    v_mfma_f32_16x16x32_bf16 v[136:139], v[16:19], a[24:27], v[136:139]
    ds_read_b64_tr_b16 v[36:37], v4 offset:24576
    ds_read_b64_tr_b16 v[38:39], v4 offset:25088
    v_mfma_f32_16x16x32_bf16 v[152:155], v[20:23], a[24:27], v[152:155]
    buffer_load_dwordx4 a[76:79], v1, s[8:11], s52 offen offset:3072 sc1
    s_add_u32 s52, s52, 4096
    v_mfma_f32_16x16x32_bf16 v[140:143], v[16:19], a[28:31], v[140:143]
    v_cndmask_b32 v58, v60, v58, vcc
    s_sub_u32 s30, s84, 12
    v_mfma_f32_16x16x32_bf16 v[156:159], v[20:23], a[28:31], v[156:159]
    s_and_b32 s68, s61, 7
    s_waitcnt lgkmcnt(4)
    v_mfma_f32_16x16x32_bf16 v[160:163], v[24:27], a[16:19], v[160:163]
    ds_read_b64_tr_b16 v[16:17], v4 offset:17408
    ds_read_b64_tr_b16 v[18:19], v4 offset:17920
    v_mfma_f32_16x16x32_bf16 v[176:179], v[28:31], a[16:19], v[176:179]
    buffer_load_dwordx4 a[80:83], v1, s[8:11], s52 offen offset:0 sc1
    v_mfma_f32_16x16x32_bf16 v[164:167], v[24:27], a[20:23], v[164:167]
    s_lshl_b32 s84, s60, 3
    s_add_u32 s84, s84, s68
    v_mfma_f32_16x16x32_bf16 v[180:183], v[28:31], a[20:23], v[180:183]
    s_lshl_b32 s84, s84, 7
    s_add_u32 s84, s84, 37814272
    v_mfma_f32_16x16x32_bf16 v[168:171], v[24:27], a[24:27], v[168:171]
    ds_read_b64_tr_b16 v[20:21], v4 offset:25600
    ds_read_b64_tr_b16 v[22:23], v4 offset:26112
    v_mfma_f32_16x16x32_bf16 v[184:187], v[28:31], a[24:27], v[184:187]
    buffer_load_dwordx4 a[84:87], v1, s[8:11], s52 offen offset:1024 sc1
    v_mfma_f32_16x16x32_bf16 v[172:175], v[24:27], a[28:31], v[172:175]
    s_lshl_b32 s83, s3, 10
    s_add_u32 s83, s83, 37912576
    v_mfma_f32_16x16x32_bf16 v[188:191], v[28:31], a[28:31], v[188:191]
    s_waitcnt vmcnt(6) lgkmcnt(4)
    v_mfma_f32_16x16x32_bf16 v[64:67], v[32:35], a[32:35], v[64:67]
    ds_read_b64_tr_b16 v[24:25], v5 offset:16384
    ds_read_b64_tr_b16 v[26:27], v5 offset:16896
    v_mfma_f32_16x16x32_bf16 v[64:67], v[36:39], a[48:51], v[64:67]
    s_mov_b32 s22, 5308416
    s_mov_b32 s23, 0x20000
    v_mfma_f32_16x16x32_bf16 v[68:71], v[32:35], a[36:39], v[68:71]
    buffer_load_dwordx4 a[88:91], v1, s[8:11], s52 offen offset:2048 sc1
    v_mfma_f32_16x16x32_bf16 v[68:71], v[36:39], a[52:55], v[68:71]
    s_mov_b32 s32, 0
    s_mov_b32 s33, 294912
    v_mfma_f32_16x16x32_bf16 v[72:75], v[32:35], a[40:43], v[72:75]
    ds_read_b64_tr_b16 v[28:29], v5 offset:24576
    ds_read_b64_tr_b16 v[30:31], v5 offset:25088
    v_mfma_f32_16x16x32_bf16 v[72:75], v[36:39], a[56:59], v[72:75]
    buffer_load_dwordx4 a[92:95], v1, s[8:11], s52 offen offset:3072 sc1
    s_add_u32 s52, s52, 4096
    v_mfma_f32_16x16x32_bf16 v[76:79], v[32:35], a[44:47], v[76:79]
    s_mov_b32 s34, 589824
    s_mov_b32 s35, 884736
    v_mfma_f32_16x16x32_bf16 v[76:79], v[36:39], a[60:63], v[76:79]
    s_mov_b32 s36, 1179648
    s_waitcnt lgkmcnt(4)
    v_mfma_f32_16x16x32_bf16 v[80:83], v[16:19], a[32:35], v[80:83]
    ds_read_b64_tr_b16 v[32:33], v5 offset:17408
    ds_read_b64_tr_b16 v[34:35], v5 offset:17920
    v_mfma_f32_16x16x32_bf16 v[80:83], v[20:23], a[48:51], v[80:83]
    s_mov_b32 s37, 1474560
    s_mov_b32 s38, 1769472
    v_mfma_f32_16x16x32_bf16 v[84:87], v[16:19], a[36:39], v[84:87]
    buffer_load_dwordx4 a[96:99], v1, s[8:11], s52 offen offset:0 sc1
    v_mfma_f32_16x16x32_bf16 v[84:87], v[20:23], a[52:55], v[84:87]
    s_mov_b32 s39, 2064384
    s_add_u32 s65, s65, 1024
    v_mfma_f32_16x16x32_bf16 v[88:91], v[16:19], a[40:43], v[88:91]
    ds_read_b64_tr_b16 v[36:37], v5 offset:25600
    ds_read_b64_tr_b16 v[38:39], v5 offset:26112
    v_mfma_f32_16x16x32_bf16 v[88:91], v[20:23], a[56:59], v[88:91]
    s_mul_i32 s66, s66, 294912
    s_add_u32 s65, s65, s66
    v_mfma_f32_16x16x32_bf16 v[92:95], v[16:19], a[44:47], v[92:95]
    buffer_load_dwordx4 a[100:103], v1, s[8:11], s52 offen offset:1024 sc1
    v_mfma_f32_16x16x32_bf16 v[92:95], v[20:23], a[60:63], v[92:95]
    s_lshl_b32 s51, s3, 10
    s_waitcnt lgkmcnt(4)
    v_mfma_f32_16x16x32_bf16 v[96:99], v[24:27], a[32:35], v[96:99]
    ds_read_b64_tr_b16 v[16:17], v6 offset:16384
    ds_read_b64_tr_b16 v[18:19], v6 offset:16896
    v_mfma_f32_16x16x32_bf16 v[96:99], v[28:31], a[48:51], v[96:99]
    s_mov_b32 s58, 0xc09d30fc
    v_and_b32 v12, 16, v1
    v_mfma_f32_16x16x32_bf16 v[100:103], v[24:27], a[36:39], v[100:103]
    buffer_load_dwordx4 a[104:107], v1, s[8:11], s52 offen offset:2048 sc1
    v_mfma_f32_16x16x32_bf16 v[100:103], v[28:31], a[52:55], v[100:103]
    v_bfe_u32 v10, v0, 1, 2
    v_bfe_u32 v11, v0, 3, 1
    v_mfma_f32_16x16x32_bf16 v[104:107], v[24:27], a[40:43], v[104:107]
    ds_read_b64_tr_b16 v[20:21], v6 offset:24576
    ds_read_b64_tr_b16 v[22:23], v6 offset:25088
    v_mfma_f32_16x16x32_bf16 v[104:107], v[28:31], a[56:59], v[104:107]
    v_lshl_add_u32 v10, v11, 3, v10
    v_bfe_u32 v11, v0, 4, 1
    v_mfma_f32_16x16x32_bf16 v[108:111], v[24:27], a[44:47], v[108:111]
    buffer_load_dwordx4 a[108:111], v1, s[8:11], s52 offen offset:3072 sc1
    s_add_u32 s52, s52, 4096
    v_mfma_f32_16x16x32_bf16 v[108:111], v[28:31], a[60:63], v[108:111]
    v_lshl_add_u32 v10, v11, 2, v10
    s_waitcnt lgkmcnt(4)
    v_mfma_f32_16x16x32_bf16 v[112:115], v[32:35], a[32:35], v[112:115]
    ds_read_b64_tr_b16 v[24:25], v6 offset:17408
    ds_read_b64_tr_b16 v[26:27], v6 offset:17920
    v_mfma_f32_16x16x32_bf16 v[112:115], v[36:39], a[48:51], v[112:115]
    v_bfe_u32 v11, v0, 5, 1
    v_lshl_add_u32 v10, v11, 4, v10
    v_mfma_f32_16x16x32_bf16 v[116:119], v[32:35], a[36:39], v[116:119]
    v_mul_u32_u24 v3, 9216, v10
    v_add3_u32 v3, v3, v12, s65
    v_mfma_f32_16x16x32_bf16 v[116:119], v[36:39], a[52:55], v[116:119]
    buffer_load_dwordx4 a[112:115], v1, s[8:11], s52 offen offset:0 sc1
    v_mfma_f32_16x16x32_bf16 v[120:123], v[32:35], a[40:43], v[120:123]
    ds_read_b64_tr_b16 v[28:29], v6 offset:25600
    ds_read_b64_tr_b16 v[30:31], v6 offset:26112
    v_mfma_f32_16x16x32_bf16 v[120:123], v[36:39], a[56:59], v[120:123]
    v_and_b32 v12, 3, v0
    v_lshlrev_b32 v12, 3, v12
    v_mfma_f32_16x16x32_bf16 v[124:127], v[32:35], a[44:47], v[124:127]
    buffer_load_dwordx4 a[116:119], v1, s[8:11], s52 offen offset:1024 sc1
    v_mfma_f32_16x16x32_bf16 v[124:127], v[36:39], a[60:63], v[124:127]
    v_bfe_u32 v13, v0, 3, 2
    s_waitcnt lgkmcnt(4)
    v_mfma_f32_16x16x32_bf16 v[128:131], v[16:19], a[32:35], v[128:131]
    ds_read_b64_tr_b16 v[32:33], v7 offset:16384
    ds_read_b64_tr_b16 v[34:35], v7 offset:16896
    v_mfma_f32_16x16x32_bf16 v[128:131], v[20:23], a[48:51], v[128:131]
    v_bfe_u32 v11, v0, 2, 3
    v_lshl_add_u32 v9, v11, 5, v12
    v_mfma_f32_16x16x32_bf16 v[132:135], v[16:19], a[36:39], v[132:135]
    v_lshrrev_b32 v10, 5, v0
    v_lshl_add_u32 v9, v10, 9, v9
    v_mfma_f32_16x16x32_bf16 v[132:135], v[20:23], a[52:55], v[132:135]
    buffer_load_dwordx4 a[120:123], v1, s[8:11], s52 offen offset:2048 sc1
    v_mfma_f32_16x16x32_bf16 v[136:139], v[16:19], a[40:43], v[136:139]
    ds_read_b64_tr_b16 v[36:37], v7 offset:24576
    ds_read_b64_tr_b16 v[38:39], v7 offset:25088
    v_mfma_f32_16x16x32_bf16 v[136:139], v[20:23], a[56:59], v[136:139]
    v_mul_u32_u24 v10, 3072, v10
    v_lshl_add_u32 v10, v11, 7, v10
    v_mfma_f32_16x16x32_bf16 v[140:143], v[16:19], a[44:47], v[140:143]
    v_lshl_add_u32 v10, v13, 5, v10
    v_add_u32 v56, v10, v12
    v_mfma_f32_16x16x32_bf16 v[140:143], v[20:23], a[60:63], v[140:143]
    v_add_u32 v56, 8192, v56
    s_waitcnt lgkmcnt(4)
    v_mfma_f32_16x16x32_bf16 v[144:147], v[24:27], a[32:35], v[144:147]
    ds_read_b64_tr_b16 v[16:17], v7 offset:17408
    ds_read_b64_tr_b16 v[18:19], v7 offset:17920
    v_mfma_f32_16x16x32_bf16 v[144:147], v[28:31], a[48:51], v[144:147]
    buffer_load_dwordx4 a[124:127], v1, s[8:11], s52 offen offset:3072 sc1
    s_add_u32 s52, s52, 4096
    v_mfma_f32_16x16x32_bf16 v[148:151], v[24:27], a[36:39], v[148:151]
    s_sub_u32 s62, s31, 37912576
    s_lshr_b32 s62, s62, 7
    v_mfma_f32_16x16x32_bf16 v[148:151], v[28:31], a[52:55], v[148:151]
    buffer_load_dwordx4 a[128:131], v1, s[8:11], s52 offen offset:0 sc1
    v_mfma_f32_16x16x32_bf16 v[152:155], v[24:27], a[40:43], v[152:155]
    ds_read_b64_tr_b16 v[20:21], v7 offset:25600
    ds_read_b64_tr_b16 v[22:23], v7 offset:26112
    v_mfma_f32_16x16x32_bf16 v[152:155], v[28:31], a[56:59], v[152:155]
    s_lshl_b32 s68, s62, 3
    s_add_u32 s68, s68, s60
    v_mfma_f32_16x16x32_bf16 v[156:159], v[24:27], a[44:47], v[156:159]
    s_lshl_b32 s68, s68, 2
    s_add_u32 s68, s68, s69
    v_mfma_f32_16x16x32_bf16 v[156:159], v[28:31], a[60:63], v[156:159]
    s_lshl_b32 s68, s68, 4
    s_waitcnt lgkmcnt(4)
    v_mfma_f32_16x16x32_bf16 v[160:163], v[32:35], a[32:35], v[160:163]
    ds_read_b64_tr_b16 v[24:25], v4 offset:32768
    ds_read_b64_tr_b16 v[26:27], v4 offset:33280
    v_mfma_f32_16x16x32_bf16 v[160:163], v[36:39], a[48:51], v[160:163]
    buffer_load_dwordx4 a[132:135], v1, s[8:11], s52 offen offset:1024 sc1
    v_mfma_f32_16x16x32_bf16 v[164:167], v[32:35], a[36:39], v[164:167]
    s_add_u32 s68, s68, 37765120
    v_mov_b32 v14, 2146435072
    v_mfma_f32_16x16x32_bf16 v[164:167], v[36:39], a[52:55], v[164:167]
    v_writelane_b32 v14, s68, 0
    s_mul_i32 s63, s62, 144
    v_mfma_f32_16x16x32_bf16 v[168:171], v[32:35], a[40:43], v[168:171]
    ds_read_b64_tr_b16 v[28:29], v4 offset:40960
    ds_read_b64_tr_b16 v[30:31], v4 offset:41472
    v_mfma_f32_16x16x32_bf16 v[168:171], v[36:39], a[56:59], v[168:171]
    buffer_load_dwordx4 a[136:139], v1, s[8:11], s52 offen offset:2048 sc1
    v_mfma_f32_16x16x32_bf16 v[172:175], v[32:35], a[44:47], v[172:175]
    s_mul_i32 s64, s60, 18
    s_add_u32 s63, s63, s64
    v_mfma_f32_16x16x32_bf16 v[172:175], v[36:39], a[60:63], v[172:175]
    s_add_u32 s63, s63, 4352
    s_waitcnt lgkmcnt(4)
    v_mfma_f32_16x16x32_bf16 v[176:179], v[16:19], a[32:35], v[176:179]
    ds_read_b64_tr_b16 v[32:33], v4 offset:33792
    ds_read_b64_tr_b16 v[34:35], v4 offset:34304
    v_mfma_f32_16x16x32_bf16 v[176:179], v[20:23], a[48:51], v[176:179]
    buffer_load_dwordx4 a[140:143], v1, s[8:11], s52 offen offset:3072 sc1
    s_add_u32 s52, s52, 4096
    v_mfma_f32_16x16x32_bf16 v[180:183], v[16:19], a[36:39], v[180:183]
    s_lshl_b32 s64, s69, 2
    s_add_u32 s64, s64, s63
    v_mfma_f32_16x16x32_bf16 v[180:183], v[20:23], a[52:55], v[180:183]
    s_lshl_b32 s53, s64, 12
    s_add_u32 s54, s53, 4096
    v_mfma_f32_16x16x32_bf16 v[184:187], v[16:19], a[40:43], v[184:187]
    ds_read_b64_tr_b16 v[36:37], v4 offset:41984
    ds_read_b64_tr_b16 v[38:39], v4 offset:42496
    v_mfma_f32_16x16x32_bf16 v[184:187], v[20:23], a[56:59], v[184:187]
    buffer_load_dwordx4 a[144:147], v1, s[8:11], s52 offen offset:0 sc1
    v_mfma_f32_16x16x32_bf16 v[188:191], v[16:19], a[44:47], v[188:191]
    s_add_u32 s55, s53, 8192
    s_add_u32 s56, s53, 12288
    v_mfma_f32_16x16x32_bf16 v[188:191], v[20:23], a[60:63], v[188:191]
    s_waitcnt vmcnt(13) lgkmcnt(4)
    v_mfma_f32_16x16x32_bf16 v[64:67], v[24:27], a[64:67], v[64:67]
    ds_read_b64_tr_b16 v[16:17], v5 offset:32768
    ds_read_b64_tr_b16 v[18:19], v5 offset:33280
    v_mfma_f32_16x16x32_bf16 v[64:67], v[28:31], a[80:83], v[64:67]
    s_lshr_b32 s64, s69, 1
    s_add_u32 s64, s64, s63
    v_mfma_f32_16x16x32_bf16 v[68:71], v[24:27], a[68:71], v[68:71]
    buffer_load_dwordx4 a[148:151], v1, s[8:11], s52 offen offset:1024 sc1
    v_mfma_f32_16x16x32_bf16 v[68:71], v[28:31], a[84:87], v[68:71]
    s_add_u32 s64, s64, 16
    s_lshl_b32 s64, s64, 12
    v_mfma_f32_16x16x32_bf16 v[72:75], v[24:27], a[72:75], v[72:75]
    ds_read_b64_tr_b16 v[20:21], v5 offset:40960
    ds_read_b64_tr_b16 v[22:23], v5 offset:41472
    v_mfma_f32_16x16x32_bf16 v[72:75], v[28:31], a[88:91], v[72:75]
    buffer_load_dwordx4 a[152:155], v1, s[8:11], s52 offen offset:2048 sc1
    v_mfma_f32_16x16x32_bf16 v[76:79], v[24:27], a[76:79], v[76:79]
    s_and_b32 s65, s69, 1
    s_lshl_b32 s65, s65, 10
    v_mfma_f32_16x16x32_bf16 v[76:79], v[28:31], a[92:95], v[76:79]
    s_add_u32 s57, s64, s65
    s_waitcnt lgkmcnt(4)
    v_mfma_f32_16x16x32_bf16 v[80:83], v[32:35], a[64:67], v[80:83]
    ds_read_b64_tr_b16 v[24:25], v5 offset:33792
    ds_read_b64_tr_b16 v[26:27], v5 offset:34304
    v_mfma_f32_16x16x32_bf16 v[80:83], v[36:39], a[80:83], v[80:83]
    s_sub_u32 s24, s24, 2048
    s_subb_u32 s25, s25, 0
    v_mfma_f32_16x16x32_bf16 v[84:87], v[32:35], a[68:71], v[84:87]
    buffer_load_dwordx4 a[156:159], v1, s[8:11], s52 offen offset:3072 sc1
    s_add_u32 s52, s52, 4096
    v_mfma_f32_16x16x32_bf16 v[84:87], v[36:39], a[84:87], v[84:87]
    s_mov_b32 s26, 5310464
    s_mov_b32 s27, 0x20000
    v_mfma_f32_16x16x32_bf16 v[88:91], v[32:35], a[72:75], v[88:91]
    ds_read_b64_tr_b16 v[28:29], v5 offset:41984
    ds_read_b64_tr_b16 v[30:31], v5 offset:42496
    v_mfma_f32_16x16x32_bf16 v[88:91], v[36:39], a[88:91], v[88:91]
    s_lshl_b32 s63, s61, 2
    s_add_u32 s63, s63, s3
    v_mfma_f32_16x16x32_bf16 v[92:95], v[32:35], a[76:79], v[92:95]
    s_add_u32 m0, s50, 98304
    s_mul_i32 s63, s63, 5184
    v_mfma_f32_16x16x32_bf16 v[92:95], v[36:39], a[92:95], v[92:95]
    s_mul_i32 s71, s67, 1327104
    s_waitcnt lgkmcnt(4)
    v_mfma_f32_16x16x32_bf16 v[96:99], v[16:19], a[64:67], v[96:99]
    ds_read_b64_tr_b16 v[32:33], v6 offset:32768
    ds_read_b64_tr_b16 v[34:35], v6 offset:33280
    v_mfma_f32_16x16x32_bf16 v[96:99], v[20:23], a[80:83], v[96:99]
    s_add_u32 s63, s63, s71
    s_add_u32 s63, s63, 2048
    v_mfma_f32_16x16x32_bf16 v[100:103], v[16:19], a[68:71], v[100:103]
    buffer_load_dwordx4 v2, s[12:15], s44 offen  lds
    v_mfma_f32_16x16x32_bf16 v[100:103], v[20:23], a[84:87], v[100:103]
    s_and_b32 s64, s2, 1
    s_mul_i32 s64, s64, 663552
    v_mfma_f32_16x16x32_bf16 v[104:107], v[16:19], a[72:75], v[104:107]
    ds_read_b64_tr_b16 v[36:37], v6 offset:40960
    ds_read_b64_tr_b16 v[38:39], v6 offset:41472
    v_mfma_f32_16x16x32_bf16 v[104:107], v[20:23], a[88:91], v[104:107]
Lpad1:
    s_cbranch_execz Lpad4
    s_add_u32 s79, s63, s64
    s_sub_u32 s63, s63, s64
    v_mfma_f32_16x16x32_bf16 v[108:111], v[16:19], a[76:79], v[108:111]
    buffer_load_dwordx4 v2, s[16:19], s44 offen offset:1024  lds
    v_mfma_f32_16x16x32_bf16 v[108:111], v[20:23], a[92:95], v[108:111]
    s_add_u32 s31, s63, 663552
    s_waitcnt lgkmcnt(4)
    v_mfma_f32_16x16x32_bf16 v[112:115], v[24:27], a[64:67], v[112:115]
    ds_read_b64_tr_b16 v[16:17], v6 offset:33792
    ds_read_b64_tr_b16 v[18:19], v6 offset:34304
    v_mfma_f32_16x16x32_bf16 v[112:115], v[28:31], a[80:83], v[112:115]
    s_and_b32 s60, s2, 1
    s_lshl_b32 s60, s60, 3
    v_mfma_f32_16x16x32_bf16 v[116:119], v[24:27], a[68:71], v[116:119]
    s_and_b32 s63, s61, 7
    s_add_u32 s60, s60, s63
    v_mfma_f32_16x16x32_bf16 v[116:119], v[28:31], a[84:87], v[116:119]
    buffer_load_dwordx4 a[160:163], v1, s[8:11], s52 offen offset:0 sc1
    v_mfma_f32_16x16x32_bf16 v[120:123], v[24:27], a[72:75], v[120:123]
    ds_read_b64_tr_b16 v[20:21], v6 offset:41984
    ds_read_b64_tr_b16 v[22:23], v6 offset:42496
    v_mfma_f32_16x16x32_bf16 v[120:123], v[28:31], a[88:91], v[120:123]
    s_lshr_b32 s61, s61, 3
    s_lshl_b32 s62, s60, 1
    v_mfma_f32_16x16x32_bf16 v[124:127], v[24:27], a[76:79], v[124:127]
    buffer_load_dwordx4 a[164:167], v1, s[8:11], s52 offen offset:1024 sc1
    v_mfma_f32_16x16x32_bf16 v[124:127], v[28:31], a[92:95], v[124:127]
    s_lshr_b32 s63, s3, 1
    s_waitcnt lgkmcnt(4)
    v_mfma_f32_16x16x32_bf16 v[128:131], v[32:35], a[64:67], v[128:131]
    ds_read_b64_tr_b16 v[24:25], v7 offset:32768
    ds_read_b64_tr_b16 v[26:27], v7 offset:33280
    v_mfma_f32_16x16x32_bf16 v[128:131], v[36:39], a[80:83], v[128:131]
    s_add_u32 s62, s62, s63
    s_lshl_b32 s64, s62, 2
    v_mfma_f32_16x16x32_bf16 v[132:135], v[32:35], a[68:71], v[132:135]
    s_add_u32 s64, s64, s67
    s_lshl_b32 s64, s64, 7
    v_mfma_f32_16x16x32_bf16 v[132:135], v[36:39], a[84:87], v[132:135]
    buffer_load_dwordx4 a[168:171], v1, s[8:11], s52 offen offset:2048 sc1
    v_mfma_f32_16x16x32_bf16 v[136:139], v[32:35], a[72:75], v[136:139]
    ds_read_b64_tr_b16 v[28:29], v7 offset:40960
    ds_read_b64_tr_b16 v[30:31], v7 offset:41472
    v_mfma_f32_16x16x32_bf16 v[136:139], v[36:39], a[88:91], v[136:139]
    s_add_u32 s74, s64, 37765120
    s_and_b32 s63, s3, 1
    v_mfma_f32_16x16x32_bf16 v[140:143], v[32:35], a[76:79], v[140:143]
    s_lshl_b32 s63, s63, 11
    s_mul_i32 s64, s62, 144
    v_mfma_f32_16x16x32_bf16 v[140:143], v[36:39], a[92:95], v[140:143]
    s_mul_i32 s65, s67, 36
    s_waitcnt lgkmcnt(4)
    v_mfma_f32_16x16x32_bf16 v[144:147], v[16:19], a[64:67], v[144:147]
    ds_read_b64_tr_b16 v[32:33], v7 offset:33792
    ds_read_b64_tr_b16 v[34:35], v7 offset:34304
    v_mfma_f32_16x16x32_bf16 v[144:147], v[20:23], a[80:83], v[144:147]
    buffer_load_dwordx4 a[172:175], v1, s[8:11], s52 offen offset:3072 sc1
    s_add_u32 s52, s52, 4096
    v_mfma_f32_16x16x32_bf16 v[148:151], v[16:19], a[68:71], v[148:151]
    s_add_u32 s64, s64, s65
    s_lshl_b32 s64, s64, 12
    v_mfma_f32_16x16x32_bf16 v[148:151], v[20:23], a[84:87], v[148:151]
    s_add_u32 m0, s50, 106496
    s_add_u32 s64, s64, s63
    v_mfma_f32_16x16x32_bf16 v[152:155], v[16:19], a[72:75], v[152:155]
    ds_read_b64_tr_b16 v[36:37], v7 offset:41984
    ds_read_b64_tr_b16 v[38:39], v7 offset:42496
    v_mfma_f32_16x16x32_bf16 v[152:155], v[20:23], a[88:91], v[152:155]
    s_add_u32 s72, s64, 17825792
    s_and_b32 s69, s61, 1
    v_mfma_f32_16x16x32_bf16 v[156:159], v[16:19], a[76:79], v[156:159]
    s_mul_i32 s69, s69, 18
    s_and_b32 s64, s61, 2
    v_mfma_f32_16x16x32_bf16 v[156:159], v[20:23], a[92:95], v[156:159]
    s_add_u32 s69, s69, s64
    s_waitcnt lgkmcnt(4)
    v_mfma_f32_16x16x32_bf16 v[160:163], v[24:27], a[64:67], v[160:163]
    ds_read_b64_tr_b16 v[16:17], v4 offset:49152
    ds_read_b64_tr_b16 v[18:19], v4 offset:49664
    v_mfma_f32_16x16x32_bf16 v[160:163], v[28:31], a[80:83], v[160:163]
    buffer_load_dwordx4 v2, s[12:15], s45 offen  lds
    v_mfma_f32_16x16x32_bf16 v[164:167], v[24:27], a[68:71], v[164:167]
    s_lshl_b32 s64, s69, 12
    s_add_u32 s64, s64, 49283072
    v_mfma_f32_16x16x32_bf16 v[164:167], v[28:31], a[84:87], v[164:167]
    s_add_u32 s73, s64, s72
    s_mul_i32 s65, s61, 6
    v_mfma_f32_16x16x32_bf16 v[168:171], v[24:27], a[72:75], v[168:171]
    ds_read_b64_tr_b16 v[20:21], v4 offset:57344
    ds_read_b64_tr_b16 v[22:23], v4 offset:57856
    v_mfma_f32_16x16x32_bf16 v[168:171], v[28:31], a[88:91], v[168:171]
    buffer_load_dwordx4 v2, s[16:19], s45 offen offset:1024  lds
    v_mfma_f32_16x16x32_bf16 v[172:175], v[24:27], a[76:79], v[172:175]
    s_mul_i32 s64, s60, 3
    s_add_u32 s64, s64, s61
    v_mfma_f32_16x16x32_bf16 v[172:175], v[28:31], a[92:95], v[172:175]
    s_lshl_b32 s64, s64, 13
    s_waitcnt lgkmcnt(4)
    v_mfma_f32_16x16x32_bf16 v[176:179], v[32:35], a[64:67], v[176:179]
    ds_read_b64_tr_b16 v[24:25], v4 offset:50176
    ds_read_b64_tr_b16 v[26:27], v4 offset:50688
    v_mfma_f32_16x16x32_bf16 v[176:179], v[36:39], a[80:83], v[176:179]
    s_add_u32 m0, s50, 114688
    s_add_u32 s64, s64, 38010880
    v_mfma_f32_16x16x32_bf16 v[180:183], v[32:35], a[68:71], v[180:183]
    s_lshl_b32 s66, s3, 11
    s_lshl_b32 s68, s67, 9
    v_mfma_f32_16x16x32_bf16 v[180:183], v[36:39], a[84:87], v[180:183]
    s_add_u32 s66, s66, s68
    s_add_u32 s75, s64, s66
    v_mfma_f32_16x16x32_bf16 v[184:187], v[32:35], a[72:75], v[184:187]
    ds_read_b64_tr_b16 v[28:29], v4 offset:58368
    ds_read_b64_tr_b16 v[30:31], v4 offset:58880
    v_mfma_f32_16x16x32_bf16 v[184:187], v[36:39], a[88:91], v[184:187]
    buffer_load_dwordx4 v2, s[12:15], s46 offen  lds
    v_mfma_f32_16x16x32_bf16 v[188:191], v[32:35], a[76:79], v[188:191]
    s_mov_b32 s77, s75
    s_lshl_b32 s66, s67, 11
    v_mfma_f32_16x16x32_bf16 v[188:191], v[36:39], a[92:95], v[188:191]
    s_waitcnt vmcnt(17) lgkmcnt(4)
    v_mfma_f32_16x16x32_bf16 v[64:67], v[16:19], a[96:99], v[64:67]
    ds_read_b64_tr_b16 v[32:33], v5 offset:49152
    ds_read_b64_tr_b16 v[34:35], v5 offset:49664
    v_mfma_f32_16x16x32_bf16 v[64:67], v[20:23], a[112:115], v[64:67]
    s_add_u32 s76, s64, s66
    s_lshl_b32 s62, s60, 1
    v_mfma_f32_16x16x32_bf16 v[68:71], v[16:19], a[100:103], v[68:71]
    buffer_load_dwordx4 v2, s[16:19], s46 offen offset:1024  lds
    v_mfma_f32_16x16x32_bf16 v[68:71], v[20:23], a[116:119], v[68:71]
    s_lshr_b32 s63, s67, 1
    s_add_u32 s62, s62, s63
    v_mfma_f32_16x16x32_bf16 v[72:75], v[16:19], a[104:107], v[72:75]
    ds_read_b64_tr_b16 v[36:37], v5 offset:57344
    ds_read_b64_tr_b16 v[38:39], v5 offset:57856
    v_mfma_f32_16x16x32_bf16 v[72:75], v[20:23], a[120:123], v[72:75]
    buffer_load_dwordx4 a[176:179], v1, s[8:11], s52 offen offset:0 sc1
    v_mfma_f32_16x16x32_bf16 v[76:79], v[16:19], a[108:111], v[76:79]
    s_mul_i32 s62, s62, 144
    s_add_u32 s62, s62, s69
    v_mfma_f32_16x16x32_bf16 v[76:79], v[20:23], a[124:127], v[76:79]
    s_lshr_b32 s64, s3, 1
    s_waitcnt lgkmcnt(4)
    v_mfma_f32_16x16x32_bf16 v[80:83], v[24:27], a[96:99], v[80:83]
    ds_read_b64_tr_b16 v[16:17], v5 offset:50176
    ds_read_b64_tr_b16 v[18:19], v5 offset:50688
    v_mfma_f32_16x16x32_bf16 v[80:83], v[28:31], a[112:115], v[80:83]
    s_add_u32 s62, s62, s64
    s_lshl_b32 s62, s62, 2
    v_mfma_f32_16x16x32_bf16 v[84:87], v[24:27], a[100:103], v[84:87]
    buffer_load_dwordx4 a[180:183], v1, s[8:11], s52 offen offset:1024 sc1
    v_mfma_f32_16x16x32_bf16 v[84:87], v[28:31], a[116:119], v[84:87]
    s_and_b32 s63, s67, 1
    s_lshl_b32 s63, s63, 1
    v_mfma_f32_16x16x32_bf16 v[88:91], v[24:27], a[104:107], v[88:91]
    ds_read_b64_tr_b16 v[20:21], v5 offset:58368
    ds_read_b64_tr_b16 v[22:23], v5 offset:58880
    v_mfma_f32_16x16x32_bf16 v[88:91], v[28:31], a[120:123], v[88:91]
    s_and_b32 s66, s3, 1
    s_add_u32 s63, s63, s66
    v_mfma_f32_16x16x32_bf16 v[92:95], v[24:27], a[108:111], v[92:95]
    buffer_load_dwordx4 a[184:187], v1, s[8:11], s52 offen offset:2048 sc1
    v_mfma_f32_16x16x32_bf16 v[92:95], v[28:31], a[124:127], v[92:95]
    s_add_u32 s62, s62, s63
    s_waitcnt lgkmcnt(4)
    v_mfma_f32_16x16x32_bf16 v[96:99], v[32:35], a[96:99], v[96:99]
    ds_read_b64_tr_b16 v[24:25], v6 offset:49152
    ds_read_b64_tr_b16 v[26:27], v6 offset:49664
    v_mfma_f32_16x16x32_bf16 v[96:99], v[36:39], a[112:115], v[96:99]
    s_lshl_b32 s62, s62, 10
    s_add_u32 s62, s62, 67108864
    v_mfma_f32_16x16x32_bf16 v[100:103], v[32:35], a[100:103], v[100:103]
    buffer_load_dwordx4 a[188:191], v1, s[8:11], s52 offen offset:3072 sc1
    s_add_u32 s52, s52, 4096
    v_mfma_f32_16x16x32_bf16 v[100:103], v[36:39], a[116:119], v[100:103]
    s_add_u32 s63, s67, 1
    s_and_b32 s63, s63, 3
    v_mfma_f32_16x16x32_bf16 v[104:107], v[32:35], a[104:107], v[104:107]
    ds_read_b64_tr_b16 v[28:29], v6 offset:57344
    ds_read_b64_tr_b16 v[30:31], v6 offset:57856
    v_mfma_f32_16x16x32_bf16 v[104:107], v[36:39], a[120:123], v[104:107]
    s_mul_i32 s63, s63, 147456
    s_add_u32 s0, s62, s63
    v_mfma_f32_16x16x32_bf16 v[108:111], v[32:35], a[108:111], v[108:111]
    s_add_u32 m0, s50, 122880
    s_add_u32 s63, s67, 2
    v_mfma_f32_16x16x32_bf16 v[108:111], v[36:39], a[124:127], v[108:111]
    s_and_b32 s63, s63, 3
    s_waitcnt lgkmcnt(4)
    v_mfma_f32_16x16x32_bf16 v[112:115], v[16:19], a[96:99], v[112:115]
    ds_read_b64_tr_b16 v[32:33], v6 offset:50176
    ds_read_b64_tr_b16 v[34:35], v6 offset:50688
    v_mfma_f32_16x16x32_bf16 v[112:115], v[20:23], a[112:115], v[112:115]
    s_mul_i32 s63, s63, 147456
    s_add_u32 s1, s62, s63
    v_mfma_f32_16x16x32_bf16 v[116:119], v[16:19], a[100:103], v[116:119]
    s_add_u32 s63, s67, 3
    s_and_b32 s63, s63, 3
    v_mfma_f32_16x16x32_bf16 v[116:119], v[20:23], a[116:119], v[116:119]
    buffer_load_dwordx4 v2, s[12:15], s47 offen  lds
    v_mfma_f32_16x16x32_bf16 v[120:123], v[16:19], a[104:107], v[120:123]
    ds_read_b64_tr_b16 v[36:37], v6 offset:58368
    ds_read_b64_tr_b16 v[38:39], v6 offset:58880
    v_mfma_f32_16x16x32_bf16 v[120:123], v[20:23], a[120:123], v[120:123]
    s_mul_i32 s63, s63, 147456
    s_add_u32 s28, s62, s63
    v_mfma_f32_16x16x32_bf16 v[124:127], v[16:19], a[108:111], v[124:127]
    buffer_load_dwordx4 v2, s[16:19], s47 offen offset:1024  lds
    v_mfma_f32_16x16x32_bf16 v[124:127], v[20:23], a[124:127], v[124:127]
    v_add_u32 v4, 65536, v4
    s_waitcnt lgkmcnt(4)
    v_mfma_f32_16x16x32_bf16 v[128:131], v[24:27], a[96:99], v[128:131]
    ds_read_b64_tr_b16 v[16:17], v4 offset:0
    ds_read_b64_tr_b16 v[18:19], v4 offset:512
    v_mfma_f32_16x16x32_bf16 v[128:131], v[28:31], a[112:115], v[128:131]
    s_lshl_b32 s62, s60, 2
    s_add_u32 s62, s62, s67
    v_mfma_f32_16x16x32_bf16 v[132:135], v[24:27], a[100:103], v[132:135]
    s_lshl_b32 s62, s62, 1
    s_add_u32 s62, s62, s66
    v_mfma_f32_16x16x32_bf16 v[132:135], v[28:31], a[116:119], v[132:135]
    s_add_u32 m0, s50, 131072
    s_add_u32 s65, s65, s64
    v_mfma_f32_16x16x32_bf16 v[136:139], v[24:27], a[104:107], v[136:139]
    ds_read_b64_tr_b16 v[20:21], v4 offset:8192
    ds_read_b64_tr_b16 v[22:23], v4 offset:8704
    v_mfma_f32_16x16x32_bf16 v[136:139], v[28:31], a[120:123], v[136:139]
    s_lshl_b32 s63, s62, 5
    s_lshl_b32 s64, s64, 17
    v_mfma_f32_16x16x32_bf16 v[140:143], v[24:27], a[108:111], v[140:143]
    s_add_u32 s63, s63, s64
    s_add_u32 s59, s63, 4718592
    v_mfma_f32_16x16x32_bf16 v[140:143], v[28:31], a[124:127], v[140:143]
    s_lshl_b32 s63, s62, 8
    s_waitcnt lgkmcnt(4)
    v_mfma_f32_16x16x32_bf16 v[144:147], v[32:35], a[96:99], v[144:147]
    ds_read_b64_tr_b16 v[24:25], v4 offset:1024
    ds_read_b64_tr_b16 v[26:27], v4 offset:1536
    v_mfma_f32_16x16x32_bf16 v[144:147], v[36:39], a[112:115], v[144:147]
    buffer_load_dwordx4 v2, s[12:15], s48 offen  lds
    v_mfma_f32_16x16x32_bf16 v[148:151], v[32:35], a[100:103], v[148:151]
    s_lshl_b32 s64, s65, 17
    s_add_u32 s63, s63, s64
    v_mfma_f32_16x16x32_bf16 v[148:151], v[36:39], a[116:119], v[148:151]
    buffer_load_dwordx4 v2, s[16:19], s48 offen offset:1024  lds
    v_mfma_f32_16x16x32_bf16 v[152:155], v[32:35], a[104:107], v[152:155]
    ds_read_b64_tr_b16 v[28:29], v4 offset:9216
    ds_read_b64_tr_b16 v[30:31], v4 offset:9728
    v_mfma_f32_16x16x32_bf16 v[152:155], v[36:39], a[120:123], v[152:155]
    s_add_u32 s29, s63, 2621440
    s_mul_i32 s62, s62, 18432
    v_mfma_f32_16x16x32_bf16 v[156:159], v[32:35], a[108:111], v[156:159]
    s_lshl_b32 s65, s65, 6
    s_add_u32 s78, s62, s65
    v_mfma_f32_16x16x32_bf16 v[156:159], v[36:39], a[124:127], v[156:159]
    v_add_u32 v5, 65536, v5
    s_waitcnt vmcnt(18) lgkmcnt(4)
    v_mfma_f32_16x16x32_bf16 v[64:67], v[16:19], a[128:131], v[64:67]
    ds_read_b64_tr_b16 v[32:33], v5 offset:0
    ds_read_b64_tr_b16 v[34:35], v5 offset:512
    v_mfma_f32_16x16x32_bf16 v[64:67], v[20:23], a[144:147], v[64:67]
    buffer_load_dwordx4 a[192:195], v1, s[8:11], s52 offen offset:0 sc1
    v_mfma_f32_16x16x32_bf16 v[68:71], v[16:19], a[132:135], v[68:71]
    s_mul_i32 s64, s61, 384
    s_mul_i32 s65, s3, 9216
    v_mfma_f32_16x16x32_bf16 v[68:71], v[20:23], a[148:151], v[68:71]
    s_add_u32 s64, s64, s65
    s_add_u32 s64, s64, 2048
    v_mfma_f32_16x16x32_bf16 v[72:75], v[16:19], a[136:139], v[72:75]
    ds_read_b64_tr_b16 v[36:37], v5 offset:8192
    ds_read_b64_tr_b16 v[38:39], v5 offset:8704
    v_mfma_f32_16x16x32_bf16 v[72:75], v[20:23], a[152:155], v[72:75]
    buffer_load_dwordx4 a[196:199], v1, s[8:11], s52 offen offset:1024 sc1
    v_mfma_f32_16x16x32_bf16 v[76:79], v[16:19], a[140:143], v[76:79]
    s_mul_i32 s70, s3, 3072
    s_add_u32 s70, s70, 8192
    v_mfma_f32_16x16x32_bf16 v[76:79], v[20:23], a[156:159], v[76:79]
    v_lshrrev_b32 v10, 3, v0
    s_waitcnt lgkmcnt(4)
    v_mfma_f32_16x16x32_bf16 v[80:83], v[24:27], a[128:131], v[80:83]
    ds_read_b64_tr_b16 v[16:17], v5 offset:1024
    ds_read_b64_tr_b16 v[18:19], v5 offset:1536
    v_mfma_f32_16x16x32_bf16 v[80:83], v[28:31], a[144:147], v[80:83]
    buffer_load_dwordx4 a[200:203], v1, s[8:11], s52 offen offset:2048 sc1
    v_mfma_f32_16x16x32_bf16 v[84:87], v[24:27], a[132:135], v[84:87]
    v_lshrrev_b32 v11, 4, v0
    v_bfe_u32 v12, v0, 1, 2
    v_mfma_f32_16x16x32_bf16 v[84:87], v[28:31], a[148:151], v[84:87]
    v_xor_b32 v11, v11, v12
    v_and_b32 v12, 1, v0
    v_mfma_f32_16x16x32_bf16 v[88:91], v[24:27], a[136:139], v[88:91]
    ds_read_b64_tr_b16 v[20:21], v5 offset:9216
    ds_read_b64_tr_b16 v[22:23], v5 offset:9728
    v_mfma_f32_16x16x32_bf16 v[88:91], v[28:31], a[152:155], v[88:91]
    buffer_load_dwordx4 a[204:207], v1, s[8:11], s52 offen offset:3072 sc1
    s_add_u32 s52, s52, 4096
    v_mfma_f32_16x16x32_bf16 v[92:95], v[24:27], a[140:143], v[92:95]
    v_lshlrev_b32 v12, 4, v12
    v_mul_u32_u24 v10, 1152, v10
    v_mfma_f32_16x16x32_bf16 v[92:95], v[28:31], a[156:159], v[92:95]
    v_add_u32 v6, 65536, v6
    s_waitcnt lgkmcnt(4)
    v_mfma_f32_16x16x32_bf16 v[96:99], v[32:35], a[128:131], v[96:99]
    ds_read_b64_tr_b16 v[24:25], v6 offset:0
    ds_read_b64_tr_b16 v[26:27], v6 offset:512
    v_mfma_f32_16x16x32_bf16 v[96:99], v[36:39], a[144:147], v[96:99]
    v_lshl_add_u32 v10, v11, 5, v10
    v_add3_u32 v61, v10, v12, s64
    v_mfma_f32_16x16x32_bf16 v[100:103], v[32:35], a[132:135], v[100:103]
    s_add_u32 m0, s50, 139264
    v_and_b32 v62, 0x70, v1
    v_mfma_f32_16x16x32_bf16 v[100:103], v[36:39], a[148:151], v[100:103]
    s_cmp_ge_u32 s2, 192
    s_cselect_b64 s[68:69], -1, 0
    v_mfma_f32_16x16x32_bf16 v[104:107], v[32:35], a[136:139], v[104:107]
    ds_read_b64_tr_b16 v[28:29], v6 offset:8192
    ds_read_b64_tr_b16 v[30:31], v6 offset:8704
    v_mfma_f32_16x16x32_bf16 v[104:107], v[36:39], a[152:155], v[104:107]
    buffer_load_dwordx4 v2, s[12:15], s49 offen  lds
    v_mfma_f32_16x16x32_bf16 v[108:111], v[32:35], a[140:143], v[108:111]
    s_and_b32 s60, s2, 7
    s_lshr_b32 s61, s2, 3
    v_mfma_f32_16x16x32_bf16 v[108:111], v[36:39], a[156:159], v[108:111]
    s_sub_u32 s85, s61, 24
    s_waitcnt lgkmcnt(4)
    v_mfma_f32_16x16x32_bf16 v[112:115], v[16:19], a[128:131], v[112:115]
    ds_read_b64_tr_b16 v[32:33], v6 offset:1024
    ds_read_b64_tr_b16 v[34:35], v6 offset:1536
    v_mfma_f32_16x16x32_bf16 v[112:115], v[20:23], a[144:147], v[112:115]
    s_cmp_ge_u32 s2, 192
    s_cselect_b32 s76, s85, s76
    v_mfma_f32_16x16x32_bf16 v[116:119], v[16:19], a[132:135], v[116:119]
    buffer_load_dwordx4 v2, s[16:19], s49 offen offset:1024  lds
    v_mfma_f32_16x16x32_bf16 v[116:119], v[20:23], a[148:151], v[116:119]
    s_lshl_b32 s62, s60, 3
    s_add_u32 s85, s62, s76
    v_mfma_f32_16x16x32_bf16 v[120:123], v[16:19], a[136:139], v[120:123]
    ds_read_b64_tr_b16 v[36:37], v6 offset:9216
    ds_read_b64_tr_b16 v[38:39], v6 offset:9728
    v_mfma_f32_16x16x32_bf16 v[120:123], v[20:23], a[152:155], v[120:123]
    s_cmp_ge_u32 s2, 192
    s_cselect_b32 s78, s85, s78
    v_mfma_f32_16x16x32_bf16 v[124:127], v[16:19], a[140:143], v[124:127]
    v_add_u32 v2, 128, v2
    s_add_u32 s63, s60, 64
    v_mfma_f32_16x16x32_bf16 v[124:127], v[20:23], a[156:159], v[124:127]
    s_lshr_b32 s64, s78, 2
    s_waitcnt lgkmcnt(4)
    v_mfma_f32_16x16x32_bf16 v[128:131], v[24:27], a[128:131], v[128:131]
    ds_read_b64_tr_b16 v[16:17], v4 offset:16384
    ds_read_b64_tr_b16 v[18:19], v4 offset:16896
    v_mfma_f32_16x16x32_bf16 v[128:131], v[28:31], a[144:147], v[128:131]
    s_lshl_b32 s64, s64, 12
    s_and_b32 s65, s78, 3
    v_mfma_f32_16x16x32_bf16 v[132:135], v[24:27], a[132:135], v[132:135]
    buffer_load_dwordx4 a[208:211], v1, s[8:11], s52 offen offset:0 sc1
    v_mfma_f32_16x16x32_bf16 v[132:135], v[28:31], a[148:151], v[132:135]
    s_lshl_b32 s65, s65, 8
    s_add_u32 s66, s64, s65
    v_mfma_f32_16x16x32_bf16 v[136:139], v[24:27], a[136:139], v[136:139]
    ds_read_b64_tr_b16 v[20:21], v4 offset:24576
    ds_read_b64_tr_b16 v[22:23], v4 offset:25088
    v_mfma_f32_16x16x32_bf16 v[136:139], v[28:31], a[152:155], v[136:139]
    s_lshr_b32 s64, s63, 2
    s_lshl_b32 s64, s64, 12
    v_mfma_f32_16x16x32_bf16 v[140:143], v[24:27], a[140:143], v[140:143]
    buffer_load_dwordx4 a[212:215], v1, s[8:11], s52 offen offset:1024 sc1
    v_mfma_f32_16x16x32_bf16 v[140:143], v[28:31], a[156:159], v[140:143]
    s_and_b32 s65, s63, 3
    s_waitcnt lgkmcnt(4)
    v_mfma_f32_16x16x32_bf16 v[144:147], v[32:35], a[128:131], v[144:147]
    ds_read_b64_tr_b16 v[24:25], v4 offset:17408
    ds_read_b64_tr_b16 v[26:27], v4 offset:17920
    v_mfma_f32_16x16x32_bf16 v[144:147], v[36:39], a[144:147], v[144:147]
    s_lshl_b32 s65, s65, 8
    s_add_u32 s67, s64, s65
    v_mfma_f32_16x16x32_bf16 v[148:151], v[32:35], a[132:135], v[148:151]
    s_mul_i32 s64, s3, 589824
    s_add_u32 s85, s66, s64
    v_mfma_f32_16x16x32_bf16 v[148:151], v[36:39], a[148:151], v[148:151]
    buffer_load_dwordx4 a[216:219], v1, s[8:11], s52 offen offset:2048 sc1
    v_mfma_f32_16x16x32_bf16 v[152:155], v[32:35], a[136:139], v[152:155]
    ds_read_b64_tr_b16 v[28:29], v4 offset:25600
    ds_read_b64_tr_b16 v[30:31], v4 offset:26112
    v_mfma_f32_16x16x32_bf16 v[152:155], v[36:39], a[152:155], v[152:155]
    s_cmp_ge_u32 s2, 192
    s_cselect_b32 s70, s85, s70
    v_mfma_f32_16x16x32_bf16 v[156:159], v[32:35], a[140:143], v[156:159]
    buffer_load_dwordx4 a[220:223], v1, s[8:11], s52 offen offset:3072 sc1
    s_add_u32 s52, s52, 4096
    v_mfma_f32_16x16x32_bf16 v[156:159], v[36:39], a[156:159], v[156:159]
    s_waitcnt vmcnt(14) lgkmcnt(4)
    v_mfma_f32_16x16x32_bf16 v[64:67], v[16:19], a[160:163], v[64:67]
    ds_read_b64_tr_b16 v[32:33], v5 offset:16384
    ds_read_b64_tr_b16 v[34:35], v5 offset:16896
    v_mfma_f32_16x16x32_bf16 v[64:67], v[20:23], a[176:179], v[64:67]
    s_lshl_b32 s64, s3, 3
    s_add_u32 s64, s64, s76
    v_mfma_f32_16x16x32_bf16 v[68:71], v[16:19], a[164:167], v[68:71]
    s_lshl_b32 s64, s64, 1
    s_add_u32 s85, s67, s64
    v_mfma_f32_16x16x32_bf16 v[68:71], v[20:23], a[180:183], v[68:71]
    buffer_load_dwordx4 a[224:227], v1, s[8:11], s52 offen offset:0 sc1
    v_mfma_f32_16x16x32_bf16 v[72:75], v[16:19], a[168:171], v[72:75]
    ds_read_b64_tr_b16 v[36:37], v5 offset:24576
    ds_read_b64_tr_b16 v[38:39], v5 offset:25088
    v_mfma_f32_16x16x32_bf16 v[72:75], v[20:23], a[184:187], v[72:75]
    s_cmp_ge_u32 s2, 192
    s_cselect_b32 s71, s85, s71
    v_mfma_f32_16x16x32_bf16 v[76:79], v[16:19], a[172:175], v[76:79]
    s_lshl_b32 s64, s78, 3
    s_add_u32 s64, s64, s3
    v_mfma_f32_16x16x32_bf16 v[76:79], v[20:23], a[188:191], v[76:79]
    s_lshl_b32 s64, s64, 12
    s_waitcnt lgkmcnt(4)
    v_mfma_f32_16x16x32_bf16 v[80:83], v[24:27], a[160:163], v[80:83]
    ds_read_b64_tr_b16 v[16:17], v5 offset:17408
    ds_read_b64_tr_b16 v[18:19], v5 offset:17920
    v_mfma_f32_16x16x32_bf16 v[80:83], v[28:31], a[176:179], v[80:83]
    buffer_load_dwordx4 a[228:231], v1, s[8:11], s52 offen offset:1024 sc1
    v_mfma_f32_16x16x32_bf16 v[84:87], v[24:27], a[164:167], v[84:87]
    s_add_u32 s85, s64, 2621440
    v_lshrrev_b32 v10, 4, v0
    v_mfma_f32_16x16x32_bf16 v[84:87], v[28:31], a[180:183], v[84:87]
    buffer_load_dwordx4 a[232:235], v1, s[8:11], s52 offen offset:2048 sc1
    v_mfma_f32_16x16x32_bf16 v[88:91], v[24:27], a[168:171], v[88:91]
    ds_read_b64_tr_b16 v[20:21], v5 offset:25600
    ds_read_b64_tr_b16 v[22:23], v5 offset:26112
    v_mfma_f32_16x16x32_bf16 v[88:91], v[28:31], a[184:187], v[88:91]
    s_cmp_ge_u32 s2, 192
    s_cselect_b32 s72, s85, s72
    v_mfma_f32_16x16x32_bf16 v[92:95], v[24:27], a[172:175], v[92:95]
    s_lshl_b32 s64, s78, 12
    s_lshl_b32 s65, s3, 10
    v_mfma_f32_16x16x32_bf16 v[92:95], v[28:31], a[188:191], v[92:95]
    s_add_u32 s64, s64, s65
    s_waitcnt lgkmcnt(4)
    v_mfma_f32_16x16x32_bf16 v[96:99], v[32:35], a[160:163], v[96:99]
    ds_read_b64_tr_b16 v[24:25], v6 offset:16384
    ds_read_b64_tr_b16 v[26:27], v6 offset:16896
    v_mfma_f32_16x16x32_bf16 v[96:99], v[36:39], a[176:179], v[96:99]
    buffer_load_dwordx4 a[236:239], v1, s[8:11], s52 offen offset:3072 sc1
    s_add_u32 s52, s52, 4096
    v_mfma_f32_16x16x32_bf16 v[100:103], v[32:35], a[164:167], v[100:103]
    s_add_u32 s85, s64, 4718592
    v_and_b32 v11, 0xf0, v1
    v_mfma_f32_16x16x32_bf16 v[100:103], v[36:39], a[180:183], v[100:103]
    s_cmp_ge_u32 s2, 192
    s_cselect_b32 s73, s85, s73
    v_mfma_f32_16x16x32_bf16 v[104:107], v[32:35], a[168:171], v[104:107]
    ds_read_b64_tr_b16 v[28:29], v6 offset:24576
    ds_read_b64_tr_b16 v[30:31], v6 offset:25088
    v_mfma_f32_16x16x32_bf16 v[104:107], v[36:39], a[184:187], v[104:107]
    buffer_load_dwordx4 a[240:243], v1, s[8:11], s52 offen offset:0 sc1
    v_mfma_f32_16x16x32_bf16 v[108:111], v[32:35], a[172:175], v[108:111]
    s_add_u32 s85, s64, 4718592
    v_lshl_add_u32 v13, v10, 10, v11
    v_mfma_f32_16x16x32_bf16 v[108:111], v[36:39], a[188:191], v[108:111]
    v_cndmask_b32 v62, v62, v13, s[68:69]
    s_waitcnt lgkmcnt(4)
    v_mfma_f32_16x16x32_bf16 v[112:115], v[16:19], a[160:163], v[112:115]
    ds_read_b64_tr_b16 v[32:33], v6 offset:17408
    ds_read_b64_tr_b16 v[34:35], v6 offset:17920
    v_mfma_f32_16x16x32_bf16 v[112:115], v[20:23], a[176:179], v[112:115]
    buffer_load_dwordx4 a[244:247], v1, s[8:11], s52 offen offset:1024 sc1
    v_mfma_f32_16x16x32_bf16 v[116:119], v[16:19], a[164:167], v[116:119]
    s_cmp_ge_u32 s2, 192
    s_cselect_b32 s75, s85, s75
    v_mfma_f32_16x16x32_bf16 v[116:119], v[20:23], a[180:183], v[116:119]
    s_lshl_b32 s64, s3, 6
    s_add_u32 s64, s64, s78
    v_mfma_f32_16x16x32_bf16 v[120:123], v[16:19], a[168:171], v[120:123]
    ds_read_b64_tr_b16 v[36:37], v6 offset:25600
    ds_read_b64_tr_b16 v[38:39], v6 offset:26112
    v_mfma_f32_16x16x32_bf16 v[120:123], v[20:23], a[184:187], v[120:123]
    buffer_load_dwordx4 a[248:251], v1, s[8:11], s52 offen offset:2048 sc1
    v_mfma_f32_16x16x32_bf16 v[124:127], v[16:19], a[172:175], v[124:127]
    s_lshl_b32 s64, s64, 5
    s_add_u32 s85, s64, 37879808
    v_mfma_f32_16x16x32_bf16 v[124:127], v[20:23], a[188:191], v[124:127]
    s_waitcnt vmcnt(11) lgkmcnt(4)
    s_barrier
    v_mfma_f32_16x16x32_bf16 v[128:131], v[24:27], a[160:163], v[128:131]
    ds_read_b64_tr_b16 v[16:17], v4 offset:32768
    ds_read_b64_tr_b16 v[18:19], v4 offset:33280
    v_mfma_f32_16x16x32_bf16 v[128:131], v[28:31], a[176:179], v[128:131]
    s_cmp_ge_u32 s2, 192
    s_cselect_b32 s77, s85, s77
    v_mfma_f32_16x16x32_bf16 v[132:135], v[24:27], a[164:167], v[132:135]
    buffer_load_dwordx4 a[252:255], v1, s[8:11], s52 offen offset:3072 sc1
    s_add_u32 s52, s52, 4096
    v_mfma_f32_16x16x32_bf16 v[132:135], v[28:31], a[180:183], v[132:135]
    s_mul_i32 s64, s3, 4128
    s_add_u32 s85, s64, 40992
    v_mfma_f32_16x16x32_bf16 v[136:139], v[24:27], a[168:171], v[136:139]
    ds_read_b64_tr_b16 v[20:21], v4 offset:40960
    ds_read_b64_tr_b16 v[22:23], v4 offset:41472
    v_mfma_f32_16x16x32_bf16 v[136:139], v[28:31], a[184:187], v[136:139]
    buffer_load_dwordx4 v[224:227], v1, s[8:11], s52 offen offset:0 sc1
    v_mfma_f32_16x16x32_bf16 v[140:143], v[24:27], a[172:175], v[140:143]
    s_cmp_ge_u32 s2, 192
    s_cselect_b32 s74, s85, s74
    v_mfma_f32_16x16x32_bf16 v[140:143], v[28:31], a[188:191], v[140:143]
    v_bfe_u32 v11, v0, 2, 2
    s_waitcnt lgkmcnt(4)
    v_mfma_f32_16x16x32_bf16 v[144:147], v[32:35], a[160:163], v[144:147]
    ds_read_b64_tr_b16 v[24:25], v4 offset:33792
    ds_read_b64_tr_b16 v[26:27], v4 offset:34304
    v_mfma_f32_16x16x32_bf16 v[144:147], v[36:39], a[176:179], v[144:147]
    v_and_b32 v12, 32, v0
    v_lshl_add_u32 v12, v11, 2, v12
    v_mfma_f32_16x16x32_bf16 v[148:151], v[32:35], a[164:167], v[148:151]
    buffer_load_dwordx4 v[228:231], v1, s[8:11], s52 offen offset:1024 sc1
    v_mfma_f32_16x16x32_bf16 v[148:151], v[36:39], a[180:183], v[148:151]
    v_and_b32 v10, 1, v10
    v_lshl_add_u32 v12, v10, 1, v12
    v_mfma_f32_16x16x32_bf16 v[152:155], v[32:35], a[168:171], v[152:155]
    ds_read_b64_tr_b16 v[28:29], v4 offset:41984
    ds_read_b64_tr_b16 v[30:31], v4 offset:42496
    v_mfma_f32_16x16x32_bf16 v[152:155], v[36:39], a[184:187], v[152:155]
    v_lshlrev_b32 v12, 4, v12
    v_and_b32 v11, 3, v0
    v_mfma_f32_16x16x32_bf16 v[156:159], v[32:35], a[172:175], v[156:159]
    buffer_load_dwordx4 v[232:235], v1, s[8:11], s52 offen offset:2048 sc1
    v_mfma_f32_16x16x32_bf16 v[156:159], v[36:39], a[188:191], v[156:159]
    s_waitcnt vmcnt(11) lgkmcnt(4)
    v_mfma_f32_16x16x32_bf16 v[64:67], v[16:19], a[192:195], v[64:67]
    ds_read_b64_tr_b16 v[32:33], v5 offset:32768
    ds_read_b64_tr_b16 v[34:35], v5 offset:33280
    v_mfma_f32_16x16x32_bf16 v[64:67], v[20:23], a[208:211], v[64:67]
    v_lshl_add_u32 v12, v11, 3, v12
    s_lshl_b32 s64, s3, 13
    v_mfma_f32_16x16x32_bf16 v[68:71], v[16:19], a[196:199], v[68:71]
    buffer_load_dwordx4 v[236:239], v1, s[8:11], s52 offen offset:3072 sc1
    s_add_u32 s52, s52, 4096
    v_mfma_f32_16x16x32_bf16 v[68:71], v[20:23], a[212:215], v[68:71]
    s_add_u32 s64, s64, 8192
    v_add_u32 v13, s64, v12
    v_mfma_f32_16x16x32_bf16 v[72:75], v[16:19], a[200:203], v[72:75]
    ds_read_b64_tr_b16 v[36:37], v5 offset:40960
    ds_read_b64_tr_b16 v[38:39], v5 offset:41472
    v_mfma_f32_16x16x32_bf16 v[72:75], v[20:23], a[216:219], v[72:75]
    v_cndmask_b32 v56, v56, v13, s[68:69]
    v_and_b32 v10, 7, v0
    v_mfma_f32_16x16x32_bf16 v[76:79], v[16:19], a[204:207], v[76:79]
    buffer_load_dwordx4 v[240:243], v1, s[8:11], s52 offen offset:0 sc1
    v_mfma_f32_16x16x32_bf16 v[76:79], v[20:23], a[220:223], v[76:79]
    v_bfe_u32 v11, v0, 3, 2
    s_waitcnt lgkmcnt(4)
    v_mfma_f32_16x16x32_bf16 v[80:83], v[24:27], a[192:195], v[80:83]
    ds_read_b64_tr_b16 v[16:17], v5 offset:33792
    ds_read_b64_tr_b16 v[18:19], v5 offset:34304
    v_mfma_f32_16x16x32_bf16 v[80:83], v[28:31], a[208:211], v[80:83]
    v_lshrrev_b32 v12, 5, v0
    v_mul_u32_u24 v11, 1152, v11
    v_mfma_f32_16x16x32_bf16 v[84:87], v[24:27], a[196:199], v[84:87]
    v_lshl_add_u32 v11, v12, 4, v11
    v_mul_u32_u24 v10, 4624, v10
    v_mfma_f32_16x16x32_bf16 v[84:87], v[28:31], a[212:215], v[84:87]
    buffer_load_dwordx4 v[244:247], v1, s[8:11], s52 offen offset:1024 sc1
    v_mfma_f32_16x16x32_bf16 v[88:91], v[24:27], a[200:203], v[88:91]
    ds_read_b64_tr_b16 v[20:21], v5 offset:41984
    ds_read_b64_tr_b16 v[22:23], v5 offset:42496
    v_mfma_f32_16x16x32_bf16 v[88:91], v[28:31], a[216:219], v[88:91]
    s_lshl_b32 s64, s3, 8
    s_add_u32 s64, s64, 78240
    v_mfma_f32_16x16x32_bf16 v[92:95], v[24:27], a[204:207], v[92:95]
    buffer_load_dwordx4 v[248:251], v1, s[8:11], s52 offen offset:2048 sc1
    v_mfma_f32_16x16x32_bf16 v[92:95], v[28:31], a[220:223], v[92:95]
    v_add3_u32 v13, v10, v11, s64
    s_waitcnt lgkmcnt(4)
    v_mfma_f32_16x16x32_bf16 v[96:99], v[32:35], a[192:195], v[96:99]
    ds_read_b64_tr_b16 v[24:25], v6 offset:32768
    ds_read_b64_tr_b16 v[26:27], v6 offset:33280
    v_mfma_f32_16x16x32_bf16 v[96:99], v[36:39], a[208:211], v[96:99]
    v_cndmask_b32 v61, v61, v13, s[68:69]
    v_mov_b32 v60, v14
    v_mfma_f32_16x16x32_bf16 v[100:103], v[32:35], a[196:199], v[100:103]
    v_writelane_b32 v60, s77, 2
    s_add_u32 s68, s77, 0x2000
    v_mfma_f32_16x16x32_bf16 v[100:103], v[36:39], a[212:215], v[100:103]
    buffer_load_dwordx4 v[252:255], v1, s[8:11], s52 offen offset:3072 sc1
    v_mfma_f32_16x16x32_bf16 v[104:107], v[32:35], a[200:203], v[104:107]
    ds_read_b64_tr_b16 v[28:29], v6 offset:40960
    ds_read_b64_tr_b16 v[30:31], v6 offset:41472
    v_mfma_f32_16x16x32_bf16 v[104:107], v[36:39], a[216:219], v[104:107]
    v_writelane_b32 v60, s68, 1
    s_add_u32 s68, s77, 128
    v_mfma_f32_16x16x32_bf16 v[108:111], v[32:35], a[204:207], v[108:111]
    v_writelane_b32 v60, s68, 3
Lpad2:
    s_cbranch_execz Lpad5
    s_add_u32 s68, s77, 256
    v_mfma_f32_16x16x32_bf16 v[108:111], v[36:39], a[220:223], v[108:111]
    buffer_load_dword v63, v57, s[20:23], 0 offen offset:0
    s_waitcnt lgkmcnt(4)
    v_mfma_f32_16x16x32_bf16 v[112:115], v[16:19], a[192:195], v[112:115]
    ds_read_b64_tr_b16 v[32:33], v6 offset:33792
    ds_read_b64_tr_b16 v[34:35], v6 offset:34304
    v_mfma_f32_16x16x32_bf16 v[112:115], v[20:23], a[208:211], v[112:115]
    v_writelane_b32 v60, s68, 4
    v_writelane_b32 v60, s30, 5
    v_mfma_f32_16x16x32_bf16 v[116:119], v[16:19], a[196:199], v[116:119]
    v_mfma_f32_16x16x32_bf16 v[116:119], v[20:23], a[212:215], v[116:119]
    v_mfma_f32_16x16x32_bf16 v[120:123], v[16:19], a[200:203], v[120:123]
    ds_read_b64_tr_b16 v[36:37], v6 offset:41984
    ds_read_b64_tr_b16 v[38:39], v6 offset:42496
    v_mfma_f32_16x16x32_bf16 v[120:123], v[20:23], a[216:219], v[120:123]
    v_mfma_f32_16x16x32_bf16 v[124:127], v[16:19], a[204:207], v[124:127]
    v_mfma_f32_16x16x32_bf16 v[124:127], v[20:23], a[220:223], v[124:127]
    s_waitcnt lgkmcnt(4)
    v_mfma_f32_16x16x32_bf16 v[128:131], v[24:27], a[192:195], v[128:131]
    ds_read_b64_tr_b16 v[16:17], v4 offset:49152
    ds_read_b64_tr_b16 v[18:19], v4 offset:49664
    v_mfma_f32_16x16x32_bf16 v[128:131], v[28:31], a[208:211], v[128:131]
    s_getpc_b64 s[80:81]
    s_lshr_b32 s82, s2, 3
    v_mfma_f32_16x16x32_bf16 v[132:135], v[24:27], a[196:199], v[132:135]
    s_add_u32 s80, s80, 0x414
    s_addc_u32 s81, s81, 0
    v_mfma_f32_16x16x32_bf16 v[132:135], v[28:31], a[212:215], v[132:135]
    v_mfma_f32_16x16x32_bf16 v[136:139], v[24:27], a[200:203], v[136:139]
    ds_read_b64_tr_b16 v[20:21], v4 offset:57344
    ds_read_b64_tr_b16 v[22:23], v4 offset:57856
    v_mfma_f32_16x16x32_bf16 v[136:139], v[28:31], a[216:219], v[136:139]
    s_lshl_b32 s82, s82, 2
    s_add_u32 s82, s82, s3
    v_mfma_f32_16x16x32_bf16 v[140:143], v[24:27], a[204:207], v[140:143]
    v_mfma_f32_16x16x32_bf16 v[140:143], v[28:31], a[220:223], v[140:143]
    s_waitcnt lgkmcnt(4)
    v_mfma_f32_16x16x32_bf16 v[144:147], v[32:35], a[192:195], v[144:147]
    ds_read_b64_tr_b16 v[24:25], v4 offset:50176
    ds_read_b64_tr_b16 v[26:27], v4 offset:50688
    v_mfma_f32_16x16x32_bf16 v[144:147], v[36:39], a[208:211], v[144:147]
    s_mul_i32 s82, s82, 100
    v_min_u32 v195, 0, v0
    v_mfma_f32_16x16x32_bf16 v[148:151], v[32:35], a[196:199], v[148:151]
    v_lshl_add_u32 v195, v195, 7, s82
    v_mfma_f32_16x16x32_bf16 v[148:151], v[36:39], a[212:215], v[148:151]
    v_mfma_f32_16x16x32_bf16 v[152:155], v[32:35], a[200:203], v[152:155]
    ds_read_b64_tr_b16 v[28:29], v4 offset:58368
    ds_read_b64_tr_b16 v[30:31], v4 offset:58880
    v_mfma_f32_16x16x32_bf16 v[152:155], v[36:39], a[216:219], v[152:155]
    global_load_dword v196, v195, s[80:81]
    v_mfma_f32_16x16x32_bf16 v[156:159], v[32:35], a[204:207], v[156:159]
    v_mfma_f32_16x16x32_bf16 v[156:159], v[36:39], a[220:223], v[156:159]
    s_waitcnt vmcnt(10) lgkmcnt(4)
    v_mfma_f32_16x16x32_bf16 v[64:67], v[16:19], a[224:227], v[64:67]
    ds_read_b64_tr_b16 v[32:33], v5 offset:49152
    ds_read_b64_tr_b16 v[34:35], v5 offset:49664
    v_mfma_f32_16x16x32_bf16 v[64:67], v[20:23], a[240:243], v[64:67]
    v_mfma_f32_16x16x32_bf16 v[68:71], v[16:19], a[228:231], v[68:71]
    v_mfma_f32_16x16x32_bf16 v[68:71], v[20:23], a[244:247], v[68:71]
    v_mfma_f32_16x16x32_bf16 v[72:75], v[16:19], a[232:235], v[72:75]
    ds_read_b64_tr_b16 v[36:37], v5 offset:57344
    ds_read_b64_tr_b16 v[38:39], v5 offset:57856
    v_mfma_f32_16x16x32_bf16 v[72:75], v[20:23], a[248:251], v[72:75]
    v_mfma_f32_16x16x32_bf16 v[76:79], v[16:19], a[236:239], v[76:79]
    v_mfma_f32_16x16x32_bf16 v[76:79], v[20:23], a[252:255], v[76:79]
    s_waitcnt lgkmcnt(4)
    v_mfma_f32_16x16x32_bf16 v[80:83], v[24:27], a[224:227], v[80:83]
    ds_read_b64_tr_b16 v[16:17], v5 offset:50176
    ds_read_b64_tr_b16 v[18:19], v5 offset:50688
    v_mfma_f32_16x16x32_bf16 v[80:83], v[28:31], a[240:243], v[80:83]
    v_mfma_f32_16x16x32_bf16 v[84:87], v[24:27], a[228:231], v[84:87]
    v_mfma_f32_16x16x32_bf16 v[84:87], v[28:31], a[244:247], v[84:87]
    v_mfma_f32_16x16x32_bf16 v[88:91], v[24:27], a[232:235], v[88:91]
    ds_read_b64_tr_b16 v[20:21], v5 offset:58368
    ds_read_b64_tr_b16 v[22:23], v5 offset:58880
    v_mfma_f32_16x16x32_bf16 v[88:91], v[28:31], a[248:251], v[88:91]
    v_mfma_f32_16x16x32_bf16 v[92:95], v[24:27], a[236:239], v[92:95]
    v_mfma_f32_16x16x32_bf16 v[92:95], v[28:31], a[252:255], v[92:95]
    s_waitcnt lgkmcnt(4)
    v_mfma_f32_16x16x32_bf16 v[96:99], v[32:35], a[224:227], v[96:99]
    ds_read_b64_tr_b16 v[24:25], v6 offset:49152
    ds_read_b64_tr_b16 v[26:27], v6 offset:49664
    v_mfma_f32_16x16x32_bf16 v[96:99], v[36:39], a[240:243], v[96:99]
    v_mfma_f32_16x16x32_bf16 v[100:103], v[32:35], a[228:231], v[100:103]
    v_mfma_f32_16x16x32_bf16 v[100:103], v[36:39], a[244:247], v[100:103]
    v_mfma_f32_16x16x32_bf16 v[104:107], v[32:35], a[232:235], v[104:107]
    ds_read_b64_tr_b16 v[28:29], v6 offset:57344
    ds_read_b64_tr_b16 v[30:31], v6 offset:57856
    v_mfma_f32_16x16x32_bf16 v[104:107], v[36:39], a[248:251], v[104:107]
    v_mfma_f32_16x16x32_bf16 v[108:111], v[32:35], a[236:239], v[108:111]
    v_mfma_f32_16x16x32_bf16 v[108:111], v[36:39], a[252:255], v[108:111]
    s_waitcnt lgkmcnt(4)
    v_mfma_f32_16x16x32_bf16 v[112:115], v[16:19], a[224:227], v[112:115]
    ds_read_b64_tr_b16 v[32:33], v6 offset:50176
    ds_read_b64_tr_b16 v[34:35], v6 offset:50688
    v_mfma_f32_16x16x32_bf16 v[112:115], v[20:23], a[240:243], v[112:115]
    v_mfma_f32_16x16x32_bf16 v[116:119], v[16:19], a[228:231], v[116:119]
    v_mfma_f32_16x16x32_bf16 v[116:119], v[20:23], a[244:247], v[116:119]
    v_mfma_f32_16x16x32_bf16 v[120:123], v[16:19], a[232:235], v[120:123]
    ds_read_b64_tr_b16 v[36:37], v6 offset:58368
    ds_read_b64_tr_b16 v[38:39], v6 offset:58880
    v_mfma_f32_16x16x32_bf16 v[120:123], v[20:23], a[248:251], v[120:123]
    v_mfma_f32_16x16x32_bf16 v[124:127], v[16:19], a[236:239], v[124:127]
    v_mfma_f32_16x16x32_bf16 v[124:127], v[20:23], a[252:255], v[124:127]
    v_add_u32 v4, 65536, v4
    s_waitcnt lgkmcnt(4)
    v_mfma_f32_16x16x32_bf16 v[128:131], v[24:27], a[224:227], v[128:131]
    ds_read_b64_tr_b16 v[16:17], v4 offset:0
    ds_read_b64_tr_b16 v[18:19], v4 offset:512
    v_mfma_f32_16x16x32_bf16 v[128:131], v[28:31], a[240:243], v[128:131]
    v_mfma_f32_16x16x32_bf16 v[132:135], v[24:27], a[228:231], v[132:135]
    v_mfma_f32_16x16x32_bf16 v[132:135], v[28:31], a[244:247], v[132:135]
    v_mfma_f32_16x16x32_bf16 v[136:139], v[24:27], a[232:235], v[136:139]
    ds_read_b64_tr_b16 v[20:21], v4 offset:8192
    ds_read_b64_tr_b16 v[22:23], v4 offset:8704
    v_mfma_f32_16x16x32_bf16 v[136:139], v[28:31], a[248:251], v[136:139]
    v_mfma_f32_16x16x32_bf16 v[140:143], v[24:27], a[236:239], v[140:143]
    v_mfma_f32_16x16x32_bf16 v[140:143], v[28:31], a[252:255], v[140:143]
    s_waitcnt lgkmcnt(4)
    v_mfma_f32_16x16x32_bf16 v[144:147], v[32:35], a[224:227], v[144:147]
    ds_read_b64_tr_b16 v[24:25], v4 offset:1024
    ds_read_b64_tr_b16 v[26:27], v4 offset:1536
    v_mfma_f32_16x16x32_bf16 v[144:147], v[36:39], a[240:243], v[144:147]
    v_mfma_f32_16x16x32_bf16 v[148:151], v[32:35], a[228:231], v[148:151]
    v_mfma_f32_16x16x32_bf16 v[148:151], v[36:39], a[244:247], v[148:151]
    v_mfma_f32_16x16x32_bf16 v[152:155], v[32:35], a[232:235], v[152:155]
    ds_read_b64_tr_b16 v[28:29], v4 offset:9216
    ds_read_b64_tr_b16 v[30:31], v4 offset:9728
    v_mfma_f32_16x16x32_bf16 v[152:155], v[36:39], a[248:251], v[152:155]
    v_mfma_f32_16x16x32_bf16 v[156:159], v[32:35], a[236:239], v[156:159]
    v_mfma_f32_16x16x32_bf16 v[156:159], v[36:39], a[252:255], v[156:159]
    v_add_u32 v5, 65536, v5
    s_waitcnt vmcnt(2) lgkmcnt(4)
    v_mfma_f32_16x16x32_bf16 v[64:67], v[16:19], v[224:227], v[64:67]
    ds_read_b64_tr_b16 v[32:33], v5 offset:0
    ds_read_b64_tr_b16 v[34:35], v5 offset:512
    v_mfma_f32_16x16x32_bf16 v[64:67], v[20:23], v[240:243], v[64:67]
    v_mfma_f32_16x16x32_bf16 v[68:71], v[16:19], v[228:231], v[68:71]
    v_mfma_f32_16x16x32_bf16 v[68:71], v[20:23], v[244:247], v[68:71]
    v_mfma_f32_16x16x32_bf16 v[72:75], v[16:19], v[232:235], v[72:75]
    ds_read_b64_tr_b16 v[36:37], v5 offset:8192
    ds_read_b64_tr_b16 v[38:39], v5 offset:8704
    v_mfma_f32_16x16x32_bf16 v[72:75], v[20:23], v[248:251], v[72:75]
    v_mfma_f32_16x16x32_bf16 v[76:79], v[16:19], v[236:239], v[76:79]
    v_mfma_f32_16x16x32_bf16 v[76:79], v[20:23], v[252:255], v[76:79]
    s_waitcnt lgkmcnt(4)
    v_mfma_f32_16x16x32_bf16 v[80:83], v[24:27], v[224:227], v[80:83]
    ds_read_b64_tr_b16 v[16:17], v5 offset:1024
    ds_read_b64_tr_b16 v[18:19], v5 offset:1536
    v_mfma_f32_16x16x32_bf16 v[80:83], v[28:31], v[240:243], v[80:83]
    v_mfma_f32_16x16x32_bf16 v[84:87], v[24:27], v[228:231], v[84:87]
    v_mfma_f32_16x16x32_bf16 v[84:87], v[28:31], v[244:247], v[84:87]
    v_mfma_f32_16x16x32_bf16 v[88:91], v[24:27], v[232:235], v[88:91]
    ds_read_b64_tr_b16 v[20:21], v5 offset:9216
    ds_read_b64_tr_b16 v[22:23], v5 offset:9728
    v_mfma_f32_16x16x32_bf16 v[88:91], v[28:31], v[248:251], v[88:91]
    v_mfma_f32_16x16x32_bf16 v[92:95], v[24:27], v[236:239], v[92:95]
    v_mfma_f32_16x16x32_bf16 v[92:95], v[28:31], v[252:255], v[92:95]
    v_add_u32 v6, 65536, v6
    s_waitcnt lgkmcnt(4)
    v_mfma_f32_16x16x32_bf16 v[96:99], v[32:35], v[224:227], v[96:99]
    ds_read_b64_tr_b16 v[24:25], v6 offset:0
    ds_read_b64_tr_b16 v[26:27], v6 offset:512
    v_mfma_f32_16x16x32_bf16 v[96:99], v[36:39], v[240:243], v[96:99]
    s_add_u32 m0, s50, 147456
    v_fma_f32 v10, -v64, v64, s58
    v_mfma_f32_16x16x32_bf16 v[100:103], v[32:35], v[228:231], v[100:103]
    buffer_load_dwordx4 v2, s[12:15], s32 offen  lds
    v_mfma_f32_16x16x32_bf16 v[100:103], v[36:39], v[244:247], v[100:103]
    buffer_load_dwordx4 v2, s[16:19], s32 offen offset:1024  lds
    v_mfma_f32_16x16x32_bf16 v[104:107], v[32:35], v[232:235], v[104:107]
    ds_read_b64_tr_b16 v[28:29], v6 offset:8192
    ds_read_b64_tr_b16 v[30:31], v6 offset:8704
    v_mfma_f32_16x16x32_bf16 v[104:107], v[36:39], v[248:251], v[104:107]
    v_fma_f32 v11, -v65, v65, s58
    v_mul_f32 v80, v80, v64
    v_mfma_f32_16x16x32_bf16 v[108:111], v[32:35], v[236:239], v[108:111]
    s_add_u32 m0, s50, 155648
    v_mul_f32 v81, v81, v65
    v_mfma_f32_16x16x32_bf16 v[108:111], v[36:39], v[252:255], v[108:111]
    v_mul_f32 v64, v10, v64
    s_waitcnt lgkmcnt(4)
    v_mfma_f32_16x16x32_bf16 v[112:115], v[16:19], v[224:227], v[112:115]
    ds_read_b64_tr_b16 v[32:33], v6 offset:1024
    ds_read_b64_tr_b16 v[34:35], v6 offset:1536
    v_mfma_f32_16x16x32_bf16 v[112:115], v[20:23], v[240:243], v[112:115]
    buffer_load_dwordx4 v2, s[12:15], s33 offen  lds
    v_mfma_f32_16x16x32_bf16 v[116:119], v[16:19], v[228:231], v[116:119]
    v_mul_f32 v65, v11, v65
    v_fma_f32 v12, -v66, v66, s58
    v_mfma_f32_16x16x32_bf16 v[116:119], v[20:23], v[244:247], v[116:119]
    buffer_load_dwordx4 v2, s[16:19], s33 offen offset:1024  lds
    v_mfma_f32_16x16x32_bf16 v[120:123], v[16:19], v[232:235], v[120:123]
    ds_read_b64_tr_b16 v[36:37], v6 offset:9216
    ds_read_b64_tr_b16 v[38:39], v6 offset:9728
    v_mfma_f32_16x16x32_bf16 v[120:123], v[20:23], v[248:251], v[120:123]
    s_add_u32 m0, s50, 0
    v_fma_f32 v13, -v67, v67, s58
    v_mfma_f32_16x16x32_bf16 v[124:127], v[16:19], v[236:239], v[124:127]
    v_exp_f32 v64, v64
    v_mfma_f32_16x16x32_bf16 v[124:127], v[20:23], v[252:255], v[124:127]
    v_mul_f32 v82, v82, v66
    s_waitcnt lgkmcnt(4)
    v_mfma_f32_16x16x32_bf16 v[128:131], v[24:27], v[224:227], v[128:131]
    ds_read_b64_tr_b16 v[16:17], v7 offset:49152
    ds_read_b64_tr_b16 v[18:19], v7 offset:49664
    v_mfma_f32_16x16x32_bf16 v[128:131], v[28:31], v[240:243], v[128:131]
    buffer_load_dwordx4 v2, s[12:15], s34 offen  lds
    v_mfma_f32_16x16x32_bf16 v[132:135], v[24:27], v[228:231], v[132:135]
    buffer_load_dwordx4 v2, s[16:19], s34 offen offset:1024  lds
    v_mfma_f32_16x16x32_bf16 v[132:135], v[28:31], v[244:247], v[132:135]
    v_exp_f32 v65, v65
    v_mfma_f32_16x16x32_bf16 v[136:139], v[24:27], v[232:235], v[136:139]
    ds_read_b64_tr_b16 v[20:21], v7 offset:57344
    ds_read_b64_tr_b16 v[22:23], v7 offset:57856
    v_mfma_f32_16x16x32_bf16 v[136:139], v[28:31], v[248:251], v[136:139]
    s_add_u32 m0, s50, 8192
    v_mul_f32 v83, v83, v67
    v_mfma_f32_16x16x32_bf16 v[140:143], v[24:27], v[236:239], v[140:143]
    buffer_load_dwordx4 v2, s[12:15], s35 offen  lds
    v_mfma_f32_16x16x32_bf16 v[140:143], v[28:31], v[252:255], v[140:143]
    v_mul_f32 v66, v12, v66
    s_waitcnt lgkmcnt(4)
    v_mfma_f32_16x16x32_bf16 v[144:147], v[32:35], v[224:227], v[144:147]
    ds_read_b64_tr_b16 v[24:25], v7 offset:50176
    ds_read_b64_tr_b16 v[26:27], v7 offset:50688
    v_mfma_f32_16x16x32_bf16 v[144:147], v[36:39], v[240:243], v[144:147]
    v_mul_f32 v67, v13, v67
    v_add_f32 v64, 1.0, v64
    v_mfma_f32_16x16x32_bf16 v[148:151], v[32:35], v[228:231], v[148:151]
    buffer_load_dwordx4 v2, s[16:19], s35 offen offset:1024  lds
    v_mfma_f32_16x16x32_bf16 v[148:151], v[36:39], v[244:247], v[148:151]
    s_add_u32 m0, s50, 16384
    v_add_f32 v65, 1.0, v65
    v_mfma_f32_16x16x32_bf16 v[152:155], v[32:35], v[232:235], v[152:155]
    ds_read_b64_tr_b16 v[28:29], v7 offset:58368
    ds_read_b64_tr_b16 v[30:31], v7 offset:58880
    v_mfma_f32_16x16x32_bf16 v[152:155], v[36:39], v[248:251], v[152:155]
    buffer_load_dwordx4 v2, s[12:15], s36 offen  lds
    v_mfma_f32_16x16x32_bf16 v[156:159], v[32:35], v[236:239], v[156:159]
    v_exp_f32 v66, v66
    v_mfma_f32_16x16x32_bf16 v[156:159], v[36:39], v[252:255], v[156:159]
    v_add_u32 v7, 65536, v7
    s_waitcnt lgkmcnt(4)
    v_mfma_f32_16x16x32_bf16 v[160:163], v[16:19], a[96:99], v[160:163]
    ds_read_b64_tr_b16 v[32:33], v7 offset:0
    ds_read_b64_tr_b16 v[34:35], v7 offset:512
    v_mfma_f32_16x16x32_bf16 v[160:163], v[20:23], a[112:115], v[160:163]
    buffer_load_dwordx4 v2, s[16:19], s36 offen offset:1024  lds
    v_mfma_f32_16x16x32_bf16 v[164:167], v[16:19], a[100:103], v[164:167]
    s_add_u32 m0, s50, 24576
    v_add_f32 v66, 1.0, v66
    v_mfma_f32_16x16x32_bf16 v[164:167], v[20:23], a[116:119], v[164:167]
    v_exp_f32 v67, v67
    v_mfma_f32_16x16x32_bf16 v[168:171], v[16:19], a[104:107], v[168:171]
    ds_read_b64_tr_b16 v[36:37], v7 offset:8192
    ds_read_b64_tr_b16 v[38:39], v7 offset:8704
    v_mfma_f32_16x16x32_bf16 v[168:171], v[20:23], a[120:123], v[168:171]
    buffer_load_dwordx4 v2, s[12:15], s37 offen  lds
    v_mfma_f32_16x16x32_bf16 v[172:175], v[16:19], a[108:111], v[172:175]
    buffer_load_dwordx4 v2, s[16:19], s37 offen offset:1024  lds
    v_mfma_f32_16x16x32_bf16 v[172:175], v[20:23], a[124:127], v[172:175]
    v_add_f32 v67, 1.0, v67
    s_waitcnt lgkmcnt(4)
    v_mfma_f32_16x16x32_bf16 v[176:179], v[24:27], a[96:99], v[176:179]
    ds_read_b64_tr_b16 v[16:17], v7 offset:1024
    ds_read_b64_tr_b16 v[18:19], v7 offset:1536
    v_mfma_f32_16x16x32_bf16 v[176:179], v[28:31], a[112:115], v[176:179]
    v_rcp_f32 v64, v64
    v_mfma_f32_16x16x32_bf16 v[180:183], v[24:27], a[100:103], v[180:183]
    s_add_u32 m0, s50, 32768
    v_mul_f32 v88, v88, v72
    v_mfma_f32_16x16x32_bf16 v[180:183], v[28:31], a[116:119], v[180:183]
    buffer_load_dwordx4 v2, s[12:15], s38 offen  lds
    v_mfma_f32_16x16x32_bf16 v[184:187], v[24:27], a[104:107], v[184:187]
    ds_read_b64_tr_b16 v[20:21], v7 offset:9216
    ds_read_b64_tr_b16 v[22:23], v7 offset:9728
    v_mfma_f32_16x16x32_bf16 v[184:187], v[28:31], a[120:123], v[184:187]
    v_rcp_f32 v65, v65
    v_mfma_f32_16x16x32_bf16 v[188:191], v[24:27], a[108:111], v[188:191]
    buffer_load_dwordx4 v2, s[16:19], s38 offen offset:1024  lds
    v_mfma_f32_16x16x32_bf16 v[188:191], v[28:31], a[124:127], v[188:191]
    v_mul_f32 v89, v89, v73
    s_waitcnt lgkmcnt(4)
    v_mfma_f32_16x16x32_bf16 v[160:163], v[32:35], a[128:131], v[160:163]
    ds_read_b64_tr_b16 v[24:25], v7 offset:16384
    ds_read_b64_tr_b16 v[26:27], v7 offset:16896
    v_mfma_f32_16x16x32_bf16 v[160:163], v[36:39], a[144:147], v[160:163]
    s_add_u32 m0, s50, 40960
    v_mul_f32 v90, v90, v74
    v_mfma_f32_16x16x32_bf16 v[164:167], v[32:35], a[132:135], v[164:167]
    v_rcp_f32 v66, v66
    v_rcp_f32 v67, v67
    v_pk_fma_f32 v[10:11], v[68:69], v[68:69], s[58:59] op_sel_hi:[1,1,0] neg_lo:[1,0,0] neg_hi:[1,0,0]
    v_pk_fma_f32 v[12:13], v[70:71], v[70:71], s[58:59] op_sel_hi:[1,1,0] neg_lo:[1,0,0] neg_hi:[1,0,0]
    v_pk_mul_f32 v[84:85], v[84:85], v[68:69]
    v_pk_mul_f32 v[86:87], v[86:87], v[70:71]
    v_pk_mul_f32 v[68:69], v[10:11], v[68:69]
    v_pk_mul_f32 v[70:71], v[12:13], v[70:71]
    v_pk_mul_f32 v[80:81], v[80:81], v[64:65]
    v_pk_mul_f32 v[82:83], v[82:83], v[66:67]
    v_mfma_f32_16x16x32_bf16 v[164:167], v[36:39], a[148:151], v[164:167]
    buffer_load_dwordx4 v2, s[12:15], s39 offen  lds
    v_mfma_f32_16x16x32_bf16 v[168:171], v[32:35], a[136:139], v[168:171]
    ds_read_b64_tr_b16 v[28:29], v7 offset:24576
    ds_read_b64_tr_b16 v[30:31], v7 offset:25088
    v_mfma_f32_16x16x32_bf16 v[168:171], v[36:39], a[152:155], v[168:171]
    buffer_load_dwordx4 v2, s[16:19], s39 offen offset:1024  lds
    v_mfma_f32_16x16x32_bf16 v[172:175], v[32:35], a[140:143], v[172:175]
    v_cvt_pk_bf16_f32 v40, v80, v81
    v_cvt_pk_bf16_f32 v41, v82, v83
    v_mfma_f32_16x16x32_bf16 v[172:175], v[36:39], a[156:159], v[172:175]
    v_fma_f32 v10, -v72, v72, s58
    s_waitcnt lgkmcnt(4)
    v_mfma_f32_16x16x32_bf16 v[176:179], v[16:19], a[128:131], v[176:179]
    ds_read_b64_tr_b16 v[32:33], v7 offset:17408
    ds_read_b64_tr_b16 v[34:35], v7 offset:17920
    v_mfma_f32_16x16x32_bf16 v[176:179], v[20:23], a[144:147], v[176:179]
    v_exp_f32 v68, v68
    v_mfma_f32_16x16x32_bf16 v[180:183], v[16:19], a[132:135], v[180:183]
    buffer_store_dwordx4 v[208:211], v194, s[8:11], 0 offen offset:0 sc1
    v_mfma_f32_16x16x32_bf16 v[180:183], v[20:23], a[148:151], v[180:183]
    v_exp_f32 v69, v69
    v_mfma_f32_16x16x32_bf16 v[184:187], v[16:19], a[136:139], v[184:187]
    ds_read_b64_tr_b16 v[36:37], v7 offset:25600
    ds_read_b64_tr_b16 v[38:39], v7 offset:26112
    v_mfma_f32_16x16x32_bf16 v[184:187], v[20:23], a[152:155], v[184:187]
    v_exp_f32 v70, v70
    v_mfma_f32_16x16x32_bf16 v[188:191], v[16:19], a[140:143], v[188:191]
    v_exp_f32 v71, v71
    v_mfma_f32_16x16x32_bf16 v[188:191], v[20:23], a[156:159], v[188:191]
    v_add_f32 v68, 1.0, v68
    s_waitcnt lgkmcnt(4)
    v_mfma_f32_16x16x32_bf16 v[160:163], v[24:27], a[160:163], v[160:163]
    ds_read_b64_tr_b16 v[16:17], v7 offset:32768
    ds_read_b64_tr_b16 v[18:19], v7 offset:33280
    v_mfma_f32_16x16x32_bf16 v[160:163], v[28:31], a[176:179], v[160:163]
    v_add_f32 v69, 1.0, v69
    v_add_f32 v70, 1.0, v70
    v_mfma_f32_16x16x32_bf16 v[164:167], v[24:27], a[164:167], v[164:167]
    v_rcp_f32 v68, v68
    v_mfma_f32_16x16x32_bf16 v[164:167], v[28:31], a[180:183], v[164:167]
    v_rcp_f32 v69, v69
    v_mfma_f32_16x16x32_bf16 v[168:171], v[24:27], a[168:171], v[168:171]
    ds_read_b64_tr_b16 v[20:21], v7 offset:40960
    ds_read_b64_tr_b16 v[22:23], v7 offset:41472
    v_mfma_f32_16x16x32_bf16 v[168:171], v[28:31], a[184:187], v[168:171]
    v_add_f32 v71, 1.0, v71
    v_mul_f32 v84, v84, v68
    v_mfma_f32_16x16x32_bf16 v[172:175], v[24:27], a[172:175], v[172:175]
    v_rcp_f32 v70, v70
    v_mfma_f32_16x16x32_bf16 v[172:175], v[28:31], a[188:191], v[172:175]
    v_mul_f32 v85, v85, v69
    s_waitcnt lgkmcnt(4)
    v_mfma_f32_16x16x32_bf16 v[176:179], v[32:35], a[160:163], v[176:179]
    ds_read_b64_tr_b16 v[24:25], v7 offset:33792
    ds_read_b64_tr_b16 v[26:27], v7 offset:34304
    v_mfma_f32_16x16x32_bf16 v[176:179], v[36:39], a[176:179], v[176:179]
    v_rcp_f32 v71, v71
    v_mfma_f32_16x16x32_bf16 v[180:183], v[32:35], a[164:167], v[180:183]
    buffer_store_dwordx4 v[212:215], v194, s[8:11], 0 offen offset:1024 sc1
    v_mfma_f32_16x16x32_bf16 v[180:183], v[36:39], a[180:183], v[180:183]
    v_mul_f32 v86, v86, v70
    v_mul_f32 v87, v87, v71
    v_mfma_f32_16x16x32_bf16 v[184:187], v[32:35], a[168:171], v[184:187]
    ds_read_b64_tr_b16 v[28:29], v7 offset:41984
    ds_read_b64_tr_b16 v[30:31], v7 offset:42496
    v_mfma_f32_16x16x32_bf16 v[184:187], v[36:39], a[184:187], v[184:187]
    v_cvt_pk_bf16_f32 v44, v84, v85
    v_cvt_pk_bf16_f32 v45, v86, v87
    v_mfma_f32_16x16x32_bf16 v[188:191], v[32:35], a[172:175], v[188:191]
    v_fma_f32 v11, -v73, v73, s58
    v_mul_f32 v72, v10, v72
    v_mfma_f32_16x16x32_bf16 v[188:191], v[36:39], a[188:191], v[188:191]
    v_mul_f32 v73, v11, v73
    s_waitcnt lgkmcnt(4)
    v_mfma_f32_16x16x32_bf16 v[160:163], v[16:19], a[192:195], v[160:163]
    ds_read_b64_tr_b16 v[32:33], v7 offset:49152
    ds_read_b64_tr_b16 v[34:35], v7 offset:49664
    v_mfma_f32_16x16x32_bf16 v[160:163], v[20:23], a[208:211], v[160:163]
    v_exp_f32 v72, v72
    v_mfma_f32_16x16x32_bf16 v[164:167], v[16:19], a[196:199], v[164:167]
    v_exp_f32 v73, v73
    v_mfma_f32_16x16x32_bf16 v[164:167], v[20:23], a[212:215], v[164:167]
    v_fma_f32 v12, -v74, v74, s58
    v_fma_f32 v13, -v75, v75, s58
    v_mfma_f32_16x16x32_bf16 v[168:171], v[16:19], a[200:203], v[168:171]
    ds_read_b64_tr_b16 v[36:37], v7 offset:57344
    ds_read_b64_tr_b16 v[38:39], v7 offset:57856
    v_mfma_f32_16x16x32_bf16 v[168:171], v[20:23], a[216:219], v[168:171]
    v_mul_f32 v91, v91, v75
    v_mul_f32 v74, v12, v74
    v_mfma_f32_16x16x32_bf16 v[172:175], v[16:19], a[204:207], v[172:175]
    v_mul_f32 v75, v13, v75
    v_add_f32 v72, 1.0, v72
    v_mfma_f32_16x16x32_bf16 v[172:175], v[20:23], a[220:223], v[172:175]
    v_add_f32 v73, 1.0, v73
    s_waitcnt lgkmcnt(4)
    v_mfma_f32_16x16x32_bf16 v[176:179], v[24:27], a[192:195], v[176:179]
    ds_read_b64_tr_b16 v[16:17], v7 offset:50176
    ds_read_b64_tr_b16 v[18:19], v7 offset:50688
    v_mfma_f32_16x16x32_bf16 v[176:179], v[28:31], a[208:211], v[176:179]
    v_exp_f32 v74, v74
    v_mfma_f32_16x16x32_bf16 v[180:183], v[24:27], a[196:199], v[180:183]
    buffer_store_dwordx4 v[216:219], v194, s[8:11], 0 offen offset:2048 sc1
    v_mfma_f32_16x16x32_bf16 v[180:183], v[28:31], a[212:215], v[180:183]
    v_exp_f32 v75, v75
    v_mfma_f32_16x16x32_bf16 v[184:187], v[24:27], a[200:203], v[184:187]
    ds_read_b64_tr_b16 v[20:21], v7 offset:58368
    ds_read_b64_tr_b16 v[22:23], v7 offset:58880
    v_mfma_f32_16x16x32_bf16 v[184:187], v[28:31], a[216:219], v[184:187]
    v_rcp_f32 v72, v72
    v_mfma_f32_16x16x32_bf16 v[188:191], v[24:27], a[204:207], v[188:191]
    v_rcp_f32 v73, v73
    v_mfma_f32_16x16x32_bf16 v[188:191], v[28:31], a[220:223], v[188:191]
    v_add_u32 v7, 65536, v7
    s_waitcnt lgkmcnt(4)
    v_mfma_f32_16x16x32_bf16 v[160:163], v[32:35], a[224:227], v[160:163]
    ds_read_b64_tr_b16 v[24:25], v7 offset:0
    ds_read_b64_tr_b16 v[26:27], v7 offset:512
    v_mfma_f32_16x16x32_bf16 v[160:163], v[36:39], a[240:243], v[160:163]
    v_add_f32 v74, 1.0, v74
    v_add_f32 v75, 1.0, v75
    v_mfma_f32_16x16x32_bf16 v[164:167], v[32:35], a[228:231], v[164:167]
    v_rcp_f32 v74, v74
    v_rcp_f32 v75, v75
    v_pk_fma_f32 v[10:11], v[76:77], v[76:77], s[58:59] op_sel_hi:[1,1,0] neg_lo:[1,0,0] neg_hi:[1,0,0]
    v_pk_fma_f32 v[12:13], v[78:79], v[78:79], s[58:59] op_sel_hi:[1,1,0] neg_lo:[1,0,0] neg_hi:[1,0,0]
    v_pk_mul_f32 v[92:93], v[92:93], v[76:77]
    v_pk_mul_f32 v[94:95], v[94:95], v[78:79]
    v_pk_mul_f32 v[76:77], v[10:11], v[76:77]
    v_pk_mul_f32 v[78:79], v[12:13], v[78:79]
    v_pk_mul_f32 v[88:89], v[88:89], v[72:73]
    v_pk_mul_f32 v[90:91], v[90:91], v[74:75]
    v_mfma_f32_16x16x32_bf16 v[164:167], v[36:39], a[244:247], v[164:167]
    v_cvt_pk_bf16_f32 v48, v88, v89
    v_cvt_pk_bf16_f32 v49, v90, v91
    v_mfma_f32_16x16x32_bf16 v[168:171], v[32:35], a[232:235], v[168:171]
    ds_read_b64_tr_b16 v[28:29], v7 offset:8192
    ds_read_b64_tr_b16 v[30:31], v7 offset:8704
    v_mfma_f32_16x16x32_bf16 v[168:171], v[36:39], a[248:251], v[168:171]
    v_exp_f32 v76, v76
    v_mfma_f32_16x16x32_bf16 v[172:175], v[32:35], a[236:239], v[172:175]
    v_exp_f32 v77, v77
    v_mfma_f32_16x16x32_bf16 v[172:175], v[36:39], a[252:255], v[172:175]
    v_add_f32 v76, 1.0, v76
    s_waitcnt lgkmcnt(4)
    v_mfma_f32_16x16x32_bf16 v[176:179], v[16:19], a[224:227], v[176:179]
    ds_read_b64_tr_b16 v[32:33], v7 offset:1024
    ds_read_b64_tr_b16 v[34:35], v7 offset:1536
    v_mfma_f32_16x16x32_bf16 v[176:179], v[20:23], a[240:243], v[176:179]
    v_exp_f32 v78, v78
    v_mfma_f32_16x16x32_bf16 v[180:183], v[16:19], a[228:231], v[180:183]
    buffer_store_dwordx4 v[220:223], v194, s[8:11], 0 offen offset:3072 sc1
    v_mfma_f32_16x16x32_bf16 v[180:183], v[20:23], a[244:247], v[180:183]
    v_exp_f32 v79, v79
    v_mfma_f32_16x16x32_bf16 v[184:187], v[16:19], a[232:235], v[184:187]
    ds_read_b64_tr_b16 v[36:37], v7 offset:9216
    ds_read_b64_tr_b16 v[38:39], v7 offset:9728
    v_mfma_f32_16x16x32_bf16 v[184:187], v[20:23], a[248:251], v[184:187]
    v_add_f32 v77, 1.0, v77
    v_add_f32 v78, 1.0, v78
    v_mfma_f32_16x16x32_bf16 v[188:191], v[16:19], a[236:239], v[188:191]
    v_rcp_f32 v76, v76
    v_mfma_f32_16x16x32_bf16 v[188:191], v[20:23], a[252:255], v[188:191]
    s_waitcnt vmcnt(8) lgkmcnt(4)
    s_barrier
    v_mfma_f32_16x16x32_bf16 v[160:163], v[24:27], v[224:227], v[160:163]
    ds_read_b64_tr_b16 v[16:17], v4 offset:16384
    ds_read_b64_tr_b16 v[18:19], v4 offset:16896
    v_mfma_f32_16x16x32_bf16 v[160:163], v[28:31], v[240:243], v[160:163]
    s_add_u32 m0, s50, 49152
    v_add_f32 v79, 1.0, v79
    v_mfma_f32_16x16x32_bf16 v[164:167], v[24:27], v[228:231], v[164:167]
    buffer_load_dwordx4 v2, s[12:15], s40 offen  lds
    v_mfma_f32_16x16x32_bf16 v[164:167], v[28:31], v[244:247], v[164:167]
    buffer_load_dwordx4 v2, s[16:19], s40 offen offset:1024  lds
    v_mfma_f32_16x16x32_bf16 v[168:171], v[24:27], v[232:235], v[168:171]
    ds_read_b64_tr_b16 v[20:21], v4 offset:24576
    ds_read_b64_tr_b16 v[22:23], v4 offset:25088
    v_mfma_f32_16x16x32_bf16 v[168:171], v[28:31], v[248:251], v[168:171]
    v_rcp_f32 v77, v77
    v_mfma_f32_16x16x32_bf16 v[172:175], v[24:27], v[236:239], v[172:175]
    s_add_u32 m0, s50, 57344
    v_mul_f32 v92, v92, v76
    v_mfma_f32_16x16x32_bf16 v[172:175], v[28:31], v[252:255], v[172:175]
    v_mul_f32 v93, v93, v77
    s_waitcnt lgkmcnt(4)
    v_mfma_f32_16x16x32_bf16 v[176:179], v[32:35], v[224:227], v[176:179]
    ds_read_b64_tr_b16 v[24:25], v4 offset:17408
    ds_read_b64_tr_b16 v[26:27], v4 offset:17920
    v_mfma_f32_16x16x32_bf16 v[176:179], v[36:39], v[240:243], v[176:179]
    buffer_load_dwordx4 v2, s[12:15], s41 offen  lds
    v_mfma_f32_16x16x32_bf16 v[180:183], v[32:35], v[228:231], v[180:183]
    buffer_load_dwordx4 v2, s[16:19], s41 offen offset:1024  lds
    v_mfma_f32_16x16x32_bf16 v[180:183], v[36:39], v[244:247], v[180:183]
    v_rcp_f32 v78, v78
    v_mfma_f32_16x16x32_bf16 v[184:187], v[32:35], v[232:235], v[184:187]
    ds_read_b64_tr_b16 v[28:29], v4 offset:25600
    ds_read_b64_tr_b16 v[30:31], v4 offset:26112
    v_mfma_f32_16x16x32_bf16 v[184:187], v[36:39], v[248:251], v[184:187]
    s_add_u32 m0, s50, 65536
    v_mul_f32 v94, v94, v78
    v_mfma_f32_16x16x32_bf16 v[188:191], v[32:35], v[236:239], v[188:191]
    buffer_load_dwordx4 v2, s[12:15], s42 offen  lds
    v_mfma_f32_16x16x32_bf16 v[188:191], v[36:39], v[252:255], v[188:191]
    v_add_u32 v4, 4294836224, v4
    s_waitcnt lgkmcnt(4)
    v_mfma_f32_16x16x32_bf16 v[192:195], v[16:19], a[0:3], 0
    ds_read_b64_tr_b16 v[32:33], v4 offset:0
    ds_read_b64_tr_b16 v[34:35], v4 offset:512
    v_mfma_f32_16x16x32_bf16 v[192:195], v[20:23], a[16:19], v[192:195]
    buffer_load_dwordx4 v2, s[16:19], s42 offen offset:1024  lds
    v_mfma_f32_16x16x32_bf16 v[196:199], v[16:19], a[4:7], 0
    v_rcp_f32 v79, v79
    v_mfma_f32_16x16x32_bf16 v[196:199], v[20:23], a[20:23], v[196:199]
    s_add_u32 m0, s50, 73728
    v_mul_f32 v95, v95, v79
    v_mfma_f32_16x16x32_bf16 v[200:203], v[16:19], a[8:11], 0
    ds_read_b64_tr_b16 v[36:37], v4 offset:8192
    ds_read_b64_tr_b16 v[38:39], v4 offset:8704
    v_mfma_f32_16x16x32_bf16 v[200:203], v[20:23], a[24:27], v[200:203]
    buffer_load_dwordx4 v2, s[12:15], s43 offen  lds
    v_mfma_f32_16x16x32_bf16 v[204:207], v[16:19], a[12:15], 0
    buffer_load_dwordx4 v2, s[16:19], s43 offen offset:1024  lds
    v_mfma_f32_16x16x32_bf16 v[204:207], v[20:23], a[28:31], v[204:207]
    v_cvt_pk_bf16_f32 v52, v92, v93
    s_waitcnt lgkmcnt(4)
    v_mfma_f32_16x16x32_bf16 v[208:211], v[24:27], a[0:3], 0
    ds_read_b64_tr_b16 v[16:17], v4 offset:1024
    ds_read_b64_tr_b16 v[18:19], v4 offset:1536
    v_mfma_f32_16x16x32_bf16 v[208:211], v[28:31], a[16:19], v[208:211]
    v_cvt_pk_bf16_f32 v53, v94, v95
    v_fma_f32 v10, -v96, v96, s58
    v_mfma_f32_16x16x32_bf16 v[212:215], v[24:27], a[4:7], 0
    s_add_u32 m0, s50, 81920
    v_fma_f32 v11, -v97, v97, s58
    v_mfma_f32_16x16x32_bf16 v[212:215], v[28:31], a[20:23], v[212:215]
    buffer_load_dwordx4 v2, s[12:15], s44 offen  lds
    v_mul_f32 v112, v112, v96
    v_mfma_f32_16x16x32_bf16 v[216:219], v[24:27], a[8:11], 0
    ds_read_b64_tr_b16 v[20:21], v4 offset:9216
    ds_read_b64_tr_b16 v[22:23], v4 offset:9728
    v_mfma_f32_16x16x32_bf16 v[216:219], v[28:31], a[24:27], v[216:219]
    buffer_load_dwordx4 v2, s[16:19], s44 offen offset:1024  lds
    v_mfma_f32_16x16x32_bf16 v[220:223], v[24:27], a[12:15], 0
    v_mul_f32 v113, v113, v97
    v_mul_f32 v96, v10, v96
    v_mfma_f32_16x16x32_bf16 v[220:223], v[28:31], a[28:31], v[220:223]
    v_mul_f32 v97, v11, v97
    s_waitcnt lgkmcnt(4)
    v_mfma_f32_16x16x32_bf16 v[192:195], v[32:35], a[32:35], v[192:195]
    ds_read_b64_tr_b16 v[24:25], v4 offset:16384
    ds_read_b64_tr_b16 v[26:27], v4 offset:16896
    v_fma_f32 v12, -v98, v98, s58
    v_mfma_f32_16x16x32_bf16 v[192:195], v[36:39], a[48:51], v[192:195]
    s_add_u32 m0, s50, 90112
    v_fma_f32 v13, -v99, v99, s58
    v_mfma_f32_16x16x32_bf16 v[196:199], v[32:35], a[36:39], v[196:199]
    buffer_load_dwordx4 v2, s[12:15], s45 offen  lds
    v_mfma_f32_16x16x32_bf16 v[196:199], v[36:39], a[52:55], v[196:199]
    buffer_load_dwordx4 v2, s[16:19], s45 offen offset:1024  lds
    v_mfma_f32_16x16x32_bf16 v[200:203], v[32:35], a[40:43], v[200:203]
    ds_read_b64_tr_b16 v[28:29], v4 offset:24576
    ds_read_b64_tr_b16 v[30:31], v4 offset:25088
    v_mfma_f32_16x16x32_bf16 v[200:203], v[36:39], a[56:59], v[200:203]
    v_exp_f32 v96, v96
Lpad3:
    s_cbranch_execz Lwd1_2
    v_mul_f32 v114, v114, v98
    v_mfma_f32_16x16x32_bf16 v[204:207], v[32:35], a[44:47], v[204:207]
    s_add_u32 m0, s50, 98304
    v_mul_f32 v115, v115, v99
    v_mfma_f32_16x16x32_bf16 v[204:207], v[36:39], a[60:63], v[204:207]
    v_mul_f32 v98, v12, v98
    s_waitcnt lgkmcnt(4)
    v_mfma_f32_16x16x32_bf16 v[208:211], v[16:19], a[32:35], v[208:211]
    ds_read_b64_tr_b16 v[32:33], v4 offset:17408
    ds_read_b64_tr_b16 v[34:35], v4 offset:17920
    v_mfma_f32_16x16x32_bf16 v[208:211], v[20:23], a[48:51], v[208:211]
    buffer_load_dwordx4 v2, s[12:15], s46 offen  lds
    v_mul_f32 v99, v13, v99
    v_mfma_f32_16x16x32_bf16 v[212:215], v[16:19], a[36:39], v[212:215]
    buffer_load_dwordx4 v2, s[16:19], s46 offen offset:1024  lds
    v_mfma_f32_16x16x32_bf16 v[212:215], v[20:23], a[52:55], v[212:215]
    v_exp_f32 v97, v97
    v_mfma_f32_16x16x32_bf16 v[216:219], v[16:19], a[40:43], v[216:219]
    ds_read_b64_tr_b16 v[36:37], v4 offset:25600
    ds_read_b64_tr_b16 v[38:39], v4 offset:26112
    v_mfma_f32_16x16x32_bf16 v[216:219], v[20:23], a[56:59], v[216:219]
    s_add_u32 m0, s50, 106496
    v_add_f32 v96, 1.0, v96
    v_mfma_f32_16x16x32_bf16 v[220:223], v[16:19], a[44:47], v[220:223]
    buffer_load_dwordx4 v2, s[12:15], s47 offen  lds
    v_add_f32 v97, 1.0, v97
    v_mfma_f32_16x16x32_bf16 v[220:223], v[20:23], a[60:63], v[220:223]
    s_waitcnt lgkmcnt(4)
    v_mfma_f32_16x16x32_bf16 v[192:195], v[24:27], a[64:67], v[192:195]
    ds_read_b64_tr_b16 v[16:17], v5 offset:16384
    ds_read_b64_tr_b16 v[18:19], v5 offset:16896
    v_mfma_f32_16x16x32_bf16 v[192:195], v[28:31], a[80:83], v[192:195]
    buffer_load_dwordx4 v2, s[16:19], s47 offen offset:1024  lds
    v_mfma_f32_16x16x32_bf16 v[196:199], v[24:27], a[68:71], v[196:199]
    v_exp_f32 v98, v98
    v_mfma_f32_16x16x32_bf16 v[196:199], v[28:31], a[84:87], v[196:199]
    s_add_u32 m0, s50, 114688
    v_exp_f32 v99, v99
    v_mfma_f32_16x16x32_bf16 v[200:203], v[24:27], a[72:75], v[200:203]
    ds_read_b64_tr_b16 v[20:21], v5 offset:24576
    ds_read_b64_tr_b16 v[22:23], v5 offset:25088
    v_mfma_f32_16x16x32_bf16 v[200:203], v[28:31], a[88:91], v[200:203]
    buffer_load_dwordx4 v2, s[12:15], s48 offen  lds
    v_mfma_f32_16x16x32_bf16 v[204:207], v[24:27], a[76:79], v[204:207]
    buffer_load_dwordx4 v2, s[16:19], s48 offen offset:1024  lds
    v_mfma_f32_16x16x32_bf16 v[204:207], v[28:31], a[92:95], v[204:207]
    v_rcp_f32 v96, v96
    s_waitcnt lgkmcnt(4)
    v_mfma_f32_16x16x32_bf16 v[208:211], v[32:35], a[64:67], v[208:211]
    ds_read_b64_tr_b16 v[24:25], v5 offset:17408
    ds_read_b64_tr_b16 v[26:27], v5 offset:17920
    v_mfma_f32_16x16x32_bf16 v[208:211], v[36:39], a[80:83], v[208:211]
    v_rcp_f32 v97, v97
    v_mfma_f32_16x16x32_bf16 v[212:215], v[32:35], a[68:71], v[212:215]
    s_add_u32 m0, s50, 122880
    v_add_f32 v98, 1.0, v98
    v_mfma_f32_16x16x32_bf16 v[212:215], v[36:39], a[84:87], v[212:215]
    buffer_load_dwordx4 v2, s[12:15], s49 offen  lds
    v_mfma_f32_16x16x32_bf16 v[216:219], v[32:35], a[72:75], v[216:219]
    ds_read_b64_tr_b16 v[28:29], v5 offset:25600
    ds_read_b64_tr_b16 v[30:31], v5 offset:26112
    v_add_f32 v99, 1.0, v99
    v_mfma_f32_16x16x32_bf16 v[216:219], v[36:39], a[88:91], v[216:219]
    buffer_load_dwordx4 v2, s[16:19], s49 offen offset:1024  lds
    v_mfma_f32_16x16x32_bf16 v[220:223], v[32:35], a[76:79], v[220:223]
    v_rcp_f32 v98, v98
    v_rcp_f32 v99, v99
    v_pk_fma_f32 v[10:11], v[100:101], v[100:101], s[58:59] op_sel_hi:[1,1,0] neg_lo:[1,0,0] neg_hi:[1,0,0]
    v_pk_fma_f32 v[12:13], v[102:103], v[102:103], s[58:59] op_sel_hi:[1,1,0] neg_lo:[1,0,0] neg_hi:[1,0,0]
    v_pk_mul_f32 v[116:117], v[116:117], v[100:101]
    v_pk_mul_f32 v[118:119], v[118:119], v[102:103]
    v_pk_mul_f32 v[100:101], v[10:11], v[100:101]
    v_pk_mul_f32 v[102:103], v[12:13], v[102:103]
    v_pk_mul_f32 v[112:113], v[112:113], v[96:97]
    v_pk_mul_f32 v[114:115], v[114:115], v[98:99]
    v_mfma_f32_16x16x32_bf16 v[220:223], v[36:39], a[92:95], v[220:223]
    v_add_u32 v5, 4294836224, v5
    s_waitcnt lgkmcnt(4)
    v_mfma_f32_16x16x32_bf16 v[64:67], v[16:19], a[0:3], 0
    ds_read_b64_tr_b16 v[32:33], v5 offset:0
    ds_read_b64_tr_b16 v[34:35], v5 offset:512
    v_cvt_pk_bf16_f32 v42, v112, v113
    v_mfma_f32_16x16x32_bf16 v[64:67], v[20:23], a[16:19], v[64:67]
    v_cvt_pk_bf16_f32 v43, v114, v115
    v_mfma_f32_16x16x32_bf16 v[68:71], v[16:19], a[4:7], 0
    v_exp_f32 v100, v100
    v_mfma_f32_16x16x32_bf16 v[68:71], v[20:23], a[20:23], v[68:71]
    v_exp_f32 v101, v101
    v_mfma_f32_16x16x32_bf16 v[72:75], v[16:19], a[8:11], 0
    ds_read_b64_tr_b16 v[36:37], v5 offset:8192
    ds_read_b64_tr_b16 v[38:39], v5 offset:8704
    v_mfma_f32_16x16x32_bf16 v[72:75], v[20:23], a[24:27], v[72:75]
    v_exp_f32 v102, v102
    v_add_f32 v100, 1.0, v100
    v_mfma_f32_16x16x32_bf16 v[76:79], v[16:19], a[12:15], 0
    v_exp_f32 v103, v103
    v_mfma_f32_16x16x32_bf16 v[76:79], v[20:23], a[28:31], v[76:79]
    v_add_f32 v101, 1.0, v101
    s_waitcnt lgkmcnt(4)
    v_mfma_f32_16x16x32_bf16 v[80:83], v[24:27], a[0:3], 0
    ds_read_b64_tr_b16 v[16:17], v5 offset:1024
    ds_read_b64_tr_b16 v[18:19], v5 offset:1536
    v_mfma_f32_16x16x32_bf16 v[80:83], v[28:31], a[16:19], v[80:83]
    v_rcp_f32 v100, v100
    v_add_f32 v102, 1.0, v102
    v_mfma_f32_16x16x32_bf16 v[84:87], v[24:27], a[4:7], 0
    v_rcp_f32 v101, v101
    v_mfma_f32_16x16x32_bf16 v[84:87], v[28:31], a[20:23], v[84:87]
    v_add_f32 v103, 1.0, v103
    v_mfma_f32_16x16x32_bf16 v[88:91], v[24:27], a[8:11], 0
    ds_read_b64_tr_b16 v[20:21], v5 offset:9216
    ds_read_b64_tr_b16 v[22:23], v5 offset:9728
    v_mfma_f32_16x16x32_bf16 v[88:91], v[28:31], a[24:27], v[88:91]
    v_rcp_f32 v102, v102
    v_rcp_f32 v103, v103
    v_pk_fma_f32 v[10:11], v[104:105], v[104:105], s[58:59] op_sel_hi:[1,1,0] neg_lo:[1,0,0] neg_hi:[1,0,0]
    v_pk_fma_f32 v[12:13], v[106:107], v[106:107], s[58:59] op_sel_hi:[1,1,0] neg_lo:[1,0,0] neg_hi:[1,0,0]
    v_pk_mul_f32 v[120:121], v[120:121], v[104:105]
    v_pk_mul_f32 v[122:123], v[122:123], v[106:107]
    v_pk_mul_f32 v[104:105], v[10:11], v[104:105]
    v_pk_mul_f32 v[106:107], v[12:13], v[106:107]
    v_pk_mul_f32 v[116:117], v[116:117], v[100:101]
    v_pk_mul_f32 v[118:119], v[118:119], v[102:103]
    v_mfma_f32_16x16x32_bf16 v[92:95], v[24:27], a[12:15], 0
    buffer_store_dwordx4 v[40:43], v1, s[8:11], s53 offen offset:0 sc1
    v_mfma_f32_16x16x32_bf16 v[92:95], v[28:31], a[28:31], v[92:95]
    v_cvt_pk_bf16_f32 v46, v116, v117
    s_waitcnt lgkmcnt(4)
    v_mfma_f32_16x16x32_bf16 v[64:67], v[32:35], a[32:35], v[64:67]
    ds_read_b64_tr_b16 v[24:25], v5 offset:16384
    ds_read_b64_tr_b16 v[26:27], v5 offset:16896
    v_cvt_pk_bf16_f32 v47, v118, v119
    v_mfma_f32_16x16x32_bf16 v[64:67], v[36:39], a[48:51], v[64:67]
    v_exp_f32 v104, v104
    v_mfma_f32_16x16x32_bf16 v[68:71], v[32:35], a[36:39], v[68:71]
    v_exp_f32 v105, v105
    v_mfma_f32_16x16x32_bf16 v[68:71], v[36:39], a[52:55], v[68:71]
    v_exp_f32 v106, v106
    v_add_f32 v104, 1.0, v104
    v_mfma_f32_16x16x32_bf16 v[72:75], v[32:35], a[40:43], v[72:75]
    ds_read_b64_tr_b16 v[28:29], v5 offset:24576
    ds_read_b64_tr_b16 v[30:31], v5 offset:25088
    v_mfma_f32_16x16x32_bf16 v[72:75], v[36:39], a[56:59], v[72:75]
    v_exp_f32 v107, v107
    v_mfma_f32_16x16x32_bf16 v[76:79], v[32:35], a[44:47], v[76:79]
    v_add_f32 v105, 1.0, v105
    v_add_f32 v106, 1.0, v106
    v_mfma_f32_16x16x32_bf16 v[76:79], v[36:39], a[60:63], v[76:79]
    v_rcp_f32 v104, v104
    s_waitcnt lgkmcnt(4)
    v_mfma_f32_16x16x32_bf16 v[80:83], v[16:19], a[32:35], v[80:83]
    ds_read_b64_tr_b16 v[32:33], v5 offset:17408
    ds_read_b64_tr_b16 v[34:35], v5 offset:17920
    v_mfma_f32_16x16x32_bf16 v[80:83], v[20:23], a[48:51], v[80:83]
    v_rcp_f32 v105, v105
    v_mfma_f32_16x16x32_bf16 v[84:87], v[16:19], a[36:39], v[84:87]
    buffer_store_dwordx4 v[44:47], v1, s[8:11], s53 offen offset:1024 sc1
    v_add_f32 v107, 1.0, v107
    v_mfma_f32_16x16x32_bf16 v[84:87], v[20:23], a[52:55], v[84:87]
    v_rcp_f32 v106, v106
    v_rcp_f32 v107, v107
    v_pk_fma_f32 v[10:11], v[108:109], v[108:109], s[58:59] op_sel_hi:[1,1,0] neg_lo:[1,0,0] neg_hi:[1,0,0]
    v_pk_fma_f32 v[12:13], v[110:111], v[110:111], s[58:59] op_sel_hi:[1,1,0] neg_lo:[1,0,0] neg_hi:[1,0,0]
    v_pk_mul_f32 v[124:125], v[124:125], v[108:109]
    v_pk_mul_f32 v[126:127], v[126:127], v[110:111]
    v_pk_mul_f32 v[108:109], v[10:11], v[108:109]
    v_pk_mul_f32 v[110:111], v[12:13], v[110:111]
    v_pk_mul_f32 v[120:121], v[120:121], v[104:105]
    v_pk_mul_f32 v[122:123], v[122:123], v[106:107]
    v_mfma_f32_16x16x32_bf16 v[88:91], v[16:19], a[40:43], v[88:91]
    ds_read_b64_tr_b16 v[36:37], v5 offset:25600
    ds_read_b64_tr_b16 v[38:39], v5 offset:26112
    v_mfma_f32_16x16x32_bf16 v[88:91], v[20:23], a[56:59], v[88:91]
    v_cvt_pk_bf16_f32 v50, v120, v121
    v_cvt_pk_bf16_f32 v51, v122, v123
    v_mfma_f32_16x16x32_bf16 v[92:95], v[16:19], a[44:47], v[92:95]
    v_exp_f32 v108, v108
    v_mfma_f32_16x16x32_bf16 v[92:95], v[20:23], a[60:63], v[92:95]
    v_exp_f32 v109, v109
    s_waitcnt lgkmcnt(4)
    v_mfma_f32_16x16x32_bf16 v[64:67], v[24:27], a[64:67], v[64:67]
    ds_read_b64_tr_b16 v[16:17], v6 offset:16384
    ds_read_b64_tr_b16 v[18:19], v6 offset:16896
    v_add_f32 v108, 1.0, v108
    v_mfma_f32_16x16x32_bf16 v[64:67], v[28:31], a[80:83], v[64:67]
    v_exp_f32 v110, v110
    v_mfma_f32_16x16x32_bf16 v[68:71], v[24:27], a[68:71], v[68:71]
    v_exp_f32 v111, v111
    v_mfma_f32_16x16x32_bf16 v[68:71], v[28:31], a[84:87], v[68:71]
    v_add_f32 v109, 1.0, v109
    v_add_f32 v110, 1.0, v110
    v_mfma_f32_16x16x32_bf16 v[72:75], v[24:27], a[72:75], v[72:75]
    ds_read_b64_tr_b16 v[20:21], v6 offset:24576
    ds_read_b64_tr_b16 v[22:23], v6 offset:25088
    v_add_f32 v111, 1.0, v111
    v_mfma_f32_16x16x32_bf16 v[72:75], v[28:31], a[88:91], v[72:75]
    v_rcp_f32 v108, v108
    v_mfma_f32_16x16x32_bf16 v[76:79], v[24:27], a[76:79], v[76:79]
    buffer_store_dwordx4 v[48:51], v1, s[8:11], s53 offen offset:2048 sc1
    v_mfma_f32_16x16x32_bf16 v[76:79], v[28:31], a[92:95], v[76:79]
    v_rcp_f32 v109, v109
    s_waitcnt lgkmcnt(4)
    v_mfma_f32_16x16x32_bf16 v[80:83], v[32:35], a[64:67], v[80:83]
    ds_read_b64_tr_b16 v[24:25], v6 offset:17408
    ds_read_b64_tr_b16 v[26:27], v6 offset:17920
    v_mfma_f32_16x16x32_bf16 v[80:83], v[36:39], a[80:83], v[80:83]
    v_rcp_f32 v110, v110
    v_mfma_f32_16x16x32_bf16 v[84:87], v[32:35], a[68:71], v[84:87]
    v_rcp_f32 v111, v111
    v_mul_f32 v124, v124, v108
    v_mfma_f32_16x16x32_bf16 v[84:87], v[36:39], a[84:87], v[84:87]
    v_mul_f32 v125, v125, v109
    v_mul_f32 v126, v126, v110
    v_mfma_f32_16x16x32_bf16 v[88:91], v[32:35], a[72:75], v[88:91]
    ds_read_b64_tr_b16 v[28:29], v6 offset:25600
    ds_read_b64_tr_b16 v[30:31], v6 offset:26112
    v_mfma_f32_16x16x32_bf16 v[88:91], v[36:39], a[88:91], v[88:91]
    v_mul_f32 v127, v127, v111
    v_cvt_pk_bf16_f32 v54, v124, v125
    v_mfma_f32_16x16x32_bf16 v[92:95], v[32:35], a[76:79], v[92:95]
    v_cvt_pk_bf16_f32 v55, v126, v127
    buffer_store_dwordx4 v[52:55], v1, s[8:11], s53 offen offset:3072 sc1
    v_mfma_f32_16x16x32_bf16 v[92:95], v[36:39], a[92:95], v[92:95]
    v_add_u32 v6, 4294836224, v6
    s_waitcnt lgkmcnt(4)
    v_mfma_f32_16x16x32_bf16 v[96:99], v[16:19], a[0:3], 0
    ds_read_b64_tr_b16 v[32:33], v6 offset:0
    ds_read_b64_tr_b16 v[34:35], v6 offset:512
    v_mfma_f32_16x16x32_bf16 v[96:99], v[20:23], a[16:19], v[96:99]
    v_fma_f32 v10, -v128, v128, s58
    v_fma_f32 v11, -v129, v129, s58
    v_mfma_f32_16x16x32_bf16 v[100:103], v[16:19], a[4:7], 0
    v_mul_f32 v144, v144, v128
    v_mul_f32 v145, v145, v129
    v_mfma_f32_16x16x32_bf16 v[100:103], v[20:23], a[20:23], v[100:103]
    v_mul_f32 v128, v10, v128
    v_mul_f32 v129, v11, v129
    v_mfma_f32_16x16x32_bf16 v[104:107], v[16:19], a[8:11], 0
    ds_read_b64_tr_b16 v[36:37], v6 offset:8192
    ds_read_b64_tr_b16 v[38:39], v6 offset:8704
    v_mfma_f32_16x16x32_bf16 v[104:107], v[20:23], a[24:27], v[104:107]
    buffer_load_dword v63, v59, s[20:23], 0 offen offset:0
    v_mfma_f32_16x16x32_bf16 v[108:111], v[16:19], a[12:15], 0
    v_exp_f32 v128, v128
    v_mfma_f32_16x16x32_bf16 v[108:111], v[20:23], a[28:31], v[108:111]
    s_waitcnt vmcnt(25) lgkmcnt(4)
    v_mfma_f32_16x16x32_bf16 v[112:115], v[24:27], a[0:3], 0
    ds_read_b64_tr_b16 v[16:17], v6 offset:1024
    ds_read_b64_tr_b16 v[18:19], v6 offset:1536
    v_mfma_f32_16x16x32_bf16 v[112:115], v[28:31], a[16:19], v[112:115]
    buffer_store_dword v15, v60, s[8:11], 0 offen offset:12 sc1
    v_mfma_f32_16x16x32_bf16 v[116:119], v[24:27], a[4:7], 0
    v_exp_f32 v129, v129
    v_mfma_f32_16x16x32_bf16 v[116:119], v[28:31], a[20:23], v[116:119]
    v_fma_f32 v12, -v130, v130, s58
    v_fma_f32 v13, -v131, v131, s58
    v_mfma_f32_16x16x32_bf16 v[120:123], v[24:27], a[8:11], 0
    ds_read_b64_tr_b16 v[20:21], v6 offset:9216
    ds_read_b64_tr_b16 v[22:23], v6 offset:9728
    v_mfma_f32_16x16x32_bf16 v[120:123], v[28:31], a[24:27], v[120:123]
    buffer_load_dword v63, v58, s[24:27], s79 offen offset:0
    v_mfma_f32_16x16x32_bf16 v[124:127], v[24:27], a[12:15], 0
    v_mul_f32 v146, v146, v130
    v_mul_f32 v147, v147, v131
    v_mfma_f32_16x16x32_bf16 v[124:127], v[28:31], a[28:31], v[124:127]
    v_mul_f32 v130, v12, v130
    s_waitcnt lgkmcnt(4)
    v_mfma_f32_16x16x32_bf16 v[96:99], v[32:35], a[32:35], v[96:99]
    ds_read_b64_tr_b16 v[24:25], v6 offset:16384
    ds_read_b64_tr_b16 v[26:27], v6 offset:16896
    v_mfma_f32_16x16x32_bf16 v[96:99], v[36:39], a[48:51], v[96:99]
    v_mul_f32 v131, v13, v131
    v_add_f32 v128, 1.0, v128
    v_mfma_f32_16x16x32_bf16 v[100:103], v[32:35], a[36:39], v[100:103]
    v_exp_f32 v130, v130
    v_mfma_f32_16x16x32_bf16 v[100:103], v[36:39], a[52:55], v[100:103]
    v_exp_f32 v131, v131
    v_mfma_f32_16x16x32_bf16 v[104:107], v[32:35], a[40:43], v[104:107]
    ds_read_b64_tr_b16 v[28:29], v6 offset:24576
    ds_read_b64_tr_b16 v[30:31], v6 offset:25088
    v_mfma_f32_16x16x32_bf16 v[104:107], v[36:39], a[56:59], v[104:107]
    v_add_f32 v129, 1.0, v129
    v_add_f32 v130, 1.0, v130
    v_mfma_f32_16x16x32_bf16 v[108:111], v[32:35], a[44:47], v[108:111]
    v_rcp_f32 v128, v128
    v_mfma_f32_16x16x32_bf16 v[108:111], v[36:39], a[60:63], v[108:111]
    v_add_f32 v131, 1.0, v131
    s_waitcnt lgkmcnt(4)
    v_mfma_f32_16x16x32_bf16 v[112:115], v[16:19], a[32:35], v[112:115]
    ds_read_b64_tr_b16 v[32:33], v6 offset:17408
    ds_read_b64_tr_b16 v[34:35], v6 offset:17920
    v_mfma_f32_16x16x32_bf16 v[112:115], v[20:23], a[48:51], v[112:115]
    v_rcp_f32 v129, v129
    v_mfma_f32_16x16x32_bf16 v[116:119], v[16:19], a[36:39], v[116:119]
    v_rcp_f32 v130, v130
    v_mfma_f32_16x16x32_bf16 v[116:119], v[20:23], a[52:55], v[116:119]
    v_rcp_f32 v131, v131
    v_mfma_f32_16x16x32_bf16 v[120:123], v[16:19], a[40:43], v[120:123]
    ds_read_b64_tr_b16 v[36:37], v6 offset:25600
    ds_read_b64_tr_b16 v[38:39], v6 offset:26112
    v_mfma_f32_16x16x32_bf16 v[120:123], v[20:23], a[56:59], v[120:123]
    v_mul_f32 v144, v144, v128
    v_mul_f32 v145, v145, v129
    v_mfma_f32_16x16x32_bf16 v[124:127], v[16:19], a[44:47], v[124:127]
    v_mul_f32 v146, v146, v130
    v_mul_f32 v147, v147, v131
    v_mfma_f32_16x16x32_bf16 v[124:127], v[20:23], a[60:63], v[124:127]
    s_waitcnt vmcnt(7) lgkmcnt(4)
    s_barrier
    v_mfma_f32_16x16x32_bf16 v[96:99], v[24:27], a[64:67], v[96:99]
    ds_read_b64_tr_b16 v[16:17], v4 offset:32768
    ds_read_b64_tr_b16 v[18:19], v4 offset:33280
    v_mfma_f32_16x16x32_bf16 v[96:99], v[28:31], a[80:83], v[96:99]
    v_cvt_pk_bf16_f32 v40, v144, v145
    v_cvt_pk_bf16_f32 v41, v146, v147
    v_mfma_f32_16x16x32_bf16 v[100:103], v[24:27], a[68:71], v[100:103]
    v_fma_f32 v10, -v132, v132, s58
    v_fma_f32 v11, -v133, v133, s58
    v_mfma_f32_16x16x32_bf16 v[100:103], v[28:31], a[84:87], v[100:103]
    v_mul_f32 v148, v148, v132
    v_mul_f32 v149, v149, v133
    v_mfma_f32_16x16x32_bf16 v[104:107], v[24:27], a[72:75], v[104:107]
    ds_read_b64_tr_b16 v[20:21], v4 offset:40960
    ds_read_b64_tr_b16 v[22:23], v4 offset:41472
    v_mfma_f32_16x16x32_bf16 v[104:107], v[28:31], a[88:91], v[104:107]
    v_mul_f32 v132, v10, v132
    v_mul_f32 v133, v11, v133
    v_mfma_f32_16x16x32_bf16 v[108:111], v[24:27], a[76:79], v[108:111]
    v_exp_f32 v132, v132
    v_mfma_f32_16x16x32_bf16 v[108:111], v[28:31], a[92:95], v[108:111]
    v_fma_f32 v12, -v134, v134, s58
    s_waitcnt lgkmcnt(4)
    v_mfma_f32_16x16x32_bf16 v[112:115], v[32:35], a[64:67], v[112:115]
    ds_read_b64_tr_b16 v[24:25], v4 offset:33792
    ds_read_b64_tr_b16 v[26:27], v4 offset:34304
    v_mfma_f32_16x16x32_bf16 v[112:115], v[36:39], a[80:83], v[112:115]
    v_exp_f32 v133, v133
    v_mfma_f32_16x16x32_bf16 v[116:119], v[32:35], a[68:71], v[116:119]
    v_fma_f32 v13, -v135, v135, s58
    v_mul_f32 v150, v150, v134
    v_mfma_f32_16x16x32_bf16 v[116:119], v[36:39], a[84:87], v[116:119]
    v_mul_f32 v151, v151, v135
    v_mul_f32 v134, v12, v134
    v_mfma_f32_16x16x32_bf16 v[120:123], v[32:35], a[72:75], v[120:123]
    ds_read_b64_tr_b16 v[28:29], v4 offset:41984
    ds_read_b64_tr_b16 v[30:31], v4 offset:42496
    v_mfma_f32_16x16x32_bf16 v[120:123], v[36:39], a[88:91], v[120:123]
    v_mul_f32 v135, v13, v135
    v_add_f32 v132, 1.0, v132
    v_mfma_f32_16x16x32_bf16 v[124:127], v[32:35], a[76:79], v[124:127]
    v_exp_f32 v134, v134
    v_mfma_f32_16x16x32_bf16 v[124:127], v[36:39], a[92:95], v[124:127]
    v_add_f32 v133, 1.0, v133
    s_waitcnt lgkmcnt(4)
    v_mfma_f32_16x16x32_bf16 v[192:195], v[16:19], a[96:99], v[192:195]
    ds_read_b64_tr_b16 v[32:33], v4 offset:49152
    ds_read_b64_tr_b16 v[34:35], v4 offset:49664
    v_mfma_f32_16x16x32_bf16 v[192:195], v[20:23], a[112:115], v[192:195]
    v_exp_f32 v135, v135
    v_mfma_f32_16x16x32_bf16 v[196:199], v[16:19], a[100:103], v[196:199]
    v_rcp_f32 v132, v132
    v_mfma_f32_16x16x32_bf16 v[196:199], v[20:23], a[116:119], v[196:199]
    v_rcp_f32 v133, v133
    v_mfma_f32_16x16x32_bf16 v[200:203], v[16:19], a[104:107], v[200:203]
    ds_read_b64_tr_b16 v[36:37], v4 offset:57344
    ds_read_b64_tr_b16 v[38:39], v4 offset:57856
    v_mfma_f32_16x16x32_bf16 v[200:203], v[20:23], a[120:123], v[200:203]
    v_add_f32 v134, 1.0, v134
    v_add_f32 v135, 1.0, v135
    v_mfma_f32_16x16x32_bf16 v[204:207], v[16:19], a[108:111], v[204:207]
    v_rcp_f32 v134, v134
    v_rcp_f32 v135, v135
    v_pk_fma_f32 v[10:11], v[136:137], v[136:137], s[58:59] op_sel_hi:[1,1,0] neg_lo:[1,0,0] neg_hi:[1,0,0]
    v_pk_fma_f32 v[12:13], v[138:139], v[138:139], s[58:59] op_sel_hi:[1,1,0] neg_lo:[1,0,0] neg_hi:[1,0,0]
    v_pk_mul_f32 v[152:153], v[152:153], v[136:137]
    v_pk_mul_f32 v[154:155], v[154:155], v[138:139]
    v_pk_mul_f32 v[136:137], v[10:11], v[136:137]
    v_pk_mul_f32 v[138:139], v[12:13], v[138:139]
    v_pk_mul_f32 v[148:149], v[148:149], v[132:133]
    v_pk_mul_f32 v[150:151], v[150:151], v[134:135]
    v_mfma_f32_16x16x32_bf16 v[204:207], v[20:23], a[124:127], v[204:207]
    v_cvt_pk_bf16_f32 v44, v148, v149
    s_waitcnt lgkmcnt(4)
    v_mfma_f32_16x16x32_bf16 v[208:211], v[24:27], a[96:99], v[208:211]
    ds_read_b64_tr_b16 v[16:17], v4 offset:50176
    ds_read_b64_tr_b16 v[18:19], v4 offset:50688
    v_mfma_f32_16x16x32_bf16 v[208:211], v[28:31], a[112:115], v[208:211]
    v_cvt_pk_bf16_f32 v45, v150, v151
    v_fma_f32 v10, -v140, v140, s58
    v_mfma_f32_16x16x32_bf16 v[212:215], v[24:27], a[100:103], v[212:215]
    v_exp_f32 v136, v136
    v_mfma_f32_16x16x32_bf16 v[212:215], v[28:31], a[116:119], v[212:215]
    v_exp_f32 v137, v137
    v_mfma_f32_16x16x32_bf16 v[216:219], v[24:27], a[104:107], v[216:219]
    ds_read_b64_tr_b16 v[20:21], v4 offset:58368
    ds_read_b64_tr_b16 v[22:23], v4 offset:58880
    v_mfma_f32_16x16x32_bf16 v[216:219], v[28:31], a[120:123], v[216:219]
    v_exp_f32 v138, v138
    v_mfma_f32_16x16x32_bf16 v[220:223], v[24:27], a[108:111], v[220:223]
    v_exp_f32 v139, v139
    v_mfma_f32_16x16x32_bf16 v[220:223], v[28:31], a[124:127], v[220:223]
    v_add_u32 v4, 65536, v4
    s_waitcnt lgkmcnt(4)
    v_mfma_f32_16x16x32_bf16 v[192:195], v[32:35], a[128:131], v[192:195]
    ds_read_b64_tr_b16 v[24:25], v4 offset:0
    ds_read_b64_tr_b16 v[26:27], v4 offset:512
    v_mfma_f32_16x16x32_bf16 v[192:195], v[36:39], a[144:147], v[192:195]
    v_add_f32 v136, 1.0, v136
    v_add_f32 v137, 1.0, v137
    v_mfma_f32_16x16x32_bf16 v[196:199], v[32:35], a[132:135], v[196:199]
    v_rcp_f32 v136, v136
    v_mfma_f32_16x16x32_bf16 v[196:199], v[36:39], a[148:151], v[196:199]
    v_rcp_f32 v137, v137
    v_mfma_f32_16x16x32_bf16 v[200:203], v[32:35], a[136:139], v[200:203]
    ds_read_b64_tr_b16 v[28:29], v4 offset:8192
    ds_read_b64_tr_b16 v[30:31], v4 offset:8704
    v_mfma_f32_16x16x32_bf16 v[200:203], v[36:39], a[152:155], v[200:203]
    v_add_f32 v138, 1.0, v138
    v_add_f32 v139, 1.0, v139
    v_mfma_f32_16x16x32_bf16 v[204:207], v[32:35], a[140:143], v[204:207]
    v_rcp_f32 v138, v138
    v_mfma_f32_16x16x32_bf16 v[204:207], v[36:39], a[156:159], v[204:207]
    v_mul_f32 v152, v152, v136
    s_waitcnt lgkmcnt(4)
    v_mfma_f32_16x16x32_bf16 v[208:211], v[16:19], a[128:131], v[208:211]
    ds_read_b64_tr_b16 v[32:33], v4 offset:1024
    ds_read_b64_tr_b16 v[34:35], v4 offset:1536
    v_mfma_f32_16x16x32_bf16 v[208:211], v[20:23], a[144:147], v[208:211]
    v_rcp_f32 v139, v139
    v_mfma_f32_16x16x32_bf16 v[212:215], v[16:19], a[132:135], v[212:215]
    v_mul_f32 v153, v153, v137
    v_mul_f32 v154, v154, v138
    v_mfma_f32_16x16x32_bf16 v[212:215], v[20:23], a[148:151], v[212:215]
    v_mul_f32 v155, v155, v139
    v_cvt_pk_bf16_f32 v48, v152, v153
    v_mfma_f32_16x16x32_bf16 v[216:219], v[16:19], a[136:139], v[216:219]
    ds_read_b64_tr_b16 v[36:37], v4 offset:9216
    ds_read_b64_tr_b16 v[38:39], v4 offset:9728
    v_mfma_f32_16x16x32_bf16 v[216:219], v[20:23], a[152:155], v[216:219]
    v_cvt_pk_bf16_f32 v49, v154, v155
    v_fma_f32 v11, -v141, v141, s58
    v_mfma_f32_16x16x32_bf16 v[220:223], v[16:19], a[140:143], v[220:223]
    v_mul_f32 v156, v156, v140
    v_mul_f32 v157, v157, v141
    v_mfma_f32_16x16x32_bf16 v[220:223], v[20:23], a[156:159], v[220:223]
    v_mul_f32 v140, v10, v140
    s_waitcnt lgkmcnt(4)
    v_mfma_f32_16x16x32_bf16 v[192:195], v[24:27], a[160:163], v[192:195]
    ds_read_b64_tr_b16 v[16:17], v4 offset:16384
    ds_read_b64_tr_b16 v[18:19], v4 offset:16896
    v_mfma_f32_16x16x32_bf16 v[192:195], v[28:31], a[176:179], v[192:195]
    v_mul_f32 v141, v11, v141
    v_fma_f32 v12, -v142, v142, s58
    v_mfma_f32_16x16x32_bf16 v[196:199], v[24:27], a[164:167], v[196:199]
    v_exp_f32 v140, v140
    v_mfma_f32_16x16x32_bf16 v[196:199], v[28:31], a[180:183], v[196:199]
    v_exp_f32 v141, v141
    v_mfma_f32_16x16x32_bf16 v[200:203], v[24:27], a[168:171], v[200:203]
    ds_read_b64_tr_b16 v[20:21], v4 offset:24576
    ds_read_b64_tr_b16 v[22:23], v4 offset:25088
    v_mfma_f32_16x16x32_bf16 v[200:203], v[28:31], a[184:187], v[200:203]
    v_fma_f32 v13, -v143, v143, s58
    v_mul_f32 v158, v158, v142
    v_mfma_f32_16x16x32_bf16 v[204:207], v[24:27], a[172:175], v[204:207]
    v_mul_f32 v159, v159, v143
    v_mul_f32 v142, v12, v142
    v_mfma_f32_16x16x32_bf16 v[204:207], v[28:31], a[188:191], v[204:207]
    v_mul_f32 v143, v13, v143
    s_waitcnt lgkmcnt(4)
    v_mfma_f32_16x16x32_bf16 v[208:211], v[32:35], a[160:163], v[208:211]
    ds_read_b64_tr_b16 v[24:25], v4 offset:17408
    ds_read_b64_tr_b16 v[26:27], v4 offset:17920
    v_mfma_f32_16x16x32_bf16 v[208:211], v[36:39], a[176:179], v[208:211]
    v_exp_f32 v142, v142
    v_mfma_f32_16x16x32_bf16 v[212:215], v[32:35], a[164:167], v[212:215]
    v_exp_f32 v143, v143
    v_mfma_f32_16x16x32_bf16 v[212:215], v[36:39], a[180:183], v[212:215]
    v_add_f32 v140, 1.0, v140
    v_add_f32 v141, 1.0, v141
    v_mfma_f32_16x16x32_bf16 v[216:219], v[32:35], a[168:171], v[216:219]
    ds_read_b64_tr_b16 v[28:29], v4 offset:25600
    ds_read_b64_tr_b16 v[30:31], v4 offset:26112
    v_mfma_f32_16x16x32_bf16 v[216:219], v[36:39], a[184:187], v[216:219]
    v_rcp_f32 v140, v140
    v_mfma_f32_16x16x32_bf16 v[220:223], v[32:35], a[172:175], v[220:223]
    v_rcp_f32 v141, v141
    v_mfma_f32_16x16x32_bf16 v[220:223], v[36:39], a[188:191], v[220:223]
    v_add_f32 v142, 1.0, v142
    s_waitcnt lgkmcnt(4)
    v_mfma_f32_16x16x32_bf16 v[192:195], v[16:19], a[192:195], v[192:195]
    ds_read_b64_tr_b16 v[32:33], v4 offset:32768
    ds_read_b64_tr_b16 v[34:35], v4 offset:33280
    v_mfma_f32_16x16x32_bf16 v[192:195], v[20:23], a[208:211], v[192:195]
    v_add_f32 v143, 1.0, v143
    v_mul_f32 v156, v156, v140
    v_mfma_f32_16x16x32_bf16 v[196:199], v[16:19], a[196:199], v[196:199]
    v_rcp_f32 v142, v142
    v_mfma_f32_16x16x32_bf16 v[196:199], v[20:23], a[212:215], v[196:199]
    v_rcp_f32 v143, v143
    v_mfma_f32_16x16x32_bf16 v[200:203], v[16:19], a[200:203], v[200:203]
    ds_read_b64_tr_b16 v[36:37], v4 offset:40960
    ds_read_b64_tr_b16 v[38:39], v4 offset:41472
    v_mfma_f32_16x16x32_bf16 v[200:203], v[20:23], a[216:219], v[200:203]
    v_mul_f32 v157, v157, v141
    v_mul_f32 v158, v158, v142
    v_mfma_f32_16x16x32_bf16 v[204:207], v[16:19], a[204:207], v[204:207]
    v_mul_f32 v159, v159, v143
    v_cvt_pk_bf16_f32 v52, v156, v157
    v_mfma_f32_16x16x32_bf16 v[204:207], v[20:23], a[220:223], v[204:207]
    v_cvt_pk_bf16_f32 v53, v158, v159
    s_waitcnt lgkmcnt(4)
    v_mfma_f32_16x16x32_bf16 v[208:211], v[24:27], a[192:195], v[208:211]
    ds_read_b64_tr_b16 v[16:17], v4 offset:33792
    ds_read_b64_tr_b16 v[18:19], v4 offset:34304
    v_mfma_f32_16x16x32_bf16 v[208:211], v[28:31], a[208:211], v[208:211]
    v_fma_f32 v10, -v160, v160, s58
    v_fma_f32 v11, -v161, v161, s58
    v_mfma_f32_16x16x32_bf16 v[212:215], v[24:27], a[196:199], v[212:215]
    v_mul_f32 v176, v176, v160
    v_mul_f32 v177, v177, v161
    v_mfma_f32_16x16x32_bf16 v[212:215], v[28:31], a[212:215], v[212:215]
    v_mul_f32 v160, v10, v160
    v_mul_f32 v161, v11, v161
    v_mfma_f32_16x16x32_bf16 v[216:219], v[24:27], a[200:203], v[216:219]
    ds_read_b64_tr_b16 v[20:21], v4 offset:41984
    ds_read_b64_tr_b16 v[22:23], v4 offset:42496
    v_mfma_f32_16x16x32_bf16 v[216:219], v[28:31], a[216:219], v[216:219]
    v_exp_f32 v160, v160
    v_mfma_f32_16x16x32_bf16 v[220:223], v[24:27], a[204:207], v[220:223]
    v_exp_f32 v161, v161
    v_mfma_f32_16x16x32_bf16 v[220:223], v[28:31], a[220:223], v[220:223]
    v_fma_f32 v12, -v162, v162, s58
    s_waitcnt lgkmcnt(4)
    v_mfma_f32_16x16x32_bf16 v[192:195], v[32:35], a[224:227], v[192:195]
    ds_read_b64_tr_b16 v[24:25], v4 offset:49152
    ds_read_b64_tr_b16 v[26:27], v4 offset:49664
    v_mfma_f32_16x16x32_bf16 v[192:195], v[36:39], a[240:243], v[192:195]
    v_fma_f32 v13, -v163, v163, s58
    v_mul_f32 v178, v178, v162
    v_mfma_f32_16x16x32_bf16 v[196:199], v[32:35], a[228:231], v[196:199]
    v_mul_f32 v179, v179, v163
    v_mul_f32 v162, v12, v162
    v_mfma_f32_16x16x32_bf16 v[196:199], v[36:39], a[244:247], v[196:199]
    v_mul_f32 v163, v13, v163
    v_add_f32 v160, 1.0, v160
    v_mfma_f32_16x16x32_bf16 v[200:203], v[32:35], a[232:235], v[200:203]
    ds_read_b64_tr_b16 v[28:29], v4 offset:57344
    ds_read_b64_tr_b16 v[30:31], v4 offset:57856
    v_mfma_f32_16x16x32_bf16 v[200:203], v[36:39], a[248:251], v[200:203]
    v_exp_f32 v162, v162
    v_mfma_f32_16x16x32_bf16 v[204:207], v[32:35], a[236:239], v[204:207]
    v_exp_f32 v163, v163
    v_mfma_f32_16x16x32_bf16 v[204:207], v[36:39], a[252:255], v[204:207]
    v_add_f32 v161, 1.0, v161
    s_waitcnt lgkmcnt(4)
    v_mfma_f32_16x16x32_bf16 v[208:211], v[16:19], a[224:227], v[208:211]
    ds_read_b64_tr_b16 v[32:33], v4 offset:50176
    ds_read_b64_tr_b16 v[34:35], v4 offset:50688
    v_mfma_f32_16x16x32_bf16 v[208:211], v[20:23], a[240:243], v[208:211]
    v_rcp_f32 v160, v160
    v_mfma_f32_16x16x32_bf16 v[212:215], v[16:19], a[228:231], v[212:215]
    v_rcp_f32 v161, v161
    v_mfma_f32_16x16x32_bf16 v[212:215], v[20:23], a[244:247], v[212:215]
    v_add_f32 v162, 1.0, v162
    v_add_f32 v163, 1.0, v163
    v_mfma_f32_16x16x32_bf16 v[216:219], v[16:19], a[232:235], v[216:219]
    ds_read_b64_tr_b16 v[36:37], v4 offset:58368
    ds_read_b64_tr_b16 v[38:39], v4 offset:58880
    v_mfma_f32_16x16x32_bf16 v[216:219], v[20:23], a[248:251], v[216:219]
    v_rcp_f32 v162, v162
    v_mfma_f32_16x16x32_bf16 v[220:223], v[16:19], a[236:239], v[220:223]
    v_rcp_f32 v163, v163
    v_mfma_f32_16x16x32_bf16 v[220:223], v[20:23], a[252:255], v[220:223]
    v_mul_f32 v176, v176, v160
    s_waitcnt lgkmcnt(4)
    v_mfma_f32_16x16x32_bf16 v[192:195], v[24:27], v[224:227], v[192:195]
    ds_read_b64_tr_b16 v[16:17], v7 offset:16384
    ds_read_b64_tr_b16 v[18:19], v7 offset:16896
    v_mfma_f32_16x16x32_bf16 v[192:195], v[28:31], v[240:243], v[192:195]
    v_mul_f32 v177, v177, v161
    v_mul_f32 v178, v178, v162
    v_mfma_f32_16x16x32_bf16 v[196:199], v[24:27], v[228:231], v[196:199]
    v_mul_f32 v179, v179, v163
    v_cvt_pk_bf16_f32 v42, v176, v177
    v_mfma_f32_16x16x32_bf16 v[196:199], v[28:31], v[244:247], v[196:199]
    v_cvt_pk_bf16_f32 v43, v178, v179
    v_fma_f32 v10, -v164, v164, s58
    v_mfma_f32_16x16x32_bf16 v[200:203], v[24:27], v[232:235], v[200:203]
    ds_read_b64_tr_b16 v[20:21], v7 offset:24576
    ds_read_b64_tr_b16 v[22:23], v7 offset:25088
    v_mfma_f32_16x16x32_bf16 v[200:203], v[28:31], v[248:251], v[200:203]
    buffer_store_dwordx4 v[40:43], v1, s[8:11], s54 offen offset:0 sc1
    v_mfma_f32_16x16x32_bf16 v[204:207], v[24:27], v[236:239], v[204:207]
    v_fma_f32 v11, -v165, v165, s58
    v_mul_f32 v180, v180, v164
    v_mfma_f32_16x16x32_bf16 v[204:207], v[28:31], v[252:255], v[204:207]
    v_mul_f32 v181, v181, v165
    s_waitcnt lgkmcnt(4)
    v_mfma_f32_16x16x32_bf16 v[208:211], v[32:35], v[224:227], v[208:211]
    ds_read_b64_tr_b16 v[24:25], v7 offset:17408
    ds_read_b64_tr_b16 v[26:27], v7 offset:17920
    v_mfma_f32_16x16x32_bf16 v[208:211], v[36:39], v[240:243], v[208:211]
    v_mul_f32 v164, v10, v164
    v_mul_f32 v165, v11, v165
    v_mfma_f32_16x16x32_bf16 v[212:215], v[32:35], v[228:231], v[212:215]
    v_exp_f32 v164, v164
    v_mfma_f32_16x16x32_bf16 v[212:215], v[36:39], v[244:247], v[212:215]
    v_exp_f32 v165, v165
    v_mfma_f32_16x16x32_bf16 v[216:219], v[32:35], v[232:235], v[216:219]
    ds_read_b64_tr_b16 v[28:29], v7 offset:25600
Lpad4:
    s_cbranch_execz Lwret1
    ds_read_b64_tr_b16 v[30:31], v7 offset:26112
    v_mfma_f32_16x16x32_bf16 v[216:219], v[36:39], v[248:251], v[216:219]
    v_fma_f32 v12, -v166, v166, s58
    v_fma_f32 v13, -v167, v167, s58
    v_mfma_f32_16x16x32_bf16 v[220:223], v[32:35], v[236:239], v[220:223]
    v_mul_f32 v182, v182, v166
    v_mul_f32 v183, v183, v167
    v_mfma_f32_16x16x32_bf16 v[220:223], v[36:39], v[252:255], v[220:223]
    v_add_u32 v7, 4294836224, v7
    s_waitcnt lgkmcnt(4)
    v_mfma_f32_16x16x32_bf16 v[128:131], v[16:19], a[0:3], 0
    ds_read_b64_tr_b16 v[32:33], v7 offset:0
    ds_read_b64_tr_b16 v[34:35], v7 offset:512
    v_mfma_f32_16x16x32_bf16 v[128:131], v[20:23], a[16:19], v[128:131]
    v_mul_f32 v166, v12, v166
    v_mul_f32 v167, v13, v167
    v_mfma_f32_16x16x32_bf16 v[132:135], v[16:19], a[4:7], 0
    v_exp_f32 v166, v166
    v_mfma_f32_16x16x32_bf16 v[132:135], v[20:23], a[20:23], v[132:135]
    v_exp_f32 v167, v167
    v_mfma_f32_16x16x32_bf16 v[136:139], v[16:19], a[8:11], 0
    ds_read_b64_tr_b16 v[36:37], v7 offset:8192
    ds_read_b64_tr_b16 v[38:39], v7 offset:8704
    v_mfma_f32_16x16x32_bf16 v[136:139], v[20:23], a[24:27], v[136:139]
    v_add_f32 v164, 1.0, v164
    v_add_f32 v165, 1.0, v165
    v_mfma_f32_16x16x32_bf16 v[140:143], v[16:19], a[12:15], 0
    v_rcp_f32 v164, v164
    v_mfma_f32_16x16x32_bf16 v[140:143], v[20:23], a[28:31], v[140:143]
    v_add_f32 v166, 1.0, v166
    s_waitcnt lgkmcnt(4)
    v_mfma_f32_16x16x32_bf16 v[144:147], v[24:27], a[0:3], 0
    ds_read_b64_tr_b16 v[16:17], v7 offset:1024
    ds_read_b64_tr_b16 v[18:19], v7 offset:1536
    v_mfma_f32_16x16x32_bf16 v[144:147], v[28:31], a[16:19], v[144:147]
    v_rcp_f32 v165, v165
    v_mfma_f32_16x16x32_bf16 v[148:151], v[24:27], a[4:7], 0
    v_add_f32 v167, 1.0, v167
    v_mul_f32 v188, v188, v172
    v_mfma_f32_16x16x32_bf16 v[148:151], v[28:31], a[20:23], v[148:151]
    v_rcp_f32 v166, v166
    v_rcp_f32 v167, v167
    v_pk_fma_f32 v[10:11], v[168:169], v[168:169], s[58:59] op_sel_hi:[1,1,0] neg_lo:[1,0,0] neg_hi:[1,0,0]
    v_pk_fma_f32 v[12:13], v[170:171], v[170:171], s[58:59] op_sel_hi:[1,1,0] neg_lo:[1,0,0] neg_hi:[1,0,0]
    v_pk_mul_f32 v[184:185], v[184:185], v[168:169]
    v_pk_mul_f32 v[186:187], v[186:187], v[170:171]
    v_pk_mul_f32 v[168:169], v[10:11], v[168:169]
    v_pk_mul_f32 v[170:171], v[12:13], v[170:171]
    v_pk_mul_f32 v[180:181], v[180:181], v[164:165]
    v_pk_mul_f32 v[182:183], v[182:183], v[166:167]
    v_mfma_f32_16x16x32_bf16 v[152:155], v[24:27], a[8:11], 0
    ds_read_b64_tr_b16 v[20:21], v7 offset:9216
    ds_read_b64_tr_b16 v[22:23], v7 offset:9728
    v_mfma_f32_16x16x32_bf16 v[152:155], v[28:31], a[24:27], v[152:155]
    v_cvt_pk_bf16_f32 v46, v180, v181
    v_cvt_pk_bf16_f32 v47, v182, v183
    v_mfma_f32_16x16x32_bf16 v[156:159], v[24:27], a[12:15], 0
    buffer_store_dwordx4 v[44:47], v1, s[8:11], s54 offen offset:1024 sc1
    v_mfma_f32_16x16x32_bf16 v[156:159], v[28:31], a[28:31], v[156:159]
    v_fma_f32 v10, -v172, v172, s58
    s_waitcnt lgkmcnt(4)
    v_mfma_f32_16x16x32_bf16 v[128:131], v[32:35], a[32:35], v[128:131]
    ds_read_b64_tr_b16 v[24:25], v7 offset:16384
    ds_read_b64_tr_b16 v[26:27], v7 offset:16896
    v_mfma_f32_16x16x32_bf16 v[128:131], v[36:39], a[48:51], v[128:131]
    v_exp_f32 v168, v168
    v_mfma_f32_16x16x32_bf16 v[132:135], v[32:35], a[36:39], v[132:135]
    v_exp_f32 v169, v169
    v_mfma_f32_16x16x32_bf16 v[132:135], v[36:39], a[52:55], v[132:135]
    v_exp_f32 v170, v170
    v_mfma_f32_16x16x32_bf16 v[136:139], v[32:35], a[40:43], v[136:139]
    ds_read_b64_tr_b16 v[28:29], v7 offset:24576
    ds_read_b64_tr_b16 v[30:31], v7 offset:25088
    v_mfma_f32_16x16x32_bf16 v[136:139], v[36:39], a[56:59], v[136:139]
    v_exp_f32 v171, v171
    v_mfma_f32_16x16x32_bf16 v[140:143], v[32:35], a[44:47], v[140:143]
    v_add_f32 v168, 1.0, v168
    v_add_f32 v169, 1.0, v169
    v_mfma_f32_16x16x32_bf16 v[140:143], v[36:39], a[60:63], v[140:143]
    v_add_f32 v170, 1.0, v170
    s_waitcnt lgkmcnt(4)
    v_mfma_f32_16x16x32_bf16 v[144:147], v[16:19], a[32:35], v[144:147]
    ds_read_b64_tr_b16 v[32:33], v7 offset:17408
    ds_read_b64_tr_b16 v[34:35], v7 offset:17920
    v_mfma_f32_16x16x32_bf16 v[144:147], v[20:23], a[48:51], v[144:147]
    v_rcp_f32 v168, v168
    v_mfma_f32_16x16x32_bf16 v[148:151], v[16:19], a[36:39], v[148:151]
    v_rcp_f32 v169, v169
    v_mfma_f32_16x16x32_bf16 v[148:151], v[20:23], a[52:55], v[148:151]
    v_add_f32 v171, 1.0, v171
    v_mul_f32 v184, v184, v168
    v_mfma_f32_16x16x32_bf16 v[152:155], v[16:19], a[40:43], v[152:155]
    ds_read_b64_tr_b16 v[36:37], v7 offset:25600
    ds_read_b64_tr_b16 v[38:39], v7 offset:26112
    v_mfma_f32_16x16x32_bf16 v[152:155], v[20:23], a[56:59], v[152:155]
    v_rcp_f32 v170, v170
    v_mfma_f32_16x16x32_bf16 v[156:159], v[16:19], a[44:47], v[156:159]
    v_rcp_f32 v171, v171
    v_mfma_f32_16x16x32_bf16 v[156:159], v[20:23], a[60:63], v[156:159]
    v_mul_f32 v185, v185, v169
    s_waitcnt lgkmcnt(4)
    v_mfma_f32_16x16x32_bf16 v[128:131], v[24:27], a[64:67], v[128:131]
    ds_read_b64_tr_b16 v[16:17], v5 offset:32768
    ds_read_b64_tr_b16 v[18:19], v5 offset:33280
    v_mfma_f32_16x16x32_bf16 v[128:131], v[28:31], a[80:83], v[128:131]
    v_mul_f32 v186, v186, v170
    v_mul_f32 v187, v187, v171
    v_mfma_f32_16x16x32_bf16 v[132:135], v[24:27], a[68:71], v[132:135]
    v_cvt_pk_bf16_f32 v50, v184, v185
    v_cvt_pk_bf16_f32 v51, v186, v187
    v_mfma_f32_16x16x32_bf16 v[132:135], v[28:31], a[84:87], v[132:135]
    buffer_store_dwordx4 v[48:51], v1, s[8:11], s54 offen offset:2048 sc1
    v_mfma_f32_16x16x32_bf16 v[136:139], v[24:27], a[72:75], v[136:139]
    ds_read_b64_tr_b16 v[20:21], v5 offset:40960
    ds_read_b64_tr_b16 v[22:23], v5 offset:41472
    v_mfma_f32_16x16x32_bf16 v[136:139], v[28:31], a[88:91], v[136:139]
    v_fma_f32 v11, -v173, v173, s58
    v_mul_f32 v189, v189, v173
    v_mfma_f32_16x16x32_bf16 v[140:143], v[24:27], a[76:79], v[140:143]
    v_mul_f32 v172, v10, v172
    v_mul_f32 v173, v11, v173
    v_mfma_f32_16x16x32_bf16 v[140:143], v[28:31], a[92:95], v[140:143]
    v_fma_f32 v12, -v174, v174, s58
    s_waitcnt lgkmcnt(4)
    v_mfma_f32_16x16x32_bf16 v[144:147], v[32:35], a[64:67], v[144:147]
    ds_read_b64_tr_b16 v[24:25], v5 offset:33792
    ds_read_b64_tr_b16 v[26:27], v5 offset:34304
    v_mfma_f32_16x16x32_bf16 v[144:147], v[36:39], a[80:83], v[144:147]
    v_exp_f32 v172, v172
    v_mfma_f32_16x16x32_bf16 v[148:151], v[32:35], a[68:71], v[148:151]
    v_exp_f32 v173, v173
    v_mfma_f32_16x16x32_bf16 v[148:151], v[36:39], a[84:87], v[148:151]
    v_fma_f32 v13, -v175, v175, s58
    v_mul_f32 v190, v190, v174
    v_mfma_f32_16x16x32_bf16 v[152:155], v[32:35], a[72:75], v[152:155]
    ds_read_b64_tr_b16 v[28:29], v5 offset:41984
    ds_read_b64_tr_b16 v[30:31], v5 offset:42496
    v_mfma_f32_16x16x32_bf16 v[152:155], v[36:39], a[88:91], v[152:155]
    v_mul_f32 v191, v191, v175
    v_mul_f32 v174, v12, v174
    v_mfma_f32_16x16x32_bf16 v[156:159], v[32:35], a[76:79], v[156:159]
    v_mul_f32 v175, v13, v175
    v_add_f32 v172, 1.0, v172
    v_mfma_f32_16x16x32_bf16 v[156:159], v[36:39], a[92:95], v[156:159]
    s_waitcnt lgkmcnt(4)
    s_barrier
    v_mfma_f32_16x16x32_bf16 v[64:67], v[16:19], a[96:99], v[64:67]
    ds_read_b64_tr_b16 v[32:33], v5 offset:49152
    ds_read_b64_tr_b16 v[34:35], v5 offset:49664
    v_mfma_f32_16x16x32_bf16 v[64:67], v[20:23], a[112:115], v[64:67]
    v_exp_f32 v174, v174
    v_mfma_f32_16x16x32_bf16 v[68:71], v[16:19], a[100:103], v[68:71]
    v_exp_f32 v175, v175
    v_mfma_f32_16x16x32_bf16 v[68:71], v[20:23], a[116:119], v[68:71]
    v_add_f32 v173, 1.0, v173
    v_add_f32 v174, 1.0, v174
    v_mfma_f32_16x16x32_bf16 v[72:75], v[16:19], a[104:107], v[72:75]
    ds_read_b64_tr_b16 v[36:37], v5 offset:57344
    ds_read_b64_tr_b16 v[38:39], v5 offset:57856
    v_mfma_f32_16x16x32_bf16 v[72:75], v[20:23], a[120:123], v[72:75]
    v_rcp_f32 v172, v172
    v_mfma_f32_16x16x32_bf16 v[76:79], v[16:19], a[108:111], v[76:79]
    v_rcp_f32 v173, v173
    v_mfma_f32_16x16x32_bf16 v[76:79], v[20:23], a[124:127], v[76:79]
    v_add_f32 v175, 1.0, v175
    s_waitcnt lgkmcnt(4)
    v_mfma_f32_16x16x32_bf16 v[80:83], v[24:27], a[96:99], v[80:83]
    ds_read_b64_tr_b16 v[16:17], v5 offset:50176
    ds_read_b64_tr_b16 v[18:19], v5 offset:50688
    v_mfma_f32_16x16x32_bf16 v[80:83], v[28:31], a[112:115], v[80:83]
    v_min_u32 v2, 8, v0
    v_lshlrev_b32 v2, 3, v2
    v_mfma_f32_16x16x32_bf16 v[84:87], v[24:27], a[100:103], v[84:87]
    v_lshlrev_b32 v57, 4, v0
    v_mul_f32 v188, v188, v172
    v_mfma_f32_16x16x32_bf16 v[84:87], v[28:31], a[116:119], v[84:87]
    v_rcp_f32 v174, v174
    v_mfma_f32_16x16x32_bf16 v[88:91], v[24:27], a[104:107], v[88:91]
    ds_read_b64_tr_b16 v[20:21], v5 offset:58368
    ds_read_b64_tr_b16 v[22:23], v5 offset:58880
    v_mfma_f32_16x16x32_bf16 v[88:91], v[28:31], a[120:123], v[88:91]
    buffer_load_dword v57, v57, s[8:11], s83 offen offset:0 sc1
    v_mfma_f32_16x16x32_bf16 v[92:95], v[24:27], a[108:111], v[92:95]
    v_rcp_f32 v175, v175
    v_mfma_f32_16x16x32_bf16 v[92:95], v[28:31], a[124:127], v[92:95]
    v_add_u32 v5, 65536, v5
    s_waitcnt lgkmcnt(4)
    v_mfma_f32_16x16x32_bf16 v[64:67], v[32:35], a[128:131], v[64:67]
    ds_read_b64_tr_b16 v[24:25], v5 offset:0
    ds_read_b64_tr_b16 v[26:27], v5 offset:512
    v_mfma_f32_16x16x32_bf16 v[64:67], v[36:39], a[144:147], v[64:67]
    buffer_load_dword v2, v2, s[8:11], s84 offen offset:0 sc1
    v_mfma_f32_16x16x32_bf16 v[68:71], v[32:35], a[132:135], v[68:71]
    v_mul_f32 v189, v189, v173
    v_mul_f32 v190, v190, v174
    v_mfma_f32_16x16x32_bf16 v[68:71], v[36:39], a[148:151], v[68:71]
    v_mul_f32 v191, v191, v175
    v_cvt_pk_bf16_f32 v54, v188, v189
    v_mfma_f32_16x16x32_bf16 v[72:75], v[32:35], a[136:139], v[72:75]
    ds_read_b64_tr_b16 v[28:29], v5 offset:8192
    ds_read_b64_tr_b16 v[30:31], v5 offset:8704
    v_mfma_f32_16x16x32_bf16 v[72:75], v[36:39], a[152:155], v[72:75]
    v_cvt_pk_bf16_f32 v55, v190, v191
    v_mfma_f32_16x16x32_bf16 v[76:79], v[32:35], a[140:143], v[76:79]
    buffer_store_dwordx4 v[52:55], v1, s[8:11], s54 offen offset:3072 sc1
    v_mfma_f32_16x16x32_bf16 v[76:79], v[36:39], a[156:159], v[76:79]
    v_fma_f32 v10, -v192, v192, s58
    s_waitcnt lgkmcnt(4)
    v_mfma_f32_16x16x32_bf16 v[80:83], v[16:19], a[128:131], v[80:83]
    ds_read_b64_tr_b16 v[32:33], v5 offset:1024
    ds_read_b64_tr_b16 v[34:35], v5 offset:1536
    v_mfma_f32_16x16x32_bf16 v[80:83], v[20:23], a[144:147], v[80:83]
    v_fma_f32 v11, -v193, v193, s58
    v_mul_f32 v208, v208, v192
    v_mfma_f32_16x16x32_bf16 v[84:87], v[16:19], a[132:135], v[84:87]
    v_mul_f32 v209, v209, v193
    v_mul_f32 v192, v10, v192
    v_mfma_f32_16x16x32_bf16 v[84:87], v[20:23], a[148:151], v[84:87]
    v_mul_f32 v193, v11, v193
    v_fma_f32 v12, -v194, v194, s58
    v_mfma_f32_16x16x32_bf16 v[88:91], v[16:19], a[136:139], v[88:91]
    ds_read_b64_tr_b16 v[36:37], v5 offset:9216
    ds_read_b64_tr_b16 v[38:39], v5 offset:9728
    v_mfma_f32_16x16x32_bf16 v[88:91], v[20:23], a[152:155], v[88:91]
    v_exp_f32 v192, v192
    v_mfma_f32_16x16x32_bf16 v[92:95], v[16:19], a[140:143], v[92:95]
    v_exp_f32 v193, v193
    v_mfma_f32_16x16x32_bf16 v[92:95], v[20:23], a[156:159], v[92:95]
    v_fma_f32 v13, -v195, v195, s58
    s_waitcnt lgkmcnt(4)
    v_mfma_f32_16x16x32_bf16 v[64:67], v[24:27], a[160:163], v[64:67]
    ds_read_b64_tr_b16 v[16:17], v5 offset:16384
    ds_read_b64_tr_b16 v[18:19], v5 offset:16896
    v_mfma_f32_16x16x32_bf16 v[64:67], v[28:31], a[176:179], v[64:67]
    s_getpc_b64 s[60:61]
    s_lshr_b32 s62, s2, 3
    v_mfma_f32_16x16x32_bf16 v[68:71], v[24:27], a[164:167], v[68:71]
    s_add_u32 s60, s60, 0x4a8
    s_addc_u32 s61, s61, 0
    v_mfma_f32_16x16x32_bf16 v[68:71], v[28:31], a[180:183], v[68:71]
    s_add_u32 m0, s51, 131072
    v_mul_f32 v210, v210, v194
    v_mfma_f32_16x16x32_bf16 v[72:75], v[24:27], a[168:171], v[72:75]
    ds_read_b64_tr_b16 v[20:21], v5 offset:24576
    ds_read_b64_tr_b16 v[22:23], v5 offset:25088
    v_mfma_f32_16x16x32_bf16 v[72:75], v[28:31], a[184:187], v[72:75]
    s_lshl_b32 s62, s62, 2
    s_add_u32 s62, s62, s3
    v_mfma_f32_16x16x32_bf16 v[76:79], v[24:27], a[172:175], v[76:79]
    v_mul_f32 v211, v211, v195
    v_mul_f32 v194, v12, v194
    v_mfma_f32_16x16x32_bf16 v[76:79], v[28:31], a[188:191], v[76:79]
    v_mul_f32 v195, v13, v195
    s_waitcnt lgkmcnt(4)
    v_mfma_f32_16x16x32_bf16 v[80:83], v[32:35], a[160:163], v[80:83]
    ds_read_b64_tr_b16 v[24:25], v5 offset:17408
    ds_read_b64_tr_b16 v[26:27], v5 offset:17920
    v_mfma_f32_16x16x32_bf16 v[80:83], v[36:39], a[176:179], v[80:83]
    s_mul_i32 s62, s62, 332
    v_min_u32 v59, 2, v0
    v_mfma_f32_16x16x32_bf16 v[84:87], v[32:35], a[164:167], v[84:87]
    v_lshl_add_u32 v59, v59, 7, s62
    v_add_f32 v192, 1.0, v192
    v_mfma_f32_16x16x32_bf16 v[84:87], v[36:39], a[180:183], v[84:87]
    v_exp_f32 v194, v194
    v_mfma_f32_16x16x32_bf16 v[88:91], v[32:35], a[168:171], v[88:91]
    ds_read_b64_tr_b16 v[28:29], v5 offset:25600
    ds_read_b64_tr_b16 v[30:31], v5 offset:26112
    v_mfma_f32_16x16x32_bf16 v[88:91], v[36:39], a[184:187], v[88:91]
    global_load_dword v63, v59, s[60:61]
    v_mfma_f32_16x16x32_bf16 v[92:95], v[32:35], a[172:175], v[92:95]
    v_exp_f32 v195, v195
    v_mfma_f32_16x16x32_bf16 v[92:95], v[36:39], a[188:191], v[92:95]
    v_add_f32 v193, 1.0, v193
    s_waitcnt lgkmcnt(4)
    v_mfma_f32_16x16x32_bf16 v[64:67], v[16:19], a[192:195], v[64:67]
    ds_read_b64_tr_b16 v[32:33], v5 offset:32768
    ds_read_b64_tr_b16 v[34:35], v5 offset:33280
    v_mfma_f32_16x16x32_bf16 v[64:67], v[20:23], a[208:211], v[64:67]
    v_rcp_f32 v192, v192
    v_mfma_f32_16x16x32_bf16 v[68:71], v[16:19], a[196:199], v[68:71]
    buffer_load_dwordx4 v3, s[20:23], s32 offen  lds
    v_mfma_f32_16x16x32_bf16 v[68:71], v[20:23], a[212:215], v[68:71]
    v_rcp_f32 v193, v193
    v_mfma_f32_16x16x32_bf16 v[72:75], v[16:19], a[200:203], v[72:75]
    ds_read_b64_tr_b16 v[36:37], v5 offset:40960
    ds_read_b64_tr_b16 v[38:39], v5 offset:41472
    v_mfma_f32_16x16x32_bf16 v[72:75], v[20:23], a[216:219], v[72:75]
    v_add_f32 v194, 1.0, v194
    v_add_f32 v195, 1.0, v195
    v_mfma_f32_16x16x32_bf16 v[76:79], v[16:19], a[204:207], v[76:79]
    v_rcp_f32 v194, v194
    v_mfma_f32_16x16x32_bf16 v[76:79], v[20:23], a[220:223], v[76:79]
    v_mul_f32 v208, v208, v192
    s_waitcnt lgkmcnt(4)
    v_mfma_f32_16x16x32_bf16 v[80:83], v[24:27], a[192:195], v[80:83]
    ds_read_b64_tr_b16 v[16:17], v5 offset:33792
    ds_read_b64_tr_b16 v[18:19], v5 offset:34304
    v_mfma_f32_16x16x32_bf16 v[80:83], v[28:31], a[208:211], v[80:83]
    v_rcp_f32 v195, v195
    v_mfma_f32_16x16x32_bf16 v[84:87], v[24:27], a[196:199], v[84:87]
    v_mul_f32 v209, v209, v193
    v_mul_f32 v210, v210, v194
    v_mfma_f32_16x16x32_bf16 v[84:87], v[28:31], a[212:215], v[84:87]
    s_add_u32 m0, s51, 135168
    v_mul_f32 v211, v211, v195
    v_mfma_f32_16x16x32_bf16 v[88:91], v[24:27], a[200:203], v[88:91]
    ds_read_b64_tr_b16 v[20:21], v5 offset:41984
    ds_read_b64_tr_b16 v[22:23], v5 offset:42496
    v_mfma_f32_16x16x32_bf16 v[88:91], v[28:31], a[216:219], v[88:91]
    v_cvt_pk_bf16_f32 v40, v208, v209
    v_cvt_pk_bf16_f32 v41, v210, v211
    v_mfma_f32_16x16x32_bf16 v[92:95], v[24:27], a[204:207], v[92:95]
    v_fma_f32 v10, -v196, v196, s58
    v_fma_f32 v11, -v197, v197, s58
    v_mfma_f32_16x16x32_bf16 v[92:95], v[28:31], a[220:223], v[92:95]
    v_mul_f32 v212, v212, v196
    s_waitcnt lgkmcnt(4)
    v_mfma_f32_16x16x32_bf16 v[64:67], v[32:35], a[224:227], v[64:67]
    ds_read_b64_tr_b16 v[24:25], v5 offset:49152
    ds_read_b64_tr_b16 v[26:27], v5 offset:49664
    v_mfma_f32_16x16x32_bf16 v[64:67], v[36:39], a[240:243], v[64:67]
    v_mul_f32 v213, v213, v197
    v_mul_f32 v196, v10, v196
    v_mfma_f32_16x16x32_bf16 v[68:71], v[32:35], a[228:231], v[68:71]
    v_mul_f32 v197, v11, v197
    v_fma_f32 v12, -v198, v198, s58
    v_mfma_f32_16x16x32_bf16 v[68:71], v[36:39], a[244:247], v[68:71]
    v_exp_f32 v196, v196
    v_mfma_f32_16x16x32_bf16 v[72:75], v[32:35], a[232:235], v[72:75]
    ds_read_b64_tr_b16 v[28:29], v5 offset:57344
    ds_read_b64_tr_b16 v[30:31], v5 offset:57856
    v_mfma_f32_16x16x32_bf16 v[72:75], v[36:39], a[248:251], v[72:75]
    buffer_load_dwordx4 v3, s[20:23], s34 offen  lds
    v_mfma_f32_16x16x32_bf16 v[76:79], v[32:35], a[236:239], v[76:79]
    v_exp_f32 v197, v197
    v_mfma_f32_16x16x32_bf16 v[76:79], v[36:39], a[252:255], v[76:79]
    v_fma_f32 v13, -v199, v199, s58
    s_waitcnt lgkmcnt(4)
    v_mfma_f32_16x16x32_bf16 v[80:83], v[16:19], a[224:227], v[80:83]
    ds_read_b64_tr_b16 v[32:33], v5 offset:50176
    ds_read_b64_tr_b16 v[34:35], v5 offset:50688
    v_mfma_f32_16x16x32_bf16 v[80:83], v[20:23], a[240:243], v[80:83]
    v_mul_f32 v214, v214, v198
    v_mul_f32 v215, v215, v199
    v_mfma_f32_16x16x32_bf16 v[84:87], v[16:19], a[228:231], v[84:87]
    v_mul_f32 v198, v12, v198
    v_mul_f32 v199, v13, v199
    v_mfma_f32_16x16x32_bf16 v[84:87], v[20:23], a[244:247], v[84:87]
    v_exp_f32 v198, v198
    v_mfma_f32_16x16x32_bf16 v[88:91], v[16:19], a[232:235], v[88:91]
    ds_read_b64_tr_b16 v[36:37], v5 offset:58368
    ds_read_b64_tr_b16 v[38:39], v5 offset:58880
    v_mfma_f32_16x16x32_bf16 v[88:91], v[20:23], a[248:251], v[88:91]
    v_exp_f32 v199, v199
    v_mfma_f32_16x16x32_bf16 v[92:95], v[16:19], a[236:239], v[92:95]
    s_add_u32 m0, s51, 139264
    v_add_f32 v196, 1.0, v196
    v_mfma_f32_16x16x32_bf16 v[92:95], v[20:23], a[252:255], v[92:95]
    v_add_f32 v197, 1.0, v197
    s_waitcnt lgkmcnt(4)
    v_mfma_f32_16x16x32_bf16 v[64:67], v[24:27], v[224:227], v[64:67]
    ds_read_b64_tr_b16 v[16:17], v6 offset:32768
    ds_read_b64_tr_b16 v[18:19], v6 offset:33280
    v_mfma_f32_16x16x32_bf16 v[64:67], v[28:31], v[240:243], v[64:67]
    v_rcp_f32 v196, v196
    v_mfma_f32_16x16x32_bf16 v[68:71], v[24:27], v[228:231], v[68:71]
    v_rcp_f32 v197, v197
    v_mfma_f32_16x16x32_bf16 v[68:71], v[28:31], v[244:247], v[68:71]
    v_add_f32 v198, 1.0, v198
    v_add_f32 v199, 1.0, v199
    v_mfma_f32_16x16x32_bf16 v[72:75], v[24:27], v[232:235], v[72:75]
    ds_read_b64_tr_b16 v[20:21], v6 offset:40960
    ds_read_b64_tr_b16 v[22:23], v6 offset:41472
    v_mfma_f32_16x16x32_bf16 v[72:75], v[28:31], v[248:251], v[72:75]
    v_rcp_f32 v198, v198
    v_rcp_f32 v199, v199
    v_pk_fma_f32 v[10:11], v[200:201], v[200:201], s[58:59] op_sel_hi:[1,1,0] neg_lo:[1,0,0] neg_hi:[1,0,0]
    v_pk_fma_f32 v[12:13], v[202:203], v[202:203], s[58:59] op_sel_hi:[1,1,0] neg_lo:[1,0,0] neg_hi:[1,0,0]
    v_pk_mul_f32 v[216:217], v[216:217], v[200:201]
    v_pk_mul_f32 v[218:219], v[218:219], v[202:203]
    v_pk_mul_f32 v[200:201], v[10:11], v[200:201]
    v_pk_mul_f32 v[202:203], v[12:13], v[202:203]
    v_pk_mul_f32 v[212:213], v[212:213], v[196:197]
    v_pk_mul_f32 v[214:215], v[214:215], v[198:199]
    v_mfma_f32_16x16x32_bf16 v[76:79], v[24:27], v[236:239], v[76:79]
    buffer_load_dwordx4 v3, s[20:23], s36 offen  lds
    v_mfma_f32_16x16x32_bf16 v[76:79], v[28:31], v[252:255], v[76:79]
    v_cvt_pk_bf16_f32 v44, v212, v213
    s_waitcnt lgkmcnt(4)
    v_mfma_f32_16x16x32_bf16 v[80:83], v[32:35], v[224:227], v[80:83]
    ds_read_b64_tr_b16 v[24:25], v6 offset:33792
    ds_read_b64_tr_b16 v[26:27], v6 offset:34304
    v_mfma_f32_16x16x32_bf16 v[80:83], v[36:39], v[240:243], v[80:83]
    v_cvt_pk_bf16_f32 v45, v214, v215
    v_fma_f32 v10, -v204, v204, s58
    v_mfma_f32_16x16x32_bf16 v[84:87], v[32:35], v[228:231], v[84:87]
    v_exp_f32 v200, v200
    v_mfma_f32_16x16x32_bf16 v[84:87], v[36:39], v[244:247], v[84:87]
    v_exp_f32 v201, v201
    v_mfma_f32_16x16x32_bf16 v[88:91], v[32:35], v[232:235], v[88:91]
    ds_read_b64_tr_b16 v[28:29], v6 offset:41984
    ds_read_b64_tr_b16 v[30:31], v6 offset:42496
    v_mfma_f32_16x16x32_bf16 v[88:91], v[36:39], v[248:251], v[88:91]
    v_exp_f32 v202, v202
    v_mfma_f32_16x16x32_bf16 v[92:95], v[32:35], v[236:239], v[92:95]
    v_exp_f32 v203, v203
    v_mfma_f32_16x16x32_bf16 v[92:95], v[36:39], v[252:255], v[92:95]
    s_waitcnt vmcnt(6) lgkmcnt(4)
    v_cmp_ne_u32 vcc, v57, v15
    s_cbranch_vccnz Lspin2
Lback2:
    s_waitcnt vmcnt(5)
    v_cmp_ne_u32 vcc, v2, v15
    s_cbranch_vccnz Lspin3
Lback3:
    v_mfma_f32_16x16x32_bf16 v[96:99], v[16:19], a[96:99], v[96:99]
    ds_read_b64_tr_b16 v[32:33], v6 offset:49152
    ds_read_b64_tr_b16 v[34:35], v6 offset:49664
    v_mfma_f32_16x16x32_bf16 v[96:99], v[20:23], a[112:115], v[96:99]
    s_add_u32 m0, s51, 143360
    v_add_f32 v200, 1.0, v200
    v_mfma_f32_16x16x32_bf16 v[100:103], v[16:19], a[100:103], v[100:103]
    v_add_f32 v201, 1.0, v201
    v_add_f32 v202, 1.0, v202
    v_mfma_f32_16x16x32_bf16 v[100:103], v[20:23], a[116:119], v[100:103]
    v_rcp_f32 v200, v200
    v_mfma_f32_16x16x32_bf16 v[104:107], v[16:19], a[104:107], v[104:107]
    ds_read_b64_tr_b16 v[36:37], v6 offset:57344
    ds_read_b64_tr_b16 v[38:39], v6 offset:57856
    v_mfma_f32_16x16x32_bf16 v[104:107], v[20:23], a[120:123], v[104:107]
    v_rcp_f32 v201, v201
    v_mfma_f32_16x16x32_bf16 v[108:111], v[16:19], a[108:111], v[108:111]
    v_add_f32 v203, 1.0, v203
    v_mul_f32 v216, v216, v200
    v_mfma_f32_16x16x32_bf16 v[108:111], v[20:23], a[124:127], v[108:111]
    v_mul_f32 v217, v217, v201
    s_waitcnt lgkmcnt(4)
    v_mfma_f32_16x16x32_bf16 v[112:115], v[24:27], a[96:99], v[112:115]
    ds_read_b64_tr_b16 v[16:17], v6 offset:50176
    ds_read_b64_tr_b16 v[18:19], v6 offset:50688
    v_mfma_f32_16x16x32_bf16 v[112:115], v[28:31], a[112:115], v[112:115]
    v_rcp_f32 v202, v202
    v_mfma_f32_16x16x32_bf16 v[116:119], v[24:27], a[100:103], v[116:119]
    buffer_load_dwordx4 v3, s[20:23], s38 offen  lds
    v_mfma_f32_16x16x32_bf16 v[116:119], v[28:31], a[116:119], v[116:119]
    v_rcp_f32 v203, v203
    v_mfma_f32_16x16x32_bf16 v[120:123], v[24:27], a[104:107], v[120:123]
    ds_read_b64_tr_b16 v[20:21], v6 offset:58368
    ds_read_b64_tr_b16 v[22:23], v6 offset:58880
    v_mfma_f32_16x16x32_bf16 v[120:123], v[28:31], a[120:123], v[120:123]
    v_mul_f32 v218, v218, v202
    v_mul_f32 v219, v219, v203
    v_mfma_f32_16x16x32_bf16 v[124:127], v[24:27], a[108:111], v[124:127]
    v_cvt_pk_bf16_f32 v48, v216, v217
    v_cvt_pk_bf16_f32 v49, v218, v219
    v_mfma_f32_16x16x32_bf16 v[124:127], v[28:31], a[124:127], v[124:127]
    v_add_u32 v6, 65536, v6
    s_waitcnt lgkmcnt(4)
    s_waitcnt vmcnt(5)
    v_mfma_f32_16x16x32_bf16 v[96:99], v[32:35], a[128:131], v[96:99]
    ds_read_b64_tr_b16 v[24:25], v6 offset:0
    ds_read_b64_tr_b16 v[26:27], v6 offset:512
    v_mfma_f32_16x16x32_bf16 v[96:99], v[36:39], a[144:147], v[96:99]
    buffer_store_dword v15, v14, s[8:11], 0 offen offset:0 sc1
    v_mfma_f32_16x16x32_bf16 v[100:103], v[32:35], a[132:135], v[100:103]
    v_fma_f32 v11, -v205, v205, s58
    v_mul_f32 v220, v220, v204
    v_mfma_f32_16x16x32_bf16 v[100:103], v[36:39], a[148:151], v[100:103]
    s_add_u32 m0, s51, 147456
    v_mul_f32 v221, v221, v205
    v_mfma_f32_16x16x32_bf16 v[104:107], v[32:35], a[136:139], v[104:107]
    ds_read_b64_tr_b16 v[28:29], v6 offset:8192
    ds_read_b64_tr_b16 v[30:31], v6 offset:8704
    v_mfma_f32_16x16x32_bf16 v[104:107], v[36:39], a[152:155], v[104:107]
    v_mul_f32 v204, v10, v204
    v_mul_f32 v205, v11, v205
    v_mfma_f32_16x16x32_bf16 v[108:111], v[32:35], a[140:143], v[108:111]
    v_exp_f32 v204, v204
    v_mfma_f32_16x16x32_bf16 v[108:111], v[36:39], a[156:159], v[108:111]
    v_fma_f32 v12, -v206, v206, s58
    s_waitcnt lgkmcnt(4)
    v_mfma_f32_16x16x32_bf16 v[112:115], v[16:19], a[128:131], v[112:115]
    ds_read_b64_tr_b16 v[32:33], v6 offset:1024
    ds_read_b64_tr_b16 v[34:35], v6 offset:1536
    v_mfma_f32_16x16x32_bf16 v[112:115], v[20:23], a[144:147], v[112:115]
    v_exp_f32 v205, v205
    v_mfma_f32_16x16x32_bf16 v[116:119], v[16:19], a[132:135], v[116:119]
    v_fma_f32 v13, -v207, v207, s58
    v_mul_f32 v222, v222, v206
    v_mfma_f32_16x16x32_bf16 v[116:119], v[20:23], a[148:151], v[116:119]
    v_mul_f32 v223, v223, v207
    v_mul_f32 v206, v12, v206
    v_mfma_f32_16x16x32_bf16 v[120:123], v[16:19], a[136:139], v[120:123]
    ds_read_b64_tr_b16 v[36:37], v6 offset:9216
    ds_read_b64_tr_b16 v[38:39], v6 offset:9728
    v_mfma_f32_16x16x32_bf16 v[120:123], v[20:23], a[152:155], v[120:123]
    buffer_load_dwordx4 v3, s[20:23], s40 offen  lds
    v_mfma_f32_16x16x32_bf16 v[124:127], v[16:19], a[140:143], v[124:127]
    v_mul_f32 v207, v13, v207
    v_add_f32 v204, 1.0, v204
    v_mfma_f32_16x16x32_bf16 v[124:127], v[20:23], a[156:159], v[124:127]
    v_add_f32 v205, 1.0, v205
    s_waitcnt lgkmcnt(4)
    v_mfma_f32_16x16x32_bf16 v[96:99], v[24:27], a[160:163], v[96:99]
    ds_read_b64_tr_b16 v[16:17], v6 offset:16384
    ds_read_b64_tr_b16 v[18:19], v6 offset:16896
    v_mfma_f32_16x16x32_bf16 v[96:99], v[28:31], a[176:179], v[96:99]
    v_exp_f32 v206, v206
    v_mfma_f32_16x16x32_bf16 v[100:103], v[24:27], a[164:167], v[100:103]
    v_exp_f32 v207, v207
    v_mfma_f32_16x16x32_bf16 v[100:103], v[28:31], a[180:183], v[100:103]
    v_rcp_f32 v204, v204
    v_mfma_f32_16x16x32_bf16 v[104:107], v[24:27], a[168:171], v[104:107]
    ds_read_b64_tr_b16 v[20:21], v6 offset:24576
    ds_read_b64_tr_b16 v[22:23], v6 offset:25088
    v_mfma_f32_16x16x32_bf16 v[104:107], v[28:31], a[184:187], v[104:107]
    s_add_u32 m0, s51, 151552
    v_add_f32 v206, 1.0, v206
    v_mfma_f32_16x16x32_bf16 v[108:111], v[24:27], a[172:175], v[108:111]
    v_rcp_f32 v205, v205
    v_mfma_f32_16x16x32_bf16 v[108:111], v[28:31], a[188:191], v[108:111]
    v_add_f32 v207, 1.0, v207
    s_waitcnt lgkmcnt(4)
    v_mfma_f32_16x16x32_bf16 v[112:115], v[32:35], a[160:163], v[112:115]
    ds_read_b64_tr_b16 v[24:25], v6 offset:17408
    ds_read_b64_tr_b16 v[26:27], v6 offset:17920
    v_mfma_f32_16x16x32_bf16 v[112:115], v[36:39], a[176:179], v[112:115]
    v_rcp_f32 v206, v206
    v_mfma_f32_16x16x32_bf16 v[116:119], v[32:35], a[164:167], v[116:119]
    v_rcp_f32 v207, v207
    v_mfma_f32_16x16x32_bf16 v[116:119], v[36:39], a[180:183], v[116:119]
    v_mul_f32 v220, v220, v204
    v_mul_f32 v221, v221, v205
    v_mfma_f32_16x16x32_bf16 v[120:123], v[32:35], a[168:171], v[120:123]
    ds_read_b64_tr_b16 v[28:29], v6 offset:25600
    ds_read_b64_tr_b16 v[30:31], v6 offset:26112
    v_mfma_f32_16x16x32_bf16 v[120:123], v[36:39], a[184:187], v[120:123]
    v_mul_f32 v222, v222, v206
    v_mul_f32 v223, v223, v207
    v_mfma_f32_16x16x32_bf16 v[124:127], v[32:35], a[172:175], v[124:127]
    buffer_load_dwordx4 v3, s[20:23], s42 offen  lds
    v_mfma_f32_16x16x32_bf16 v[124:127], v[36:39], a[188:191], v[124:127]
    v_cvt_pk_bf16_f32 v52, v220, v221
    s_waitcnt lgkmcnt(4)
    v_mfma_f32_16x16x32_bf16 v[96:99], v[16:19], a[192:195], v[96:99]
    ds_read_b64_tr_b16 v[32:33], v6 offset:32768
    ds_read_b64_tr_b16 v[34:35], v6 offset:33280
    v_mfma_f32_16x16x32_bf16 v[96:99], v[20:23], a[208:211], v[96:99]
    v_cvt_pk_bf16_f32 v53, v222, v223
    v_fma_f32 v10, -v64, v64, s58
    v_mfma_f32_16x16x32_bf16 v[100:103], v[16:19], a[196:199], v[100:103]
    v_fma_f32 v11, -v65, v65, s58
    v_mul_f32 v80, v80, v64
    v_mfma_f32_16x16x32_bf16 v[100:103], v[20:23], a[212:215], v[100:103]
    v_mul_f32 v81, v81, v65
    v_mul_f32 v64, v10, v64
    v_mfma_f32_16x16x32_bf16 v[104:107], v[16:19], a[200:203], v[104:107]
    ds_read_b64_tr_b16 v[36:37], v6 offset:40960
    ds_read_b64_tr_b16 v[38:39], v6 offset:41472
    v_mfma_f32_16x16x32_bf16 v[104:107], v[20:23], a[216:219], v[104:107]
    v_mul_f32 v65, v11, v65
    v_fma_f32 v12, -v66, v66, s58
    v_mfma_f32_16x16x32_bf16 v[108:111], v[16:19], a[204:207], v[108:111]
    v_exp_f32 v64, v64
    v_mfma_f32_16x16x32_bf16 v[108:111], v[20:23], a[220:223], v[108:111]
    v_fma_f32 v13, -v67, v67, s58
    s_waitcnt lgkmcnt(4)
    v_mfma_f32_16x16x32_bf16 v[112:115], v[24:27], a[192:195], v[112:115]
    ds_read_b64_tr_b16 v[16:17], v6 offset:33792
    ds_read_b64_tr_b16 v[18:19], v6 offset:34304
    v_mfma_f32_16x16x32_bf16 v[112:115], v[28:31], a[208:211], v[112:115]
    s_add_u32 m0, s51, 155648
    v_mul_f32 v82, v82, v66
    v_mfma_f32_16x16x32_bf16 v[116:119], v[24:27], a[196:199], v[116:119]
    v_exp_f32 v65, v65
    v_mfma_f32_16x16x32_bf16 v[116:119], v[28:31], a[212:215], v[116:119]
    v_mul_f32 v83, v83, v67
    v_mul_f32 v66, v12, v66
    v_mfma_f32_16x16x32_bf16 v[120:123], v[24:27], a[200:203], v[120:123]
    ds_read_b64_tr_b16 v[20:21], v6 offset:41984
    ds_read_b64_tr_b16 v[22:23], v6 offset:42496
    v_mfma_f32_16x16x32_bf16 v[120:123], v[28:31], a[216:219], v[120:123]
    v_mul_f32 v67, v13, v67
    v_add_f32 v64, 1.0, v64
    v_mfma_f32_16x16x32_bf16 v[124:127], v[24:27], a[204:207], v[124:127]
    v_exp_f32 v66, v66
    v_mfma_f32_16x16x32_bf16 v[124:127], v[28:31], a[220:223], v[124:127]
    v_add_f32 v65, 1.0, v65
    s_waitcnt lgkmcnt(4)
    v_mfma_f32_16x16x32_bf16 v[96:99], v[32:35], a[224:227], v[96:99]
    ds_read_b64_tr_b16 v[24:25], v6 offset:49152
    ds_read_b64_tr_b16 v[26:27], v6 offset:49664
    v_mfma_f32_16x16x32_bf16 v[96:99], v[36:39], a[240:243], v[96:99]
    v_exp_f32 v67, v67
    v_mfma_f32_16x16x32_bf16 v[100:103], v[32:35], a[228:231], v[100:103]
    buffer_load_dwordx4 v3, s[20:23], s44 offen  lds
    v_mfma_f32_16x16x32_bf16 v[100:103], v[36:39], a[244:247], v[100:103]
    v_rcp_f32 v64, v64
    v_mfma_f32_16x16x32_bf16 v[104:107], v[32:35], a[232:235], v[104:107]
    ds_read_b64_tr_b16 v[28:29], v6 offset:57344
    ds_read_b64_tr_b16 v[30:31], v6 offset:57856
    v_mfma_f32_16x16x32_bf16 v[104:107], v[36:39], a[248:251], v[104:107]
    v_rcp_f32 v65, v65
    v_mfma_f32_16x16x32_bf16 v[108:111], v[32:35], a[236:239], v[108:111]
    v_add_f32 v66, 1.0, v66
    v_add_f32 v67, 1.0, v67
    v_mfma_f32_16x16x32_bf16 v[108:111], v[36:39], a[252:255], v[108:111]
    v_mul_f32 v80, v80, v64
    s_waitcnt lgkmcnt(4)
    v_mfma_f32_16x16x32_bf16 v[112:115], v[16:19], a[224:227], v[112:115]
    ds_read_b64_tr_b16 v[32:33], v6 offset:50176
    ds_read_b64_tr_b16 v[34:35], v6 offset:50688
    v_mfma_f32_16x16x32_bf16 v[112:115], v[20:23], a[240:243], v[112:115]
Lpad5:
    s_cbranch_execz Lwret1
    v_rcp_f32 v66, v66
    v_mfma_f32_16x16x32_bf16 v[116:119], v[16:19], a[228:231], v[116:119]
    s_add_u32 m0, s51, 159744
    v_mul_f32 v81, v81, v65
    v_mfma_f32_16x16x32_bf16 v[116:119], v[20:23], a[244:247], v[116:119]
    v_rcp_f32 v67, v67
    v_mfma_f32_16x16x32_bf16 v[120:123], v[16:19], a[232:235], v[120:123]
    ds_read_b64_tr_b16 v[36:37], v6 offset:58368
    ds_read_b64_tr_b16 v[38:39], v6 offset:58880
    v_mfma_f32_16x16x32_bf16 v[120:123], v[20:23], a[248:251], v[120:123]
    v_mul_f32 v82, v82, v66
    v_mul_f32 v83, v83, v67
    v_mfma_f32_16x16x32_bf16 v[124:127], v[16:19], a[236:239], v[124:127]
    v_cvt_pk_bf16_f32 v42, v80, v81
    v_cvt_pk_bf16_f32 v43, v82, v83
    v_mfma_f32_16x16x32_bf16 v[124:127], v[20:23], a[252:255], v[124:127]
    v_fma_f32 v10, -v68, v68, s58
    s_waitcnt lgkmcnt(4)
    v_mfma_f32_16x16x32_bf16 v[96:99], v[24:27], v[224:227], v[96:99]
    ds_read_b64_tr_b16 v[16:17], v7 offset:32768
    ds_read_b64_tr_b16 v[18:19], v7 offset:33280
    v_mfma_f32_16x16x32_bf16 v[96:99], v[28:31], v[240:243], v[96:99]
    buffer_store_dwordx4 v[40:43], v1, s[8:11], s55 offen offset:0 sc1
    v_mfma_f32_16x16x32_bf16 v[100:103], v[24:27], v[228:231], v[100:103]
    v_fma_f32 v11, -v69, v69, s58
    v_mul_f32 v84, v84, v68
    v_mfma_f32_16x16x32_bf16 v[100:103], v[28:31], v[244:247], v[100:103]
    buffer_load_dwordx4 v3, s[20:23], s46 offen  lds
    v_mfma_f32_16x16x32_bf16 v[104:107], v[24:27], v[232:235], v[104:107]
    ds_read_b64_tr_b16 v[20:21], v7 offset:40960
    ds_read_b64_tr_b16 v[22:23], v7 offset:41472
    v_mfma_f32_16x16x32_bf16 v[104:107], v[28:31], v[248:251], v[104:107]
    v_mul_f32 v85, v85, v69
    v_mul_f32 v68, v10, v68
    v_mfma_f32_16x16x32_bf16 v[108:111], v[24:27], v[236:239], v[108:111]
    v_mul_f32 v69, v11, v69
    v_fma_f32 v12, -v70, v70, s58
    v_mfma_f32_16x16x32_bf16 v[108:111], v[28:31], v[252:255], v[108:111]
    v_fma_f32 v13, -v71, v71, s58
    s_waitcnt lgkmcnt(4)
    v_mfma_f32_16x16x32_bf16 v[112:115], v[32:35], v[224:227], v[112:115]
    ds_read_b64_tr_b16 v[24:25], v7 offset:33792
    ds_read_b64_tr_b16 v[26:27], v7 offset:34304
    v_mfma_f32_16x16x32_bf16 v[112:115], v[36:39], v[240:243], v[112:115]
    v_exp_f32 v68, v68
    v_mfma_f32_16x16x32_bf16 v[116:119], v[32:35], v[228:231], v[116:119]
    v_exp_f32 v69, v69
    v_mfma_f32_16x16x32_bf16 v[116:119], v[36:39], v[244:247], v[116:119]
    v_mul_f32 v86, v86, v70
    v_mul_f32 v87, v87, v71
    v_mfma_f32_16x16x32_bf16 v[120:123], v[32:35], v[232:235], v[120:123]
    ds_read_b64_tr_b16 v[28:29], v7 offset:41984
    ds_read_b64_tr_b16 v[30:31], v7 offset:42496
    v_mfma_f32_16x16x32_bf16 v[120:123], v[36:39], v[248:251], v[120:123]
    s_add_u32 m0, s51, 0
    v_mul_f32 v70, v12, v70
    v_mfma_f32_16x16x32_bf16 v[124:127], v[32:35], v[236:239], v[124:127]
    v_mul_f32 v71, v13, v71
    v_add_f32 v68, 1.0, v68
    v_mfma_f32_16x16x32_bf16 v[124:127], v[36:39], v[252:255], v[124:127]
    v_add_f32 v69, 1.0, v69
    s_waitcnt lgkmcnt(4)
    v_mfma_f32_16x16x32_bf16 v[128:131], v[16:19], a[96:99], v[128:131]
    ds_read_b64_tr_b16 v[32:33], v7 offset:49152
    ds_read_b64_tr_b16 v[34:35], v7 offset:49664
    v_mfma_f32_16x16x32_bf16 v[128:131], v[20:23], a[112:115], v[128:131]
    v_exp_f32 v70, v70
    v_mfma_f32_16x16x32_bf16 v[132:135], v[16:19], a[100:103], v[132:135]
    v_exp_f32 v71, v71
    v_mfma_f32_16x16x32_bf16 v[132:135], v[20:23], a[116:119], v[132:135]
    v_rcp_f32 v68, v68
    v_mfma_f32_16x16x32_bf16 v[136:139], v[16:19], a[104:107], v[136:139]
    ds_read_b64_tr_b16 v[36:37], v7 offset:57344
    ds_read_b64_tr_b16 v[38:39], v7 offset:57856
    v_mfma_f32_16x16x32_bf16 v[136:139], v[20:23], a[120:123], v[136:139]
    v_rcp_f32 v69, v69
    v_mfma_f32_16x16x32_bf16 v[140:143], v[16:19], a[108:111], v[140:143]
    buffer_load_dwordx4 v3, s[20:23], s48 offen  lds
    v_mfma_f32_16x16x32_bf16 v[140:143], v[20:23], a[124:127], v[140:143]
    v_add_f32 v70, 1.0, v70
    s_waitcnt lgkmcnt(4)
    v_mfma_f32_16x16x32_bf16 v[144:147], v[24:27], a[96:99], v[144:147]
    ds_read_b64_tr_b16 v[16:17], v7 offset:50176
    ds_read_b64_tr_b16 v[18:19], v7 offset:50688
    v_mfma_f32_16x16x32_bf16 v[144:147], v[28:31], a[112:115], v[144:147]
    v_add_f32 v71, 1.0, v71
    v_mul_f32 v92, v92, v76
    v_mfma_f32_16x16x32_bf16 v[148:151], v[24:27], a[100:103], v[148:151]
    v_rcp_f32 v70, v70
    v_rcp_f32 v71, v71
    v_pk_fma_f32 v[10:11], v[72:73], v[72:73], s[58:59] op_sel_hi:[1,1,0] neg_lo:[1,0,0] neg_hi:[1,0,0]
    v_pk_fma_f32 v[12:13], v[74:75], v[74:75], s[58:59] op_sel_hi:[1,1,0] neg_lo:[1,0,0] neg_hi:[1,0,0]
    v_pk_mul_f32 v[88:89], v[88:89], v[72:73]
    v_pk_mul_f32 v[90:91], v[90:91], v[74:75]
    v_pk_mul_f32 v[72:73], v[10:11], v[72:73]
    v_pk_mul_f32 v[74:75], v[12:13], v[74:75]
    v_pk_mul_f32 v[84:85], v[84:85], v[68:69]
    v_pk_mul_f32 v[86:87], v[86:87], v[70:71]
    v_mfma_f32_16x16x32_bf16 v[148:151], v[28:31], a[116:119], v[148:151]
    v_cvt_pk_bf16_f32 v46, v84, v85
    v_cvt_pk_bf16_f32 v47, v86, v87
    v_mfma_f32_16x16x32_bf16 v[152:155], v[24:27], a[104:107], v[152:155]
    ds_read_b64_tr_b16 v[20:21], v7 offset:58368
    ds_read_b64_tr_b16 v[22:23], v7 offset:58880
    v_mfma_f32_16x16x32_bf16 v[152:155], v[28:31], a[120:123], v[152:155]
    buffer_store_dwordx4 v[44:47], v1, s[8:11], s55 offen offset:1024 sc1
    v_mfma_f32_16x16x32_bf16 v[156:159], v[24:27], a[108:111], v[156:159]
    v_exp_f32 v72, v72
    v_mfma_f32_16x16x32_bf16 v[156:159], v[28:31], a[124:127], v[156:159]
    v_add_u32 v7, 65536, v7
    s_waitcnt lgkmcnt(4)
    v_mfma_f32_16x16x32_bf16 v[128:131], v[32:35], a[128:131], v[128:131]
    ds_read_b64_tr_b16 v[24:25], v7 offset:0
    ds_read_b64_tr_b16 v[26:27], v7 offset:512
    v_mfma_f32_16x16x32_bf16 v[128:131], v[36:39], a[144:147], v[128:131]
    v_exp_f32 v73, v73
    v_mfma_f32_16x16x32_bf16 v[132:135], v[32:35], a[132:135], v[132:135]
    v_exp_f32 v74, v74
    v_mfma_f32_16x16x32_bf16 v[132:135], v[36:39], a[148:151], v[132:135]
    v_exp_f32 v75, v75
    v_mfma_f32_16x16x32_bf16 v[136:139], v[32:35], a[136:139], v[136:139]
    ds_read_b64_tr_b16 v[28:29], v7 offset:8192
    ds_read_b64_tr_b16 v[30:31], v7 offset:8704
    v_mfma_f32_16x16x32_bf16 v[136:139], v[36:39], a[152:155], v[136:139]
    v_add_f32 v72, 1.0, v72
    v_add_f32 v73, 1.0, v73
    v_mfma_f32_16x16x32_bf16 v[140:143], v[32:35], a[140:143], v[140:143]
    v_rcp_f32 v72, v72
    v_mfma_f32_16x16x32_bf16 v[140:143], v[36:39], a[156:159], v[140:143]
    v_add_f32 v74, 1.0, v74
    s_waitcnt lgkmcnt(4)
    v_mfma_f32_16x16x32_bf16 v[144:147], v[16:19], a[128:131], v[144:147]
    ds_read_b64_tr_b16 v[32:33], v7 offset:1024
    ds_read_b64_tr_b16 v[34:35], v7 offset:1536
    v_mfma_f32_16x16x32_bf16 v[144:147], v[20:23], a[144:147], v[144:147]
    v_rcp_f32 v73, v73
    v_mfma_f32_16x16x32_bf16 v[148:151], v[16:19], a[132:135], v[148:151]
    v_add_f32 v75, 1.0, v75
    v_mul_f32 v88, v88, v72
    v_mfma_f32_16x16x32_bf16 v[148:151], v[20:23], a[148:151], v[148:151]
    v_rcp_f32 v74, v74
    v_mfma_f32_16x16x32_bf16 v[152:155], v[16:19], a[136:139], v[152:155]
    ds_read_b64_tr_b16 v[36:37], v7 offset:9216
    ds_read_b64_tr_b16 v[38:39], v7 offset:9728
    v_mfma_f32_16x16x32_bf16 v[152:155], v[20:23], a[152:155], v[152:155]
    v_rcp_f32 v75, v75
    v_mfma_f32_16x16x32_bf16 v[156:159], v[16:19], a[140:143], v[156:159]
    v_mul_f32 v89, v89, v73
    v_mul_f32 v90, v90, v74
    v_mfma_f32_16x16x32_bf16 v[156:159], v[20:23], a[156:159], v[156:159]
    v_mul_f32 v91, v91, v75
    s_waitcnt lgkmcnt(4)
    v_mfma_f32_16x16x32_bf16 v[128:131], v[24:27], a[160:163], v[128:131]
    ds_read_b64_tr_b16 v[16:17], v7 offset:16384
    ds_read_b64_tr_b16 v[18:19], v7 offset:16896
    v_mfma_f32_16x16x32_bf16 v[128:131], v[28:31], a[176:179], v[128:131]
    v_cvt_pk_bf16_f32 v50, v88, v89
    v_cvt_pk_bf16_f32 v51, v90, v91
    v_mfma_f32_16x16x32_bf16 v[132:135], v[24:27], a[164:167], v[132:135]
    buffer_store_dwordx4 v[48:51], v1, s[8:11], s55 offen offset:2048 sc1
    v_mfma_f32_16x16x32_bf16 v[132:135], v[28:31], a[180:183], v[132:135]
    v_fma_f32 v10, -v76, v76, s58
    v_fma_f32 v11, -v77, v77, s58
    v_mfma_f32_16x16x32_bf16 v[136:139], v[24:27], a[168:171], v[136:139]
    ds_read_b64_tr_b16 v[20:21], v7 offset:24576
    ds_read_b64_tr_b16 v[22:23], v7 offset:25088
    v_mfma_f32_16x16x32_bf16 v[136:139], v[28:31], a[184:187], v[136:139]
    v_mul_f32 v93, v93, v77
    v_mul_f32 v76, v10, v76
    v_mfma_f32_16x16x32_bf16 v[140:143], v[24:27], a[172:175], v[140:143]
    v_mul_f32 v77, v11, v77
    v_fma_f32 v12, -v78, v78, s58
    v_mfma_f32_16x16x32_bf16 v[140:143], v[28:31], a[188:191], v[140:143]
    v_fma_f32 v13, -v79, v79, s58
    s_waitcnt lgkmcnt(4)
    v_mfma_f32_16x16x32_bf16 v[144:147], v[32:35], a[160:163], v[144:147]
    ds_read_b64_tr_b16 v[24:25], v7 offset:17408
    ds_read_b64_tr_b16 v[26:27], v7 offset:17920
    v_mfma_f32_16x16x32_bf16 v[144:147], v[36:39], a[176:179], v[144:147]
    v_exp_f32 v76, v76
    v_mfma_f32_16x16x32_bf16 v[148:151], v[32:35], a[164:167], v[148:151]
    v_exp_f32 v77, v77
    v_mfma_f32_16x16x32_bf16 v[148:151], v[36:39], a[180:183], v[148:151]
    v_mul_f32 v94, v94, v78
    v_mul_f32 v95, v95, v79
    v_mfma_f32_16x16x32_bf16 v[152:155], v[32:35], a[168:171], v[152:155]
    ds_read_b64_tr_b16 v[28:29], v7 offset:25600
    ds_read_b64_tr_b16 v[30:31], v7 offset:26112
    v_mfma_f32_16x16x32_bf16 v[152:155], v[36:39], a[184:187], v[152:155]
    v_mul_f32 v78, v12, v78
    v_mul_f32 v79, v13, v79
    v_mfma_f32_16x16x32_bf16 v[156:159], v[32:35], a[172:175], v[156:159]
    v_exp_f32 v78, v78
    v_mfma_f32_16x16x32_bf16 v[156:159], v[36:39], a[188:191], v[156:159]
    v_add_f32 v76, 1.0, v76
    s_waitcnt lgkmcnt(4)
    v_mfma_f32_16x16x32_bf16 v[128:131], v[16:19], a[192:195], v[128:131]
    ds_read_b64_tr_b16 v[32:33], v7 offset:32768
    ds_read_b64_tr_b16 v[34:35], v7 offset:33280
    v_mfma_f32_16x16x32_bf16 v[128:131], v[20:23], a[208:211], v[128:131]
    v_exp_f32 v79, v79
    v_mfma_f32_16x16x32_bf16 v[132:135], v[16:19], a[196:199], v[132:135]
    v_add_f32 v77, 1.0, v77
    v_add_f32 v78, 1.0, v78
    v_mfma_f32_16x16x32_bf16 v[132:135], v[20:23], a[212:215], v[132:135]
    v_rcp_f32 v76, v76
    v_mfma_f32_16x16x32_bf16 v[136:139], v[16:19], a[200:203], v[136:139]
    ds_read_b64_tr_b16 v[36:37], v7 offset:40960
    ds_read_b64_tr_b16 v[38:39], v7 offset:41472
    v_mfma_f32_16x16x32_bf16 v[136:139], v[20:23], a[216:219], v[136:139]
    v_rcp_f32 v77, v77
    v_mfma_f32_16x16x32_bf16 v[140:143], v[16:19], a[204:207], v[140:143]
    v_add_f32 v79, 1.0, v79
    v_mul_f32 v92, v92, v76
    v_mfma_f32_16x16x32_bf16 v[140:143], v[20:23], a[220:223], v[140:143]
    v_mul_f32 v93, v93, v77
    s_waitcnt lgkmcnt(4)
    v_mfma_f32_16x16x32_bf16 v[144:147], v[24:27], a[192:195], v[144:147]
    ds_read_b64_tr_b16 v[16:17], v7 offset:33792
    ds_read_b64_tr_b16 v[18:19], v7 offset:34304
    v_mfma_f32_16x16x32_bf16 v[144:147], v[28:31], a[208:211], v[144:147]
    v_rcp_f32 v78, v78
    v_mfma_f32_16x16x32_bf16 v[148:151], v[24:27], a[196:199], v[148:151]
    v_rcp_f32 v79, v79
    v_mfma_f32_16x16x32_bf16 v[148:151], v[28:31], a[212:215], v[148:151]
    v_mul_f32 v94, v94, v78
    v_mul_f32 v95, v95, v79
    v_mfma_f32_16x16x32_bf16 v[152:155], v[24:27], a[200:203], v[152:155]
    ds_read_b64_tr_b16 v[20:21], v7 offset:41984
    ds_read_b64_tr_b16 v[22:23], v7 offset:42496
    v_mfma_f32_16x16x32_bf16 v[152:155], v[28:31], a[216:219], v[152:155]
    v_cvt_pk_bf16_f32 v54, v92, v93
    v_cvt_pk_bf16_f32 v55, v94, v95
    v_mfma_f32_16x16x32_bf16 v[156:159], v[24:27], a[204:207], v[156:159]
    buffer_store_dwordx4 v[52:55], v1, s[8:11], s55 offen offset:3072 sc1
    v_mfma_f32_16x16x32_bf16 v[156:159], v[28:31], a[220:223], v[156:159]
    v_fma_f32 v10, -v96, v96, s58
    s_waitcnt lgkmcnt(4)
    v_mfma_f32_16x16x32_bf16 v[128:131], v[32:35], a[224:227], v[128:131]
    ds_read_b64_tr_b16 v[24:25], v7 offset:49152
    ds_read_b64_tr_b16 v[26:27], v7 offset:49664
    v_mfma_f32_16x16x32_bf16 v[128:131], v[36:39], a[240:243], v[128:131]
    v_fma_f32 v11, -v97, v97, s58
    v_mul_f32 v112, v112, v96
    v_mfma_f32_16x16x32_bf16 v[132:135], v[32:35], a[228:231], v[132:135]
    v_mul_f32 v113, v113, v97
    v_mul_f32 v96, v10, v96
    v_mfma_f32_16x16x32_bf16 v[132:135], v[36:39], a[244:247], v[132:135]
    v_mul_f32 v97, v11, v97
    v_fma_f32 v12, -v98, v98, s58
    v_mfma_f32_16x16x32_bf16 v[136:139], v[32:35], a[232:235], v[136:139]
    ds_read_b64_tr_b16 v[28:29], v7 offset:57344
    ds_read_b64_tr_b16 v[30:31], v7 offset:57856
    v_mfma_f32_16x16x32_bf16 v[136:139], v[36:39], a[248:251], v[136:139]
    v_exp_f32 v96, v96
    v_mfma_f32_16x16x32_bf16 v[140:143], v[32:35], a[236:239], v[140:143]
    v_exp_f32 v97, v97
    v_mfma_f32_16x16x32_bf16 v[140:143], v[36:39], a[252:255], v[140:143]
    v_fma_f32 v13, -v99, v99, s58
    s_waitcnt lgkmcnt(4)
    v_mfma_f32_16x16x32_bf16 v[144:147], v[16:19], a[224:227], v[144:147]
    ds_read_b64_tr_b16 v[32:33], v7 offset:50176
    ds_read_b64_tr_b16 v[34:35], v7 offset:50688
    v_mfma_f32_16x16x32_bf16 v[144:147], v[20:23], a[240:243], v[144:147]
    v_mul_f32 v114, v114, v98
    v_mul_f32 v115, v115, v99
    v_mfma_f32_16x16x32_bf16 v[148:151], v[16:19], a[228:231], v[148:151]
    v_mul_f32 v98, v12, v98
    v_mul_f32 v99, v13, v99
    v_mfma_f32_16x16x32_bf16 v[148:151], v[20:23], a[244:247], v[148:151]
    v_exp_f32 v98, v98
    v_mfma_f32_16x16x32_bf16 v[152:155], v[16:19], a[232:235], v[152:155]
    ds_read_b64_tr_b16 v[36:37], v7 offset:58368
    ds_read_b64_tr_b16 v[38:39], v7 offset:58880
    v_mfma_f32_16x16x32_bf16 v[152:155], v[20:23], a[248:251], v[152:155]
    v_exp_f32 v99, v99
    v_mfma_f32_16x16x32_bf16 v[156:159], v[16:19], a[236:239], v[156:159]
    v_add_f32 v96, 1.0, v96
    v_add_f32 v97, 1.0, v97
    v_mfma_f32_16x16x32_bf16 v[156:159], v[20:23], a[252:255], v[156:159]
    v_add_u32 v9, 131072, v9
    s_waitcnt lgkmcnt(4)
    s_waitcnt vmcnt(3)
    s_barrier
    v_mfma_f32_16x16x32_bf16 v[128:131], v[24:27], v[224:227], v[128:131]
    ds_read_b64_tr_b16 v[16:17], v9 offset:0
    ds_read_b64_tr_b16 v[18:19], v9 offset:256
    v_mfma_f32_16x16x32_bf16 v[128:131], v[28:31], v[240:243], v[128:131]
    v_rcp_f32 v96, v96
    v_mfma_f32_16x16x32_bf16 v[132:135], v[24:27], v[228:231], v[132:135]
    v_rcp_f32 v97, v97
    v_mfma_f32_16x16x32_bf16 v[132:135], v[28:31], v[244:247], v[132:135]
    v_add_f32 v98, 1.0, v98
    v_add_f32 v99, 1.0, v99
    v_mfma_f32_16x16x32_bf16 v[136:139], v[24:27], v[232:235], v[136:139]
    ds_read_b64_tr_b16 v[20:21], v9 offset:2048
    ds_read_b64_tr_b16 v[22:23], v9 offset:2304
    v_mfma_f32_16x16x32_bf16 v[136:139], v[28:31], v[248:251], v[136:139]
    v_rcp_f32 v98, v98
    v_mfma_f32_16x16x32_bf16 v[140:143], v[24:27], v[236:239], v[140:143]
    v_rcp_f32 v99, v99
    v_mfma_f32_16x16x32_bf16 v[140:143], v[28:31], v[252:255], v[140:143]
    v_mul_f32 v112, v112, v96
    s_waitcnt lgkmcnt(4)
    v_mfma_f32_16x16x32_bf16 v[144:147], v[32:35], v[224:227], v[144:147]
    ds_read_b64_tr_b16 v[24:25], v9 offset:1024
    ds_read_b64_tr_b16 v[26:27], v9 offset:1280
    v_mfma_f32_16x16x32_bf16 v[144:147], v[36:39], v[240:243], v[144:147]
    v_mul_f32 v113, v113, v97
    v_mul_f32 v114, v114, v98
    v_mfma_f32_16x16x32_bf16 v[148:151], v[32:35], v[228:231], v[148:151]
    v_mul_f32 v115, v115, v99
    v_cvt_pk_bf16_f32 v40, v112, v113
    v_mfma_f32_16x16x32_bf16 v[148:151], v[36:39], v[244:247], v[148:151]
    v_cvt_pk_bf16_f32 v41, v114, v115
    v_fma_f32 v10, -v100, v100, s58
    v_mfma_f32_16x16x32_bf16 v[152:155], v[32:35], v[232:235], v[152:155]
    ds_read_b64_tr_b16 v[28:29], v9 offset:3072
    ds_read_b64_tr_b16 v[30:31], v9 offset:3328
    v_mfma_f32_16x16x32_bf16 v[152:155], v[36:39], v[248:251], v[152:155]
    v_fma_f32 v11, -v101, v101, s58
    v_mul_f32 v116, v116, v100
    v_mfma_f32_16x16x32_bf16 v[156:159], v[32:35], v[236:239], v[156:159]
    v_mul_f32 v117, v117, v101
    v_mul_f32 v100, v10, v100
    v_mfma_f32_16x16x32_bf16 v[156:159], v[36:39], v[252:255], v[156:159]
    v_mul_f32 v101, v11, v101
    s_waitcnt lgkmcnt(4)
    s_cmp_ge_u32 s2, 192
    s_cbranch_scc1 Lrole_ssm
    v_mfma_f32_16x16x32_bf16 v[160:163], v[16:19], a[0:3], 0
    ds_read_b64_tr_b16 v[32:33], v9 offset:4096
    ds_read_b64_tr_b16 v[34:35], v9 offset:4352
    v_fma_f32 v12, -v102, v102, s58
    v_mfma_f32_16x16x32_bf16 v[160:163], v[20:23], a[16:19], v[160:163]
    buffer_load_dword v57, v62, s[8:11], s74 offen offset:0 sc1
    v_fma_f32 v13, -v103, v103, s58
    v_mfma_f32_16x16x32_bf16 v[164:167], v[16:19], a[4:7], 0
    v_subrev_u32 v2, 896, v61
    v_subrev_u32 v3, 1792, v61
    v_mul_f32 v118, v118, v102
    v_mfma_f32_16x16x32_bf16 v[164:167], v[20:23], a[20:23], v[164:167]
    v_add_u32 v58, 36864, v61
    v_add_u32 v59, 35968, v61
    v_mul_f32 v119, v119, v103
    v_mfma_f32_16x16x32_bf16 v[168:171], v[16:19], a[8:11], 0
    ds_read_b64_tr_b16 v[36:37], v9 offset:6144
    ds_read_b64_tr_b16 v[38:39], v9 offset:6400
    v_mul_f32 v102, v12, v102
    v_mfma_f32_16x16x32_bf16 v[168:171], v[20:23], a[24:27], v[168:171]
    v_add_u32 v60, 35072, v61
    v_add_u32 v63, 4096, v1
    v_exp_f32 v100, v100
    v_mfma_f32_16x16x32_bf16 v[172:175], v[16:19], a[12:15], 0
    v_exp_f32 v101, v101
    v_mul_f32 v103, v13, v103
    v_mfma_f32_16x16x32_bf16 v[172:175], v[20:23], a[28:31], v[172:175]
    v_exp_f32 v102, v102
    s_waitcnt lgkmcnt(4)
    v_mfma_f32_16x16x32_bf16 v[176:179], v[24:27], a[0:3], 0
    ds_read_b64_tr_b16 v[16:17], v9 offset:5120
    ds_read_b64_tr_b16 v[18:19], v9 offset:5376
    v_add_f32 v100, 1.0, v100
    v_mfma_f32_16x16x32_bf16 v[176:179], v[28:31], a[16:19], v[176:179]
    s_add_u32 m0, s70, 0
    s_add_u32 s81, s71, 0
    v_add_f32 v101, 1.0, v101
    v_mfma_f32_16x16x32_bf16 v[180:183], v[24:27], a[4:7], 0
    buffer_load_dwordx4 v61, s[24:27], s81 offen offset:0  lds
    v_add_f32 v102, 1.0, v102
    v_mfma_f32_16x16x32_bf16 v[180:183], v[28:31], a[20:23], v[180:183]
    buffer_load_dwordx4 v2, s[24:27], s81 offen offset:1024  lds
    v_mul_f32 v124, v124, v108
    v_mfma_f32_16x16x32_bf16 v[184:187], v[24:27], a[8:11], 0
    ds_read_b64_tr_b16 v[20:21], v9 offset:7168
    ds_read_b64_tr_b16 v[22:23], v9 offset:7424
    v_mul_f32 v125, v125, v109
    v_mfma_f32_16x16x32_bf16 v[184:187], v[28:31], a[24:27], v[184:187]
    buffer_load_dwordx4 v3, s[24:27], s81 offen offset:2048  lds
    v_mfma_f32_16x16x32_bf16 v[188:191], v[24:27], a[12:15], 0
    s_add_u32 m0, s70, 12288
    v_exp_f32 v103, v103
    v_mfma_f32_16x16x32_bf16 v[188:191], v[28:31], a[28:31], v[188:191]
    v_rcp_f32 v100, v100
    v_add_f32 v103, 1.0, v103
    s_waitcnt lgkmcnt(4)
    v_mfma_f32_16x16x32_bf16 v[160:163], v[32:35], a[32:35], v[160:163]
    ds_read_b64_tr_b16 v[24:25], v9 offset:8192
    ds_read_b64_tr_b16 v[26:27], v9 offset:8448
    v_mfma_f32_16x16x32_bf16 v[160:163], v[36:39], a[48:51], v[160:163]
    buffer_load_dwordx4 v58, s[24:27], s81 offen offset:0  lds
    v_rcp_f32 v101, v101
    v_mul_f32 v126, v126, v110
    v_mfma_f32_16x16x32_bf16 v[164:167], v[32:35], a[36:39], v[164:167]
    buffer_load_dwordx4 v59, s[24:27], s81 offen offset:1024  lds
    v_mul_f32 v127, v127, v111
    v_mfma_f32_16x16x32_bf16 v[164:167], v[36:39], a[52:55], v[164:167]
    buffer_load_dwordx4 v60, s[24:27], s81 offen offset:2048  lds
    v_mfma_f32_16x16x32_bf16 v[168:171], v[32:35], a[40:43], v[168:171]
    ds_read_b64_tr_b16 v[28:29], v9 offset:10240
    ds_read_b64_tr_b16 v[30:31], v9 offset:10496
    v_mfma_f32_16x16x32_bf16 v[168:171], v[36:39], a[56:59], v[168:171]
    s_add_u32 m0, s70, 24576
    s_add_u32 s81, s71, 147456
    v_mfma_f32_16x16x32_bf16 v[172:175], v[32:35], a[44:47], v[172:175]
    v_rcp_f32 v102, v102
    v_rcp_f32 v103, v103
    v_pk_fma_f32 v[10:11], v[104:105], v[104:105], s[58:59] op_sel_hi:[1,1,0] neg_lo:[1,0,0] neg_hi:[1,0,0]
    v_pk_fma_f32 v[12:13], v[106:107], v[106:107], s[58:59] op_sel_hi:[1,1,0] neg_lo:[1,0,0] neg_hi:[1,0,0]
    v_pk_mul_f32 v[120:121], v[120:121], v[104:105]
    v_pk_mul_f32 v[122:123], v[122:123], v[106:107]
    v_pk_mul_f32 v[104:105], v[10:11], v[104:105]
    v_pk_mul_f32 v[106:107], v[12:13], v[106:107]
    v_pk_mul_f32 v[116:117], v[116:117], v[100:101]
    v_pk_mul_f32 v[118:119], v[118:119], v[102:103]
    v_mfma_f32_16x16x32_bf16 v[172:175], v[36:39], a[60:63], v[172:175]
    v_cvt_pk_bf16_f32 v44, v116, v117
    v_cvt_pk_bf16_f32 v45, v118, v119
    s_waitcnt lgkmcnt(4)
    v_mfma_f32_16x16x32_bf16 v[176:179], v[16:19], a[32:35], v[176:179]
    ds_read_b64_tr_b16 v[32:33], v9 offset:9216
    ds_read_b64_tr_b16 v[34:35], v9 offset:9472
    v_exp_f32 v104, v104
    v_mfma_f32_16x16x32_bf16 v[176:179], v[20:23], a[48:51], v[176:179]
    buffer_load_dwordx4 v61, s[24:27], s81 offen offset:0  lds
    v_add_f32 v104, 1.0, v104
    v_mfma_f32_16x16x32_bf16 v[180:183], v[16:19], a[36:39], v[180:183]
    buffer_load_dwordx4 v2, s[24:27], s81 offen offset:1024  lds
    v_fma_f32 v10, -v108, v108, s58
    v_mfma_f32_16x16x32_bf16 v[180:183], v[20:23], a[52:55], v[180:183]
    buffer_load_dwordx4 v3, s[24:27], s81 offen offset:2048  lds
    v_fma_f32 v11, -v109, v109, s58
    v_mfma_f32_16x16x32_bf16 v[184:187], v[16:19], a[40:43], v[184:187]
    ds_read_b64_tr_b16 v[36:37], v9 offset:11264
    ds_read_b64_tr_b16 v[38:39], v9 offset:11520
    v_mul_f32 v108, v10, v108
    v_mfma_f32_16x16x32_bf16 v[184:187], v[20:23], a[56:59], v[184:187]
    s_add_u32 m0, s70, 36864
    v_exp_f32 v105, v105
    v_mfma_f32_16x16x32_bf16 v[188:191], v[16:19], a[44:47], v[188:191]
    buffer_load_dwordx4 v58, s[24:27], s81 offen offset:0  lds
    v_exp_f32 v106, v106
    v_mfma_f32_16x16x32_bf16 v[188:191], v[20:23], a[60:63], v[188:191]
    v_exp_f32 v107, v107
    s_waitcnt lgkmcnt(4)
    v_mfma_f32_16x16x32_bf16 v[160:163], v[24:27], a[64:67], v[160:163]
    ds_read_b64_tr_b16 v[16:17], v9 offset:12288
    ds_read_b64_tr_b16 v[18:19], v9 offset:12544
    v_add_f32 v105, 1.0, v105
    v_mfma_f32_16x16x32_bf16 v[160:163], v[28:31], a[80:83], v[160:163]
    buffer_load_dwordx4 v59, s[24:27], s81 offen offset:1024  lds
    v_add_f32 v106, 1.0, v106
    v_mfma_f32_16x16x32_bf16 v[164:167], v[24:27], a[68:71], v[164:167]
    buffer_load_dwordx4 v60, s[24:27], s81 offen offset:2048  lds
    v_add_f32 v107, 1.0, v107
    v_mfma_f32_16x16x32_bf16 v[164:167], v[28:31], a[84:87], v[164:167]
    v_mov_b32 v4, v56
    v_xor_b32 v5, 32, v56
    v_rcp_f32 v104, v104
    v_mfma_f32_16x16x32_bf16 v[168:171], v[24:27], a[72:75], v[168:171]
    ds_read_b64_tr_b16 v[20:21], v9 offset:14336
    ds_read_b64_tr_b16 v[22:23], v9 offset:14592
    v_mul_f32 v120, v120, v104
    v_mfma_f32_16x16x32_bf16 v[168:171], v[28:31], a[88:91], v[168:171]
    v_xor_b32 v6, 64, v56
    v_xor_b32 v7, 96, v56
    v_mul_f32 v109, v11, v109
    v_mfma_f32_16x16x32_bf16 v[172:175], v[24:27], a[76:79], v[172:175]
    v_rcp_f32 v105, v105
    v_fma_f32 v12, -v110, v110, s58
    v_mfma_f32_16x16x32_bf16 v[172:175], v[28:31], a[92:95], v[172:175]
    v_mul_f32 v121, v121, v105
    s_waitcnt lgkmcnt(4)
    s_waitcnt vmcnt(12)
    v_cmp_ne_u32 vcc, v57, v15
    s_cbranch_vccnz Lspin4
Lback4:
    v_mfma_f32_16x16x32_bf16 v[176:179], v[32:35], a[64:67], v[176:179]
    ds_read_b64_tr_b16 v[24:25], v9 offset:13312
    ds_read_b64_tr_b16 v[26:27], v9 offset:13568
    v_rcp_f32 v106, v106
    v_mfma_f32_16x16x32_bf16 v[176:179], v[36:39], a[80:83], v[176:179]
    s_add_u32 s82, s72, 0
    v_rcp_f32 v107, v107
    v_mfma_f32_16x16x32_bf16 v[180:183], v[32:35], a[68:71], v[180:183]
    buffer_load_dwordx4 a[0:3], v1, s[8:11], s82 offen offset:0 sc1
    v_mul_f32 v122, v122, v106
    v_mfma_f32_16x16x32_bf16 v[180:183], v[36:39], a[84:87], v[180:183]
    v_mul_f32 v123, v123, v107
    v_cvt_pk_bf16_f32 v48, v120, v121
    v_cvt_pk_bf16_f32 v49, v122, v123
    v_mfma_f32_16x16x32_bf16 v[184:187], v[32:35], a[72:75], v[184:187]
    ds_read_b64_tr_b16 v[28:29], v9 offset:15360
    ds_read_b64_tr_b16 v[30:31], v9 offset:15616
    v_fma_f32 v13, -v111, v111, s58
    v_mfma_f32_16x16x32_bf16 v[184:187], v[36:39], a[88:91], v[184:187]
    buffer_load_dwordx4 a[4:7], v1, s[8:11], s82 offen offset:1024 sc1
    v_exp_f32 v108, v108
    v_mfma_f32_16x16x32_bf16 v[188:191], v[32:35], a[76:79], v[188:191]
    v_exp_f32 v109, v109
    v_mul_f32 v110, v12, v110
    v_mfma_f32_16x16x32_bf16 v[188:191], v[36:39], a[92:95], v[188:191]
    v_mul_f32 v111, v13, v111
    v_add_f32 v108, 1.0, v108
    s_waitcnt lgkmcnt(4)
    v_mfma_f32_16x16x32_bf16 v[160:163], v[16:19], a[96:99], v[160:163]
    ds_read_b64_tr_b16 v[32:33], v9 offset:16384
    ds_read_b64_tr_b16 v[34:35], v9 offset:16640
    v_add_f32 v109, 1.0, v109
    v_mfma_f32_16x16x32_bf16 v[160:163], v[20:23], a[112:115], v[160:163]
    buffer_load_dwordx4 a[8:11], v63, s[8:11], s82 offen offset:0 sc1
    v_mfma_f32_16x16x32_bf16 v[164:167], v[16:19], a[100:103], v[164:167]
    v_exp_f32 v110, v110
    v_exp_f32 v111, v111
    v_mfma_f32_16x16x32_bf16 v[164:167], v[20:23], a[116:119], v[164:167]
    buffer_load_dwordx4 a[12:15], v63, s[8:11], s82 offen offset:1024 sc1
    v_rcp_f32 v108, v108
    v_mfma_f32_16x16x32_bf16 v[168:171], v[16:19], a[104:107], v[168:171]
    ds_read_b64_tr_b16 v[36:37], v9 offset:18432
    ds_read_b64_tr_b16 v[38:39], v9 offset:18688
    v_add_f32 v110, 1.0, v110
    v_mfma_f32_16x16x32_bf16 v[168:171], v[20:23], a[120:123], v[168:171]
    v_rcp_f32 v109, v109
    v_add_f32 v111, 1.0, v111
    v_mfma_f32_16x16x32_bf16 v[172:175], v[16:19], a[108:111], v[172:175]
    s_add_u32 s82, s72, 16384
    v_rcp_f32 v110, v110
    v_mfma_f32_16x16x32_bf16 v[172:175], v[20:23], a[124:127], v[172:175]
    v_rcp_f32 v111, v111
    v_mul_f32 v124, v124, v108
    s_waitcnt lgkmcnt(4)
    v_mfma_f32_16x16x32_bf16 v[176:179], v[24:27], a[96:99], v[176:179]
    ds_read_b64_tr_b16 v[16:17], v9 offset:17408
    ds_read_b64_tr_b16 v[18:19], v9 offset:17664
    v_mul_f32 v125, v125, v109
    v_mfma_f32_16x16x32_bf16 v[176:179], v[28:31], a[112:115], v[176:179]
    v_mul_f32 v126, v126, v110
    v_mul_f32 v127, v127, v111
    v_cvt_pk_bf16_f32 v52, v124, v125
    v_mfma_f32_16x16x32_bf16 v[180:183], v[24:27], a[100:103], v[180:183]
    buffer_load_dwordx4 a[16:19], v1, s[8:11], s82 offen offset:0 sc1
    v_cvt_pk_bf16_f32 v53, v126, v127
    v_mfma_f32_16x16x32_bf16 v[180:183], v[28:31], a[116:119], v[180:183]
    v_fma_f32 v10, -v128, v128, s58
    v_fma_f32 v11, -v129, v129, s58
    v_mfma_f32_16x16x32_bf16 v[184:187], v[24:27], a[104:107], v[184:187]
    ds_read_b64_tr_b16 v[20:21], v9 offset:19456
    ds_read_b64_tr_b16 v[22:23], v9 offset:19712
    v_mul_f32 v144, v144, v128
    v_mfma_f32_16x16x32_bf16 v[184:187], v[28:31], a[120:123], v[184:187]
    buffer_load_dwordx4 a[20:23], v1, s[8:11], s82 offen offset:1024 sc1
    v_mfma_f32_16x16x32_bf16 v[188:191], v[24:27], a[108:111], v[188:191]
    v_mul_f32 v145, v145, v129
    v_mul_f32 v128, v10, v128
    v_mul_f32 v129, v11, v129
    v_mfma_f32_16x16x32_bf16 v[188:191], v[28:31], a[124:127], v[188:191]
    v_fma_f32 v12, -v130, v130, s58
    s_waitcnt lgkmcnt(4)
    v_mfma_f32_16x16x32_bf16 v[160:163], v[32:35], a[128:131], v[160:163]
    ds_read_b64_tr_b16 v[24:25], v9 offset:20480
    ds_read_b64_tr_b16 v[26:27], v9 offset:20736
    v_mfma_f32_16x16x32_bf16 v[160:163], v[36:39], a[144:147], v[160:163]
    buffer_load_dwordx4 a[24:27], v63, s[8:11], s82 offen offset:0 sc1
    v_fma_f32 v13, -v131, v131, s58
    v_mfma_f32_16x16x32_bf16 v[164:167], v[32:35], a[132:135], v[164:167]
    v_exp_f32 v128, v128
    v_mfma_f32_16x16x32_bf16 v[164:167], v[36:39], a[148:151], v[164:167]
    buffer_load_dwordx4 a[28:31], v63, s[8:11], s82 offen offset:1024 sc1
    v_mul_f32 v146, v146, v130
    v_mfma_f32_16x16x32_bf16 v[168:171], v[32:35], a[136:139], v[168:171]
    ds_read_b64_tr_b16 v[28:29], v9 offset:22528
    ds_read_b64_tr_b16 v[30:31], v9 offset:22784
    v_mfma_f32_16x16x32_bf16 v[168:171], v[36:39], a[152:155], v[168:171]
    v_exp_f32 v129, v129
    v_mul_f32 v147, v147, v131
    v_mfma_f32_16x16x32_bf16 v[172:175], v[32:35], a[140:143], v[172:175]
    s_add_u32 m0, s70, 49152
    s_add_u32 s81, s71, 294912
    v_mfma_f32_16x16x32_bf16 v[172:175], v[36:39], a[156:159], v[172:175]
    v_mul_f32 v130, v12, v130
    v_mul_f32 v131, v13, v131
    s_waitcnt lgkmcnt(4)
    v_mfma_f32_16x16x32_bf16 v[176:179], v[16:19], a[128:131], v[176:179]
    ds_read_b64_tr_b16 v[32:33], v9 offset:21504
    ds_read_b64_tr_b16 v[34:35], v9 offset:21760
    v_mfma_f32_16x16x32_bf16 v[176:179], v[20:23], a[144:147], v[176:179]
    v_exp_f32 v130, v130
    v_add_f32 v128, 1.0, v128
    v_mfma_f32_16x16x32_bf16 v[180:183], v[16:19], a[132:135], v[180:183]
    buffer_load_dwordx4 v61, s[24:27], s81 offen offset:0  lds
    v_mfma_f32_16x16x32_bf16 v[180:183], v[20:23], a[148:151], v[180:183]
    v_exp_f32 v131, v131
    v_add_f32 v129, 1.0, v129
    v_mfma_f32_16x16x32_bf16 v[184:187], v[16:19], a[136:139], v[184:187]
    ds_read_b64_tr_b16 v[36:37], v9 offset:23552
    ds_read_b64_tr_b16 v[38:39], v9 offset:23808
    v_mfma_f32_16x16x32_bf16 v[184:187], v[20:23], a[152:155], v[184:187]
    buffer_load_dwordx4 v2, s[24:27], s81 offen offset:1024  lds
    v_add_f32 v130, 1.0, v130
    v_mfma_f32_16x16x32_bf16 v[188:191], v[16:19], a[140:143], v[188:191]
    v_rcp_f32 v128, v128
    v_mfma_f32_16x16x32_bf16 v[188:191], v[20:23], a[156:159], v[188:191]
    v_rcp_f32 v129, v129
    s_waitcnt lgkmcnt(4)
    v_mfma_f32_16x16x32_bf16 v[160:163], v[24:27], a[160:163], v[160:163]
    ds_read_b64_tr_b16 v[16:17], v9 offset:24576
    ds_read_b64_tr_b16 v[18:19], v9 offset:24832
    v_mfma_f32_16x16x32_bf16 v[160:163], v[28:31], a[176:179], v[160:163]
    buffer_load_dwordx4 v3, s[24:27], s81 offen offset:2048  lds
    v_add_f32 v131, 1.0, v131
    v_mfma_f32_16x16x32_bf16 v[164:167], v[24:27], a[164:167], v[164:167]
    v_rcp_f32 v130, v130
    v_rcp_f32 v131, v131
    v_pk_fma_f32 v[10:11], v[132:133], v[132:133], s[58:59] op_sel_hi:[1,1,0] neg_lo:[1,0,0] neg_hi:[1,0,0]
    v_pk_fma_f32 v[12:13], v[134:135], v[134:135], s[58:59] op_sel_hi:[1,1,0] neg_lo:[1,0,0] neg_hi:[1,0,0]
    v_pk_mul_f32 v[148:149], v[148:149], v[132:133]
Lpad6:
    s_cbranch_execz Lwret1
    v_pk_mul_f32 v[150:151], v[150:151], v[134:135]
    v_pk_mul_f32 v[132:133], v[10:11], v[132:133]
    v_pk_mul_f32 v[134:135], v[12:13], v[134:135]
    v_pk_mul_f32 v[144:145], v[144:145], v[128:129]
    v_pk_mul_f32 v[146:147], v[146:147], v[130:131]
    v_mfma_f32_16x16x32_bf16 v[164:167], v[28:31], a[180:183], v[164:167]
    s_add_u32 s82, s72, 32768
    v_cvt_pk_bf16_f32 v42, v144, v145
    v_mfma_f32_16x16x32_bf16 v[168:171], v[24:27], a[168:171], v[168:171]
    ds_read_b64_tr_b16 v[20:21], v9 offset:26624
    ds_read_b64_tr_b16 v[22:23], v9 offset:26880
    v_cvt_pk_bf16_f32 v43, v146, v147
    v_mfma_f32_16x16x32_bf16 v[168:171], v[28:31], a[184:187], v[168:171]
    buffer_store_dwordx4 v[40:43], v1, s[8:11], s56 offen offset:0 sc1
    v_mfma_f32_16x16x32_bf16 v[172:175], v[24:27], a[172:175], v[172:175]
    buffer_load_dwordx4 a[32:35], v1, s[8:11], s82 offen offset:0 sc1
    v_mfma_f32_16x16x32_bf16 v[172:175], v[28:31], a[188:191], v[172:175]
    v_exp_f32 v132, v132
    s_waitcnt lgkmcnt(4)
    v_mfma_f32_16x16x32_bf16 v[176:179], v[32:35], a[160:163], v[176:179]
    ds_read_b64_tr_b16 v[24:25], v9 offset:25600
    ds_read_b64_tr_b16 v[26:27], v9 offset:25856
    v_add_f32 v132, 1.0, v132
    v_mfma_f32_16x16x32_bf16 v[176:179], v[36:39], a[176:179], v[176:179]
    v_exp_f32 v133, v133
    v_mfma_f32_16x16x32_bf16 v[180:183], v[32:35], a[164:167], v[180:183]
    buffer_load_dwordx4 a[36:39], v1, s[8:11], s82 offen offset:1024 sc1
    v_add_f32 v133, 1.0, v133
    v_mfma_f32_16x16x32_bf16 v[180:183], v[36:39], a[180:183], v[180:183]
    v_exp_f32 v134, v134
    v_mfma_f32_16x16x32_bf16 v[184:187], v[32:35], a[168:171], v[184:187]
    ds_read_b64_tr_b16 v[28:29], v9 offset:27648
    ds_read_b64_tr_b16 v[30:31], v9 offset:27904
    v_add_f32 v134, 1.0, v134
    v_mfma_f32_16x16x32_bf16 v[184:187], v[36:39], a[184:187], v[184:187]
    s_add_u32 m0, s70, 61440
    v_mfma_f32_16x16x32_bf16 v[188:191], v[32:35], a[172:175], v[188:191]
    v_exp_f32 v135, v135
    v_mfma_f32_16x16x32_bf16 v[188:191], v[36:39], a[188:191], v[188:191]
    v_rcp_f32 v132, v132
    s_waitcnt lgkmcnt(4)
    v_mfma_f32_16x16x32_bf16 v[160:163], v[16:19], a[192:195], v[160:163]
    ds_read_b64_tr_b16 v[32:33], v9 offset:28672
    ds_read_b64_tr_b16 v[34:35], v9 offset:28928
    v_add_f32 v135, 1.0, v135
    v_mfma_f32_16x16x32_bf16 v[160:163], v[20:23], a[208:211], v[160:163]
    buffer_load_dwordx4 v58, s[24:27], s81 offen offset:0  lds
    v_mfma_f32_16x16x32_bf16 v[164:167], v[16:19], a[196:199], v[164:167]
    v_rcp_f32 v133, v133
    v_mfma_f32_16x16x32_bf16 v[164:167], v[20:23], a[212:215], v[164:167]
    buffer_load_dwordx4 v59, s[24:27], s81 offen offset:1024  lds
    v_mfma_f32_16x16x32_bf16 v[168:171], v[16:19], a[200:203], v[168:171]
    ds_read_b64_tr_b16 v[36:37], v9 offset:30720
    ds_read_b64_tr_b16 v[38:39], v9 offset:30976
    v_mfma_f32_16x16x32_bf16 v[168:171], v[20:23], a[216:219], v[168:171]
    v_rcp_f32 v134, v134
    v_rcp_f32 v135, v135
    v_pk_fma_f32 v[10:11], v[136:137], v[136:137], s[58:59] op_sel_hi:[1,1,0] neg_lo:[1,0,0] neg_hi:[1,0,0]
    v_pk_fma_f32 v[12:13], v[138:139], v[138:139], s[58:59] op_sel_hi:[1,1,0] neg_lo:[1,0,0] neg_hi:[1,0,0]
    v_pk_mul_f32 v[152:153], v[152:153], v[136:137]
    v_pk_mul_f32 v[154:155], v[154:155], v[138:139]
    v_pk_mul_f32 v[136:137], v[10:11], v[136:137]
    v_pk_mul_f32 v[138:139], v[12:13], v[138:139]
    v_pk_mul_f32 v[148:149], v[148:149], v[132:133]
    v_pk_mul_f32 v[150:151], v[150:151], v[134:135]
    v_mfma_f32_16x16x32_bf16 v[172:175], v[16:19], a[204:207], v[172:175]
    buffer_load_dwordx4 v60, s[24:27], s81 offen offset:2048  lds
    v_cvt_pk_bf16_f32 v46, v148, v149
    v_mfma_f32_16x16x32_bf16 v[172:175], v[20:23], a[220:223], v[172:175]
    v_cvt_pk_bf16_f32 v47, v150, v151
    s_waitcnt lgkmcnt(4)
    v_mfma_f32_16x16x32_bf16 v[176:179], v[24:27], a[192:195], v[176:179]
    ds_read_b64_tr_b16 v[16:17], v9 offset:29696
    ds_read_b64_tr_b16 v[18:19], v9 offset:29952
    v_mfma_f32_16x16x32_bf16 v[176:179], v[28:31], a[208:211], v[176:179]
    buffer_store_dwordx4 v[44:47], v1, s[8:11], s56 offen offset:1024 sc1
    v_exp_f32 v136, v136
    v_mfma_f32_16x16x32_bf16 v[180:183], v[24:27], a[196:199], v[180:183]
    buffer_load_dwordx4 a[40:43], v63, s[8:11], s82 offen offset:0 sc1
    v_mfma_f32_16x16x32_bf16 v[180:183], v[28:31], a[212:215], v[180:183]
    v_exp_f32 v137, v137
    v_add_f32 v136, 1.0, v136
    v_mfma_f32_16x16x32_bf16 v[184:187], v[24:27], a[200:203], v[184:187]
    ds_read_b64_tr_b16 v[20:21], v9 offset:31744
    ds_read_b64_tr_b16 v[22:23], v9 offset:32000
    v_mfma_f32_16x16x32_bf16 v[184:187], v[28:31], a[216:219], v[184:187]
    buffer_load_dwordx4 a[44:47], v63, s[8:11], s82 offen offset:1024 sc1
    v_add_f32 v137, 1.0, v137
    v_mfma_f32_16x16x32_bf16 v[188:191], v[24:27], a[204:207], v[188:191]
    v_exp_f32 v138, v138
    v_mfma_f32_16x16x32_bf16 v[188:191], v[28:31], a[220:223], v[188:191]
    v_add_u32 v9, 4294836224, v9
    s_waitcnt lgkmcnt(4)
    v_mfma_f32_16x16x32_bf16 v[160:163], v[32:35], a[224:227], v[160:163]
    ds_read_b64_tr_b16 v[24:25], v9 offset:0
    ds_read_b64_tr_b16 v[26:27], v9 offset:256
    v_add_f32 v138, 1.0, v138
    v_mfma_f32_16x16x32_bf16 v[160:163], v[36:39], a[240:243], v[160:163]
    s_add_u32 s82, s72, 49152
    v_exp_f32 v139, v139
    v_mfma_f32_16x16x32_bf16 v[164:167], v[32:35], a[228:231], v[164:167]
    v_rcp_f32 v136, v136
    v_mfma_f32_16x16x32_bf16 v[164:167], v[36:39], a[244:247], v[164:167]
    buffer_load_dwordx4 a[48:51], v1, s[8:11], s82 offen offset:0 sc1
    v_add_f32 v139, 1.0, v139
    v_mfma_f32_16x16x32_bf16 v[168:171], v[32:35], a[232:235], v[168:171]
    ds_read_b64_tr_b16 v[28:29], v9 offset:2048
    ds_read_b64_tr_b16 v[30:31], v9 offset:2304
    v_mfma_f32_16x16x32_bf16 v[168:171], v[36:39], a[248:251], v[168:171]
    v_rcp_f32 v137, v137
    v_mfma_f32_16x16x32_bf16 v[172:175], v[32:35], a[236:239], v[172:175]
    buffer_load_dwordx4 a[52:55], v1, s[8:11], s82 offen offset:1024 sc1
    v_mfma_f32_16x16x32_bf16 v[172:175], v[36:39], a[252:255], v[172:175]
    s_waitcnt lgkmcnt(4)
    v_mfma_f32_16x16x32_bf16 v[176:179], v[16:19], a[224:227], v[176:179]
    ds_read_b64_tr_b16 v[32:33], v9 offset:1024
    ds_read_b64_tr_b16 v[34:35], v9 offset:1280
    v_mfma_f32_16x16x32_bf16 v[176:179], v[20:23], a[240:243], v[176:179]
    v_rcp_f32 v138, v138
    v_rcp_f32 v139, v139
    v_pk_fma_f32 v[10:11], v[140:141], v[140:141], s[58:59] op_sel_hi:[1,1,0] neg_lo:[1,0,0] neg_hi:[1,0,0]
    v_pk_fma_f32 v[12:13], v[142:143], v[142:143], s[58:59] op_sel_hi:[1,1,0] neg_lo:[1,0,0] neg_hi:[1,0,0]
    v_pk_mul_f32 v[156:157], v[156:157], v[140:141]
    v_pk_mul_f32 v[158:159], v[158:159], v[142:143]
    v_pk_mul_f32 v[140:141], v[10:11], v[140:141]
    v_pk_mul_f32 v[142:143], v[12:13], v[142:143]
    v_pk_mul_f32 v[152:153], v[152:153], v[136:137]
    v_pk_mul_f32 v[154:155], v[154:155], v[138:139]
    v_mfma_f32_16x16x32_bf16 v[180:183], v[16:19], a[228:231], v[180:183]
    buffer_load_dwordx4 a[56:59], v63, s[8:11], s82 offen offset:0 sc1
    v_mfma_f32_16x16x32_bf16 v[180:183], v[20:23], a[244:247], v[180:183]
    v_cvt_pk_bf16_f32 v50, v152, v153
    v_cvt_pk_bf16_f32 v51, v154, v155
    v_mfma_f32_16x16x32_bf16 v[184:187], v[16:19], a[232:235], v[184:187]
    ds_read_b64_tr_b16 v[36:37], v9 offset:3072
    ds_read_b64_tr_b16 v[38:39], v9 offset:3328
    buffer_store_dwordx4 v[48:51], v1, s[8:11], s56 offen offset:2048 sc1
    v_mfma_f32_16x16x32_bf16 v[184:187], v[20:23], a[248:251], v[184:187]
    buffer_load_dwordx4 a[60:63], v63, s[8:11], s82 offen offset:1024 sc1
    v_mfma_f32_16x16x32_bf16 v[188:191], v[16:19], a[236:239], v[188:191]
    v_exp_f32 v140, v140
    v_mfma_f32_16x16x32_bf16 v[188:191], v[20:23], a[252:255], v[188:191]
    v_exp_f32 v141, v141
    s_waitcnt lgkmcnt(4)
    s_waitcnt vmcnt(17)
    s_barrier
    v_mfma_f32_16x16x32_bf16 v[160:163], v[24:27], v[224:227], v[160:163]
    ds_read_b64_tr_b16 v[192:193], v4 offset:0
    ds_read_b64_tr_b16 v[194:195], v4 offset:6144
    v_add_f32 v140, 1.0, v140
    v_mfma_f32_16x16x32_bf16 v[160:163], v[28:31], v[240:243], v[160:163]
    v_exp_f32 v142, v142
    v_add_f32 v141, 1.0, v141
    v_mfma_f32_16x16x32_bf16 v[164:167], v[24:27], v[228:231], v[164:167]
    ds_read_b64_tr_b16 v[196:197], v4 offset:12288
    ds_read_b64_tr_b16 v[198:199], v4 offset:18432
    v_mfma_f32_16x16x32_bf16 v[164:167], v[28:31], v[244:247], v[164:167]
    v_exp_f32 v143, v143
    v_add_f32 v142, 1.0, v142
    v_mfma_f32_16x16x32_bf16 v[168:171], v[24:27], v[232:235], v[168:171]
    ds_read_b64_tr_b16 v[200:201], v5 offset:0
    ds_read_b64_tr_b16 v[202:203], v5 offset:6144
    v_add_f32 v143, 1.0, v143
    v_mfma_f32_16x16x32_bf16 v[168:171], v[28:31], v[248:251], v[168:171]
    v_rcp_f32 v140, v140
    v_mfma_f32_16x16x32_bf16 v[172:175], v[24:27], v[236:239], v[172:175]
    ds_read_b64_tr_b16 v[204:205], v5 offset:12288
    ds_read_b64_tr_b16 v[206:207], v5 offset:18432
    v_mul_f32 v156, v156, v140
    v_mfma_f32_16x16x32_bf16 v[172:175], v[28:31], v[252:255], v[172:175]
    v_rcp_f32 v141, v141
    s_waitcnt lgkmcnt(8)
    v_mfma_f32_16x16x32_bf16 v[176:179], v[32:35], v[224:227], v[176:179]
    ds_read_b64_tr_b16 v[208:209], v6 offset:0
    ds_read_b64_tr_b16 v[210:211], v6 offset:6144
    v_mul_f32 v157, v157, v141
    v_mfma_f32_16x16x32_bf16 v[176:179], v[36:39], v[240:243], v[176:179]
    v_rcp_f32 v142, v142
    v_cvt_pk_bf16_f32 v54, v156, v157
    v_mfma_f32_16x16x32_bf16 v[180:183], v[32:35], v[228:231], v[180:183]
    ds_read_b64_tr_b16 v[212:213], v6 offset:12288
    ds_read_b64_tr_b16 v[214:215], v6 offset:18432
    v_mfma_f32_16x16x32_bf16 v[180:183], v[36:39], v[244:247], v[180:183]
    v_rcp_f32 v143, v143
    v_mul_f32 v158, v158, v142
    v_mfma_f32_16x16x32_bf16 v[184:187], v[32:35], v[232:235], v[184:187]
    ds_read_b64_tr_b16 v[216:217], v7 offset:0
    ds_read_b64_tr_b16 v[218:219], v7 offset:6144
    v_mul_f32 v159, v159, v143
    v_mfma_f32_16x16x32_bf16 v[184:187], v[36:39], v[248:251], v[184:187]
    s_add_u32 s81, s71, 442368
    v_cvt_pk_bf16_f32 v55, v158, v159
    v_mfma_f32_16x16x32_bf16 v[188:191], v[32:35], v[236:239], v[188:191]
    ds_read_b64_tr_b16 v[220:221], v7 offset:12288
    ds_read_b64_tr_b16 v[222:223], v7 offset:18432
    buffer_store_dwordx4 v[52:55], v1, s[8:11], s56 offen offset:3072 sc1
    v_mfma_f32_16x16x32_bf16 v[188:191], v[36:39], v[252:255], v[188:191]
    s_add_u32 m0, s70, 73728
    s_waitcnt lgkmcnt(8)
    v_mfma_f32_16x16x32_bf16 v[64:67], v[192:195], a[0:3], 0
    ds_read_b64_tr_b16 v[16:17], v4 offset:1024
    ds_read_b64_tr_b16 v[18:19], v4 offset:7168
    v_mfma_f32_16x16x32_bf16 v[64:67], v[196:199], a[8:11], v[64:67]
    buffer_load_dwordx4 v61, s[24:27], s81 offen offset:0  lds
    v_mfma_f32_16x16x32_bf16 v[68:71], v[192:195], a[4:7], 0
    ds_read_b64_tr_b16 v[20:21], v4 offset:13312
    ds_read_b64_tr_b16 v[22:23], v4 offset:19456
    v_mfma_f32_16x16x32_bf16 v[68:71], v[196:199], a[12:15], v[68:71]
    buffer_load_dwordx4 v2, s[24:27], s81 offen offset:1024  lds
    v_mfma_f32_16x16x32_bf16 v[72:75], v[200:203], a[0:3], 0
    ds_read_b64_tr_b16 v[24:25], v5 offset:1024
    ds_read_b64_tr_b16 v[26:27], v5 offset:7168
    v_mfma_f32_16x16x32_bf16 v[72:75], v[204:207], a[8:11], v[72:75]
    buffer_load_dwordx4 v3, s[24:27], s81 offen offset:2048  lds
    v_add_u32 v32, 49152, v4
    v_mfma_f32_16x16x32_bf16 v[76:79], v[200:203], a[4:7], 0
    ds_read_b64_tr_b16 v[28:29], v5 offset:13312
    ds_read_b64_tr_b16 v[30:31], v5 offset:19456
    v_mfma_f32_16x16x32_bf16 v[76:79], v[204:207], a[12:15], v[76:79]
    v_add_u32 v33, 49152, v5
    s_waitcnt lgkmcnt(8)
    v_mfma_f32_16x16x32_bf16 v[80:83], v[208:211], a[0:3], 0
    ds_read_b64_tr_b16 v[192:193], v6 offset:1024
    ds_read_b64_tr_b16 v[194:195], v6 offset:7168
    v_add_u32 v34, 49152, v6
    v_mfma_f32_16x16x32_bf16 v[80:83], v[212:215], a[8:11], v[80:83]
    v_add_u32 v35, 49152, v7
    v_add_u32 v36, 98304, v4
    v_mfma_f32_16x16x32_bf16 v[84:87], v[208:211], a[4:7], 0
    ds_read_b64_tr_b16 v[196:197], v6 offset:13312
    ds_read_b64_tr_b16 v[198:199], v6 offset:19456
    v_add_u32 v37, 98304, v5
    v_mfma_f32_16x16x32_bf16 v[84:87], v[212:215], a[12:15], v[84:87]
    v_add_u32 v38, 98304, v6
    v_add_u32 v39, 98304, v7
    v_mfma_f32_16x16x32_bf16 v[88:91], v[216:219], a[0:3], 0
    ds_read_b64_tr_b16 v[200:201], v7 offset:1024
    ds_read_b64_tr_b16 v[202:203], v7 offset:7168
    v_mfma_f32_16x16x32_bf16 v[88:91], v[220:223], a[8:11], v[88:91]
    v_fma_f32 v10, -v160, v160, s58
    v_fma_f32 v11, -v161, v161, s58
    v_mul_f32 v176, v176, v160
    v_mfma_f32_16x16x32_bf16 v[92:95], v[216:219], a[4:7], 0
    ds_read_b64_tr_b16 v[204:205], v7 offset:13312
    ds_read_b64_tr_b16 v[206:207], v7 offset:19456
    v_mfma_f32_16x16x32_bf16 v[92:95], v[220:223], a[12:15], v[92:95]
    s_add_u32 m0, s70, 86016
    s_waitcnt lgkmcnt(8)
    v_mfma_f32_16x16x32_bf16 v[96:99], v[16:19], a[0:3], 0
    ds_read_b64_tr_b16 v[208:209], v4 offset:2048
    ds_read_b64_tr_b16 v[210:211], v4 offset:8192
    v_mul_f32 v177, v177, v161
    v_mfma_f32_16x16x32_bf16 v[96:99], v[20:23], a[8:11], v[96:99]
    buffer_load_dwordx4 v58, s[24:27], s81 offen offset:0  lds
    v_mfma_f32_16x16x32_bf16 v[100:103], v[16:19], a[4:7], 0
    ds_read_b64_tr_b16 v[212:213], v4 offset:14336
    ds_read_b64_tr_b16 v[214:215], v4 offset:20480
    v_mul_f32 v160, v10, v160
    v_mfma_f32_16x16x32_bf16 v[100:103], v[20:23], a[12:15], v[100:103]
    buffer_load_dwordx4 v59, s[24:27], s81 offen offset:1024  lds
    v_mfma_f32_16x16x32_bf16 v[104:107], v[24:27], a[0:3], 0
    ds_read_b64_tr_b16 v[216:217], v5 offset:2048
    ds_read_b64_tr_b16 v[218:219], v5 offset:8192
    v_mfma_f32_16x16x32_bf16 v[104:107], v[28:31], a[8:11], v[104:107]
    buffer_load_dwordx4 v60, s[24:27], s81 offen offset:2048  lds
    v_mul_f32 v161, v11, v161
    v_mfma_f32_16x16x32_bf16 v[108:111], v[24:27], a[4:7], 0
    ds_read_b64_tr_b16 v[220:221], v5 offset:14336
    ds_read_b64_tr_b16 v[222:223], v5 offset:20480
    v_mfma_f32_16x16x32_bf16 v[108:111], v[28:31], a[12:15], v[108:111]
    s_add_u32 m0, s70, 98304
    s_add_u32 s81, s71, 663552
    s_waitcnt lgkmcnt(8)
    v_mfma_f32_16x16x32_bf16 v[112:115], v[192:195], a[0:3], 0
    ds_read_b64_tr_b16 v[16:17], v6 offset:2048
    ds_read_b64_tr_b16 v[18:19], v6 offset:8192
    v_fma_f32 v12, -v162, v162, s58
    v_mfma_f32_16x16x32_bf16 v[112:115], v[196:199], a[8:11], v[112:115]
    buffer_load_dwordx4 v61, s[24:27], s81 offen offset:0  lds
    v_mfma_f32_16x16x32_bf16 v[116:119], v[192:195], a[4:7], 0
    ds_read_b64_tr_b16 v[20:21], v6 offset:14336
    ds_read_b64_tr_b16 v[22:23], v6 offset:20480
    v_fma_f32 v13, -v163, v163, s58
    v_mfma_f32_16x16x32_bf16 v[116:119], v[196:199], a[12:15], v[116:119]
    buffer_load_dwordx4 v2, s[24:27], s81 offen offset:1024  lds
    v_mfma_f32_16x16x32_bf16 v[120:123], v[200:203], a[0:3], 0
    ds_read_b64_tr_b16 v[24:25], v7 offset:2048
    ds_read_b64_tr_b16 v[26:27], v7 offset:8192
    v_mfma_f32_16x16x32_bf16 v[120:123], v[204:207], a[8:11], v[120:123]
    buffer_load_dwordx4 v3, s[24:27], s81 offen offset:2048  lds
    v_mul_f32 v178, v178, v162
    v_mfma_f32_16x16x32_bf16 v[124:127], v[200:203], a[4:7], 0
    ds_read_b64_tr_b16 v[28:29], v7 offset:14336
    ds_read_b64_tr_b16 v[30:31], v7 offset:20480
    v_mfma_f32_16x16x32_bf16 v[124:127], v[204:207], a[12:15], v[124:127]
    v_mul_f32 v179, v179, v163
    s_waitcnt lgkmcnt(8)
    v_mfma_f32_16x16x32_bf16 v[128:131], v[208:211], a[0:3], 0
    ds_read_b64_tr_b16 v[192:193], v4 offset:24576
    ds_read_b64_tr_b16 v[194:195], v4 offset:30720
    v_mul_f32 v162, v12, v162
    v_mfma_f32_16x16x32_bf16 v[128:131], v[212:215], a[8:11], v[128:131]
    v_exp_f32 v160, v160
    v_mfma_f32_16x16x32_bf16 v[132:135], v[208:211], a[4:7], 0
    ds_read_b64_tr_b16 v[196:197], v4 offset:36864
    ds_read_b64_tr_b16 v[198:199], v4 offset:43008
    v_mul_f32 v163, v13, v163
    v_mfma_f32_16x16x32_bf16 v[132:135], v[212:215], a[12:15], v[132:135]
    v_exp_f32 v161, v161
    v_mfma_f32_16x16x32_bf16 v[136:139], v[216:219], a[0:3], 0
    ds_read_b64_tr_b16 v[200:201], v5 offset:24576
    ds_read_b64_tr_b16 v[202:203], v5 offset:30720
    v_mfma_f32_16x16x32_bf16 v[136:139], v[220:223], a[8:11], v[136:139]
    v_exp_f32 v162, v162
    v_add_f32 v160, 1.0, v160
    v_mfma_f32_16x16x32_bf16 v[140:143], v[216:219], a[4:7], 0
    ds_read_b64_tr_b16 v[204:205], v5 offset:36864
    ds_read_b64_tr_b16 v[206:207], v5 offset:43008
    v_mfma_f32_16x16x32_bf16 v[140:143], v[220:223], a[12:15], v[140:143]
    s_add_u32 m0, s70, 110592
    s_waitcnt lgkmcnt(8)
    v_mfma_f32_16x16x32_bf16 v[144:147], v[16:19], a[0:3], 0
    ds_read_b64_tr_b16 v[208:209], v6 offset:24576
    ds_read_b64_tr_b16 v[210:211], v6 offset:30720
    v_add_f32 v161, 1.0, v161
    v_mfma_f32_16x16x32_bf16 v[144:147], v[20:23], a[8:11], v[144:147]
    buffer_load_dwordx4 v58, s[24:27], s81 offen offset:0  lds
    v_mfma_f32_16x16x32_bf16 v[148:151], v[16:19], a[4:7], 0
    ds_read_b64_tr_b16 v[212:213], v6 offset:36864
    ds_read_b64_tr_b16 v[214:215], v6 offset:43008
    v_add_f32 v162, 1.0, v162
    v_mfma_f32_16x16x32_bf16 v[148:151], v[20:23], a[12:15], v[148:151]
    buffer_load_dwordx4 v59, s[24:27], s81 offen offset:1024  lds
    v_mfma_f32_16x16x32_bf16 v[152:155], v[24:27], a[0:3], 0
    ds_read_b64_tr_b16 v[216:217], v7 offset:24576
    ds_read_b64_tr_b16 v[218:219], v7 offset:30720
    v_mfma_f32_16x16x32_bf16 v[152:155], v[28:31], a[8:11], v[152:155]
    buffer_load_dwordx4 v60, s[24:27], s81 offen offset:2048  lds
    v_mfma_f32_16x16x32_bf16 v[156:159], v[24:27], a[4:7], 0
    ds_read_b64_tr_b16 v[220:221], v7 offset:36864
    ds_read_b64_tr_b16 v[222:223], v7 offset:43008
    v_mfma_f32_16x16x32_bf16 v[156:159], v[28:31], a[12:15], v[156:159]
    v_exp_f32 v163, v163
    s_waitcnt lgkmcnt(8)
    v_mfma_f32_16x16x32_bf16 v[64:67], v[192:195], a[16:19], v[64:67]
    ds_read_b64_tr_b16 v[16:17], v4 offset:25600
    ds_read_b64_tr_b16 v[18:19], v4 offset:31744
    v_add_f32 v163, 1.0, v163
    v_mfma_f32_16x16x32_bf16 v[64:67], v[196:199], a[24:27], v[64:67]
    s_add_u32 s48, s71, 811008
    s_add_u32 s49, s71, 958208
    v_mfma_f32_16x16x32_bf16 v[68:71], v[192:195], a[20:23], v[68:71]
    ds_read_b64_tr_b16 v[20:21], v4 offset:37888
    ds_read_b64_tr_b16 v[22:23], v4 offset:44032
    v_mfma_f32_16x16x32_bf16 v[68:71], v[196:199], a[28:31], v[68:71]
    v_rcp_f32 v160, v160
    v_mfma_f32_16x16x32_bf16 v[72:75], v[200:203], a[16:19], v[72:75]
    ds_read_b64_tr_b16 v[24:25], v5 offset:25600
    ds_read_b64_tr_b16 v[26:27], v5 offset:31744
    v_mfma_f32_16x16x32_bf16 v[72:75], v[204:207], a[24:27], v[72:75]
    s_add_u32 s81, s71, 811008
    v_rcp_f32 v161, v161
    v_mfma_f32_16x16x32_bf16 v[76:79], v[200:203], a[20:23], v[76:79]
    ds_read_b64_tr_b16 v[28:29], v5 offset:37888
    ds_read_b64_tr_b16 v[30:31], v5 offset:44032
    v_mfma_f32_16x16x32_bf16 v[76:79], v[204:207], a[28:31], v[76:79]
    s_add_u32 m0, s70, 122880
    s_waitcnt lgkmcnt(8)
    v_mfma_f32_16x16x32_bf16 v[80:83], v[208:211], a[16:19], v[80:83]
    ds_read_b64_tr_b16 v[192:193], v6 offset:25600
    ds_read_b64_tr_b16 v[194:195], v6 offset:31744
    v_mfma_f32_16x16x32_bf16 v[80:83], v[212:215], a[24:27], v[80:83]
    buffer_load_dwordx4 v61, s[24:27], s81 offen offset:0  lds
    v_mfma_f32_16x16x32_bf16 v[84:87], v[208:211], a[20:23], v[84:87]
    ds_read_b64_tr_b16 v[196:197], v6 offset:37888
    ds_read_b64_tr_b16 v[198:199], v6 offset:44032
    v_mfma_f32_16x16x32_bf16 v[84:87], v[212:215], a[28:31], v[84:87]
    buffer_load_dwordx4 v2, s[24:27], s48 offen offset:1024  lds
    v_mfma_f32_16x16x32_bf16 v[88:91], v[216:219], a[16:19], v[88:91]
    ds_read_b64_tr_b16 v[200:201], v7 offset:25600
    ds_read_b64_tr_b16 v[202:203], v7 offset:31744
    v_mfma_f32_16x16x32_bf16 v[88:91], v[220:223], a[24:27], v[88:91]
    buffer_load_dwordx4 v3, s[24:27], s49 offen offset:2048  lds
    v_mfma_f32_16x16x32_bf16 v[92:95], v[216:219], a[20:23], v[92:95]
    ds_read_b64_tr_b16 v[204:205], v7 offset:37888
    ds_read_b64_tr_b16 v[206:207], v7 offset:44032
    v_mfma_f32_16x16x32_bf16 v[92:95], v[220:223], a[28:31], v[92:95]
    s_add_u32 m0, s70, 135168
    s_waitcnt lgkmcnt(8)
    v_mfma_f32_16x16x32_bf16 v[96:99], v[16:19], a[16:19], v[96:99]
    ds_read_b64_tr_b16 v[208:209], v4 offset:26624
    ds_read_b64_tr_b16 v[210:211], v4 offset:32768
    v_mfma_f32_16x16x32_bf16 v[96:99], v[20:23], a[24:27], v[96:99]
    buffer_load_dwordx4 v58, s[24:27], s81 offen offset:0  lds
    v_mfma_f32_16x16x32_bf16 v[100:103], v[16:19], a[20:23], v[100:103]
    ds_read_b64_tr_b16 v[212:213], v4 offset:38912
    ds_read_b64_tr_b16 v[214:215], v4 offset:45056
    v_mfma_f32_16x16x32_bf16 v[100:103], v[20:23], a[28:31], v[100:103]
    buffer_load_dwordx4 v59, s[24:27], s48 offen offset:1024  lds
    v_mfma_f32_16x16x32_bf16 v[104:107], v[24:27], a[16:19], v[104:107]
    ds_read_b64_tr_b16 v[216:217], v5 offset:26624
    ds_read_b64_tr_b16 v[218:219], v5 offset:32768
    v_mfma_f32_16x16x32_bf16 v[104:107], v[28:31], a[24:27], v[104:107]
    buffer_load_dwordx4 v60, s[24:27], s49 offen offset:2048  lds
    v_mfma_f32_16x16x32_bf16 v[108:111], v[24:27], a[20:23], v[108:111]
    ds_read_b64_tr_b16 v[220:221], v5 offset:38912
    ds_read_b64_tr_b16 v[222:223], v5 offset:45056
    v_mfma_f32_16x16x32_bf16 v[108:111], v[28:31], a[28:31], v[108:111]
    s_add_u32 s82, s72, 73728
    s_waitcnt vmcnt(18) lgkmcnt(8)
    v_mfma_f32_16x16x32_bf16 v[112:115], v[192:195], a[16:19], v[112:115]
    ds_read_b64_tr_b16 v[16:17], v6 offset:26624
    ds_read_b64_tr_b16 v[18:19], v6 offset:32768
    v_mfma_f32_16x16x32_bf16 v[112:115], v[196:199], a[24:27], v[112:115]
    buffer_load_dwordx4 a[64:67], v1, s[8:11], s82 offen offset:0 sc1
    v_mfma_f32_16x16x32_bf16 v[116:119], v[192:195], a[20:23], v[116:119]
    ds_read_b64_tr_b16 v[20:21], v6 offset:38912
    ds_read_b64_tr_b16 v[22:23], v6 offset:45056
    v_mfma_f32_16x16x32_bf16 v[116:119], v[196:199], a[28:31], v[116:119]
    v_rcp_f32 v162, v162
    v_rcp_f32 v163, v163
    v_pk_fma_f32 v[10:11], v[164:165], v[164:165], s[58:59] op_sel_hi:[1,1,0] neg_lo:[1,0,0] neg_hi:[1,0,0]
    v_pk_fma_f32 v[12:13], v[166:167], v[166:167], s[58:59] op_sel_hi:[1,1,0] neg_lo:[1,0,0] neg_hi:[1,0,0]
    v_pk_mul_f32 v[180:181], v[180:181], v[164:165]
    v_pk_mul_f32 v[182:183], v[182:183], v[166:167]
    v_pk_mul_f32 v[164:165], v[10:11], v[164:165]
    v_pk_mul_f32 v[166:167], v[12:13], v[166:167]
    v_pk_mul_f32 v[176:177], v[176:177], v[160:161]
    v_pk_mul_f32 v[178:179], v[178:179], v[162:163]
    v_mfma_f32_16x16x32_bf16 v[120:123], v[200:203], a[16:19], v[120:123]
    ds_read_b64_tr_b16 v[24:25], v7 offset:26624
    ds_read_b64_tr_b16 v[26:27], v7 offset:32768
    v_mfma_f32_16x16x32_bf16 v[120:123], v[204:207], a[24:27], v[120:123]
    buffer_load_dwordx4 a[68:71], v1, s[8:11], s82 offen offset:1024 sc1
    v_cvt_pk_bf16_f32 v40, v176, v177
    v_mfma_f32_16x16x32_bf16 v[124:127], v[200:203], a[20:23], v[124:127]
    ds_read_b64_tr_b16 v[28:29], v7 offset:38912
    ds_read_b64_tr_b16 v[30:31], v7 offset:45056
    v_mfma_f32_16x16x32_bf16 v[124:127], v[204:207], a[28:31], v[124:127]
    buffer_store_dword v15, v14, s[8:11], 0 offen offset:4 sc1
    v_cvt_pk_bf16_f32 v41, v178, v179
    s_waitcnt lgkmcnt(8)
    s_barrier
    v_mfma_f32_16x16x32_bf16 v[128:131], v[208:211], a[16:19], v[128:131]
    ds_read_b64_tr_b16 v[192:193], v32 offset:0
    ds_read_b64_tr_b16 v[194:195], v32 offset:6144
    v_mfma_f32_16x16x32_bf16 v[128:131], v[212:215], a[24:27], v[128:131]
    buffer_load_dwordx4 a[72:75], v63, s[8:11], s82 offen offset:0 sc1
    v_mfma_f32_16x16x32_bf16 v[132:135], v[208:211], a[20:23], v[132:135]
    ds_read_b64_tr_b16 v[196:197], v32 offset:12288
    ds_read_b64_tr_b16 v[198:199], v32 offset:18432
    v_mfma_f32_16x16x32_bf16 v[132:135], v[212:215], a[28:31], v[132:135]
    v_exp_f32 v164, v164
    v_mfma_f32_16x16x32_bf16 v[136:139], v[216:219], a[16:19], v[136:139]
    ds_read_b64_tr_b16 v[200:201], v33 offset:0
    ds_read_b64_tr_b16 v[202:203], v33 offset:6144
    v_exp_f32 v165, v165
    v_mfma_f32_16x16x32_bf16 v[136:139], v[220:223], a[24:27], v[136:139]
    buffer_load_dwordx4 a[76:79], v63, s[8:11], s82 offen offset:1024 sc1
    v_mfma_f32_16x16x32_bf16 v[140:143], v[216:219], a[20:23], v[140:143]
    ds_read_b64_tr_b16 v[204:205], v33 offset:12288
    ds_read_b64_tr_b16 v[206:207], v33 offset:18432
    v_add_f32 v164, 1.0, v164
    v_mfma_f32_16x16x32_bf16 v[140:143], v[220:223], a[28:31], v[140:143]
    s_add_u32 s82, s72, 90112
    s_waitcnt lgkmcnt(8)
    v_mfma_f32_16x16x32_bf16 v[144:147], v[16:19], a[16:19], v[144:147]
    ds_read_b64_tr_b16 v[208:209], v34 offset:0
    ds_read_b64_tr_b16 v[210:211], v34 offset:6144
    v_add_f32 v165, 1.0, v165
    v_mfma_f32_16x16x32_bf16 v[144:147], v[20:23], a[24:27], v[144:147]
    buffer_load_dwordx4 a[80:83], v1, s[8:11], s82 offen offset:0 sc1
    v_mfma_f32_16x16x32_bf16 v[148:151], v[16:19], a[20:23], v[148:151]
    ds_read_b64_tr_b16 v[212:213], v34 offset:12288
    ds_read_b64_tr_b16 v[214:215], v34 offset:18432
    v_mfma_f32_16x16x32_bf16 v[148:151], v[20:23], a[28:31], v[148:151]
    v_exp_f32 v166, v166
    v_mfma_f32_16x16x32_bf16 v[152:155], v[24:27], a[16:19], v[152:155]
    ds_read_b64_tr_b16 v[216:217], v35 offset:0
    ds_read_b64_tr_b16 v[218:219], v35 offset:6144
    v_exp_f32 v167, v167
    v_mfma_f32_16x16x32_bf16 v[152:155], v[28:31], a[24:27], v[152:155]
    buffer_load_dwordx4 a[84:87], v1, s[8:11], s82 offen offset:1024 sc1
    v_mfma_f32_16x16x32_bf16 v[156:159], v[24:27], a[20:23], v[156:159]
    ds_read_b64_tr_b16 v[220:221], v35 offset:12288
    ds_read_b64_tr_b16 v[222:223], v35 offset:18432
    v_add_f32 v166, 1.0, v166
    v_mfma_f32_16x16x32_bf16 v[156:159], v[28:31], a[28:31], v[156:159]
    v_add_f32 v167, 1.0, v167
    s_waitcnt lgkmcnt(8)
    v_mfma_f32_16x16x32_bf16 v[64:67], v[192:195], a[32:35], v[64:67]
    ds_read_b64_tr_b16 v[16:17], v32 offset:1024
    ds_read_b64_tr_b16 v[18:19], v32 offset:7168
    v_mfma_f32_16x16x32_bf16 v[64:67], v[196:199], a[40:43], v[64:67]
    buffer_load_dwordx4 a[88:91], v63, s[8:11], s82 offen offset:0 sc1
    v_mfma_f32_16x16x32_bf16 v[68:71], v[192:195], a[36:39], v[68:71]
    ds_read_b64_tr_b16 v[20:21], v32 offset:13312
    ds_read_b64_tr_b16 v[22:23], v32 offset:19456
    v_mfma_f32_16x16x32_bf16 v[68:71], v[196:199], a[44:47], v[68:71]
    v_rcp_f32 v164, v164
    v_rcp_f32 v165, v165
    v_mfma_f32_16x16x32_bf16 v[72:75], v[200:203], a[32:35], v[72:75]
    ds_read_b64_tr_b16 v[24:25], v33 offset:1024
    ds_read_b64_tr_b16 v[26:27], v33 offset:7168
    v_mfma_f32_16x16x32_bf16 v[72:75], v[204:207], a[40:43], v[72:75]
    buffer_load_dwordx4 a[92:95], v63, s[8:11], s82 offen offset:1024 sc1
    v_mfma_f32_16x16x32_bf16 v[76:79], v[200:203], a[36:39], v[76:79]
    ds_read_b64_tr_b16 v[28:29], v33 offset:13312
    ds_read_b64_tr_b16 v[30:31], v33 offset:19456
    v_mfma_f32_16x16x32_bf16 v[76:79], v[204:207], a[44:47], v[76:79]
    s_waitcnt lgkmcnt(8)
    v_mfma_f32_16x16x32_bf16 v[80:83], v[208:211], a[32:35], v[80:83]
    ds_read_b64_tr_b16 v[192:193], v34 offset:1024
    ds_read_b64_tr_b16 v[194:195], v34 offset:7168
    v_mfma_f32_16x16x32_bf16 v[80:83], v[212:215], a[40:43], v[80:83]
    s_add_u32 s48, s71, 1105792
    s_add_u32 s49, s71, 1105792
    v_mfma_f32_16x16x32_bf16 v[84:87], v[208:211], a[36:39], v[84:87]
    ds_read_b64_tr_b16 v[196:197], v34 offset:13312
    ds_read_b64_tr_b16 v[198:199], v34 offset:19456
    v_mfma_f32_16x16x32_bf16 v[84:87], v[212:215], a[44:47], v[84:87]
    v_rcp_f32 v166, v166
    v_rcp_f32 v167, v167
    v_pk_fma_f32 v[10:11], v[168:169], v[168:169], s[58:59] op_sel_hi:[1,1,0] neg_lo:[1,0,0] neg_hi:[1,0,0]
    v_pk_fma_f32 v[12:13], v[170:171], v[170:171], s[58:59] op_sel_hi:[1,1,0] neg_lo:[1,0,0] neg_hi:[1,0,0]
    v_pk_mul_f32 v[184:185], v[184:185], v[168:169]
    v_pk_mul_f32 v[186:187], v[186:187], v[170:171]
    v_pk_mul_f32 v[168:169], v[10:11], v[168:169]
    v_pk_mul_f32 v[170:171], v[12:13], v[170:171]
    v_pk_mul_f32 v[180:181], v[180:181], v[164:165]
    v_pk_mul_f32 v[182:183], v[182:183], v[166:167]
    v_mfma_f32_16x16x32_bf16 v[88:91], v[216:219], a[32:35], v[88:91]
    ds_read_b64_tr_b16 v[200:201], v35 offset:1024
    ds_read_b64_tr_b16 v[202:203], v35 offset:7168
    v_mfma_f32_16x16x32_bf16 v[88:91], v[220:223], a[40:43], v[88:91]
    s_add_u32 s81, s71, 958592
    v_cvt_pk_bf16_f32 v42, v180, v181
    v_cvt_pk_bf16_f32 v43, v182, v183
    v_mfma_f32_16x16x32_bf16 v[92:95], v[216:219], a[36:39], v[92:95]
    ds_read_b64_tr_b16 v[204:205], v35 offset:13312
    ds_read_b64_tr_b16 v[206:207], v35 offset:19456
    v_mfma_f32_16x16x32_bf16 v[92:95], v[220:223], a[44:47], v[92:95]
    s_add_u32 m0, s70, 0
    s_waitcnt lgkmcnt(8)
    v_mfma_f32_16x16x32_bf16 v[96:99], v[16:19], a[32:35], v[96:99]
    ds_read_b64_tr_b16 v[208:209], v32 offset:2048
    ds_read_b64_tr_b16 v[210:211], v32 offset:8192
    buffer_store_dwordx4 v[40:43], v1, s[8:11], s57 offen offset:0 sc1
    v_mfma_f32_16x16x32_bf16 v[96:99], v[20:23], a[40:43], v[96:99]
    buffer_load_dwordx4 v61, s[24:27], s81 offen offset:0  lds
    v_mfma_f32_16x16x32_bf16 v[100:103], v[16:19], a[36:39], v[100:103]
    ds_read_b64_tr_b16 v[212:213], v32 offset:14336
    ds_read_b64_tr_b16 v[214:215], v32 offset:20480
    v_mfma_f32_16x16x32_bf16 v[100:103], v[20:23], a[44:47], v[100:103]
    buffer_load_dwordx4 v2, s[24:27], s48 offen offset:1024  lds
    v_mfma_f32_16x16x32_bf16 v[104:107], v[24:27], a[32:35], v[104:107]
    ds_read_b64_tr_b16 v[216:217], v33 offset:2048
    ds_read_b64_tr_b16 v[218:219], v33 offset:8192
    v_exp_f32 v168, v168
    v_mfma_f32_16x16x32_bf16 v[104:107], v[28:31], a[40:43], v[104:107]
    buffer_load_dwordx4 v3, s[24:27], s49 offen offset:2048  lds
Lpad7:
    s_cbranch_execz Lwret2
    v_mfma_f32_16x16x32_bf16 v[108:111], v[24:27], a[36:39], v[108:111]
    ds_read_b64_tr_b16 v[220:221], v33 offset:14336
    ds_read_b64_tr_b16 v[222:223], v33 offset:20480
    v_add_f32 v168, 1.0, v168
    v_mfma_f32_16x16x32_bf16 v[108:111], v[28:31], a[44:47], v[108:111]
    s_add_u32 m0, s70, 12288
    s_waitcnt lgkmcnt(8)
    v_mfma_f32_16x16x32_bf16 v[112:115], v[192:195], a[32:35], v[112:115]
    ds_read_b64_tr_b16 v[16:17], v34 offset:2048
    ds_read_b64_tr_b16 v[18:19], v34 offset:8192
    v_mfma_f32_16x16x32_bf16 v[112:115], v[196:199], a[40:43], v[112:115]
    buffer_load_dwordx4 v58, s[24:27], s81 offen offset:0  lds
    v_mfma_f32_16x16x32_bf16 v[116:119], v[192:195], a[36:39], v[116:119]
    ds_read_b64_tr_b16 v[20:21], v34 offset:14336
    ds_read_b64_tr_b16 v[22:23], v34 offset:20480
    v_exp_f32 v169, v169
    v_mfma_f32_16x16x32_bf16 v[116:119], v[196:199], a[44:47], v[116:119]
    buffer_load_dwordx4 v59, s[24:27], s48 offen offset:1024  lds
    v_mfma_f32_16x16x32_bf16 v[120:123], v[200:203], a[32:35], v[120:123]
    ds_read_b64_tr_b16 v[24:25], v35 offset:2048
    ds_read_b64_tr_b16 v[26:27], v35 offset:8192
    v_add_f32 v169, 1.0, v169
    v_mfma_f32_16x16x32_bf16 v[120:123], v[204:207], a[40:43], v[120:123]
    buffer_load_dwordx4 v60, s[24:27], s49 offen offset:2048  lds
    v_mfma_f32_16x16x32_bf16 v[124:127], v[200:203], a[36:39], v[124:127]
    ds_read_b64_tr_b16 v[28:29], v35 offset:14336
    ds_read_b64_tr_b16 v[30:31], v35 offset:20480
    v_mfma_f32_16x16x32_bf16 v[124:127], v[204:207], a[44:47], v[124:127]
    v_exp_f32 v170, v170
    s_waitcnt vmcnt(28) lgkmcnt(8)
    s_barrier
    v_mfma_f32_16x16x32_bf16 v[128:131], v[208:211], a[32:35], v[128:131]
    ds_read_b64_tr_b16 v[192:193], v32 offset:24576
    ds_read_b64_tr_b16 v[194:195], v32 offset:30720
    v_mfma_f32_16x16x32_bf16 v[128:131], v[212:215], a[40:43], v[128:131]
    s_add_u32 s48, s71, 73728
    s_add_u32 s49, s71, 220928
    v_add_f32 v170, 1.0, v170
    v_mfma_f32_16x16x32_bf16 v[132:135], v[208:211], a[36:39], v[132:135]
    ds_read_b64_tr_b16 v[196:197], v32 offset:36864
    ds_read_b64_tr_b16 v[198:199], v32 offset:43008
    v_mfma_f32_16x16x32_bf16 v[132:135], v[212:215], a[44:47], v[132:135]
    v_exp_f32 v171, v171
    v_mfma_f32_16x16x32_bf16 v[136:139], v[216:219], a[32:35], v[136:139]
    ds_read_b64_tr_b16 v[200:201], v33 offset:24576
    ds_read_b64_tr_b16 v[202:203], v33 offset:30720
    v_add_f32 v171, 1.0, v171
    v_mfma_f32_16x16x32_bf16 v[136:139], v[220:223], a[40:43], v[136:139]
    s_add_u32 s81, s71, 73728
    v_rcp_f32 v168, v168
    v_mfma_f32_16x16x32_bf16 v[140:143], v[216:219], a[36:39], v[140:143]
    ds_read_b64_tr_b16 v[204:205], v33 offset:36864
    ds_read_b64_tr_b16 v[206:207], v33 offset:43008
    v_mfma_f32_16x16x32_bf16 v[140:143], v[220:223], a[44:47], v[140:143]
    s_add_u32 m0, s70, 24576
    s_waitcnt lgkmcnt(8)
    v_mfma_f32_16x16x32_bf16 v[144:147], v[16:19], a[32:35], v[144:147]
    ds_read_b64_tr_b16 v[208:209], v34 offset:24576
    ds_read_b64_tr_b16 v[210:211], v34 offset:30720
    v_mfma_f32_16x16x32_bf16 v[144:147], v[20:23], a[40:43], v[144:147]
    buffer_load_dwordx4 v61, s[24:27], s81 offen offset:0  lds
    v_rcp_f32 v169, v169
    v_mfma_f32_16x16x32_bf16 v[148:151], v[16:19], a[36:39], v[148:151]
    ds_read_b64_tr_b16 v[212:213], v34 offset:36864
    ds_read_b64_tr_b16 v[214:215], v34 offset:43008
    v_mfma_f32_16x16x32_bf16 v[148:151], v[20:23], a[44:47], v[148:151]
    buffer_load_dwordx4 v2, s[24:27], s48 offen offset:1024  lds
    v_mfma_f32_16x16x32_bf16 v[152:155], v[24:27], a[32:35], v[152:155]
    ds_read_b64_tr_b16 v[216:217], v35 offset:24576
    ds_read_b64_tr_b16 v[218:219], v35 offset:30720
    v_mfma_f32_16x16x32_bf16 v[152:155], v[28:31], a[40:43], v[152:155]
    buffer_load_dwordx4 v3, s[24:27], s49 offen offset:2048  lds
    v_mfma_f32_16x16x32_bf16 v[156:159], v[24:27], a[36:39], v[156:159]
    ds_read_b64_tr_b16 v[220:221], v35 offset:36864
    ds_read_b64_tr_b16 v[222:223], v35 offset:43008
    v_mfma_f32_16x16x32_bf16 v[156:159], v[28:31], a[44:47], v[156:159]
    s_add_u32 m0, s70, 36864
    s_waitcnt lgkmcnt(8)
    v_mfma_f32_16x16x32_bf16 v[64:67], v[192:195], a[48:51], v[64:67]
    ds_read_b64_tr_b16 v[16:17], v32 offset:25600
    ds_read_b64_tr_b16 v[18:19], v32 offset:31744
    v_mfma_f32_16x16x32_bf16 v[64:67], v[196:199], a[56:59], v[64:67]
    buffer_load_dwordx4 v58, s[24:27], s81 offen offset:0  lds
    v_mfma_f32_16x16x32_bf16 v[68:71], v[192:195], a[52:55], v[68:71]
    ds_read_b64_tr_b16 v[20:21], v32 offset:37888
    ds_read_b64_tr_b16 v[22:23], v32 offset:44032
    v_mfma_f32_16x16x32_bf16 v[68:71], v[196:199], a[60:63], v[68:71]
    buffer_load_dwordx4 v59, s[24:27], s48 offen offset:1024  lds
    v_mfma_f32_16x16x32_bf16 v[72:75], v[200:203], a[48:51], v[72:75]
    ds_read_b64_tr_b16 v[24:25], v33 offset:25600
    ds_read_b64_tr_b16 v[26:27], v33 offset:31744
    v_mfma_f32_16x16x32_bf16 v[72:75], v[204:207], a[56:59], v[72:75]
    buffer_load_dwordx4 v60, s[24:27], s49 offen offset:2048  lds
    v_mfma_f32_16x16x32_bf16 v[76:79], v[200:203], a[52:55], v[76:79]
    ds_read_b64_tr_b16 v[28:29], v33 offset:37888
    ds_read_b64_tr_b16 v[30:31], v33 offset:44032
    v_mfma_f32_16x16x32_bf16 v[76:79], v[204:207], a[60:63], v[76:79]
    s_waitcnt lgkmcnt(8)
    v_mfma_f32_16x16x32_bf16 v[80:83], v[208:211], a[48:51], v[80:83]
    ds_read_b64_tr_b16 v[192:193], v34 offset:25600
    ds_read_b64_tr_b16 v[194:195], v34 offset:31744
    v_mfma_f32_16x16x32_bf16 v[80:83], v[212:215], a[56:59], v[80:83]
    v_rcp_f32 v170, v170
    v_rcp_f32 v171, v171
    v_pk_fma_f32 v[10:11], v[172:173], v[172:173], s[58:59] op_sel_hi:[1,1,0] neg_lo:[1,0,0] neg_hi:[1,0,0]
    v_pk_fma_f32 v[12:13], v[174:175], v[174:175], s[58:59] op_sel_hi:[1,1,0] neg_lo:[1,0,0] neg_hi:[1,0,0]
    v_pk_mul_f32 v[188:189], v[188:189], v[172:173]
    v_pk_mul_f32 v[190:191], v[190:191], v[174:175]
    v_pk_mul_f32 v[172:173], v[10:11], v[172:173]
    v_pk_mul_f32 v[174:175], v[12:13], v[174:175]
    v_pk_mul_f32 v[184:185], v[184:185], v[168:169]
    v_pk_mul_f32 v[186:187], v[186:187], v[170:171]
    v_mfma_f32_16x16x32_bf16 v[84:87], v[208:211], a[52:55], v[84:87]
    ds_read_b64_tr_b16 v[196:197], v34 offset:37888
    ds_read_b64_tr_b16 v[198:199], v34 offset:44032
    v_cvt_pk_bf16_f32 v44, v184, v185
    v_mfma_f32_16x16x32_bf16 v[84:87], v[212:215], a[60:63], v[84:87]
    v_cvt_pk_bf16_f32 v45, v186, v187
    v_exp_f32 v172, v172
    v_mfma_f32_16x16x32_bf16 v[88:91], v[216:219], a[48:51], v[88:91]
    ds_read_b64_tr_b16 v[200:201], v35 offset:25600
    ds_read_b64_tr_b16 v[202:203], v35 offset:31744
    v_add_f32 v172, 1.0, v172
    v_mfma_f32_16x16x32_bf16 v[88:91], v[220:223], a[56:59], v[88:91]
    v_exp_f32 v173, v173
    v_mfma_f32_16x16x32_bf16 v[92:95], v[216:219], a[52:55], v[92:95]
    ds_read_b64_tr_b16 v[204:205], v35 offset:37888
    ds_read_b64_tr_b16 v[206:207], v35 offset:44032
    v_exp_f32 v174, v174
    v_mfma_f32_16x16x32_bf16 v[92:95], v[220:223], a[60:63], v[92:95]
    s_add_u32 s82, s72, 106496
    buffer_load_dword v57, v62, s[8:11], s74 offen offset:4 sc1
    v_add_f32 v173, 1.0, v173
    s_waitcnt lgkmcnt(8)
    v_mfma_f32_16x16x32_bf16 v[96:99], v[16:19], a[48:51], v[96:99]
    ds_read_b64_tr_b16 v[208:209], v32 offset:26624
    ds_read_b64_tr_b16 v[210:211], v32 offset:32768
    v_mfma_f32_16x16x32_bf16 v[96:99], v[20:23], a[56:59], v[96:99]
    buffer_load_dwordx4 a[96:99], v1, s[8:11], s82 offen offset:0 sc1
    v_add_f32 v174, 1.0, v174
    v_mfma_f32_16x16x32_bf16 v[100:103], v[16:19], a[52:55], v[100:103]
    ds_read_b64_tr_b16 v[212:213], v32 offset:38912
    ds_read_b64_tr_b16 v[214:215], v32 offset:45056
    v_mfma_f32_16x16x32_bf16 v[100:103], v[20:23], a[60:63], v[100:103]
    v_exp_f32 v175, v175
    v_rcp_f32 v172, v172
    v_mfma_f32_16x16x32_bf16 v[104:107], v[24:27], a[48:51], v[104:107]
    ds_read_b64_tr_b16 v[216:217], v33 offset:26624
    ds_read_b64_tr_b16 v[218:219], v33 offset:32768
    v_rcp_f32 v173, v173
    v_mfma_f32_16x16x32_bf16 v[104:107], v[28:31], a[56:59], v[104:107]
    buffer_load_dwordx4 a[100:103], v1, s[8:11], s82 offen offset:1024 sc1
    v_mfma_f32_16x16x32_bf16 v[108:111], v[24:27], a[52:55], v[108:111]
    ds_read_b64_tr_b16 v[220:221], v33 offset:38912
    ds_read_b64_tr_b16 v[222:223], v33 offset:45056
    v_add_f32 v175, 1.0, v175
    v_mfma_f32_16x16x32_bf16 v[108:111], v[28:31], a[60:63], v[108:111]
    v_rcp_f32 v174, v174
    s_waitcnt lgkmcnt(8)
    v_mfma_f32_16x16x32_bf16 v[112:115], v[192:195], a[48:51], v[112:115]
    ds_read_b64_tr_b16 v[16:17], v34 offset:26624
    ds_read_b64_tr_b16 v[18:19], v34 offset:32768
    v_mul_f32 v188, v188, v172
    v_mfma_f32_16x16x32_bf16 v[112:115], v[196:199], a[56:59], v[112:115]
    buffer_load_dwordx4 a[104:107], v63, s[8:11], s82 offen offset:0 sc1
    v_mul_f32 v189, v189, v173
    v_mfma_f32_16x16x32_bf16 v[116:119], v[192:195], a[52:55], v[116:119]
    ds_read_b64_tr_b16 v[20:21], v34 offset:38912
    ds_read_b64_tr_b16 v[22:23], v34 offset:45056
    v_mul_f32 v190, v190, v174
    v_mfma_f32_16x16x32_bf16 v[116:119], v[196:199], a[60:63], v[116:119]
    v_rcp_f32 v175, v175
    v_cvt_pk_bf16_f32 v46, v188, v189
    v_mfma_f32_16x16x32_bf16 v[120:123], v[200:203], a[48:51], v[120:123]
    ds_read_b64_tr_b16 v[24:25], v35 offset:26624
    ds_read_b64_tr_b16 v[26:27], v35 offset:32768
    v_mul_f32 v191, v191, v175
    v_mfma_f32_16x16x32_bf16 v[120:123], v[204:207], a[56:59], v[120:123]
    buffer_load_dwordx4 a[108:111], v63, s[8:11], s82 offen offset:1024 sc1
    v_cvt_pk_bf16_f32 v47, v190, v191
    v_mfma_f32_16x16x32_bf16 v[124:127], v[200:203], a[52:55], v[124:127]
    ds_read_b64_tr_b16 v[28:29], v35 offset:38912
    ds_read_b64_tr_b16 v[30:31], v35 offset:45056
    v_mfma_f32_16x16x32_bf16 v[124:127], v[204:207], a[60:63], v[124:127]
    s_add_u32 s82, s72, 122880
    buffer_store_dwordx4 v[44:47], v1, s[8:11], s57 offen offset:2048 sc1
    s_waitcnt vmcnt(23) lgkmcnt(8)
    s_barrier
    v_mfma_f32_16x16x32_bf16 v[128:131], v[208:211], a[48:51], v[128:131]
    ds_read_b64_tr_b16 v[192:193], v36 offset:0
    ds_read_b64_tr_b16 v[194:195], v36 offset:6144
    v_mfma_f32_16x16x32_bf16 v[128:131], v[212:215], a[56:59], v[128:131]
    buffer_load_dwordx4 a[112:115], v1, s[8:11], s82 offen offset:0 sc1
    v_mfma_f32_16x16x32_bf16 v[132:135], v[208:211], a[52:55], v[132:135]
    ds_read_b64_tr_b16 v[196:197], v36 offset:12288
    ds_read_b64_tr_b16 v[198:199], v36 offset:18432
    v_mfma_f32_16x16x32_bf16 v[132:135], v[212:215], a[60:63], v[132:135]
    s_bfe_u32 s83, s2, 0x20001
    v_mfma_f32_16x16x32_bf16 v[136:139], v[216:219], a[48:51], v[136:139]
    ds_read_b64_tr_b16 v[200:201], v37 offset:0
    ds_read_b64_tr_b16 v[202:203], v37 offset:6144
    v_mfma_f32_16x16x32_bf16 v[136:139], v[220:223], a[56:59], v[136:139]
    buffer_load_dwordx4 a[116:119], v1, s[8:11], s82 offen offset:1024 sc1
    v_mfma_f32_16x16x32_bf16 v[140:143], v[216:219], a[52:55], v[140:143]
    ds_read_b64_tr_b16 v[204:205], v37 offset:12288
    ds_read_b64_tr_b16 v[206:207], v37 offset:18432
    v_mfma_f32_16x16x32_bf16 v[140:143], v[220:223], a[60:63], v[140:143]
    s_waitcnt lgkmcnt(8)
    v_mfma_f32_16x16x32_bf16 v[144:147], v[16:19], a[48:51], v[144:147]
    ds_read_b64_tr_b16 v[208:209], v38 offset:0
    ds_read_b64_tr_b16 v[210:211], v38 offset:6144
    v_mfma_f32_16x16x32_bf16 v[144:147], v[20:23], a[56:59], v[144:147]
    buffer_load_dwordx4 a[120:123], v63, s[8:11], s82 offen offset:0 sc1
    v_mfma_f32_16x16x32_bf16 v[148:151], v[16:19], a[52:55], v[148:151]
    ds_read_b64_tr_b16 v[212:213], v38 offset:12288
    ds_read_b64_tr_b16 v[214:215], v38 offset:18432
    v_mfma_f32_16x16x32_bf16 v[148:151], v[20:23], a[60:63], v[148:151]
    s_add_u32 s48, s71, 368512
    s_add_u32 s49, s71, 368512
    v_mfma_f32_16x16x32_bf16 v[152:155], v[24:27], a[48:51], v[152:155]
    ds_read_b64_tr_b16 v[216:217], v39 offset:0
    ds_read_b64_tr_b16 v[218:219], v39 offset:6144
    v_mfma_f32_16x16x32_bf16 v[152:155], v[28:31], a[56:59], v[152:155]
    buffer_load_dwordx4 a[124:127], v63, s[8:11], s82 offen offset:1024 sc1
    v_mfma_f32_16x16x32_bf16 v[156:159], v[24:27], a[52:55], v[156:159]
    ds_read_b64_tr_b16 v[220:221], v39 offset:12288
    ds_read_b64_tr_b16 v[222:223], v39 offset:18432
    v_mfma_f32_16x16x32_bf16 v[156:159], v[28:31], a[60:63], v[156:159]
    s_add_u32 m0, s70, 49152
    s_add_u32 s81, s71, 221312
    s_waitcnt lgkmcnt(8)
    v_mfma_f32_16x16x32_bf16 v[64:67], v[192:195], a[64:67], v[64:67]
    ds_read_b64_tr_b16 v[16:17], v36 offset:1024
    ds_read_b64_tr_b16 v[18:19], v36 offset:7168
    v_mfma_f32_16x16x32_bf16 v[64:67], v[196:199], a[72:75], v[64:67]
    buffer_load_dwordx4 v61, s[24:27], s81 offen offset:0  lds
    v_mfma_f32_16x16x32_bf16 v[68:71], v[192:195], a[68:71], v[68:71]
    ds_read_b64_tr_b16 v[20:21], v36 offset:13312
    ds_read_b64_tr_b16 v[22:23], v36 offset:19456
    v_mfma_f32_16x16x32_bf16 v[68:71], v[196:199], a[76:79], v[68:71]
    buffer_load_dwordx4 v2, s[24:27], s48 offen offset:1024  lds
    v_mfma_f32_16x16x32_bf16 v[72:75], v[200:203], a[64:67], v[72:75]
    ds_read_b64_tr_b16 v[24:25], v37 offset:1024
    ds_read_b64_tr_b16 v[26:27], v37 offset:7168
    v_mfma_f32_16x16x32_bf16 v[72:75], v[204:207], a[72:75], v[72:75]
    buffer_load_dwordx4 v3, s[24:27], s49 offen offset:2048  lds
    v_mfma_f32_16x16x32_bf16 v[76:79], v[200:203], a[68:71], v[76:79]
    ds_read_b64_tr_b16 v[28:29], v37 offset:13312
    ds_read_b64_tr_b16 v[30:31], v37 offset:19456
    v_mfma_f32_16x16x32_bf16 v[76:79], v[204:207], a[76:79], v[76:79]
    s_waitcnt lgkmcnt(8)
    v_mfma_f32_16x16x32_bf16 v[80:83], v[208:211], a[64:67], v[80:83]
    ds_read_b64_tr_b16 v[192:193], v38 offset:1024
    ds_read_b64_tr_b16 v[194:195], v38 offset:7168
    v_mfma_f32_16x16x32_bf16 v[80:83], v[212:215], a[72:75], v[80:83]
    s_cmp_eq_u32 s83, s3
    s_cselect_b32 s84, 2146435072, 0
    s_cselect_b32 s46, 1, 0
    v_mfma_f32_16x16x32_bf16 v[84:87], v[208:211], a[68:71], v[84:87]
    ds_read_b64_tr_b16 v[196:197], v38 offset:13312
    ds_read_b64_tr_b16 v[198:199], v38 offset:19456
    v_mfma_f32_16x16x32_bf16 v[84:87], v[212:215], a[76:79], v[84:87]
    v_or_b32 v176, s84, v1
    v_mfma_f32_16x16x32_bf16 v[88:91], v[216:219], a[64:67], v[88:91]
    ds_read_b64_tr_b16 v[200:201], v39 offset:1024
    ds_read_b64_tr_b16 v[202:203], v39 offset:7168
    v_mfma_f32_16x16x32_bf16 v[88:91], v[220:223], a[72:75], v[88:91]
    v_mfma_f32_16x16x32_bf16 v[92:95], v[216:219], a[68:71], v[92:95]
    ds_read_b64_tr_b16 v[204:205], v39 offset:13312
    ds_read_b64_tr_b16 v[206:207], v39 offset:19456
    v_mfma_f32_16x16x32_bf16 v[92:95], v[220:223], a[76:79], v[92:95]
    s_add_u32 s82, s72, 8192
    s_waitcnt vmcnt(12) lgkmcnt(8)
    v_cmp_ne_u32 vcc, v57, v15
    s_cbranch_vccnz Lspin5
Lback5:
    v_mfma_f32_16x16x32_bf16 v[96:99], v[16:19], a[64:67], v[96:99]
    ds_read_b64_tr_b16 v[208:209], v36 offset:2048
    ds_read_b64_tr_b16 v[210:211], v36 offset:8192
    v_mfma_f32_16x16x32_bf16 v[96:99], v[20:23], a[72:75], v[96:99]
    buffer_load_dwordx4 a[128:131], v1, s[8:11], s82 offen offset:0 sc1
    v_mfma_f32_16x16x32_bf16 v[100:103], v[16:19], a[68:71], v[100:103]
    ds_read_b64_tr_b16 v[212:213], v36 offset:14336
    ds_read_b64_tr_b16 v[214:215], v36 offset:20480
    v_mfma_f32_16x16x32_bf16 v[100:103], v[20:23], a[76:79], v[100:103]
    v_mfma_f32_16x16x32_bf16 v[104:107], v[24:27], a[64:67], v[104:107]
    ds_read_b64_tr_b16 v[216:217], v37 offset:2048
    ds_read_b64_tr_b16 v[218:219], v37 offset:8192
    v_mfma_f32_16x16x32_bf16 v[104:107], v[28:31], a[72:75], v[104:107]
    buffer_load_dwordx4 a[132:135], v1, s[8:11], s82 offen offset:1024 sc1
    v_mfma_f32_16x16x32_bf16 v[108:111], v[24:27], a[68:71], v[108:111]
    ds_read_b64_tr_b16 v[220:221], v37 offset:14336
    ds_read_b64_tr_b16 v[222:223], v37 offset:20480
    v_mfma_f32_16x16x32_bf16 v[108:111], v[28:31], a[76:79], v[108:111]
    s_waitcnt lgkmcnt(8)
    v_mfma_f32_16x16x32_bf16 v[112:115], v[192:195], a[64:67], v[112:115]
    ds_read_b64_tr_b16 v[16:17], v38 offset:2048
    ds_read_b64_tr_b16 v[18:19], v38 offset:8192
    v_mfma_f32_16x16x32_bf16 v[112:115], v[196:199], a[72:75], v[112:115]
    buffer_load_dwordx4 a[136:139], v63, s[8:11], s82 offen offset:0 sc1
    v_mfma_f32_16x16x32_bf16 v[116:119], v[192:195], a[68:71], v[116:119]
    ds_read_b64_tr_b16 v[20:21], v38 offset:14336
    ds_read_b64_tr_b16 v[22:23], v38 offset:20480
    v_mfma_f32_16x16x32_bf16 v[116:119], v[196:199], a[76:79], v[116:119]
    v_mfma_f32_16x16x32_bf16 v[120:123], v[200:203], a[64:67], v[120:123]
    ds_read_b64_tr_b16 v[24:25], v39 offset:2048
    ds_read_b64_tr_b16 v[26:27], v39 offset:8192
    v_mfma_f32_16x16x32_bf16 v[120:123], v[204:207], a[72:75], v[120:123]
    buffer_load_dwordx4 a[140:143], v63, s[8:11], s82 offen offset:1024 sc1
    v_mfma_f32_16x16x32_bf16 v[124:127], v[200:203], a[68:71], v[124:127]
    ds_read_b64_tr_b16 v[28:29], v39 offset:14336
    ds_read_b64_tr_b16 v[30:31], v39 offset:20480
    v_mfma_f32_16x16x32_bf16 v[124:127], v[204:207], a[76:79], v[124:127]
    s_add_u32 m0, s70, 61440
    s_waitcnt lgkmcnt(8)
    v_mfma_f32_16x16x32_bf16 v[128:131], v[208:211], a[64:67], v[128:131]
    ds_read_b64_tr_b16 v[192:193], v36 offset:24576
    ds_read_b64_tr_b16 v[194:195], v36 offset:30720
    v_mfma_f32_16x16x32_bf16 v[128:131], v[212:215], a[72:75], v[128:131]
    buffer_load_dwordx4 v58, s[24:27], s81 offen offset:0  lds
    v_mfma_f32_16x16x32_bf16 v[132:135], v[208:211], a[68:71], v[132:135]
    ds_read_b64_tr_b16 v[196:197], v36 offset:36864
    ds_read_b64_tr_b16 v[198:199], v36 offset:43008
    v_mfma_f32_16x16x32_bf16 v[132:135], v[212:215], a[76:79], v[132:135]
    buffer_load_dwordx4 v59, s[24:27], s48 offen offset:1024  lds
    v_mfma_f32_16x16x32_bf16 v[136:139], v[216:219], a[64:67], v[136:139]
    ds_read_b64_tr_b16 v[200:201], v37 offset:24576
    ds_read_b64_tr_b16 v[202:203], v37 offset:30720
    v_mfma_f32_16x16x32_bf16 v[136:139], v[220:223], a[72:75], v[136:139]
    buffer_load_dwordx4 v60, s[24:27], s49 offen offset:2048  lds
    v_mfma_f32_16x16x32_bf16 v[140:143], v[216:219], a[68:71], v[140:143]
    ds_read_b64_tr_b16 v[204:205], v37 offset:36864
    ds_read_b64_tr_b16 v[206:207], v37 offset:43008
    v_mfma_f32_16x16x32_bf16 v[140:143], v[220:223], a[76:79], v[140:143]
    s_add_u32 m0, s70, 73728
    s_add_u32 s81, s71, 516096
    s_waitcnt lgkmcnt(8)
    v_mfma_f32_16x16x32_bf16 v[144:147], v[16:19], a[64:67], v[144:147]
    ds_read_b64_tr_b16 v[208:209], v38 offset:24576
    ds_read_b64_tr_b16 v[210:211], v38 offset:30720
    v_mfma_f32_16x16x32_bf16 v[144:147], v[20:23], a[72:75], v[144:147]
    s_add_u32 s48, s71, 737152
    buffer_load_dwordx4 v61, s[24:27], s81 offen offset:0  lds
    v_mfma_f32_16x16x32_bf16 v[148:151], v[16:19], a[68:71], v[148:151]
    ds_read_b64_tr_b16 v[212:213], v38 offset:36864
    ds_read_b64_tr_b16 v[214:215], v38 offset:43008
    v_mfma_f32_16x16x32_bf16 v[148:151], v[20:23], a[76:79], v[148:151]
    s_add_u32 s49, s71, 884480
    buffer_load_dwordx4 v2, s[24:27], s48 offen offset:1024  lds
    v_mfma_f32_16x16x32_bf16 v[152:155], v[24:27], a[64:67], v[152:155]
    ds_read_b64_tr_b16 v[216:217], v39 offset:24576
    ds_read_b64_tr_b16 v[218:219], v39 offset:30720
    v_mfma_f32_16x16x32_bf16 v[152:155], v[28:31], a[72:75], v[152:155]
    buffer_load_dwordx4 v3, s[24:27], s49 offen offset:2048  lds
    v_mfma_f32_16x16x32_bf16 v[156:159], v[24:27], a[68:71], v[156:159]
    ds_read_b64_tr_b16 v[220:221], v39 offset:36864
    ds_read_b64_tr_b16 v[222:223], v39 offset:43008
    v_mfma_f32_16x16x32_bf16 v[156:159], v[28:31], a[76:79], v[156:159]
    s_waitcnt lgkmcnt(8)
    v_mfma_f32_16x16x32_bf16 v[64:67], v[192:195], a[80:83], v[64:67]
    ds_read_b64_tr_b16 v[16:17], v36 offset:25600
    ds_read_b64_tr_b16 v[18:19], v36 offset:31744
    v_mfma_f32_16x16x32_bf16 v[64:67], v[196:199], a[88:91], v[64:67]
    v_bfe_u32 v10, v1, 8, 1
    v_bfe_u32 v11, v1, 9, 1
    v_mfma_f32_16x16x32_bf16 v[68:71], v[192:195], a[84:87], v[68:71]
    ds_read_b64_tr_b16 v[20:21], v36 offset:37888
    ds_read_b64_tr_b16 v[22:23], v36 offset:44032
    v_mfma_f32_16x16x32_bf16 v[68:71], v[196:199], a[92:95], v[68:71]
    v_lshl_add_u32 v10, v10, 1, v11
    v_and_b32 v11, 0xf0, v1
    v_mfma_f32_16x16x32_bf16 v[72:75], v[200:203], a[80:83], v[72:75]
    ds_read_b64_tr_b16 v[24:25], v37 offset:25600
    ds_read_b64_tr_b16 v[26:27], v37 offset:31744
    v_mfma_f32_16x16x32_bf16 v[72:75], v[204:207], a[88:91], v[72:75]
    v_add_u32 v177, 147456, v1
    v_mul_u32_u24 v178, 72, v11
    v_mfma_f32_16x16x32_bf16 v[76:79], v[200:203], a[84:87], v[76:79]
    ds_read_b64_tr_b16 v[28:29], v37 offset:37888
    ds_read_b64_tr_b16 v[30:31], v37 offset:44032
    v_mfma_f32_16x16x32_bf16 v[76:79], v[204:207], a[92:95], v[76:79]
    s_add_u32 m0, s70, 86016
    s_waitcnt vmcnt(17) lgkmcnt(8)
    v_mfma_f32_16x16x32_bf16 v[80:83], v[208:211], a[80:83], v[80:83]
    ds_read_b64_tr_b16 v[192:193], v38 offset:25600
    ds_read_b64_tr_b16 v[194:195], v38 offset:31744
    v_mfma_f32_16x16x32_bf16 v[80:83], v[212:215], a[88:91], v[80:83]
    buffer_load_dwordx4 v58, s[24:27], s81 offen offset:0  lds
    v_mfma_f32_16x16x32_bf16 v[84:87], v[208:211], a[84:87], v[84:87]
    ds_read_b64_tr_b16 v[196:197], v38 offset:37888
    ds_read_b64_tr_b16 v[198:199], v38 offset:44032
    v_mfma_f32_16x16x32_bf16 v[84:87], v[212:215], a[92:95], v[84:87]
    buffer_load_dwordx4 v59, s[24:27], s48 offen offset:1024  lds
    v_mfma_f32_16x16x32_bf16 v[88:91], v[216:219], a[80:83], v[88:91]
    ds_read_b64_tr_b16 v[200:201], v39 offset:25600
    ds_read_b64_tr_b16 v[202:203], v39 offset:31744
    v_mfma_f32_16x16x32_bf16 v[88:91], v[220:223], a[88:91], v[88:91]
    buffer_load_dwordx4 v60, s[24:27], s49 offen offset:2048  lds
    v_mfma_f32_16x16x32_bf16 v[92:95], v[216:219], a[84:87], v[92:95]
    ds_read_b64_tr_b16 v[204:205], v39 offset:37888
    ds_read_b64_tr_b16 v[206:207], v39 offset:44032
    v_mfma_f32_16x16x32_bf16 v[92:95], v[220:223], a[92:95], v[92:95]
    s_add_u32 s82, s72, 24576
    buffer_store_dword v15, v14, s[8:11], 0 offen offset:8 sc1
    s_waitcnt lgkmcnt(8)
    v_mfma_f32_16x16x32_bf16 v[96:99], v[16:19], a[80:83], v[96:99]
    ds_read_b64_tr_b16 v[208:209], v36 offset:26624
    ds_read_b64_tr_b16 v[210:211], v36 offset:32768
    v_mfma_f32_16x16x32_bf16 v[96:99], v[20:23], a[88:91], v[96:99]
    buffer_load_dwordx4 a[144:147], v1, s[8:11], s82 offen offset:0 sc1
    v_mfma_f32_16x16x32_bf16 v[100:103], v[16:19], a[84:87], v[100:103]
    ds_read_b64_tr_b16 v[212:213], v36 offset:38912
    ds_read_b64_tr_b16 v[214:215], v36 offset:45056
    v_mfma_f32_16x16x32_bf16 v[100:103], v[20:23], a[92:95], v[100:103]
    v_lshl_add_u32 v178, v10, 4, v178
    s_lshl_b32 s83, s3, 10
    v_mfma_f32_16x16x32_bf16 v[104:107], v[24:27], a[80:83], v[104:107]
    ds_read_b64_tr_b16 v[216:217], v37 offset:26624
    ds_read_b64_tr_b16 v[218:219], v37 offset:32768
    v_mfma_f32_16x16x32_bf16 v[104:107], v[28:31], a[88:91], v[104:107]
    buffer_load_dwordx4 a[148:151], v1, s[8:11], s82 offen offset:1024 sc1
    v_mfma_f32_16x16x32_bf16 v[108:111], v[24:27], a[84:87], v[108:111]
    ds_read_b64_tr_b16 v[220:221], v37 offset:38912
    ds_read_b64_tr_b16 v[222:223], v37 offset:45056
    v_mfma_f32_16x16x32_bf16 v[108:111], v[28:31], a[92:95], v[108:111]
    v_add_u32 v9, s83, v1
    s_waitcnt lgkmcnt(8)
    v_mfma_f32_16x16x32_bf16 v[112:115], v[192:195], a[80:83], v[112:115]
    ds_read_b64_tr_b16 v[16:17], v38 offset:26624
    ds_read_b64_tr_b16 v[18:19], v38 offset:32768
    v_mfma_f32_16x16x32_bf16 v[112:115], v[196:199], a[88:91], v[112:115]
    buffer_load_dwordx4 a[152:155], v63, s[8:11], s82 offen offset:0 sc1
    v_mfma_f32_16x16x32_bf16 v[116:119], v[192:195], a[84:87], v[116:119]
    ds_read_b64_tr_b16 v[20:21], v38 offset:38912
    ds_read_b64_tr_b16 v[22:23], v38 offset:45056
    v_mfma_f32_16x16x32_bf16 v[116:119], v[196:199], a[92:95], v[116:119]
    v_add_u32 v182, s83, v177
    v_add_u32 v180, 16384, v1
    v_mfma_f32_16x16x32_bf16 v[120:123], v[200:203], a[80:83], v[120:123]
    ds_read_b64_tr_b16 v[24:25], v39 offset:26624
    ds_read_b64_tr_b16 v[26:27], v39 offset:32768
    v_mfma_f32_16x16x32_bf16 v[120:123], v[204:207], a[88:91], v[120:123]
    buffer_load_dwordx4 a[156:159], v63, s[8:11], s82 offen offset:1024 sc1
    v_mfma_f32_16x16x32_bf16 v[124:127], v[200:203], a[84:87], v[124:127]
    ds_read_b64_tr_b16 v[28:29], v39 offset:38912
    ds_read_b64_tr_b16 v[30:31], v39 offset:45056
    v_mfma_f32_16x16x32_bf16 v[124:127], v[204:207], a[92:95], v[124:127]
    s_add_u32 s82, s72, 40960
    v_writelane_b32 v14, 0, 0
    s_waitcnt lgkmcnt(8)
    s_barrier
    v_mfma_f32_16x16x32_bf16 v[64:67], v[208:211], a[96:99], v[64:67]
    ds_read_b64_tr_b16 v[192:193], v4 offset:0
    ds_read_b64_tr_b16 v[194:195], v4 offset:6144
    v_mfma_f32_16x16x32_bf16 v[64:67], v[212:215], a[104:107], v[64:67]
    buffer_load_dwordx4 a[160:163], v1, s[8:11], s82 offen offset:0 sc1
    v_mfma_f32_16x16x32_bf16 v[68:71], v[208:211], a[100:103], v[68:71]
    ds_read_b64_tr_b16 v[196:197], v4 offset:12288
    ds_read_b64_tr_b16 v[198:199], v4 offset:18432
    v_mfma_f32_16x16x32_bf16 v[68:71], v[212:215], a[108:111], v[68:71]
    v_add_u32 v181, 32768, v1
    s_mov_b32 s12, s4
    v_mfma_f32_16x16x32_bf16 v[72:75], v[216:219], a[96:99], v[72:75]
    ds_read_b64_tr_b16 v[200:201], v5 offset:0
    ds_read_b64_tr_b16 v[202:203], v5 offset:6144
    v_mfma_f32_16x16x32_bf16 v[72:75], v[220:223], a[104:107], v[72:75]
    buffer_load_dwordx4 a[164:167], v1, s[8:11], s82 offen offset:1024 sc1
    v_mfma_f32_16x16x32_bf16 v[76:79], v[216:219], a[100:103], v[76:79]
    ds_read_b64_tr_b16 v[204:205], v5 offset:12288
    ds_read_b64_tr_b16 v[206:207], v5 offset:18432
    v_mfma_f32_16x16x32_bf16 v[76:79], v[220:223], a[108:111], v[76:79]
    s_mov_b32 s13, s5
    s_waitcnt lgkmcnt(8)
    v_mfma_f32_16x16x32_bf16 v[80:83], v[16:19], a[96:99], v[80:83]
    ds_read_b64_tr_b16 v[208:209], v6 offset:0
    ds_read_b64_tr_b16 v[210:211], v6 offset:6144
    v_mfma_f32_16x16x32_bf16 v[80:83], v[20:23], a[104:107], v[80:83]
    buffer_load_dwordx4 a[168:171], v63, s[8:11], s82 offen offset:0 sc1
    v_mfma_f32_16x16x32_bf16 v[84:87], v[16:19], a[100:103], v[84:87]
    ds_read_b64_tr_b16 v[212:213], v6 offset:12288
    ds_read_b64_tr_b16 v[214:215], v6 offset:18432
    v_mfma_f32_16x16x32_bf16 v[84:87], v[20:23], a[108:111], v[84:87]
    s_mov_b32 s14, 2359296
    s_mov_b32 s16, s6
    v_mfma_f32_16x16x32_bf16 v[88:91], v[24:27], a[96:99], v[88:91]
    ds_read_b64_tr_b16 v[216:217], v7 offset:0
    ds_read_b64_tr_b16 v[218:219], v7 offset:6144
    v_mfma_f32_16x16x32_bf16 v[88:91], v[28:31], a[104:107], v[88:91]
    buffer_load_dwordx4 a[172:175], v63, s[8:11], s82 offen offset:1024 sc1
    v_mfma_f32_16x16x32_bf16 v[92:95], v[24:27], a[100:103], v[92:95]
    ds_read_b64_tr_b16 v[220:221], v7 offset:12288
    ds_read_b64_tr_b16 v[222:223], v7 offset:18432
    v_mfma_f32_16x16x32_bf16 v[92:95], v[28:31], a[108:111], v[92:95]
    s_add_u32 s82, s72, 57344
    s_waitcnt lgkmcnt(8)
    v_mfma_f32_16x16x32_bf16 v[96:99], v[192:195], a[96:99], v[96:99]
    ds_read_b64_tr_b16 v[16:17], v4 offset:1024
    ds_read_b64_tr_b16 v[18:19], v4 offset:7168
    v_mfma_f32_16x16x32_bf16 v[96:99], v[196:199], a[104:107], v[96:99]
    buffer_load_dwordx4 a[176:179], v1, s[8:11], s82 offen offset:0 sc1
    v_mfma_f32_16x16x32_bf16 v[100:103], v[192:195], a[100:103], v[100:103]
    ds_read_b64_tr_b16 v[20:21], v4 offset:13312
    ds_read_b64_tr_b16 v[22:23], v4 offset:19456
    v_mfma_f32_16x16x32_bf16 v[100:103], v[196:199], a[108:111], v[100:103]
    s_mov_b32 s17, s7
    s_mov_b32 s18, 2359296
    v_mfma_f32_16x16x32_bf16 v[104:107], v[200:203], a[96:99], v[104:107]
    ds_read_b64_tr_b16 v[24:25], v5 offset:1024
    ds_read_b64_tr_b16 v[26:27], v5 offset:7168
    v_mfma_f32_16x16x32_bf16 v[104:107], v[204:207], a[104:107], v[104:107]
    buffer_load_dwordx4 a[180:183], v1, s[8:11], s82 offen offset:1024 sc1
    v_mfma_f32_16x16x32_bf16 v[108:111], v[200:203], a[100:103], v[108:111]
    ds_read_b64_tr_b16 v[28:29], v5 offset:13312
    ds_read_b64_tr_b16 v[30:31], v5 offset:19456
    v_mfma_f32_16x16x32_bf16 v[108:111], v[204:207], a[108:111], v[108:111]
    s_bfe_u32 s83, s2, 0x20001
    s_waitcnt lgkmcnt(8)
    v_mfma_f32_16x16x32_bf16 v[112:115], v[208:211], a[96:99], v[112:115]
    ds_read_b64_tr_b16 v[192:193], v6 offset:1024
    ds_read_b64_tr_b16 v[194:195], v6 offset:7168
    v_mfma_f32_16x16x32_bf16 v[112:115], v[212:215], a[104:107], v[112:115]
    buffer_load_dwordx4 a[184:187], v63, s[8:11], s82 offen offset:0 sc1
    v_mfma_f32_16x16x32_bf16 v[116:119], v[208:211], a[100:103], v[116:119]
    ds_read_b64_tr_b16 v[196:197], v6 offset:13312
    ds_read_b64_tr_b16 v[198:199], v6 offset:19456
    v_mfma_f32_16x16x32_bf16 v[116:119], v[212:215], a[108:111], v[116:119]
    s_bfe_u32 s36, s2, 0x20002
    s_lshl_b32 s36, s36, 11
    v_mfma_f32_16x16x32_bf16 v[120:123], v[216:219], a[96:99], v[120:123]
    ds_read_b64_tr_b16 v[200:201], v7 offset:1024
    ds_read_b64_tr_b16 v[202:203], v7 offset:7168
    v_mfma_f32_16x16x32_bf16 v[120:123], v[220:223], a[104:107], v[120:123]
    buffer_load_dwordx4 a[188:191], v63, s[8:11], s82 offen offset:1024 sc1
    v_mfma_f32_16x16x32_bf16 v[124:127], v[216:219], a[100:103], v[124:127]
    ds_read_b64_tr_b16 v[204:205], v7 offset:13312
    ds_read_b64_tr_b16 v[206:207], v7 offset:19456
    v_mfma_f32_16x16x32_bf16 v[124:127], v[220:223], a[108:111], v[124:127]
    s_add_u32 s82, s72, 81920
    s_waitcnt vmcnt(29) lgkmcnt(8)
    v_mfma_f32_16x16x32_bf16 v[64:67], v[16:19], a[112:115], v[64:67]
    ds_read_b64_tr_b16 v[208:209], v4 offset:2048
    ds_read_b64_tr_b16 v[210:211], v4 offset:8192
    v_mfma_f32_16x16x32_bf16 v[64:67], v[20:23], a[120:123], v[64:67]
    buffer_load_dwordx4 a[192:195], v1, s[8:11], s82 offen offset:0 sc1
    v_mfma_f32_16x16x32_bf16 v[68:71], v[16:19], a[116:119], v[68:71]
    ds_read_b64_tr_b16 v[212:213], v4 offset:14336
Lpad8:
    s_cbranch_execz Lpad9
    ds_read_b64_tr_b16 v[214:215], v4 offset:20480
    v_mfma_f32_16x16x32_bf16 v[68:71], v[20:23], a[124:127], v[68:71]
    s_add_u32 s36, s36, 37879808
    v_and_b32 v56, 3, v0
    v_mfma_f32_16x16x32_bf16 v[72:75], v[24:27], a[112:115], v[72:75]
    ds_read_b64_tr_b16 v[216:217], v5 offset:2048
    ds_read_b64_tr_b16 v[218:219], v5 offset:8192
    v_mfma_f32_16x16x32_bf16 v[72:75], v[28:31], a[120:123], v[72:75]
    buffer_load_dwordx4 a[196:199], v1, s[8:11], s82 offen offset:1024 sc1
    v_mfma_f32_16x16x32_bf16 v[76:79], v[24:27], a[116:119], v[76:79]
    ds_read_b64_tr_b16 v[220:221], v5 offset:14336
    ds_read_b64_tr_b16 v[222:223], v5 offset:20480
    v_mfma_f32_16x16x32_bf16 v[76:79], v[28:31], a[124:127], v[76:79]
    v_max_u32 v56, 1, v56
    s_waitcnt lgkmcnt(8)
    v_mfma_f32_16x16x32_bf16 v[80:83], v[192:195], a[112:115], v[80:83]
    ds_read_b64_tr_b16 v[16:17], v6 offset:2048
    ds_read_b64_tr_b16 v[18:19], v6 offset:8192
    v_mfma_f32_16x16x32_bf16 v[80:83], v[196:199], a[120:123], v[80:83]
    buffer_load_dwordx4 a[200:203], v63, s[8:11], s82 offen offset:0 sc1
    v_mfma_f32_16x16x32_bf16 v[84:87], v[192:195], a[116:119], v[84:87]
    ds_read_b64_tr_b16 v[20:21], v6 offset:14336
    ds_read_b64_tr_b16 v[22:23], v6 offset:20480
    v_mfma_f32_16x16x32_bf16 v[84:87], v[196:199], a[124:127], v[84:87]
    v_add_u32 v56, s83, v56
    v_and_b32 v56, 3, v56
    v_mfma_f32_16x16x32_bf16 v[88:91], v[200:203], a[112:115], v[88:91]
    ds_read_b64_tr_b16 v[24:25], v7 offset:2048
    ds_read_b64_tr_b16 v[26:27], v7 offset:8192
    v_mfma_f32_16x16x32_bf16 v[88:91], v[204:207], a[120:123], v[88:91]
    buffer_load_dwordx4 a[204:207], v63, s[8:11], s82 offen offset:1024 sc1
    v_mfma_f32_16x16x32_bf16 v[92:95], v[200:203], a[116:119], v[92:95]
    ds_read_b64_tr_b16 v[28:29], v7 offset:14336
    ds_read_b64_tr_b16 v[30:31], v7 offset:20480
    v_mfma_f32_16x16x32_bf16 v[92:95], v[204:207], a[124:127], v[92:95]
    v_lshlrev_b32 v56, 9, v56
    s_waitcnt lgkmcnt(8)
    v_mfma_f32_16x16x32_bf16 v[96:99], v[208:211], a[112:115], v[96:99]
    ds_read_b64_tr_b16 v[192:193], v4 offset:24576
    ds_read_b64_tr_b16 v[194:195], v4 offset:30720
    v_mfma_f32_16x16x32_bf16 v[96:99], v[212:215], a[120:123], v[96:99]
    s_add_u32 s48, s71, 1179520
    s_add_u32 s49, s71, 589568
    v_mfma_f32_16x16x32_bf16 v[100:103], v[208:211], a[116:119], v[100:103]
    ds_read_b64_tr_b16 v[196:197], v4 offset:36864
    ds_read_b64_tr_b16 v[198:199], v4 offset:43008
    v_mfma_f32_16x16x32_bf16 v[100:103], v[212:215], a[124:127], v[100:103]
    s_lshr_b32 s37, s2, 6
    s_mul_i32 s84, s37, 6
    v_mfma_f32_16x16x32_bf16 v[104:107], v[216:219], a[112:115], v[104:107]
    ds_read_b64_tr_b16 v[200:201], v5 offset:24576
    ds_read_b64_tr_b16 v[202:203], v5 offset:30720
    v_mfma_f32_16x16x32_bf16 v[104:107], v[220:223], a[120:123], v[104:107]
    s_add_u32 s81, s71, 1032192
    s_lshr_b32 s42, s3, 1
    v_mfma_f32_16x16x32_bf16 v[108:111], v[216:219], a[116:119], v[108:111]
    ds_read_b64_tr_b16 v[204:205], v5 offset:36864
    ds_read_b64_tr_b16 v[206:207], v5 offset:43008
    v_mfma_f32_16x16x32_bf16 v[108:111], v[220:223], a[124:127], v[108:111]
    s_add_u32 m0, s70, 98304
    s_waitcnt lgkmcnt(8)
    v_mfma_f32_16x16x32_bf16 v[112:115], v[16:19], a[112:115], v[112:115]
    ds_read_b64_tr_b16 v[208:209], v6 offset:24576
    ds_read_b64_tr_b16 v[210:211], v6 offset:30720
    v_mfma_f32_16x16x32_bf16 v[112:115], v[20:23], a[120:123], v[112:115]
    buffer_load_dwordx4 v61, s[24:27], s81 offen offset:0  lds
    v_mfma_f32_16x16x32_bf16 v[116:119], v[16:19], a[116:119], v[116:119]
    ds_read_b64_tr_b16 v[212:213], v6 offset:36864
    ds_read_b64_tr_b16 v[214:215], v6 offset:43008
    v_mfma_f32_16x16x32_bf16 v[116:119], v[20:23], a[124:127], v[116:119]
    buffer_load_dwordx4 v2, s[24:27], s48 offen offset:1024  lds
    v_mfma_f32_16x16x32_bf16 v[120:123], v[24:27], a[112:115], v[120:123]
    ds_read_b64_tr_b16 v[216:217], v7 offset:24576
    ds_read_b64_tr_b16 v[218:219], v7 offset:30720
    v_mfma_f32_16x16x32_bf16 v[120:123], v[28:31], a[120:123], v[120:123]
    buffer_load_dwordx4 v3, s[24:27], s49 offen offset:2048  lds
    v_mfma_f32_16x16x32_bf16 v[124:127], v[24:27], a[116:119], v[124:127]
    ds_read_b64_tr_b16 v[220:221], v7 offset:36864
    ds_read_b64_tr_b16 v[222:223], v7 offset:43008
    v_mfma_f32_16x16x32_bf16 v[124:127], v[28:31], a[124:127], v[124:127]
    s_add_u32 m0, s70, 110592
    s_waitcnt vmcnt(29) lgkmcnt(8)
    v_mfma_f32_16x16x32_bf16 v[64:67], v[192:195], a[128:131], v[64:67]
    ds_read_b64_tr_b16 v[16:17], v4 offset:25600
    ds_read_b64_tr_b16 v[18:19], v4 offset:31744
    v_mfma_f32_16x16x32_bf16 v[64:67], v[196:199], a[136:139], v[64:67]
    buffer_load_dwordx4 v58, s[24:27], s81 offen offset:0  lds
    v_mfma_f32_16x16x32_bf16 v[68:71], v[192:195], a[132:135], v[68:71]
    ds_read_b64_tr_b16 v[20:21], v4 offset:37888
    ds_read_b64_tr_b16 v[22:23], v4 offset:44032
    v_mfma_f32_16x16x32_bf16 v[68:71], v[196:199], a[140:143], v[68:71]
    buffer_load_dwordx4 v59, s[24:27], s48 offen offset:1024  lds
    v_mfma_f32_16x16x32_bf16 v[72:75], v[200:203], a[128:131], v[72:75]
    ds_read_b64_tr_b16 v[24:25], v5 offset:25600
    ds_read_b64_tr_b16 v[26:27], v5 offset:31744
    v_mfma_f32_16x16x32_bf16 v[72:75], v[204:207], a[136:139], v[72:75]
    buffer_load_dwordx4 v60, s[24:27], s49 offen offset:2048  lds
    v_mfma_f32_16x16x32_bf16 v[76:79], v[200:203], a[132:135], v[76:79]
    ds_read_b64_tr_b16 v[28:29], v5 offset:37888
    ds_read_b64_tr_b16 v[30:31], v5 offset:44032
    v_mfma_f32_16x16x32_bf16 v[76:79], v[204:207], a[140:143], v[76:79]
    s_add_u32 s84, s84, s42
    s_waitcnt lgkmcnt(8)
    v_mfma_f32_16x16x32_bf16 v[80:83], v[208:211], a[128:131], v[80:83]
    ds_read_b64_tr_b16 v[192:193], v6 offset:25600
    ds_read_b64_tr_b16 v[194:195], v6 offset:31744
    v_mfma_f32_16x16x32_bf16 v[80:83], v[212:215], a[136:139], v[80:83]
    s_add_u32 s48, s71, 516096
    s_add_u32 s49, s71, 737152
    v_mfma_f32_16x16x32_bf16 v[84:87], v[208:211], a[132:135], v[84:87]
    ds_read_b64_tr_b16 v[196:197], v6 offset:37888
    ds_read_b64_tr_b16 v[198:199], v6 offset:44032
    v_mfma_f32_16x16x32_bf16 v[84:87], v[212:215], a[140:143], v[84:87]
    s_lshl_b32 s84, s84, 2
    s_lshr_b32 s37, s37, 1
    v_mfma_f32_16x16x32_bf16 v[88:91], v[216:219], a[128:131], v[88:91]
    ds_read_b64_tr_b16 v[200:201], v7 offset:25600
    ds_read_b64_tr_b16 v[202:203], v7 offset:31744
    v_mfma_f32_16x16x32_bf16 v[88:91], v[220:223], a[136:139], v[88:91]
    s_add_u32 s81, s71, 1253376
    s_sub_u32 s34, 2, s37
    v_mfma_f32_16x16x32_bf16 v[92:95], v[216:219], a[132:135], v[92:95]
    ds_read_b64_tr_b16 v[204:205], v7 offset:37888
    ds_read_b64_tr_b16 v[206:207], v7 offset:44032
    v_mfma_f32_16x16x32_bf16 v[92:95], v[220:223], a[140:143], v[92:95]
    s_add_u32 m0, s70, 122880
    buffer_load_dword v57, v62, s[8:11], s74 offen offset:8 sc1
    s_waitcnt lgkmcnt(8)
    v_mfma_f32_16x16x32_bf16 v[96:99], v[16:19], a[128:131], v[96:99]
    ds_read_b64_tr_b16 v[208:209], v4 offset:26624
    ds_read_b64_tr_b16 v[210:211], v4 offset:32768
    v_mfma_f32_16x16x32_bf16 v[96:99], v[20:23], a[136:139], v[96:99]
    buffer_load_dwordx4 v61, s[24:27], s81 offen offset:0  lds
    v_mfma_f32_16x16x32_bf16 v[100:103], v[16:19], a[132:135], v[100:103]
    ds_read_b64_tr_b16 v[212:213], v4 offset:38912
    ds_read_b64_tr_b16 v[214:215], v4 offset:45056
    v_mfma_f32_16x16x32_bf16 v[100:103], v[20:23], a[140:143], v[100:103]
    buffer_load_dwordx4 v2, s[24:27], s48 offen offset:1024  lds
    v_mfma_f32_16x16x32_bf16 v[104:107], v[24:27], a[128:131], v[104:107]
    ds_read_b64_tr_b16 v[216:217], v5 offset:26624
    ds_read_b64_tr_b16 v[218:219], v5 offset:32768
    v_mfma_f32_16x16x32_bf16 v[104:107], v[28:31], a[136:139], v[104:107]
    buffer_load_dwordx4 v3, s[24:27], s49 offen offset:2048  lds
    v_mfma_f32_16x16x32_bf16 v[108:111], v[24:27], a[132:135], v[108:111]
    ds_read_b64_tr_b16 v[220:221], v5 offset:38912
    ds_read_b64_tr_b16 v[222:223], v5 offset:45056
    v_mfma_f32_16x16x32_bf16 v[108:111], v[28:31], a[140:143], v[108:111]
    s_add_u32 m0, s70, 135168
    s_waitcnt lgkmcnt(8)
    v_mfma_f32_16x16x32_bf16 v[112:115], v[192:195], a[128:131], v[112:115]
    ds_read_b64_tr_b16 v[16:17], v6 offset:26624
    ds_read_b64_tr_b16 v[18:19], v6 offset:32768
    v_mfma_f32_16x16x32_bf16 v[112:115], v[196:199], a[136:139], v[112:115]
    buffer_load_dwordx4 v58, s[24:27], s81 offen offset:0  lds
    v_mfma_f32_16x16x32_bf16 v[116:119], v[192:195], a[132:135], v[116:119]
    ds_read_b64_tr_b16 v[20:21], v6 offset:38912
    ds_read_b64_tr_b16 v[22:23], v6 offset:45056
    v_mfma_f32_16x16x32_bf16 v[116:119], v[196:199], a[140:143], v[116:119]
    buffer_load_dwordx4 v59, s[24:27], s48 offen offset:1024  lds
    v_mfma_f32_16x16x32_bf16 v[120:123], v[200:203], a[128:131], v[120:123]
    ds_read_b64_tr_b16 v[24:25], v7 offset:26624
    ds_read_b64_tr_b16 v[26:27], v7 offset:32768
    v_mfma_f32_16x16x32_bf16 v[120:123], v[204:207], a[136:139], v[120:123]
    buffer_load_dwordx4 v60, s[24:27], s49 offen offset:2048  lds
    v_mfma_f32_16x16x32_bf16 v[124:127], v[200:203], a[132:135], v[124:127]
    ds_read_b64_tr_b16 v[28:29], v7 offset:38912
    ds_read_b64_tr_b16 v[30:31], v7 offset:45056
    v_mfma_f32_16x16x32_bf16 v[124:127], v[204:207], a[140:143], v[124:127]
    s_waitcnt vmcnt(25) lgkmcnt(8)
    s_barrier
    v_mfma_f32_16x16x32_bf16 v[64:67], v[208:211], a[144:147], v[64:67]
    ds_read_b64_tr_b16 v[192:193], v32 offset:0
    ds_read_b64_tr_b16 v[194:195], v32 offset:6144
    v_mfma_f32_16x16x32_bf16 v[64:67], v[212:215], a[152:155], v[64:67]
    v_lshrrev_b32 v8, 2, v0
    v_min_u32 v8, s34, v8
    v_mfma_f32_16x16x32_bf16 v[68:71], v[208:211], a[148:151], v[68:71]
    ds_read_b64_tr_b16 v[196:197], v32 offset:12288
    ds_read_b64_tr_b16 v[198:199], v32 offset:18432
    v_mfma_f32_16x16x32_bf16 v[68:71], v[212:215], a[156:159], v[68:71]
    v_and_b32 v179, 3, v0
    v_lshl_add_u32 v8, v8, 3, v179
    v_mfma_f32_16x16x32_bf16 v[72:75], v[216:219], a[144:147], v[72:75]
    ds_read_b64_tr_b16 v[200:201], v33 offset:0
    ds_read_b64_tr_b16 v[202:203], v33 offset:6144
    v_mfma_f32_16x16x32_bf16 v[72:75], v[220:223], a[152:155], v[72:75]
    v_add_u32 v8, s84, v8
    v_lshl_add_u32 v8, v8, 5, s36
    v_mfma_f32_16x16x32_bf16 v[76:79], v[216:219], a[148:151], v[76:79]
    ds_read_b64_tr_b16 v[204:205], v33 offset:12288
    ds_read_b64_tr_b16 v[206:207], v33 offset:18432
    v_mfma_f32_16x16x32_bf16 v[76:79], v[220:223], a[156:159], v[76:79]
    s_add_u32 s82, s72, 98304
    s_waitcnt lgkmcnt(8)
    v_mfma_f32_16x16x32_bf16 v[80:83], v[16:19], a[144:147], v[80:83]
    ds_read_b64_tr_b16 v[208:209], v34 offset:0
    ds_read_b64_tr_b16 v[210:211], v34 offset:6144
    v_mfma_f32_16x16x32_bf16 v[80:83], v[20:23], a[152:155], v[80:83]
    buffer_load_dwordx4 a[208:211], v1, s[8:11], s82 offen offset:0 sc1
    v_mfma_f32_16x16x32_bf16 v[84:87], v[16:19], a[148:151], v[84:87]
    ds_read_b64_tr_b16 v[212:213], v34 offset:12288
    ds_read_b64_tr_b16 v[214:215], v34 offset:18432
    v_mfma_f32_16x16x32_bf16 v[84:87], v[20:23], a[156:159], v[84:87]
    s_and_b32 s34, s2, 1
    s_lshl_b32 s34, s34, 1
    v_mfma_f32_16x16x32_bf16 v[88:91], v[24:27], a[144:147], v[88:91]
    ds_read_b64_tr_b16 v[216:217], v35 offset:0
    ds_read_b64_tr_b16 v[218:219], v35 offset:6144
    v_mfma_f32_16x16x32_bf16 v[88:91], v[28:31], a[152:155], v[88:91]
    buffer_load_dwordx4 a[212:215], v1, s[8:11], s82 offen offset:1024 sc1
    v_mfma_f32_16x16x32_bf16 v[92:95], v[24:27], a[148:151], v[92:95]
    ds_read_b64_tr_b16 v[220:221], v35 offset:12288
    ds_read_b64_tr_b16 v[222:223], v35 offset:18432
    v_mfma_f32_16x16x32_bf16 v[92:95], v[28:31], a[156:159], v[92:95]
    s_bfe_u32 s35, s2, 0x10005
    s_waitcnt lgkmcnt(8)
    v_mfma_f32_16x16x32_bf16 v[96:99], v[192:195], a[144:147], v[96:99]
    ds_read_b64_tr_b16 v[16:17], v32 offset:1024
    ds_read_b64_tr_b16 v[18:19], v32 offset:7168
    v_mfma_f32_16x16x32_bf16 v[96:99], v[196:199], a[152:155], v[96:99]
    buffer_load_dwordx4 a[216:219], v63, s[8:11], s82 offen offset:0 sc1
    v_mfma_f32_16x16x32_bf16 v[100:103], v[192:195], a[148:151], v[100:103]
    ds_read_b64_tr_b16 v[20:21], v32 offset:13312
    ds_read_b64_tr_b16 v[22:23], v32 offset:19456
    v_mfma_f32_16x16x32_bf16 v[100:103], v[196:199], a[156:159], v[100:103]
    s_add_u32 s34, s34, s35
    s_lshl_b32 s34, s34, 1
    v_mfma_f32_16x16x32_bf16 v[104:107], v[200:203], a[144:147], v[104:107]
    ds_read_b64_tr_b16 v[24:25], v33 offset:1024
    ds_read_b64_tr_b16 v[26:27], v33 offset:7168
    v_mfma_f32_16x16x32_bf16 v[104:107], v[204:207], a[152:155], v[104:107]
    buffer_load_dwordx4 a[220:223], v63, s[8:11], s82 offen offset:1024 sc1
    v_mfma_f32_16x16x32_bf16 v[108:111], v[200:203], a[148:151], v[108:111]
    ds_read_b64_tr_b16 v[28:29], v33 offset:13312
    ds_read_b64_tr_b16 v[30:31], v33 offset:19456
    v_mfma_f32_16x16x32_bf16 v[108:111], v[204:207], a[156:159], v[108:111]
    s_add_u32 s82, s72, 114688
    s_waitcnt lgkmcnt(8)
    v_mfma_f32_16x16x32_bf16 v[112:115], v[208:211], a[144:147], v[112:115]
    ds_read_b64_tr_b16 v[192:193], v34 offset:1024
    ds_read_b64_tr_b16 v[194:195], v34 offset:7168
    v_mfma_f32_16x16x32_bf16 v[112:115], v[212:215], a[152:155], v[112:115]
    buffer_load_dwordx4 a[224:227], v1, s[8:11], s82 offen offset:0 sc1
    v_mfma_f32_16x16x32_bf16 v[116:119], v[208:211], a[148:151], v[116:119]
    ds_read_b64_tr_b16 v[196:197], v34 offset:13312
    ds_read_b64_tr_b16 v[198:199], v34 offset:19456
    v_mfma_f32_16x16x32_bf16 v[116:119], v[212:215], a[156:159], v[116:119]
    s_add_u32 s42, s42, s34
    s_lshl_b32 s42, s42, 10
    v_mfma_f32_16x16x32_bf16 v[120:123], v[216:219], a[144:147], v[120:123]
    ds_read_b64_tr_b16 v[200:201], v35 offset:1024
    ds_read_b64_tr_b16 v[202:203], v35 offset:7168
    v_mfma_f32_16x16x32_bf16 v[120:123], v[220:223], a[152:155], v[120:123]
    buffer_load_dwordx4 a[228:231], v1, s[8:11], s82 offen offset:1024 sc1
    v_mfma_f32_16x16x32_bf16 v[124:127], v[216:219], a[148:151], v[124:127]
    ds_read_b64_tr_b16 v[204:205], v35 offset:13312
    ds_read_b64_tr_b16 v[206:207], v35 offset:19456
    v_mfma_f32_16x16x32_bf16 v[124:127], v[220:223], a[156:159], v[124:127]
    s_waitcnt vmcnt(27) lgkmcnt(8)
    s_waitcnt vmcnt(12)
    v_cmp_ne_u32 vcc, v57, v15
    s_cbranch_vccnz Lspin6
Lback6:
    v_mfma_f32_16x16x32_bf16 v[64:67], v[16:19], a[160:163], v[64:67]
    ds_read_b64_tr_b16 v[208:209], v32 offset:2048
    ds_read_b64_tr_b16 v[210:211], v32 offset:8192
    v_mfma_f32_16x16x32_bf16 v[64:67], v[20:23], a[168:171], v[64:67]
    buffer_load_dwordx4 a[232:235], v63, s[8:11], s82 offen offset:0 sc1
    v_mfma_f32_16x16x32_bf16 v[68:71], v[16:19], a[164:167], v[68:71]
    ds_read_b64_tr_b16 v[212:213], v32 offset:14336
    ds_read_b64_tr_b16 v[214:215], v32 offset:20480
    v_mfma_f32_16x16x32_bf16 v[68:71], v[20:23], a[172:175], v[68:71]
    s_add_u32 s42, s42, 37886976
    v_lshl_add_u32 v179, v0, 5, s42
    v_mfma_f32_16x16x32_bf16 v[72:75], v[24:27], a[160:163], v[72:75]
    ds_read_b64_tr_b16 v[216:217], v33 offset:2048
    ds_read_b64_tr_b16 v[218:219], v33 offset:8192
    v_mfma_f32_16x16x32_bf16 v[72:75], v[28:31], a[168:171], v[72:75]
    buffer_load_dwordx4 a[236:239], v63, s[8:11], s82 offen offset:1024 sc1
    v_mfma_f32_16x16x32_bf16 v[76:79], v[24:27], a[164:167], v[76:79]
    ds_read_b64_tr_b16 v[220:221], v33 offset:14336
    ds_read_b64_tr_b16 v[222:223], v33 offset:20480
    v_mfma_f32_16x16x32_bf16 v[76:79], v[28:31], a[172:175], v[76:79]
    s_add_u32 s82, s72, 131072
    s_waitcnt lgkmcnt(8)
    v_mfma_f32_16x16x32_bf16 v[80:83], v[192:195], a[160:163], v[80:83]
    ds_read_b64_tr_b16 v[16:17], v34 offset:2048
    ds_read_b64_tr_b16 v[18:19], v34 offset:8192
    v_mfma_f32_16x16x32_bf16 v[80:83], v[196:199], a[168:171], v[80:83]
    buffer_load_dwordx4 a[240:243], v1, s[8:11], s82 offen offset:0 sc1
    v_mfma_f32_16x16x32_bf16 v[84:87], v[192:195], a[164:167], v[84:87]
    ds_read_b64_tr_b16 v[20:21], v34 offset:14336
    ds_read_b64_tr_b16 v[22:23], v34 offset:20480
    v_mfma_f32_16x16x32_bf16 v[84:87], v[196:199], a[172:175], v[84:87]
    s_sub_u32 s35, 0, s37
    s_mov_b32 s34, 0
    v_mfma_f32_16x16x32_bf16 v[88:91], v[200:203], a[160:163], v[88:91]
    ds_read_b64_tr_b16 v[24:25], v35 offset:2048
    ds_read_b64_tr_b16 v[26:27], v35 offset:8192
    v_mfma_f32_16x16x32_bf16 v[88:91], v[204:207], a[168:171], v[88:91]
    buffer_load_dwordx4 a[244:247], v1, s[8:11], s82 offen offset:1024 sc1
    v_mfma_f32_16x16x32_bf16 v[92:95], v[200:203], a[164:167], v[92:95]
    ds_read_b64_tr_b16 v[28:29], v35 offset:14336
    ds_read_b64_tr_b16 v[30:31], v35 offset:20480
    v_mfma_f32_16x16x32_bf16 v[92:95], v[204:207], a[172:175], v[92:95]
    v_cndmask_b32 v8, v8, v179, s[34:35]
    s_waitcnt lgkmcnt(8)
    v_mfma_f32_16x16x32_bf16 v[96:99], v[208:211], a[160:163], v[96:99]
    ds_read_b64_tr_b16 v[192:193], v32 offset:24576
    ds_read_b64_tr_b16 v[194:195], v32 offset:30720
    v_mfma_f32_16x16x32_bf16 v[96:99], v[212:215], a[168:171], v[96:99]
    buffer_load_dwordx4 a[248:251], v63, s[8:11], s82 offen offset:0 sc1
    v_mfma_f32_16x16x32_bf16 v[100:103], v[208:211], a[164:167], v[100:103]
    ds_read_b64_tr_b16 v[196:197], v32 offset:36864
    ds_read_b64_tr_b16 v[198:199], v32 offset:43008
    v_mfma_f32_16x16x32_bf16 v[100:103], v[212:215], a[172:175], v[100:103]
    s_add_u32 s34, s76, 256
    v_add_u32 v179, s34, v56
    v_mfma_f32_16x16x32_bf16 v[104:107], v[216:219], a[160:163], v[104:107]
    ds_read_b64_tr_b16 v[200:201], v33 offset:24576
    ds_read_b64_tr_b16 v[202:203], v33 offset:30720
    v_mfma_f32_16x16x32_bf16 v[104:107], v[220:223], a[168:171], v[104:107]
    buffer_load_dwordx4 a[252:255], v63, s[8:11], s82 offen offset:1024 sc1
    v_mfma_f32_16x16x32_bf16 v[108:111], v[216:219], a[164:167], v[108:111]
    ds_read_b64_tr_b16 v[204:205], v33 offset:36864
    ds_read_b64_tr_b16 v[206:207], v33 offset:43008
    v_mfma_f32_16x16x32_bf16 v[108:111], v[220:223], a[172:175], v[108:111]
    s_add_u32 s82, s72, 65536
    s_waitcnt lgkmcnt(8)
    v_mfma_f32_16x16x32_bf16 v[112:115], v[16:19], a[160:163], v[112:115]
    ds_read_b64_tr_b16 v[208:209], v34 offset:24576
    ds_read_b64_tr_b16 v[210:211], v34 offset:30720
    v_mfma_f32_16x16x32_bf16 v[112:115], v[20:23], a[168:171], v[112:115]
    buffer_load_dwordx2 v[224:225], v1, s[8:11], s82 offen offset:0
    v_mfma_f32_16x16x32_bf16 v[116:119], v[16:19], a[164:167], v[116:119]
    ds_read_b64_tr_b16 v[212:213], v34 offset:36864
    ds_read_b64_tr_b16 v[214:215], v34 offset:43008
    v_mfma_f32_16x16x32_bf16 v[116:119], v[20:23], a[172:175], v[116:119]
    buffer_load_dwordx2 v[228:229], v1, s[8:11], s82 offen offset:8
    v_mfma_f32_16x16x32_bf16 v[120:123], v[24:27], a[160:163], v[120:123]
    ds_read_b64_tr_b16 v[216:217], v35 offset:24576
    ds_read_b64_tr_b16 v[218:219], v35 offset:30720
    v_mfma_f32_16x16x32_bf16 v[120:123], v[28:31], a[168:171], v[120:123]
    buffer_load_dwordx2 v[226:227], v1, s[8:11], s82 offen offset:1024
    v_mfma_f32_16x16x32_bf16 v[124:127], v[24:27], a[164:167], v[124:127]
    ds_read_b64_tr_b16 v[220:221], v35 offset:36864
    ds_read_b64_tr_b16 v[222:223], v35 offset:43008
    v_mfma_f32_16x16x32_bf16 v[124:127], v[28:31], a[172:175], v[124:127]
    s_waitcnt lgkmcnt(8)
    v_mfma_f32_16x16x32_bf16 v[64:67], v[192:195], a[176:179], v[64:67]
    ds_read_b64_tr_b16 v[16:17], v32 offset:25600
    ds_read_b64_tr_b16 v[18:19], v32 offset:31744
    v_mfma_f32_16x16x32_bf16 v[64:67], v[196:199], a[184:187], v[64:67]
    buffer_load_dwordx2 v[230:231], v1, s[8:11], s82 offen offset:1032
    v_mfma_f32_16x16x32_bf16 v[68:71], v[192:195], a[180:183], v[68:71]
    ds_read_b64_tr_b16 v[20:21], v32 offset:37888
    ds_read_b64_tr_b16 v[22:23], v32 offset:44032
    v_mfma_f32_16x16x32_bf16 v[68:71], v[196:199], a[188:191], v[68:71]
    buffer_load_dwordx2 v[232:233], v63, s[8:11], s82 offen offset:0
    v_mfma_f32_16x16x32_bf16 v[72:75], v[200:203], a[176:179], v[72:75]
    ds_read_b64_tr_b16 v[24:25], v33 offset:25600
    ds_read_b64_tr_b16 v[26:27], v33 offset:31744
    v_mfma_f32_16x16x32_bf16 v[72:75], v[204:207], a[184:187], v[72:75]
    buffer_load_dwordx2 v[236:237], v63, s[8:11], s82 offen offset:8
    v_mfma_f32_16x16x32_bf16 v[76:79], v[200:203], a[180:183], v[76:79]
    ds_read_b64_tr_b16 v[28:29], v33 offset:37888
    ds_read_b64_tr_b16 v[30:31], v33 offset:44032
    v_mfma_f32_16x16x32_bf16 v[76:79], v[204:207], a[188:191], v[76:79]
    s_mov_b32 s34, 0x000f0000
    s_waitcnt lgkmcnt(8)
    v_mfma_f32_16x16x32_bf16 v[80:83], v[208:211], a[176:179], v[80:83]
    ds_read_b64_tr_b16 v[192:193], v34 offset:25600
    ds_read_b64_tr_b16 v[194:195], v34 offset:31744
    v_mfma_f32_16x16x32_bf16 v[80:83], v[212:215], a[184:187], v[80:83]
    buffer_load_dwordx2 v[234:235], v63, s[8:11], s82 offen offset:1024
    v_mfma_f32_16x16x32_bf16 v[84:87], v[208:211], a[180:183], v[84:87]
    ds_read_b64_tr_b16 v[196:197], v34 offset:37888
    ds_read_b64_tr_b16 v[198:199], v34 offset:44032
    v_mfma_f32_16x16x32_bf16 v[84:87], v[212:215], a[188:191], v[84:87]
    s_mov_b32 s35, 0
    v_cndmask_b32 v8, v8, v179, s[34:35]
    v_mfma_f32_16x16x32_bf16 v[88:91], v[216:219], a[176:179], v[88:91]
    ds_read_b64_tr_b16 v[200:201], v35 offset:25600
    ds_read_b64_tr_b16 v[202:203], v35 offset:31744
    v_mfma_f32_16x16x32_bf16 v[88:91], v[220:223], a[184:187], v[88:91]
    buffer_load_dwordx2 v[238:239], v63, s[8:11], s82 offen offset:1032
    v_mfma_f32_16x16x32_bf16 v[92:95], v[216:219], a[180:183], v[92:95]
    ds_read_b64_tr_b16 v[204:205], v35 offset:37888
    ds_read_b64_tr_b16 v[206:207], v35 offset:44032
    v_mfma_f32_16x16x32_bf16 v[92:95], v[220:223], a[188:191], v[92:95]
    s_add_u32 s82, s72, 139264
    s_waitcnt lgkmcnt(8)
    v_mfma_f32_16x16x32_bf16 v[64:67], v[16:19], a[192:195], v[64:67]
    ds_read_b64_tr_b16 v[208:209], v32 offset:26624
    ds_read_b64_tr_b16 v[210:211], v32 offset:32768
    v_mfma_f32_16x16x32_bf16 v[64:67], v[20:23], a[200:203], v[64:67]
    buffer_load_dwordx2 v[240:241], v1, s[8:11], s82 offen offset:0
    v_mfma_f32_16x16x32_bf16 v[68:71], v[16:19], a[196:199], v[68:71]
    ds_read_b64_tr_b16 v[212:213], v32 offset:38912
    ds_read_b64_tr_b16 v[214:215], v32 offset:45056
    v_mfma_f32_16x16x32_bf16 v[68:71], v[20:23], a[204:207], v[68:71]
    buffer_load_dwordx2 v[244:245], v1, s[8:11], s82 offen offset:8
    v_mfma_f32_16x16x32_bf16 v[72:75], v[24:27], a[192:195], v[72:75]
    ds_read_b64_tr_b16 v[216:217], v33 offset:26624
    ds_read_b64_tr_b16 v[218:219], v33 offset:32768
    v_mfma_f32_16x16x32_bf16 v[72:75], v[28:31], a[200:203], v[72:75]
    buffer_load_dwordx2 v[242:243], v1, s[8:11], s82 offen offset:1024
    v_mfma_f32_16x16x32_bf16 v[76:79], v[24:27], a[196:199], v[76:79]
    ds_read_b64_tr_b16 v[220:221], v33 offset:38912
    ds_read_b64_tr_b16 v[222:223], v33 offset:45056
    v_mfma_f32_16x16x32_bf16 v[76:79], v[28:31], a[204:207], v[76:79]
    v_lshrrev_b32 v13, 3, v11
    s_waitcnt lgkmcnt(8)
    v_mfma_f32_16x16x32_bf16 v[80:83], v[192:195], a[192:195], v[80:83]
    ds_read_b64_tr_b16 v[16:17], v34 offset:26624
    ds_read_b64_tr_b16 v[18:19], v34 offset:32768
    v_mfma_f32_16x16x32_bf16 v[80:83], v[196:199], a[200:203], v[80:83]
    buffer_load_dwordx2 v[246:247], v1, s[8:11], s82 offen offset:1032
    v_mfma_f32_16x16x32_bf16 v[84:87], v[192:195], a[196:199], v[84:87]
    ds_read_b64_tr_b16 v[20:21], v34 offset:38912
    ds_read_b64_tr_b16 v[22:23], v34 offset:45056
    v_mfma_f32_16x16x32_bf16 v[84:87], v[196:199], a[204:207], v[84:87]
    buffer_load_dwordx2 v[248:249], v63, s[8:11], s82 offen offset:0
    v_mfma_f32_16x16x32_bf16 v[88:91], v[200:203], a[192:195], v[88:91]
    ds_read_b64_tr_b16 v[24:25], v35 offset:26624
    ds_read_b64_tr_b16 v[26:27], v35 offset:32768
    v_mfma_f32_16x16x32_bf16 v[88:91], v[204:207], a[200:203], v[88:91]
    buffer_load_dwordx2 v[252:253], v63, s[8:11], s82 offen offset:8
    v_mfma_f32_16x16x32_bf16 v[92:95], v[200:203], a[196:199], v[92:95]
    ds_read_b64_tr_b16 v[28:29], v35 offset:38912
    ds_read_b64_tr_b16 v[30:31], v35 offset:45056
    v_mfma_f32_16x16x32_bf16 v[92:95], v[204:207], a[204:207], v[92:95]
    s_waitcnt vmcnt(18) lgkmcnt(8)
    s_barrier
    v_mfma_f32_16x16x32_bf16 v[64:67], v[208:211], a[208:211], v[64:67]
    ds_read_b64_tr_b16 v[192:193], v36 offset:0
    ds_read_b64_tr_b16 v[194:195], v36 offset:6144
    v_mfma_f32_16x16x32_bf16 v[64:67], v[212:215], a[216:219], v[64:67]
    buffer_load_dwordx2 v[250:251], v63, s[8:11], s82 offen offset:1024
    v_mfma_f32_16x16x32_bf16 v[68:71], v[208:211], a[212:215], v[68:71]
    ds_read_b64_tr_b16 v[196:197], v36 offset:12288
    ds_read_b64_tr_b16 v[198:199], v36 offset:18432
    v_mfma_f32_16x16x32_bf16 v[68:71], v[212:215], a[220:223], v[68:71]
    s_add_u32 s48, s71, 1032192
    s_add_u32 s49, s71, 1179520
    v_mfma_f32_16x16x32_bf16 v[72:75], v[216:219], a[208:211], v[72:75]
    ds_read_b64_tr_b16 v[200:201], v37 offset:0
    ds_read_b64_tr_b16 v[202:203], v37 offset:6144
    v_mfma_f32_16x16x32_bf16 v[72:75], v[220:223], a[216:219], v[72:75]
    buffer_load_dwordx2 v[254:255], v63, s[8:11], s82 offen offset:1032
    v_mfma_f32_16x16x32_bf16 v[76:79], v[216:219], a[212:215], v[76:79]
    ds_read_b64_tr_b16 v[204:205], v37 offset:12288
    ds_read_b64_tr_b16 v[206:207], v37 offset:18432
    v_mfma_f32_16x16x32_bf16 v[76:79], v[220:223], a[220:223], v[76:79]
    s_add_u32 m0, s70, 0
    s_add_u32 s81, s71, 884864
    s_waitcnt lgkmcnt(8)
    v_mfma_f32_16x16x32_bf16 v[80:83], v[16:19], a[208:211], v[80:83]
    ds_read_b64_tr_b16 v[208:209], v38 offset:0
    ds_read_b64_tr_b16 v[210:211], v38 offset:6144
    v_mfma_f32_16x16x32_bf16 v[80:83], v[20:23], a[216:219], v[80:83]
    buffer_load_dwordx4 v61, s[24:27], s81 offen offset:0  lds
    v_mfma_f32_16x16x32_bf16 v[84:87], v[16:19], a[212:215], v[84:87]
    ds_read_b64_tr_b16 v[212:213], v38 offset:12288
    ds_read_b64_tr_b16 v[214:215], v38 offset:18432
    v_mfma_f32_16x16x32_bf16 v[84:87], v[20:23], a[220:223], v[84:87]
    buffer_load_dwordx4 v2, s[24:27], s48 offen offset:1024  lds
    v_mfma_f32_16x16x32_bf16 v[88:91], v[24:27], a[208:211], v[88:91]
    ds_read_b64_tr_b16 v[216:217], v39 offset:0
    ds_read_b64_tr_b16 v[218:219], v39 offset:6144
    v_mfma_f32_16x16x32_bf16 v[88:91], v[28:31], a[216:219], v[88:91]
    buffer_load_dwordx4 v3, s[24:27], s49 offen offset:2048  lds
    v_mfma_f32_16x16x32_bf16 v[92:95], v[24:27], a[212:215], v[92:95]
    ds_read_b64_tr_b16 v[220:221], v39 offset:12288
    ds_read_b64_tr_b16 v[222:223], v39 offset:18432
    v_mfma_f32_16x16x32_bf16 v[92:95], v[28:31], a[220:223], v[92:95]
    s_add_u32 m0, s70, 12288
    s_waitcnt lgkmcnt(8)
    v_mfma_f32_16x16x32_bf16 v[64:67], v[192:195], a[224:227], v[64:67]
    ds_read_b64_tr_b16 v[16:17], v36 offset:1024
    ds_read_b64_tr_b16 v[18:19], v36 offset:7168
    v_mfma_f32_16x16x32_bf16 v[64:67], v[196:199], a[232:235], v[64:67]
    buffer_load_dwordx4 v58, s[24:27], s81 offen offset:0  lds
    v_mfma_f32_16x16x32_bf16 v[68:71], v[192:195], a[228:231], v[68:71]
    ds_read_b64_tr_b16 v[20:21], v36 offset:13312
    ds_read_b64_tr_b16 v[22:23], v36 offset:19456
    v_mfma_f32_16x16x32_bf16 v[68:71], v[196:199], a[236:239], v[68:71]
    buffer_load_dwordx4 v59, s[24:27], s48 offen offset:1024  lds
    v_mfma_f32_16x16x32_bf16 v[72:75], v[200:203], a[224:227], v[72:75]
    ds_read_b64_tr_b16 v[24:25], v37 offset:1024
    ds_read_b64_tr_b16 v[26:27], v37 offset:7168
    v_mfma_f32_16x16x32_bf16 v[72:75], v[204:207], a[232:235], v[72:75]
    buffer_load_dwordx4 v60, s[24:27], s49 offen offset:2048  lds
    v_mfma_f32_16x16x32_bf16 v[76:79], v[200:203], a[228:231], v[76:79]
    ds_read_b64_tr_b16 v[28:29], v37 offset:13312
    ds_read_b64_tr_b16 v[30:31], v37 offset:19456
    v_mfma_f32_16x16x32_bf16 v[76:79], v[204:207], a[236:239], v[76:79]
    v_lshl_add_u32 v11, v10, 15, v11
    s_waitcnt lgkmcnt(8)
    v_mfma_f32_16x16x32_bf16 v[80:83], v[208:211], a[224:227], v[80:83]
    ds_read_b64_tr_b16 v[192:193], v38 offset:1024
    ds_read_b64_tr_b16 v[194:195], v38 offset:7168
    v_mfma_f32_16x16x32_bf16 v[80:83], v[212:215], a[232:235], v[80:83]
    v_lshrrev_b32 v10, 8, v1
    v_lshl_add_u32 v13, v10, 14, v13
    v_mfma_f32_16x16x32_bf16 v[84:87], v[208:211], a[228:231], v[84:87]
    ds_read_b64_tr_b16 v[196:197], v38 offset:13312
    ds_read_b64_tr_b16 v[198:199], v38 offset:19456
    v_mfma_f32_16x16x32_bf16 v[84:87], v[212:215], a[236:239], v[84:87]
    s_mov_b32 s38, 0x00003f80
    s_mov_b32 s39, 0x3f800000
    v_mfma_f32_16x16x32_bf16 v[88:91], v[216:219], a[224:227], v[88:91]
    ds_read_b64_tr_b16 v[200:201], v39 offset:1024
    ds_read_b64_tr_b16 v[202:203], v39 offset:7168
    v_mfma_f32_16x16x32_bf16 v[88:91], v[220:223], a[232:235], v[88:91]
    s_mov_b32 s40, 0xc0d22e3c
    s_mov_b32 s41, 0xc0d22e3c
    v_mfma_f32_16x16x32_bf16 v[92:95], v[216:219], a[228:231], v[92:95]
    ds_read_b64_tr_b16 v[204:205], v39 offset:13312
    ds_read_b64_tr_b16 v[206:207], v39 offset:19456
    v_mfma_f32_16x16x32_bf16 v[92:95], v[220:223], a[236:239], v[92:95]
    s_waitcnt vmcnt(14) lgkmcnt(8)
    v_mfma_f32_16x16x32_bf16 v[64:67], v[16:19], a[240:243], v[64:67]
    ds_read_b64_tr_b16 v[208:209], v36 offset:2048
    ds_read_b64_tr_b16 v[210:211], v36 offset:8192
    v_mfma_f32_16x16x32_bf16 v[64:67], v[20:23], a[248:251], v[64:67]
    s_add_u32 s48, s71, 1253376
    s_add_u32 s49, s71, 811008
    v_mfma_f32_16x16x32_bf16 v[68:71], v[16:19], a[244:247], v[68:71]
    ds_read_b64_tr_b16 v[212:213], v36 offset:14336
    ds_read_b64_tr_b16 v[214:215], v36 offset:20480
    v_mfma_f32_16x16x32_bf16 v[68:71], v[20:23], a[252:255], v[68:71]
    v_mfma_f32_16x16x32_bf16 v[72:75], v[24:27], a[240:243], v[72:75]
    ds_read_b64_tr_b16 v[216:217], v37 offset:2048
    ds_read_b64_tr_b16 v[218:219], v37 offset:8192
    v_mfma_f32_16x16x32_bf16 v[72:75], v[28:31], a[248:251], v[72:75]
    s_add_u32 s81, s71, 589952
    v_mfma_f32_16x16x32_bf16 v[76:79], v[24:27], a[244:247], v[76:79]
    ds_read_b64_tr_b16 v[220:221], v37 offset:14336
    ds_read_b64_tr_b16 v[222:223], v37 offset:20480
    v_mfma_f32_16x16x32_bf16 v[76:79], v[28:31], a[252:255], v[76:79]
    s_add_u32 m0, s70, 24576
Lpad9:
    s_cbranch_execz Lwret6
    s_waitcnt lgkmcnt(8)
    v_mfma_f32_16x16x32_bf16 v[80:83], v[192:195], a[240:243], v[80:83]
    ds_read_b64_tr_b16 v[16:17], v38 offset:2048
    ds_read_b64_tr_b16 v[18:19], v38 offset:8192
    v_mfma_f32_16x16x32_bf16 v[80:83], v[196:199], a[248:251], v[80:83]
    buffer_load_dwordx4 v61, s[24:27], s81 offen offset:0  lds
    v_mfma_f32_16x16x32_bf16 v[84:87], v[192:195], a[244:247], v[84:87]
    ds_read_b64_tr_b16 v[20:21], v38 offset:14336
    ds_read_b64_tr_b16 v[22:23], v38 offset:20480
    v_mfma_f32_16x16x32_bf16 v[84:87], v[196:199], a[252:255], v[84:87]
    buffer_load_dwordx4 v2, s[24:27], s48 offen offset:1024  lds
    v_mfma_f32_16x16x32_bf16 v[88:91], v[200:203], a[240:243], v[88:91]
    ds_read_b64_tr_b16 v[24:25], v39 offset:2048
    ds_read_b64_tr_b16 v[26:27], v39 offset:8192
    v_mfma_f32_16x16x32_bf16 v[88:91], v[204:207], a[248:251], v[88:91]
    buffer_load_dwordx4 v3, s[24:27], s49 offen offset:2048  lds
    v_mfma_f32_16x16x32_bf16 v[92:95], v[200:203], a[244:247], v[92:95]
    ds_read_b64_tr_b16 v[28:29], v39 offset:14336
    ds_read_b64_tr_b16 v[30:31], v39 offset:20480
    v_mfma_f32_16x16x32_bf16 v[92:95], v[204:207], a[252:255], v[92:95]
    s_waitcnt lgkmcnt(8)
    v_mfma_f32_16x16x32_bf16 v[64:67], v[208:211], v[224:227], v[64:67]
    ds_read_b64_tr_b16 v[192:193], v36 offset:24576
    ds_read_b64_tr_b16 v[194:195], v36 offset:30720
    v_mfma_f32_16x16x32_bf16 v[64:67], v[212:215], v[232:235], v[64:67]
    v_mfma_f32_16x16x32_bf16 v[68:71], v[208:211], v[228:231], v[68:71]
    ds_read_b64_tr_b16 v[196:197], v36 offset:36864
    ds_read_b64_tr_b16 v[198:199], v36 offset:43008
    v_mfma_f32_16x16x32_bf16 v[68:71], v[212:215], v[236:239], v[68:71]
    v_mfma_f32_16x16x32_bf16 v[72:75], v[216:219], v[224:227], v[72:75]
    ds_read_b64_tr_b16 v[200:201], v37 offset:24576
    ds_read_b64_tr_b16 v[202:203], v37 offset:30720
    v_mfma_f32_16x16x32_bf16 v[72:75], v[220:223], v[232:235], v[72:75]
    v_mfma_f32_16x16x32_bf16 v[76:79], v[216:219], v[228:231], v[76:79]
    ds_read_b64_tr_b16 v[204:205], v37 offset:36864
    ds_read_b64_tr_b16 v[206:207], v37 offset:43008
    v_mfma_f32_16x16x32_bf16 v[76:79], v[220:223], v[236:239], v[76:79]
    s_add_u32 m0, s70, 36864
    s_waitcnt lgkmcnt(8)
    v_mfma_f32_16x16x32_bf16 v[80:83], v[16:19], v[224:227], v[80:83]
    ds_read_b64_tr_b16 v[208:209], v38 offset:24576
    ds_read_b64_tr_b16 v[210:211], v38 offset:30720
    v_mfma_f32_16x16x32_bf16 v[80:83], v[20:23], v[232:235], v[80:83]
    buffer_load_dwordx4 v58, s[24:27], s81 offen offset:0  lds
    v_mfma_f32_16x16x32_bf16 v[84:87], v[16:19], v[228:231], v[84:87]
    ds_read_b64_tr_b16 v[212:213], v38 offset:36864
    ds_read_b64_tr_b16 v[214:215], v38 offset:43008
    v_mfma_f32_16x16x32_bf16 v[84:87], v[20:23], v[236:239], v[84:87]
    buffer_load_dwordx4 v59, s[24:27], s48 offen offset:1024  lds
    v_mfma_f32_16x16x32_bf16 v[88:91], v[24:27], v[224:227], v[88:91]
    ds_read_b64_tr_b16 v[216:217], v39 offset:24576
    ds_read_b64_tr_b16 v[218:219], v39 offset:30720
    v_mfma_f32_16x16x32_bf16 v[88:91], v[28:31], v[232:235], v[88:91]
    buffer_load_dwordx4 v60, s[24:27], s49 offen offset:2048  lds
    v_mfma_f32_16x16x32_bf16 v[92:95], v[24:27], v[228:231], v[92:95]
    ds_read_b64_tr_b16 v[220:221], v39 offset:36864
    ds_read_b64_tr_b16 v[222:223], v39 offset:43008
    v_mfma_f32_16x16x32_bf16 v[92:95], v[28:31], v[236:239], v[92:95]
    s_waitcnt vmcnt(12) lgkmcnt(8)
    v_mfma_f32_16x16x32_bf16 v[64:67], v[192:195], v[240:243], v[64:67]
    ds_read_b64_tr_b16 v[16:17], v36 offset:25600
    ds_read_b64_tr_b16 v[18:19], v36 offset:31744
    v_mfma_f32_16x16x32_bf16 v[64:67], v[196:199], v[248:251], v[64:67]
    s_add_u32 s48, s71, 1106048
    s_add_u32 s49, s71, 73728
    v_mfma_f32_16x16x32_bf16 v[68:71], v[192:195], v[244:247], v[68:71]
    ds_read_b64_tr_b16 v[20:21], v36 offset:37888
    ds_read_b64_tr_b16 v[22:23], v36 offset:44032
    v_mfma_f32_16x16x32_bf16 v[68:71], v[196:199], v[252:255], v[68:71]
    v_mfma_f32_16x16x32_bf16 v[72:75], v[200:203], v[240:243], v[72:75]
    ds_read_b64_tr_b16 v[24:25], v37 offset:25600
    ds_read_b64_tr_b16 v[26:27], v37 offset:31744
    v_mfma_f32_16x16x32_bf16 v[72:75], v[204:207], v[248:251], v[72:75]
    s_add_u32 s81, s71, 958720
    v_mfma_f32_16x16x32_bf16 v[76:79], v[200:203], v[244:247], v[76:79]
    ds_read_b64_tr_b16 v[28:29], v37 offset:37888
    ds_read_b64_tr_b16 v[30:31], v37 offset:44032
    v_mfma_f32_16x16x32_bf16 v[76:79], v[204:207], v[252:255], v[76:79]
    s_add_u32 m0, s70, 49152
    s_waitcnt lgkmcnt(8)
    v_mfma_f32_16x16x32_bf16 v[80:83], v[208:211], v[240:243], v[80:83]
    ds_read_b64_tr_b16 v[192:193], v38 offset:25600
    ds_read_b64_tr_b16 v[194:195], v38 offset:31744
    v_mfma_f32_16x16x32_bf16 v[80:83], v[212:215], v[248:251], v[80:83]
    buffer_load_dwordx4 v61, s[24:27], s81 offen offset:0  lds
    v_mfma_f32_16x16x32_bf16 v[84:87], v[208:211], v[244:247], v[84:87]
    ds_read_b64_tr_b16 v[196:197], v38 offset:37888
    ds_read_b64_tr_b16 v[198:199], v38 offset:44032
    v_mfma_f32_16x16x32_bf16 v[84:87], v[212:215], v[252:255], v[84:87]
    buffer_load_dwordx4 v2, s[24:27], s48 offen offset:1024  lds
    v_mfma_f32_16x16x32_bf16 v[88:91], v[216:219], v[240:243], v[88:91]
    ds_read_b64_tr_b16 v[200:201], v39 offset:25600
    ds_read_b64_tr_b16 v[202:203], v39 offset:31744
    v_mfma_f32_16x16x32_bf16 v[88:91], v[220:223], v[248:251], v[88:91]
    buffer_load_dwordx4 v3, s[24:27], s49 offen offset:2048  lds
    v_mfma_f32_16x16x32_bf16 v[92:95], v[216:219], v[244:247], v[92:95]
    ds_read_b64_tr_b16 v[204:205], v39 offset:37888
    ds_read_b64_tr_b16 v[206:207], v39 offset:44032
    v_cvt_pk_bf16_f32 v64, v64, v65
    v_mfma_f32_16x16x32_bf16 v[92:95], v[220:223], v[252:255], v[92:95]
    v_cvt_pk_bf16_f32 v65, v66, v67
    s_waitcnt lgkmcnt(8)
    v_mfma_f32_16x16x32_bf16 v[96:99], v[16:19], a[176:179], v[96:99]
    ds_read_b64_tr_b16 v[208:209], v36 offset:26624
    ds_read_b64_tr_b16 v[210:211], v36 offset:32768
    v_mfma_f32_16x16x32_bf16 v[96:99], v[20:23], a[184:187], v[96:99]
    v_cvt_pk_bf16_f32 v66, v72, v73
    v_cvt_pk_bf16_f32 v67, v74, v75
    v_mfma_f32_16x16x32_bf16 v[100:103], v[16:19], a[180:183], v[100:103]
    ds_read_b64_tr_b16 v[212:213], v36 offset:38912
    ds_read_b64_tr_b16 v[214:215], v36 offset:45056
    v_mfma_f32_16x16x32_bf16 v[100:103], v[20:23], a[188:191], v[100:103]
    buffer_store_dwordx4 v[64:67], v176, s[8:11], s73 offen offset:0 sc1
    v_mfma_f32_16x16x32_bf16 v[104:107], v[24:27], a[176:179], v[104:107]
    ds_read_b64_tr_b16 v[216:217], v37 offset:26624
    ds_read_b64_tr_b16 v[218:219], v37 offset:32768
    v_mfma_f32_16x16x32_bf16 v[104:107], v[28:31], a[184:187], v[104:107]
    v_cvt_pk_bf16_f32 v68, v68, v69
    v_cvt_pk_bf16_f32 v69, v70, v71
    v_mfma_f32_16x16x32_bf16 v[108:111], v[24:27], a[180:183], v[108:111]
    ds_read_b64_tr_b16 v[220:221], v37 offset:38912
    ds_read_b64_tr_b16 v[222:223], v37 offset:45056
    v_mfma_f32_16x16x32_bf16 v[108:111], v[28:31], a[188:191], v[108:111]
    v_cvt_pk_bf16_f32 v70, v76, v77
    s_waitcnt lgkmcnt(8)
    v_mfma_f32_16x16x32_bf16 v[112:115], v[192:195], a[176:179], v[112:115]
    ds_read_b64_tr_b16 v[16:17], v38 offset:26624
    ds_read_b64_tr_b16 v[18:19], v38 offset:32768
    v_mfma_f32_16x16x32_bf16 v[112:115], v[196:199], a[184:187], v[112:115]
    v_cvt_pk_bf16_f32 v71, v78, v79
    v_cvt_pk_bf16_f32 v80, v80, v81
    v_mfma_f32_16x16x32_bf16 v[116:119], v[192:195], a[180:183], v[116:119]
    ds_read_b64_tr_b16 v[20:21], v38 offset:38912
    ds_read_b64_tr_b16 v[22:23], v38 offset:45056
    v_mfma_f32_16x16x32_bf16 v[116:119], v[196:199], a[188:191], v[116:119]
    v_cvt_pk_bf16_f32 v81, v82, v83
    v_cvt_pk_bf16_f32 v82, v88, v89
    v_mfma_f32_16x16x32_bf16 v[120:123], v[200:203], a[176:179], v[120:123]
    ds_read_b64_tr_b16 v[24:25], v39 offset:26624
    ds_read_b64_tr_b16 v[26:27], v39 offset:32768
    v_mfma_f32_16x16x32_bf16 v[120:123], v[204:207], a[184:187], v[120:123]
    v_cvt_pk_bf16_f32 v83, v90, v91
    v_cvt_pk_bf16_f32 v84, v84, v85
    v_mfma_f32_16x16x32_bf16 v[124:127], v[200:203], a[180:183], v[124:127]
    ds_read_b64_tr_b16 v[28:29], v39 offset:38912
    ds_read_b64_tr_b16 v[30:31], v39 offset:45056
    v_mfma_f32_16x16x32_bf16 v[124:127], v[204:207], a[188:191], v[124:127]
    s_waitcnt vmcnt(4) lgkmcnt(8)
    s_barrier
    v_mfma_f32_16x16x32_bf16 v[96:99], v[208:211], a[192:195], v[96:99]
    ds_read_b64_tr_b16 v[192:193], v4 offset:0
    ds_read_b64_tr_b16 v[194:195], v4 offset:6144
    v_mfma_f32_16x16x32_bf16 v[96:99], v[212:215], a[200:203], v[96:99]
    v_cvt_pk_bf16_f32 v85, v86, v87
    v_cvt_pk_bf16_f32 v86, v92, v93
    v_mfma_f32_16x16x32_bf16 v[100:103], v[208:211], a[196:199], v[100:103]
    ds_read_b64_tr_b16 v[196:197], v4 offset:12288
    ds_read_b64_tr_b16 v[198:199], v4 offset:18432
    v_mfma_f32_16x16x32_bf16 v[100:103], v[212:215], a[204:207], v[100:103]
    buffer_store_dwordx4 v[68:71], v176, s[8:11], s73 offen offset:1024 sc1
    v_mfma_f32_16x16x32_bf16 v[104:107], v[216:219], a[192:195], v[104:107]
    ds_read_b64_tr_b16 v[200:201], v5 offset:0
    ds_read_b64_tr_b16 v[202:203], v5 offset:6144
    v_mfma_f32_16x16x32_bf16 v[104:107], v[220:223], a[200:203], v[104:107]
    v_cvt_pk_bf16_f32 v87, v94, v95
    v_mfma_f32_16x16x32_bf16 v[108:111], v[216:219], a[196:199], v[108:111]
    ds_read_b64_tr_b16 v[204:205], v5 offset:12288
    ds_read_b64_tr_b16 v[206:207], v5 offset:18432
    v_mfma_f32_16x16x32_bf16 v[108:111], v[220:223], a[204:207], v[108:111]
    s_add_u32 m0, s70, 61440
    s_add_u32 s73, s73, 4096
    s_waitcnt lgkmcnt(8)
    v_mfma_f32_16x16x32_bf16 v[112:115], v[16:19], a[192:195], v[112:115]
    ds_read_b64_tr_b16 v[208:209], v6 offset:0
    ds_read_b64_tr_b16 v[210:211], v6 offset:6144
    v_mfma_f32_16x16x32_bf16 v[112:115], v[20:23], a[200:203], v[112:115]
    buffer_load_dwordx4 v58, s[24:27], s81 offen offset:0  lds
    v_mfma_f32_16x16x32_bf16 v[116:119], v[16:19], a[196:199], v[116:119]
    ds_read_b64_tr_b16 v[212:213], v6 offset:12288
    ds_read_b64_tr_b16 v[214:215], v6 offset:18432
    v_mfma_f32_16x16x32_bf16 v[116:119], v[20:23], a[204:207], v[116:119]
    buffer_load_dwordx4 v59, s[24:27], s48 offen offset:1024  lds
    v_mfma_f32_16x16x32_bf16 v[120:123], v[24:27], a[192:195], v[120:123]
    ds_read_b64_tr_b16 v[216:217], v7 offset:0
    ds_read_b64_tr_b16 v[218:219], v7 offset:6144
    v_mfma_f32_16x16x32_bf16 v[120:123], v[28:31], a[200:203], v[120:123]
    buffer_load_dwordx4 v60, s[24:27], s49 offen offset:2048  lds
    v_mfma_f32_16x16x32_bf16 v[124:127], v[24:27], a[196:199], v[124:127]
    ds_read_b64_tr_b16 v[220:221], v7 offset:12288
    ds_read_b64_tr_b16 v[222:223], v7 offset:18432
    v_mfma_f32_16x16x32_bf16 v[124:127], v[28:31], a[204:207], v[124:127]
    s_waitcnt lgkmcnt(8)
    v_mfma_f32_16x16x32_bf16 v[96:99], v[192:195], a[208:211], v[96:99]
    ds_read_b64_tr_b16 v[16:17], v4 offset:1024
    ds_read_b64_tr_b16 v[18:19], v4 offset:7168
    v_mfma_f32_16x16x32_bf16 v[96:99], v[196:199], a[216:219], v[96:99]
    s_add_u32 s48, s71, 368768
    s_add_u32 s49, s71, 516096
    v_mfma_f32_16x16x32_bf16 v[100:103], v[192:195], a[212:215], v[100:103]
    ds_read_b64_tr_b16 v[20:21], v4 offset:13312
    ds_read_b64_tr_b16 v[22:23], v4 offset:19456
    v_mfma_f32_16x16x32_bf16 v[100:103], v[196:199], a[220:223], v[100:103]
    buffer_store_dwordx4 v[80:83], v176, s[8:11], s73 offen offset:0 sc1
    v_mfma_f32_16x16x32_bf16 v[104:107], v[200:203], a[208:211], v[104:107]
    ds_read_b64_tr_b16 v[24:25], v5 offset:1024
    ds_read_b64_tr_b16 v[26:27], v5 offset:7168
    v_mfma_f32_16x16x32_bf16 v[104:107], v[204:207], a[216:219], v[104:107]
    s_add_u32 s81, s71, 221440
    v_mfma_f32_16x16x32_bf16 v[108:111], v[200:203], a[212:215], v[108:111]
    ds_read_b64_tr_b16 v[28:29], v5 offset:13312
    ds_read_b64_tr_b16 v[30:31], v5 offset:19456
    v_mfma_f32_16x16x32_bf16 v[108:111], v[204:207], a[220:223], v[108:111]
    s_add_u32 m0, s70, 73728
    s_waitcnt lgkmcnt(8)
    v_mfma_f32_16x16x32_bf16 v[112:115], v[208:211], a[208:211], v[112:115]
    ds_read_b64_tr_b16 v[192:193], v6 offset:1024
    ds_read_b64_tr_b16 v[194:195], v6 offset:7168
    v_mfma_f32_16x16x32_bf16 v[112:115], v[212:215], a[216:219], v[112:115]
    buffer_load_dwordx4 v61, s[24:27], s81 offen offset:0  lds
    v_mfma_f32_16x16x32_bf16 v[116:119], v[208:211], a[212:215], v[116:119]
    ds_read_b64_tr_b16 v[196:197], v6 offset:13312
    ds_read_b64_tr_b16 v[198:199], v6 offset:19456
    v_mfma_f32_16x16x32_bf16 v[116:119], v[212:215], a[220:223], v[116:119]
    buffer_load_dwordx4 v2, s[24:27], s48 offen offset:1024  lds
    v_mfma_f32_16x16x32_bf16 v[120:123], v[216:219], a[208:211], v[120:123]
    ds_read_b64_tr_b16 v[200:201], v7 offset:1024
    ds_read_b64_tr_b16 v[202:203], v7 offset:7168
    v_mfma_f32_16x16x32_bf16 v[120:123], v[220:223], a[216:219], v[120:123]
    buffer_load_dwordx4 v3, s[24:27], s49 offen offset:2048  lds
    v_mfma_f32_16x16x32_bf16 v[124:127], v[216:219], a[212:215], v[124:127]
    ds_read_b64_tr_b16 v[204:205], v7 offset:13312
    ds_read_b64_tr_b16 v[206:207], v7 offset:19456
    v_mfma_f32_16x16x32_bf16 v[124:127], v[220:223], a[220:223], v[124:127]
    s_waitcnt lgkmcnt(8)
    v_mfma_f32_16x16x32_bf16 v[96:99], v[16:19], a[224:227], v[96:99]
    ds_read_b64_tr_b16 v[208:209], v4 offset:2048
    ds_read_b64_tr_b16 v[210:211], v4 offset:8192
    v_mfma_f32_16x16x32_bf16 v[96:99], v[20:23], a[232:235], v[96:99]
    v_mfma_f32_16x16x32_bf16 v[100:103], v[16:19], a[228:231], v[100:103]
    ds_read_b64_tr_b16 v[212:213], v4 offset:14336
    ds_read_b64_tr_b16 v[214:215], v4 offset:20480
    v_mfma_f32_16x16x32_bf16 v[100:103], v[20:23], a[236:239], v[100:103]
    buffer_store_dwordx4 v[84:87], v176, s[8:11], s73 offen offset:1024 sc1
    v_mfma_f32_16x16x32_bf16 v[104:107], v[24:27], a[224:227], v[104:107]
    ds_read_b64_tr_b16 v[216:217], v5 offset:2048
    ds_read_b64_tr_b16 v[218:219], v5 offset:8192
    v_mfma_f32_16x16x32_bf16 v[104:107], v[28:31], a[232:235], v[104:107]
    v_mfma_f32_16x16x32_bf16 v[108:111], v[24:27], a[228:231], v[108:111]
    ds_read_b64_tr_b16 v[220:221], v5 offset:14336
    ds_read_b64_tr_b16 v[222:223], v5 offset:20480
    v_mfma_f32_16x16x32_bf16 v[108:111], v[28:31], a[236:239], v[108:111]
    s_add_u32 m0, s70, 86016
    s_add_u32 s73, s73, 12288
    s_waitcnt lgkmcnt(8)
    v_mfma_f32_16x16x32_bf16 v[112:115], v[192:195], a[224:227], v[112:115]
    ds_read_b64_tr_b16 v[16:17], v6 offset:2048
    ds_read_b64_tr_b16 v[18:19], v6 offset:8192
    v_mfma_f32_16x16x32_bf16 v[112:115], v[196:199], a[232:235], v[112:115]
    buffer_load_dwordx4 v58, s[24:27], s81 offen offset:0  lds
    v_mfma_f32_16x16x32_bf16 v[116:119], v[192:195], a[228:231], v[116:119]
    ds_read_b64_tr_b16 v[20:21], v6 offset:14336
    ds_read_b64_tr_b16 v[22:23], v6 offset:20480
    v_mfma_f32_16x16x32_bf16 v[116:119], v[196:199], a[236:239], v[116:119]
    buffer_load_dwordx4 v59, s[24:27], s48 offen offset:1024  lds
    v_mfma_f32_16x16x32_bf16 v[120:123], v[200:203], a[224:227], v[120:123]
    ds_read_b64_tr_b16 v[24:25], v7 offset:2048
    ds_read_b64_tr_b16 v[26:27], v7 offset:8192
    v_mfma_f32_16x16x32_bf16 v[120:123], v[204:207], a[232:235], v[120:123]
    buffer_load_dwordx4 v60, s[24:27], s49 offen offset:2048  lds
    v_mfma_f32_16x16x32_bf16 v[124:127], v[200:203], a[228:231], v[124:127]
    ds_read_b64_tr_b16 v[28:29], v7 offset:14336
    ds_read_b64_tr_b16 v[30:31], v7 offset:20480
    v_mfma_f32_16x16x32_bf16 v[124:127], v[204:207], a[236:239], v[124:127]
    s_waitcnt lgkmcnt(8)
    v_mfma_f32_16x16x32_bf16 v[96:99], v[208:211], a[240:243], v[96:99]
    ds_read_b64_tr_b16 v[192:193], v4 offset:24576
    ds_read_b64_tr_b16 v[194:195], v4 offset:30720
    v_mfma_f32_16x16x32_bf16 v[96:99], v[212:215], a[248:251], v[96:99]
    s_add_u32 s48, s71, 884864
    s_add_u32 s49, s71, 1032192
    v_mfma_f32_16x16x32_bf16 v[100:103], v[208:211], a[244:247], v[100:103]
    ds_read_b64_tr_b16 v[196:197], v4 offset:36864
    ds_read_b64_tr_b16 v[198:199], v4 offset:43008
    v_mfma_f32_16x16x32_bf16 v[100:103], v[212:215], a[252:255], v[100:103]
    v_mfma_f32_16x16x32_bf16 v[104:107], v[216:219], a[240:243], v[104:107]
    ds_read_b64_tr_b16 v[200:201], v5 offset:24576
    ds_read_b64_tr_b16 v[202:203], v5 offset:30720
    v_mfma_f32_16x16x32_bf16 v[104:107], v[220:223], a[248:251], v[104:107]
    s_add_u32 s81, s71, 737536
    v_mfma_f32_16x16x32_bf16 v[108:111], v[216:219], a[244:247], v[108:111]
    ds_read_b64_tr_b16 v[204:205], v5 offset:36864
    ds_read_b64_tr_b16 v[206:207], v5 offset:43008
    v_mfma_f32_16x16x32_bf16 v[108:111], v[220:223], a[252:255], v[108:111]
    s_add_u32 m0, s70, 98304
    s_waitcnt lgkmcnt(8)
    v_mfma_f32_16x16x32_bf16 v[112:115], v[16:19], a[240:243], v[112:115]
    ds_read_b64_tr_b16 v[208:209], v6 offset:24576
    ds_read_b64_tr_b16 v[210:211], v6 offset:30720
    v_mfma_f32_16x16x32_bf16 v[112:115], v[20:23], a[248:251], v[112:115]
    buffer_load_dwordx4 v61, s[24:27], s81 offen offset:0  lds
    v_mfma_f32_16x16x32_bf16 v[116:119], v[16:19], a[244:247], v[116:119]
    ds_read_b64_tr_b16 v[212:213], v6 offset:36864
    ds_read_b64_tr_b16 v[214:215], v6 offset:43008
    v_mfma_f32_16x16x32_bf16 v[116:119], v[20:23], a[252:255], v[116:119]
    buffer_load_dwordx4 v2, s[24:27], s48 offen offset:1024  lds
    v_mfma_f32_16x16x32_bf16 v[120:123], v[24:27], a[240:243], v[120:123]
    ds_read_b64_tr_b16 v[216:217], v7 offset:24576
    ds_read_b64_tr_b16 v[218:219], v7 offset:30720
    v_mfma_f32_16x16x32_bf16 v[120:123], v[28:31], a[248:251], v[120:123]
    buffer_load_dwordx4 v3, s[24:27], s49 offen offset:2048  lds
    v_mfma_f32_16x16x32_bf16 v[124:127], v[24:27], a[244:247], v[124:127]
    ds_read_b64_tr_b16 v[220:221], v7 offset:36864
    ds_read_b64_tr_b16 v[222:223], v7 offset:43008
    v_mfma_f32_16x16x32_bf16 v[124:127], v[28:31], a[252:255], v[124:127]
    s_waitcnt lgkmcnt(8)
    v_mfma_f32_16x16x32_bf16 v[96:99], v[192:195], v[224:227], v[96:99]
    ds_read_b64_tr_b16 v[16:17], v4 offset:25600
    ds_read_b64_tr_b16 v[18:19], v4 offset:31744
    v_mfma_f32_16x16x32_bf16 v[96:99], v[196:199], v[232:235], v[96:99]
    v_mfma_f32_16x16x32_bf16 v[100:103], v[192:195], v[228:231], v[100:103]
    ds_read_b64_tr_b16 v[20:21], v4 offset:37888
    ds_read_b64_tr_b16 v[22:23], v4 offset:44032
    v_mfma_f32_16x16x32_bf16 v[100:103], v[196:199], v[236:239], v[100:103]
    v_mfma_f32_16x16x32_bf16 v[104:107], v[200:203], v[224:227], v[104:107]
    ds_read_b64_tr_b16 v[24:25], v5 offset:25600
    ds_read_b64_tr_b16 v[26:27], v5 offset:31744
    v_mfma_f32_16x16x32_bf16 v[104:107], v[204:207], v[232:235], v[104:107]
    v_mfma_f32_16x16x32_bf16 v[108:111], v[200:203], v[228:231], v[108:111]
    ds_read_b64_tr_b16 v[28:29], v5 offset:37888
    ds_read_b64_tr_b16 v[30:31], v5 offset:44032
    v_mfma_f32_16x16x32_bf16 v[108:111], v[204:207], v[236:239], v[108:111]
    s_add_u32 m0, s70, 110592
    s_waitcnt lgkmcnt(8)
    v_mfma_f32_16x16x32_bf16 v[112:115], v[208:211], v[224:227], v[112:115]
    ds_read_b64_tr_b16 v[192:193], v6 offset:25600
    ds_read_b64_tr_b16 v[194:195], v6 offset:31744
    v_mfma_f32_16x16x32_bf16 v[112:115], v[212:215], v[232:235], v[112:115]
    buffer_load_dwordx4 v58, s[24:27], s81 offen offset:0  lds
    v_mfma_f32_16x16x32_bf16 v[116:119], v[208:211], v[228:231], v[116:119]
    ds_read_b64_tr_b16 v[196:197], v6 offset:37888
    ds_read_b64_tr_b16 v[198:199], v6 offset:44032
    v_mfma_f32_16x16x32_bf16 v[116:119], v[212:215], v[236:239], v[116:119]
    buffer_load_dwordx4 v59, s[24:27], s48 offen offset:1024  lds
    v_mfma_f32_16x16x32_bf16 v[120:123], v[216:219], v[224:227], v[120:123]
    ds_read_b64_tr_b16 v[200:201], v7 offset:25600
    ds_read_b64_tr_b16 v[202:203], v7 offset:31744
    v_mfma_f32_16x16x32_bf16 v[120:123], v[220:223], v[232:235], v[120:123]
    buffer_load_dwordx4 v60, s[24:27], s49 offen offset:2048  lds
    v_mfma_f32_16x16x32_bf16 v[124:127], v[216:219], v[228:231], v[124:127]
    ds_read_b64_tr_b16 v[204:205], v7 offset:37888
    ds_read_b64_tr_b16 v[206:207], v7 offset:44032
    v_mfma_f32_16x16x32_bf16 v[124:127], v[220:223], v[236:239], v[124:127]
    s_waitcnt lgkmcnt(8)
    s_waitcnt vmcnt(9)
    v_mfma_f32_16x16x32_bf16 v[96:99], v[16:19], v[240:243], v[96:99]
    ds_read_b64_tr_b16 v[208:209], v4 offset:26624
    ds_read_b64_tr_b16 v[210:211], v4 offset:32768
    v_mfma_f32_16x16x32_bf16 v[96:99], v[20:23], v[248:251], v[96:99]
    v_mfma_f32_16x16x32_bf16 v[100:103], v[16:19], v[244:247], v[100:103]
    ds_read_b64_tr_b16 v[212:213], v4 offset:38912
    ds_read_b64_tr_b16 v[214:215], v4 offset:45056
    v_mfma_f32_16x16x32_bf16 v[100:103], v[20:23], v[252:255], v[100:103]
    v_mfma_f32_16x16x32_bf16 v[104:107], v[24:27], v[240:243], v[104:107]
    ds_read_b64_tr_b16 v[216:217], v5 offset:26624
    ds_read_b64_tr_b16 v[218:219], v5 offset:32768
    v_mfma_f32_16x16x32_bf16 v[104:107], v[28:31], v[248:251], v[104:107]
    v_mfma_f32_16x16x32_bf16 v[108:111], v[24:27], v[244:247], v[108:111]
    ds_read_b64_tr_b16 v[220:221], v5 offset:38912
    ds_read_b64_tr_b16 v[222:223], v5 offset:45056
    v_mfma_f32_16x16x32_bf16 v[108:111], v[28:31], v[252:255], v[108:111]
    buffer_store_dword v15, v14, s[8:11], s75 offen offset:0 sc1
    s_waitcnt lgkmcnt(8)
    v_mfma_f32_16x16x32_bf16 v[112:115], v[192:195], v[240:243], v[112:115]
    ds_read_b64_tr_b16 v[16:17], v6 offset:26624
    ds_read_b64_tr_b16 v[18:19], v6 offset:32768
    v_mfma_f32_16x16x32_bf16 v[112:115], v[196:199], v[248:251], v[112:115]
    v_mfma_f32_16x16x32_bf16 v[116:119], v[192:195], v[244:247], v[116:119]
    ds_read_b64_tr_b16 v[20:21], v6 offset:38912
    ds_read_b64_tr_b16 v[22:23], v6 offset:45056
    v_mfma_f32_16x16x32_bf16 v[116:119], v[196:199], v[252:255], v[116:119]
    v_cvt_pk_bf16_f32 v96, v96, v97
    v_cvt_pk_bf16_f32 v97, v98, v99
    v_mfma_f32_16x16x32_bf16 v[120:123], v[200:203], v[240:243], v[120:123]
    ds_read_b64_tr_b16 v[24:25], v7 offset:26624
    ds_read_b64_tr_b16 v[26:27], v7 offset:32768
    v_mfma_f32_16x16x32_bf16 v[120:123], v[204:207], v[248:251], v[120:123]
    v_cvt_pk_bf16_f32 v98, v104, v105
    v_cvt_pk_bf16_f32 v99, v106, v107
    v_mfma_f32_16x16x32_bf16 v[124:127], v[200:203], v[244:247], v[124:127]
    ds_read_b64_tr_b16 v[28:29], v7 offset:38912
    ds_read_b64_tr_b16 v[30:31], v7 offset:45056
    v_mfma_f32_16x16x32_bf16 v[124:127], v[204:207], v[252:255], v[124:127]
    s_waitcnt vmcnt(7) lgkmcnt(8)
    s_barrier
    v_mfma_f32_16x16x32_bf16 v[128:131], v[208:211], a[80:83], v[128:131]
    ds_read_b64_tr_b16 v[192:193], v32 offset:0
    ds_read_b64_tr_b16 v[194:195], v32 offset:6144
    v_mfma_f32_16x16x32_bf16 v[128:131], v[212:215], a[88:91], v[128:131]
    s_add_u32 s48, s71, 589952
    s_add_u32 s49, s71, 1253376
    v_mfma_f32_16x16x32_bf16 v[132:135], v[208:211], a[84:87], v[132:135]
    ds_read_b64_tr_b16 v[196:197], v32 offset:12288
    ds_read_b64_tr_b16 v[198:199], v32 offset:18432
    v_mfma_f32_16x16x32_bf16 v[132:135], v[212:215], a[92:95], v[132:135]
    buffer_store_dwordx4 v[96:99], v176, s[8:11], s73 offen offset:0 sc1
    v_mfma_f32_16x16x32_bf16 v[136:139], v[216:219], a[80:83], v[136:139]
    ds_read_b64_tr_b16 v[200:201], v33 offset:0
    ds_read_b64_tr_b16 v[202:203], v33 offset:6144
    v_mfma_f32_16x16x32_bf16 v[136:139], v[220:223], a[88:91], v[136:139]
    s_add_u32 s81, s71, 1179904
    v_cvt_pk_bf16_f32 v100, v100, v101
    v_mfma_f32_16x16x32_bf16 v[140:143], v[216:219], a[84:87], v[140:143]
    ds_read_b64_tr_b16 v[204:205], v33 offset:12288
    ds_read_b64_tr_b16 v[206:207], v33 offset:18432
    v_mfma_f32_16x16x32_bf16 v[140:143], v[220:223], a[92:95], v[140:143]
    s_add_u32 m0, s70, 122880
    s_waitcnt lgkmcnt(8)
    v_mfma_f32_16x16x32_bf16 v[144:147], v[16:19], a[80:83], v[144:147]
    ds_read_b64_tr_b16 v[208:209], v34 offset:0
    ds_read_b64_tr_b16 v[210:211], v34 offset:6144
    v_mfma_f32_16x16x32_bf16 v[144:147], v[20:23], a[88:91], v[144:147]
    buffer_load_dwordx4 v61, s[24:27], s81 offen offset:0  lds
    v_mfma_f32_16x16x32_bf16 v[148:151], v[16:19], a[84:87], v[148:151]
    ds_read_b64_tr_b16 v[212:213], v34 offset:12288
    ds_read_b64_tr_b16 v[214:215], v34 offset:18432
    v_mfma_f32_16x16x32_bf16 v[148:151], v[20:23], a[92:95], v[148:151]
    buffer_load_dwordx4 v2, s[24:27], s48 offen offset:1024  lds
    v_mfma_f32_16x16x32_bf16 v[152:155], v[24:27], a[80:83], v[152:155]
    ds_read_b64_tr_b16 v[216:217], v35 offset:0
    ds_read_b64_tr_b16 v[218:219], v35 offset:6144
    v_mfma_f32_16x16x32_bf16 v[152:155], v[28:31], a[88:91], v[152:155]
    buffer_load_dwordx4 v3, s[24:27], s49 offen offset:2048  lds
    v_mfma_f32_16x16x32_bf16 v[156:159], v[24:27], a[84:87], v[156:159]
    ds_read_b64_tr_b16 v[220:221], v35 offset:12288
    ds_read_b64_tr_b16 v[222:223], v35 offset:18432
    v_mfma_f32_16x16x32_bf16 v[156:159], v[28:31], a[92:95], v[156:159]
    v_cvt_pk_bf16_f32 v101, v102, v103
    s_waitcnt lgkmcnt(8)
    v_mfma_f32_16x16x32_bf16 v[128:131], v[192:195], a[96:99], v[128:131]
    ds_read_b64_tr_b16 v[16:17], v32 offset:1024
    ds_read_b64_tr_b16 v[18:19], v32 offset:7168
    v_mfma_f32_16x16x32_bf16 v[128:131], v[196:199], a[104:107], v[128:131]
    v_cvt_pk_bf16_f32 v102, v108, v109
    v_cvt_pk_bf16_f32 v103, v110, v111
    v_mfma_f32_16x16x32_bf16 v[132:135], v[192:195], a[100:103], v[132:135]
    ds_read_b64_tr_b16 v[20:21], v32 offset:13312
    ds_read_b64_tr_b16 v[22:23], v32 offset:19456
    v_mfma_f32_16x16x32_bf16 v[132:135], v[196:199], a[108:111], v[132:135]
    buffer_store_dwordx4 v[100:103], v176, s[8:11], s73 offen offset:1024 sc1
    v_mfma_f32_16x16x32_bf16 v[136:139], v[200:203], a[96:99], v[136:139]
    ds_read_b64_tr_b16 v[24:25], v33 offset:1024
    ds_read_b64_tr_b16 v[26:27], v33 offset:7168
    v_mfma_f32_16x16x32_bf16 v[136:139], v[204:207], a[104:107], v[136:139]
    v_cvt_pk_bf16_f32 v112, v112, v113
    v_cvt_pk_bf16_f32 v113, v114, v115
    v_mfma_f32_16x16x32_bf16 v[140:143], v[200:203], a[100:103], v[140:143]
    ds_read_b64_tr_b16 v[28:29], v33 offset:13312
    ds_read_b64_tr_b16 v[30:31], v33 offset:19456
    v_mfma_f32_16x16x32_bf16 v[140:143], v[204:207], a[108:111], v[140:143]
    s_add_u32 m0, s70, 135168
    s_add_u32 s73, s73, 4096
    s_waitcnt lgkmcnt(8)
    v_mfma_f32_16x16x32_bf16 v[144:147], v[208:211], a[96:99], v[144:147]
    ds_read_b64_tr_b16 v[192:193], v34 offset:1024
    ds_read_b64_tr_b16 v[194:195], v34 offset:7168
    v_mfma_f32_16x16x32_bf16 v[144:147], v[212:215], a[104:107], v[144:147]
    buffer_load_dwordx4 v58, s[24:27], s81 offen offset:0  lds
    v_mfma_f32_16x16x32_bf16 v[148:151], v[208:211], a[100:103], v[148:151]
    ds_read_b64_tr_b16 v[196:197], v34 offset:13312
    ds_read_b64_tr_b16 v[198:199], v34 offset:19456
    v_mfma_f32_16x16x32_bf16 v[148:151], v[212:215], a[108:111], v[148:151]
    buffer_load_dwordx4 v59, s[24:27], s48 offen offset:1024  lds
    v_mfma_f32_16x16x32_bf16 v[152:155], v[216:219], a[96:99], v[152:155]
    ds_read_b64_tr_b16 v[200:201], v35 offset:1024
    ds_read_b64_tr_b16 v[202:203], v35 offset:7168
    v_mfma_f32_16x16x32_bf16 v[152:155], v[220:223], a[104:107], v[152:155]
    buffer_load_dwordx4 v60, s[24:27], s49 offen offset:2048  lds
    v_mfma_f32_16x16x32_bf16 v[156:159], v[216:219], a[100:103], v[156:159]
    ds_read_b64_tr_b16 v[204:205], v35 offset:13312
    ds_read_b64_tr_b16 v[206:207], v35 offset:19456
    v_mfma_f32_16x16x32_bf16 v[156:159], v[220:223], a[108:111], v[156:159]
    v_cvt_pk_bf16_f32 v114, v120, v121
    s_waitcnt lgkmcnt(8)
    v_mfma_f32_16x16x32_bf16 v[128:131], v[16:19], a[112:115], v[128:131]
    ds_read_b64_tr_b16 v[208:209], v32 offset:2048
    ds_read_b64_tr_b16 v[210:211], v32 offset:8192
    v_mfma_f32_16x16x32_bf16 v[128:131], v[20:23], a[120:123], v[128:131]
    v_cvt_pk_bf16_f32 v115, v122, v123
    v_cvt_pk_bf16_f32 v116, v116, v117
    v_mfma_f32_16x16x32_bf16 v[132:135], v[16:19], a[116:119], v[132:135]
    ds_read_b64_tr_b16 v[212:213], v32 offset:14336
    ds_read_b64_tr_b16 v[214:215], v32 offset:20480
    v_mfma_f32_16x16x32_bf16 v[132:135], v[20:23], a[124:127], v[132:135]
    buffer_store_dwordx4 v[112:115], v176, s[8:11], s73 offen offset:0 sc1
    v_mfma_f32_16x16x32_bf16 v[136:139], v[24:27], a[112:115], v[136:139]
    ds_read_b64_tr_b16 v[216:217], v33 offset:2048
    ds_read_b64_tr_b16 v[218:219], v33 offset:8192
    v_mfma_f32_16x16x32_bf16 v[136:139], v[28:31], a[120:123], v[136:139]
    v_cvt_pk_bf16_f32 v117, v118, v119
    v_cvt_pk_bf16_f32 v118, v124, v125
    v_mfma_f32_16x16x32_bf16 v[140:143], v[24:27], a[116:119], v[140:143]
    ds_read_b64_tr_b16 v[220:221], v33 offset:14336
    ds_read_b64_tr_b16 v[222:223], v33 offset:20480
    v_mfma_f32_16x16x32_bf16 v[140:143], v[28:31], a[124:127], v[140:143]
    v_cvt_pk_bf16_f32 v119, v126, v127
    s_waitcnt lgkmcnt(8)
    v_mfma_f32_16x16x32_bf16 v[144:147], v[192:195], a[112:115], v[144:147]
    ds_read_b64_tr_b16 v[16:17], v34 offset:2048
    ds_read_b64_tr_b16 v[18:19], v34 offset:8192
    v_mfma_f32_16x16x32_bf16 v[144:147], v[196:199], a[120:123], v[144:147]
    v_mfma_f32_16x16x32_bf16 v[148:151], v[192:195], a[116:119], v[148:151]
    ds_read_b64_tr_b16 v[20:21], v34 offset:14336
    ds_read_b64_tr_b16 v[22:23], v34 offset:20480
    v_mfma_f32_16x16x32_bf16 v[148:151], v[196:199], a[124:127], v[148:151]
    v_mfma_f32_16x16x32_bf16 v[152:155], v[200:203], a[112:115], v[152:155]
    ds_read_b64_tr_b16 v[24:25], v35 offset:2048
    ds_read_b64_tr_b16 v[26:27], v35 offset:8192
    v_mfma_f32_16x16x32_bf16 v[152:155], v[204:207], a[120:123], v[152:155]
    v_mfma_f32_16x16x32_bf16 v[156:159], v[200:203], a[116:119], v[156:159]
    ds_read_b64_tr_b16 v[28:29], v35 offset:14336
    ds_read_b64_tr_b16 v[30:31], v35 offset:20480
    v_mfma_f32_16x16x32_bf16 v[156:159], v[204:207], a[124:127], v[156:159]
    s_waitcnt lgkmcnt(8)
    v_mfma_f32_16x16x32_bf16 v[128:131], v[208:211], a[128:131], v[128:131]
    ds_read_b64_tr_b16 v[192:193], v32 offset:24576
    ds_read_b64_tr_b16 v[194:195], v32 offset:30720
Lpad10:
    s_cbranch_execz Lwret4
    v_mfma_f32_16x16x32_bf16 v[128:131], v[212:215], a[136:139], v[128:131]
    v_mfma_f32_16x16x32_bf16 v[132:135], v[208:211], a[132:135], v[132:135]
    ds_read_b64_tr_b16 v[196:197], v32 offset:36864
    ds_read_b64_tr_b16 v[198:199], v32 offset:43008
    v_mfma_f32_16x16x32_bf16 v[132:135], v[212:215], a[140:143], v[132:135]
    buffer_store_dwordx4 v[116:119], v176, s[8:11], s73 offen offset:1024 sc1
    v_mfma_f32_16x16x32_bf16 v[136:139], v[216:219], a[128:131], v[136:139]
    ds_read_b64_tr_b16 v[200:201], v33 offset:24576
    ds_read_b64_tr_b16 v[202:203], v33 offset:30720
    v_mfma_f32_16x16x32_bf16 v[136:139], v[220:223], a[136:139], v[136:139]
    v_mfma_f32_16x16x32_bf16 v[140:143], v[216:219], a[132:135], v[140:143]
    ds_read_b64_tr_b16 v[204:205], v33 offset:36864
    ds_read_b64_tr_b16 v[206:207], v33 offset:43008
    v_mfma_f32_16x16x32_bf16 v[140:143], v[220:223], a[140:143], v[140:143]
    s_add_u32 s73, s73, 12288
    s_waitcnt lgkmcnt(8)
    v_mfma_f32_16x16x32_bf16 v[144:147], v[16:19], a[128:131], v[144:147]
    ds_read_b64_tr_b16 v[208:209], v34 offset:24576
    ds_read_b64_tr_b16 v[210:211], v34 offset:30720
    v_mfma_f32_16x16x32_bf16 v[144:147], v[20:23], a[136:139], v[144:147]
    v_mfma_f32_16x16x32_bf16 v[148:151], v[16:19], a[132:135], v[148:151]
    ds_read_b64_tr_b16 v[212:213], v34 offset:36864
    ds_read_b64_tr_b16 v[214:215], v34 offset:43008
    v_mfma_f32_16x16x32_bf16 v[148:151], v[20:23], a[140:143], v[148:151]
    v_mfma_f32_16x16x32_bf16 v[152:155], v[24:27], a[128:131], v[152:155]
    ds_read_b64_tr_b16 v[216:217], v35 offset:24576
    ds_read_b64_tr_b16 v[218:219], v35 offset:30720
    v_mfma_f32_16x16x32_bf16 v[152:155], v[28:31], a[136:139], v[152:155]
    v_mfma_f32_16x16x32_bf16 v[156:159], v[24:27], a[132:135], v[156:159]
    ds_read_b64_tr_b16 v[220:221], v35 offset:36864
    ds_read_b64_tr_b16 v[222:223], v35 offset:43008
    v_mfma_f32_16x16x32_bf16 v[156:159], v[28:31], a[140:143], v[156:159]
    s_waitcnt lgkmcnt(8)
    v_mfma_f32_16x16x32_bf16 v[128:131], v[192:195], a[144:147], v[128:131]
    ds_read_b64_tr_b16 v[16:17], v32 offset:25600
    ds_read_b64_tr_b16 v[18:19], v32 offset:31744
    v_mfma_f32_16x16x32_bf16 v[128:131], v[196:199], a[152:155], v[128:131]
    v_mfma_f32_16x16x32_bf16 v[132:135], v[192:195], a[148:151], v[132:135]
    ds_read_b64_tr_b16 v[20:21], v32 offset:37888
    ds_read_b64_tr_b16 v[22:23], v32 offset:44032
    v_mfma_f32_16x16x32_bf16 v[132:135], v[196:199], a[156:159], v[132:135]
    v_mfma_f32_16x16x32_bf16 v[136:139], v[200:203], a[144:147], v[136:139]
    ds_read_b64_tr_b16 v[24:25], v33 offset:25600
    ds_read_b64_tr_b16 v[26:27], v33 offset:31744
    v_mfma_f32_16x16x32_bf16 v[136:139], v[204:207], a[152:155], v[136:139]
    v_mfma_f32_16x16x32_bf16 v[140:143], v[200:203], a[148:151], v[140:143]
    ds_read_b64_tr_b16 v[28:29], v33 offset:37888
    ds_read_b64_tr_b16 v[30:31], v33 offset:44032
    v_mfma_f32_16x16x32_bf16 v[140:143], v[204:207], a[156:159], v[140:143]
    buffer_load_dword v57, v56, s[8:11], s76 offen offset:0 sc1
    s_waitcnt lgkmcnt(8)
    v_mfma_f32_16x16x32_bf16 v[144:147], v[208:211], a[144:147], v[144:147]
    ds_read_b64_tr_b16 v[192:193], v34 offset:25600
    ds_read_b64_tr_b16 v[194:195], v34 offset:31744
    v_mfma_f32_16x16x32_bf16 v[144:147], v[212:215], a[152:155], v[144:147]
    buffer_load_dwordx4 v[160:163], v178, s[12:15], s78 offen offset:0
    v_mfma_f32_16x16x32_bf16 v[148:151], v[208:211], a[148:151], v[148:151]
    ds_read_b64_tr_b16 v[196:197], v34 offset:37888
    ds_read_b64_tr_b16 v[198:199], v34 offset:44032
    v_mfma_f32_16x16x32_bf16 v[148:151], v[212:215], a[156:159], v[148:151]
    buffer_load_dwordx4 v[164:167], v178, s[12:15], s78 offen offset:128
    v_mfma_f32_16x16x32_bf16 v[152:155], v[216:219], a[144:147], v[152:155]
    ds_read_b64_tr_b16 v[200:201], v35 offset:25600
    ds_read_b64_tr_b16 v[202:203], v35 offset:31744
    v_mfma_f32_16x16x32_bf16 v[152:155], v[220:223], a[152:155], v[152:155]
    buffer_load_dwordx4 v[168:171], v178, s[12:15], s78 offen offset:256
    v_mfma_f32_16x16x32_bf16 v[156:159], v[216:219], a[148:151], v[156:159]
    ds_read_b64_tr_b16 v[204:205], v35 offset:37888
    ds_read_b64_tr_b16 v[206:207], v35 offset:44032
    v_mfma_f32_16x16x32_bf16 v[156:159], v[220:223], a[156:159], v[156:159]
    s_waitcnt lgkmcnt(8)
    v_mfma_f32_16x16x32_bf16 v[128:131], v[16:19], a[160:163], v[128:131]
    ds_read_b64_tr_b16 v[208:209], v32 offset:26624
    ds_read_b64_tr_b16 v[210:211], v32 offset:32768
    v_mfma_f32_16x16x32_bf16 v[128:131], v[20:23], a[168:171], v[128:131]
    v_mfma_f32_16x16x32_bf16 v[132:135], v[16:19], a[164:167], v[132:135]
    ds_read_b64_tr_b16 v[212:213], v32 offset:38912
    ds_read_b64_tr_b16 v[214:215], v32 offset:45056
    v_mfma_f32_16x16x32_bf16 v[132:135], v[20:23], a[172:175], v[132:135]
    v_mfma_f32_16x16x32_bf16 v[136:139], v[24:27], a[160:163], v[136:139]
    ds_read_b64_tr_b16 v[216:217], v33 offset:26624
    ds_read_b64_tr_b16 v[218:219], v33 offset:32768
    v_mfma_f32_16x16x32_bf16 v[136:139], v[28:31], a[168:171], v[136:139]
    v_mfma_f32_16x16x32_bf16 v[140:143], v[24:27], a[164:167], v[140:143]
    ds_read_b64_tr_b16 v[220:221], v33 offset:38912
    ds_read_b64_tr_b16 v[222:223], v33 offset:45056
    v_mfma_f32_16x16x32_bf16 v[140:143], v[28:31], a[172:175], v[140:143]
    s_waitcnt lgkmcnt(8)
    v_mfma_f32_16x16x32_bf16 v[144:147], v[192:195], a[160:163], v[144:147]
    ds_read_b64_tr_b16 v[16:17], v34 offset:26624
    ds_read_b64_tr_b16 v[18:19], v34 offset:32768
    v_mfma_f32_16x16x32_bf16 v[144:147], v[196:199], a[168:171], v[144:147]
    v_mfma_f32_16x16x32_bf16 v[148:151], v[192:195], a[164:167], v[148:151]
    ds_read_b64_tr_b16 v[20:21], v34 offset:38912
    ds_read_b64_tr_b16 v[22:23], v34 offset:45056
    v_mfma_f32_16x16x32_bf16 v[148:151], v[196:199], a[172:175], v[148:151]
    v_mfma_f32_16x16x32_bf16 v[152:155], v[200:203], a[160:163], v[152:155]
    ds_read_b64_tr_b16 v[24:25], v35 offset:26624
    ds_read_b64_tr_b16 v[26:27], v35 offset:32768
    v_mfma_f32_16x16x32_bf16 v[152:155], v[204:207], a[168:171], v[152:155]
    v_mfma_f32_16x16x32_bf16 v[156:159], v[200:203], a[164:167], v[156:159]
    ds_read_b64_tr_b16 v[28:29], v35 offset:38912
    ds_read_b64_tr_b16 v[30:31], v35 offset:45056
    v_mfma_f32_16x16x32_bf16 v[156:159], v[204:207], a[172:175], v[156:159]
    s_waitcnt vmcnt(6) lgkmcnt(8)
    s_barrier
    s_waitcnt vmcnt(4)
    v_mfma_f32_16x16x32_bf16 v[128:131], v[208:211], a[176:179], v[128:131]
    ds_read_b64_tr_b16 v[192:193], v36 offset:0
    ds_read_b64_tr_b16 v[194:195], v36 offset:6144
    v_mfma_f32_16x16x32_bf16 v[128:131], v[212:215], a[184:187], v[128:131]
    v_mfma_f32_16x16x32_bf16 v[132:135], v[208:211], a[180:183], v[132:135]
    ds_read_b64_tr_b16 v[196:197], v36 offset:12288
    ds_read_b64_tr_b16 v[198:199], v36 offset:18432
    v_mfma_f32_16x16x32_bf16 v[132:135], v[212:215], a[188:191], v[132:135]
    v_mfma_f32_16x16x32_bf16 v[136:139], v[216:219], a[176:179], v[136:139]
    ds_read_b64_tr_b16 v[200:201], v37 offset:0
    ds_read_b64_tr_b16 v[202:203], v37 offset:6144
    v_mfma_f32_16x16x32_bf16 v[136:139], v[220:223], a[184:187], v[136:139]
    v_mfma_f32_16x16x32_bf16 v[140:143], v[216:219], a[180:183], v[140:143]
    ds_read_b64_tr_b16 v[204:205], v37 offset:12288
    ds_read_b64_tr_b16 v[206:207], v37 offset:18432
    v_mfma_f32_16x16x32_bf16 v[140:143], v[220:223], a[188:191], v[140:143]
    buffer_store_dword v15, v14, s[8:11], s75 offen offset:128 sc1
    s_waitcnt lgkmcnt(8)
    v_mfma_f32_16x16x32_bf16 v[144:147], v[16:19], a[176:179], v[144:147]
    ds_read_b64_tr_b16 v[208:209], v36 offset:1024
    ds_read_b64_tr_b16 v[210:211], v36 offset:7168
    v_mfma_f32_16x16x32_bf16 v[144:147], v[20:23], a[184:187], v[144:147]
    v_mfma_f32_16x16x32_bf16 v[148:151], v[16:19], a[180:183], v[148:151]
    ds_read_b64_tr_b16 v[212:213], v36 offset:13312
    ds_read_b64_tr_b16 v[214:215], v36 offset:19456
    v_mfma_f32_16x16x32_bf16 v[148:151], v[20:23], a[188:191], v[148:151]
    v_mfma_f32_16x16x32_bf16 v[152:155], v[24:27], a[176:179], v[152:155]
    ds_read_b64_tr_b16 v[216:217], v37 offset:1024
    ds_read_b64_tr_b16 v[218:219], v37 offset:7168
    v_mfma_f32_16x16x32_bf16 v[152:155], v[28:31], a[184:187], v[152:155]
    v_mfma_f32_16x16x32_bf16 v[156:159], v[24:27], a[180:183], v[156:159]
    ds_read_b64_tr_b16 v[220:221], v37 offset:13312
    ds_read_b64_tr_b16 v[222:223], v37 offset:19456
    v_mfma_f32_16x16x32_bf16 v[156:159], v[28:31], a[188:191], v[156:159]
    s_waitcnt lgkmcnt(8)
    v_mfma_f32_16x16x32_bf16 v[128:131], v[192:195], a[192:195], v[128:131]
    ds_read_b64_tr_b16 v[16:17], v36 offset:2048
    ds_read_b64_tr_b16 v[18:19], v36 offset:8192
    v_mfma_f32_16x16x32_bf16 v[128:131], v[196:199], a[200:203], v[128:131]
    v_mfma_f32_16x16x32_bf16 v[132:135], v[192:195], a[196:199], v[132:135]
    ds_read_b64_tr_b16 v[20:21], v36 offset:14336
    ds_read_b64_tr_b16 v[22:23], v36 offset:20480
    v_mfma_f32_16x16x32_bf16 v[132:135], v[196:199], a[204:207], v[132:135]
    v_mfma_f32_16x16x32_bf16 v[136:139], v[200:203], a[192:195], v[136:139]
    ds_read_b64_tr_b16 v[24:25], v37 offset:2048
    ds_read_b64_tr_b16 v[26:27], v37 offset:8192
    v_mfma_f32_16x16x32_bf16 v[136:139], v[204:207], a[200:203], v[136:139]
    v_mfma_f32_16x16x32_bf16 v[140:143], v[200:203], a[196:199], v[140:143]
    ds_read_b64_tr_b16 v[28:29], v37 offset:14336
    ds_read_b64_tr_b16 v[30:31], v37 offset:20480
    v_mfma_f32_16x16x32_bf16 v[140:143], v[204:207], a[204:207], v[140:143]
    s_waitcnt lgkmcnt(8)
    v_mfma_f32_16x16x32_bf16 v[128:131], v[208:211], a[208:211], v[128:131]
    ds_read_b64_tr_b16 v[192:193], v36 offset:24576
    ds_read_b64_tr_b16 v[194:195], v36 offset:30720
    v_mfma_f32_16x16x32_bf16 v[128:131], v[212:215], a[216:219], v[128:131]
    v_mfma_f32_16x16x32_bf16 v[132:135], v[208:211], a[212:215], v[132:135]
    ds_read_b64_tr_b16 v[196:197], v36 offset:36864
    ds_read_b64_tr_b16 v[198:199], v36 offset:43008
    v_mfma_f32_16x16x32_bf16 v[132:135], v[212:215], a[220:223], v[132:135]
    v_mfma_f32_16x16x32_bf16 v[136:139], v[216:219], a[208:211], v[136:139]
    ds_read_b64_tr_b16 v[200:201], v37 offset:24576
    ds_read_b64_tr_b16 v[202:203], v37 offset:30720
    v_mfma_f32_16x16x32_bf16 v[136:139], v[220:223], a[216:219], v[136:139]
    v_mfma_f32_16x16x32_bf16 v[140:143], v[216:219], a[212:215], v[140:143]
    ds_read_b64_tr_b16 v[204:205], v37 offset:36864
    ds_read_b64_tr_b16 v[206:207], v37 offset:43008
    v_mfma_f32_16x16x32_bf16 v[140:143], v[220:223], a[220:223], v[140:143]
    s_waitcnt lgkmcnt(8)
    v_mfma_f32_16x16x32_bf16 v[128:131], v[16:19], a[224:227], v[128:131]
    ds_read_b64_tr_b16 v[208:209], v36 offset:25600
    ds_read_b64_tr_b16 v[210:211], v36 offset:31744
    v_mfma_f32_16x16x32_bf16 v[128:131], v[20:23], a[232:235], v[128:131]
    v_mfma_f32_16x16x32_bf16 v[132:135], v[16:19], a[228:231], v[132:135]
    ds_read_b64_tr_b16 v[212:213], v36 offset:37888
    ds_read_b64_tr_b16 v[214:215], v36 offset:44032
    v_mfma_f32_16x16x32_bf16 v[132:135], v[20:23], a[236:239], v[132:135]
    v_mfma_f32_16x16x32_bf16 v[136:139], v[24:27], a[224:227], v[136:139]
    ds_read_b64_tr_b16 v[216:217], v37 offset:25600
    ds_read_b64_tr_b16 v[218:219], v37 offset:31744
    v_mfma_f32_16x16x32_bf16 v[136:139], v[28:31], a[232:235], v[136:139]
    v_mfma_f32_16x16x32_bf16 v[140:143], v[24:27], a[228:231], v[140:143]
    ds_read_b64_tr_b16 v[220:221], v37 offset:37888
    ds_read_b64_tr_b16 v[222:223], v37 offset:44032
    v_mfma_f32_16x16x32_bf16 v[140:143], v[28:31], a[236:239], v[140:143]
    s_waitcnt lgkmcnt(8)
    v_mfma_f32_16x16x32_bf16 v[128:131], v[192:195], a[240:243], v[128:131]
    ds_read_b64_tr_b16 v[16:17], v36 offset:26624
    ds_read_b64_tr_b16 v[18:19], v36 offset:32768
    v_mfma_f32_16x16x32_bf16 v[128:131], v[196:199], a[248:251], v[128:131]
    v_mfma_f32_16x16x32_bf16 v[132:135], v[192:195], a[244:247], v[132:135]
    ds_read_b64_tr_b16 v[20:21], v36 offset:38912
    ds_read_b64_tr_b16 v[22:23], v36 offset:45056
    v_mfma_f32_16x16x32_bf16 v[132:135], v[196:199], a[252:255], v[132:135]
    v_mfma_f32_16x16x32_bf16 v[136:139], v[200:203], a[240:243], v[136:139]
    ds_read_b64_tr_b16 v[24:25], v37 offset:26624
    ds_read_b64_tr_b16 v[26:27], v37 offset:32768
    v_mfma_f32_16x16x32_bf16 v[136:139], v[204:207], a[248:251], v[136:139]
    v_mfma_f32_16x16x32_bf16 v[140:143], v[200:203], a[244:247], v[140:143]
    ds_read_b64_tr_b16 v[28:29], v37 offset:38912
    ds_read_b64_tr_b16 v[30:31], v37 offset:45056
    v_mfma_f32_16x16x32_bf16 v[140:143], v[204:207], a[252:255], v[140:143]
    s_waitcnt lgkmcnt(8)
    s_waitcnt vmcnt(4)
    v_cmp_ne_u32 vcc, v57, v15
    s_cbranch_vccnz Lspin7
Lback7:
    v_mfma_f32_16x16x32_bf16 v[128:131], v[208:211], v[224:227], v[128:131]
    ds_read_b64_tr_b16 v[192:193], v38 offset:0
    ds_read_b64_tr_b16 v[194:195], v38 offset:6144
    v_mfma_f32_16x16x32_bf16 v[128:131], v[212:215], v[232:235], v[128:131]
    buffer_load_dwordx4 v[40:43], v1, s[8:11], s0 offen sc1
    v_mfma_f32_16x16x32_bf16 v[132:135], v[208:211], v[228:231], v[132:135]
    ds_read_b64_tr_b16 v[196:197], v38 offset:12288
    ds_read_b64_tr_b16 v[198:199], v38 offset:18432
    v_mfma_f32_16x16x32_bf16 v[132:135], v[212:215], v[236:239], v[132:135]
    buffer_load_dwordx4 v[44:47], v1, s[8:11], s1 offen sc1
    v_mfma_f32_16x16x32_bf16 v[136:139], v[216:219], v[224:227], v[136:139]
    ds_read_b64_tr_b16 v[200:201], v39 offset:0
    ds_read_b64_tr_b16 v[202:203], v39 offset:6144
    v_mfma_f32_16x16x32_bf16 v[136:139], v[220:223], v[232:235], v[136:139]
    buffer_load_dwordx4 v[48:51], v1, s[8:11], s28 offen sc1
    v_mfma_f32_16x16x32_bf16 v[140:143], v[216:219], v[228:231], v[140:143]
    ds_read_b64_tr_b16 v[204:205], v39 offset:12288
    ds_read_b64_tr_b16 v[206:207], v39 offset:18432
    v_mfma_f32_16x16x32_bf16 v[140:143], v[220:223], v[236:239], v[140:143]
    buffer_load_dword v184, v56, s[8:11], s76 offen offset:128 sc1
    s_waitcnt lgkmcnt(8)
    v_mfma_f32_16x16x32_bf16 v[128:131], v[16:19], v[240:243], v[128:131]
    ds_read_b64_tr_b16 v[208:209], v38 offset:1024
    ds_read_b64_tr_b16 v[210:211], v38 offset:7168
    v_mfma_f32_16x16x32_bf16 v[128:131], v[20:23], v[248:251], v[128:131]
    v_mfma_f32_16x16x32_bf16 v[132:135], v[16:19], v[244:247], v[132:135]
    ds_read_b64_tr_b16 v[212:213], v38 offset:13312
    ds_read_b64_tr_b16 v[214:215], v38 offset:19456
    v_mfma_f32_16x16x32_bf16 v[132:135], v[20:23], v[252:255], v[132:135]
    v_mfma_f32_16x16x32_bf16 v[136:139], v[24:27], v[240:243], v[136:139]
    ds_read_b64_tr_b16 v[216:217], v39 offset:1024
    ds_read_b64_tr_b16 v[218:219], v39 offset:7168
    v_mfma_f32_16x16x32_bf16 v[136:139], v[28:31], v[248:251], v[136:139]
    v_mfma_f32_16x16x32_bf16 v[140:143], v[24:27], v[244:247], v[140:143]
    ds_read_b64_tr_b16 v[220:221], v39 offset:13312
    ds_read_b64_tr_b16 v[222:223], v39 offset:19456
    v_mfma_f32_16x16x32_bf16 v[140:143], v[28:31], v[252:255], v[140:143]
    s_waitcnt lgkmcnt(8)
    v_mfma_f32_16x16x32_bf16 v[144:147], v[192:195], a[192:195], v[144:147]
    ds_read_b64_tr_b16 v[16:17], v38 offset:2048
    ds_read_b64_tr_b16 v[18:19], v38 offset:8192
    v_mfma_f32_16x16x32_bf16 v[144:147], v[196:199], a[200:203], v[144:147]
    v_mfma_f32_16x16x32_bf16 v[148:151], v[192:195], a[196:199], v[148:151]
    ds_read_b64_tr_b16 v[20:21], v38 offset:14336
    ds_read_b64_tr_b16 v[22:23], v38 offset:20480
    v_mfma_f32_16x16x32_bf16 v[148:151], v[196:199], a[204:207], v[148:151]
    v_cvt_pk_bf16_f32 v128, v128, v129
    v_cvt_pk_bf16_f32 v129, v130, v131
    v_mfma_f32_16x16x32_bf16 v[152:155], v[200:203], a[192:195], v[152:155]
    ds_read_b64_tr_b16 v[24:25], v39 offset:2048
    ds_read_b64_tr_b16 v[26:27], v39 offset:8192
    v_mfma_f32_16x16x32_bf16 v[152:155], v[204:207], a[200:203], v[152:155]
    v_cvt_pk_bf16_f32 v130, v136, v137
    v_cvt_pk_bf16_f32 v131, v138, v139
    v_mfma_f32_16x16x32_bf16 v[156:159], v[200:203], a[196:199], v[156:159]
    ds_read_b64_tr_b16 v[28:29], v39 offset:14336
    ds_read_b64_tr_b16 v[30:31], v39 offset:20480
    v_mfma_f32_16x16x32_bf16 v[156:159], v[204:207], a[204:207], v[156:159]
    v_cvt_pk_bf16_f32 v132, v132, v133
    s_waitcnt lgkmcnt(8)
    v_mfma_f32_16x16x32_bf16 v[144:147], v[208:211], a[208:211], v[144:147]
    ds_read_b64_tr_b16 v[192:193], v38 offset:24576
    ds_read_b64_tr_b16 v[194:195], v38 offset:30720
    v_mfma_f32_16x16x32_bf16 v[144:147], v[212:215], a[216:219], v[144:147]
    v_cvt_pk_bf16_f32 v133, v134, v135
    v_cvt_pk_bf16_f32 v134, v140, v141
    v_mfma_f32_16x16x32_bf16 v[148:151], v[208:211], a[212:215], v[148:151]
    ds_read_b64_tr_b16 v[196:197], v38 offset:36864
    ds_read_b64_tr_b16 v[198:199], v38 offset:43008
    v_mfma_f32_16x16x32_bf16 v[148:151], v[212:215], a[220:223], v[148:151]
    buffer_store_dwordx4 v[128:131], v176, s[8:11], s73 offen offset:0 sc1
    v_mfma_f32_16x16x32_bf16 v[152:155], v[216:219], a[208:211], v[152:155]
    ds_read_b64_tr_b16 v[200:201], v39 offset:24576
    ds_read_b64_tr_b16 v[202:203], v39 offset:30720
    v_mfma_f32_16x16x32_bf16 v[152:155], v[220:223], a[216:219], v[152:155]
    v_cvt_pk_bf16_f32 v135, v142, v143
    v_mfma_f32_16x16x32_bf16 v[156:159], v[216:219], a[212:215], v[156:159]
    ds_read_b64_tr_b16 v[204:205], v39 offset:36864
    ds_read_b64_tr_b16 v[206:207], v39 offset:43008
    v_mfma_f32_16x16x32_bf16 v[156:159], v[220:223], a[220:223], v[156:159]
    s_waitcnt lgkmcnt(8)
    v_mfma_f32_16x16x32_bf16 v[144:147], v[16:19], a[224:227], v[144:147]
    ds_read_b64_tr_b16 v[208:209], v38 offset:25600
    ds_read_b64_tr_b16 v[210:211], v38 offset:31744
    v_mfma_f32_16x16x32_bf16 v[144:147], v[20:23], a[232:235], v[144:147]
    v_mfma_f32_16x16x32_bf16 v[148:151], v[16:19], a[228:231], v[148:151]
    ds_read_b64_tr_b16 v[212:213], v38 offset:37888
    ds_read_b64_tr_b16 v[214:215], v38 offset:44032
    v_mfma_f32_16x16x32_bf16 v[148:151], v[20:23], a[236:239], v[148:151]
    v_mfma_f32_16x16x32_bf16 v[152:155], v[24:27], a[224:227], v[152:155]
    ds_read_b64_tr_b16 v[216:217], v39 offset:25600
    ds_read_b64_tr_b16 v[218:219], v39 offset:31744
    v_mfma_f32_16x16x32_bf16 v[152:155], v[28:31], a[232:235], v[152:155]
    v_mfma_f32_16x16x32_bf16 v[156:159], v[24:27], a[228:231], v[156:159]
    ds_read_b64_tr_b16 v[220:221], v39 offset:37888
    ds_read_b64_tr_b16 v[222:223], v39 offset:44032
    v_mfma_f32_16x16x32_bf16 v[156:159], v[28:31], a[236:239], v[156:159]
    s_waitcnt lgkmcnt(8)
    v_mfma_f32_16x16x32_bf16 v[144:147], v[192:195], a[240:243], v[144:147]
    ds_read_b64_tr_b16 v[16:17], v38 offset:26624
    ds_read_b64_tr_b16 v[18:19], v38 offset:32768
    v_mfma_f32_16x16x32_bf16 v[144:147], v[196:199], a[248:251], v[144:147]
    v_mfma_f32_16x16x32_bf16 v[148:151], v[192:195], a[244:247], v[148:151]
    ds_read_b64_tr_b16 v[20:21], v38 offset:38912
    ds_read_b64_tr_b16 v[22:23], v38 offset:45056
    v_mfma_f32_16x16x32_bf16 v[148:151], v[196:199], a[252:255], v[148:151]
    buffer_store_dwordx4 v[132:135], v176, s[8:11], s73 offen offset:1024 sc1
    v_mfma_f32_16x16x32_bf16 v[152:155], v[200:203], a[240:243], v[152:155]
    ds_read_b64_tr_b16 v[24:25], v39 offset:26624
    ds_read_b64_tr_b16 v[26:27], v39 offset:32768
    v_mfma_f32_16x16x32_bf16 v[152:155], v[204:207], a[248:251], v[152:155]
    v_mfma_f32_16x16x32_bf16 v[156:159], v[200:203], a[244:247], v[156:159]
    ds_read_b64_tr_b16 v[28:29], v39 offset:38912
    ds_read_b64_tr_b16 v[30:31], v39 offset:45056
    v_mfma_f32_16x16x32_bf16 v[156:159], v[204:207], a[252:255], v[156:159]
    s_add_u32 s73, s73, 4096
    s_waitcnt lgkmcnt(8)
    v_mfma_f32_16x16x32_bf16 v[144:147], v[208:211], v[224:227], v[144:147]
    v_mfma_f32_16x16x32_bf16 v[144:147], v[212:215], v[232:235], v[144:147]
    v_mfma_f32_16x16x32_bf16 v[148:151], v[208:211], v[228:231], v[148:151]
    v_mfma_f32_16x16x32_bf16 v[148:151], v[212:215], v[236:239], v[148:151]
    v_mfma_f32_16x16x32_bf16 v[152:155], v[216:219], v[224:227], v[152:155]
    v_mfma_f32_16x16x32_bf16 v[152:155], v[220:223], v[232:235], v[152:155]
    v_mfma_f32_16x16x32_bf16 v[156:159], v[216:219], v[228:231], v[156:159]
    v_mfma_f32_16x16x32_bf16 v[156:159], v[220:223], v[236:239], v[156:159]
    s_waitcnt lgkmcnt(0)
    v_mfma_f32_16x16x32_bf16 v[144:147], v[16:19], v[240:243], v[144:147]
    v_mfma_f32_16x16x32_bf16 v[144:147], v[20:23], v[248:251], v[144:147]
    v_mfma_f32_16x16x32_bf16 v[148:151], v[16:19], v[244:247], v[148:151]
    v_mfma_f32_16x16x32_bf16 v[148:151], v[20:23], v[252:255], v[148:151]
    v_mfma_f32_16x16x32_bf16 v[152:155], v[24:27], v[240:243], v[152:155]
    v_mfma_f32_16x16x32_bf16 v[152:155], v[28:31], v[248:251], v[152:155]
    v_mfma_f32_16x16x32_bf16 v[156:159], v[24:27], v[244:247], v[156:159]
    v_mfma_f32_16x16x32_bf16 v[156:159], v[28:31], v[252:255], v[156:159]
    s_nop 1
    v_cvt_pk_bf16_f32 v144, v144, v145
    v_cvt_pk_bf16_f32 v145, v146, v147
    s_nop 1
    v_cvt_pk_bf16_f32 v146, v152, v153
    v_cvt_pk_bf16_f32 v147, v154, v155
    buffer_store_dwordx4 v[144:147], v176, s[8:11], s73 offen offset:0 sc1
    v_cvt_pk_bf16_f32 v148, v148, v149
    v_cvt_pk_bf16_f32 v149, v150, v151
    v_cvt_pk_bf16_f32 v150, v156, v157
    v_cvt_pk_bf16_f32 v151, v158, v159
    buffer_store_dwordx4 v[148:151], v176, s[8:11], s73 offen offset:1024 sc1
    s_cmp_eq_u32 s46, 0
    s_cbranch_scc1 Lnoown
    ds_write_b128 v1, v[64:67] offset:0
    ds_write_b128 v1, v[68:71] offset:1024
    ds_write_b128 v1, v[80:83] offset:2048
    ds_write_b128 v1, v[84:87] offset:3072
    ds_write_b128 v1, v[96:99] offset:4096
    ds_write_b128 v1, v[100:103] offset:5120
    ds_write_b128 v1, v[112:115] offset:6144
    ds_write_b128 v1, v[116:119] offset:7168
    ds_write_b128 v177, v[128:131] offset:8192
    ds_write_b128 v177, v[132:135] offset:9216
    ds_write_b128 v177, v[144:147] offset:10240
    ds_write_b128 v177, v[148:151] offset:11264
Lnoown:
    v_mov_b32 v32, 0
    v_mov_b32 v33, 0
    v_mov_b32 v34, 0
    v_mov_b32 v35, 0
    v_mov_b32 v36, 0
    v_mov_b32 v37, 0
    v_mov_b32 v38, 0
    v_mov_b32 v39, 0
    s_mov_b32 s44, 0
    s_mov_b32 s45, 0
    s_mov_b32 s85, 0
    s_waitcnt vmcnt(9)
    v_permlane16_swap_b32 v160, v162
    v_permlane16_swap_b32 v161, v163
    v_permlane16_swap_b32 v164, v166
    v_permlane16_swap_b32 v165, v167
    v_permlane16_swap_b32 v168, v170
    v_permlane16_swap_b32 v169, v171
    v_lshlrev_b32 v196, 16, v160
    v_and_b32 v197, 0xffff0000, v160
    v_lshlrev_b32 v198, 16, v161
    v_and_b32 v199, 0xffff0000, v161
    v_lshlrev_b32 v200, 16, v162
    v_and_b32 v201, 0xffff0000, v162
    v_lshlrev_b32 v202, 16, v163
    v_and_b32 v203, 0xffff0000, v163
    v_lshlrev_b32 v204, 16, v164
    v_and_b32 v205, 0xffff0000, v164
    v_lshlrev_b32 v206, 16, v165
    v_and_b32 v207, 0xffff0000, v165
    v_lshlrev_b32 v208, 16, v166
    v_and_b32 v209, 0xffff0000, v166
    v_lshlrev_b32 v210, 16, v167
    v_and_b32 v211, 0xffff0000, v167
    v_lshlrev_b32 v212, 16, v168
    v_and_b32 v213, 0xffff0000, v168
    v_lshlrev_b32 v214, 16, v169
    v_and_b32 v215, 0xffff0000, v169
    v_lshlrev_b32 v216, 16, v170
    v_and_b32 v217, 0xffff0000, v170
    v_lshlrev_b32 v218, 16, v171
    v_and_b32 v219, 0xffff0000, v171
    s_waitcnt vmcnt(0)
    buffer_store_dword v15, v14, s[8:11], s75 offen offset:256 sc1
    s_waitcnt lgkmcnt(0)
    s_barrier
    s_mov_b32 s85, 0
Lin8:
    v_cmp_ne_u32 vcc, v184, v15
    s_cbranch_vccz Lback8
    buffer_load_dword v184, v56, s[8:11], s76 offen offset:128 sc1
    s_add_u32 s85, s85, 1
    s_cmp_lt_u32 s85, 0x80000
    s_waitcnt vmcnt(0)
    s_cbranch_scc1 Lin8
Lback8:
    buffer_load_dwordx4 v[52:55], v180, s[8:11], s0 offen sc1
    buffer_load_dwordx4 v[72:75], v180, s[8:11], s1 offen sc1
    buffer_load_dwordx4 v[76:79], v180, s[8:11], s28 offen sc1
    buffer_load_dword v183, v8, s[8:11], 0 offen sc1
    ds_read_b128 v[232:235], v9 offset:0
    ds_read_b128 v[236:239], v9 offset:4096
    ds_read_b128 v[240:243], v182 offset:8192
    s_waitcnt lgkmcnt(2)
    v_lshlrev_b32 v128, 16, v232
    v_and_b32 v129, 0xffff0000, v232
    v_lshlrev_b32 v130, 16, v233
    v_and_b32 v131, 0xffff0000, v233
    v_lshlrev_b32 v132, 16, v234
    v_and_b32 v133, 0xffff0000, v234
    v_lshlrev_b32 v134, 16, v235
    v_and_b32 v135, 0xffff0000, v235
    s_waitcnt lgkmcnt(1)
    v_lshlrev_b32 v136, 16, v236
    v_and_b32 v137, 0xffff0000, v236
    v_lshlrev_b32 v138, 16, v237
    v_and_b32 v139, 0xffff0000, v237
    v_lshlrev_b32 v140, 16, v238
    v_and_b32 v141, 0xffff0000, v238
    v_lshlrev_b32 v142, 16, v239
    v_and_b32 v143, 0xffff0000, v239
    s_waitcnt lgkmcnt(0)
    v_lshlrev_b32 v144, 16, v240
    v_and_b32 v145, 0xffff0000, v240
    v_lshlrev_b32 v146, 16, v241
    v_and_b32 v147, 0xffff0000, v241
    v_lshlrev_b32 v148, 16, v242
    v_and_b32 v149, 0xffff0000, v242
    v_lshlrev_b32 v150, 16, v243
    v_and_b32 v151, 0xffff0000, v243
    v_dot2c_f32_bf16 v128, s38, v40
    v_dot2c_f32_bf16 v129, s39, v40
    v_dot2c_f32_bf16 v130, s38, v41
    v_dot2c_f32_bf16 v131, s39, v41
    v_dot2c_f32_bf16 v132, s38, v42
    v_dot2c_f32_bf16 v133, s39, v42
    v_dot2c_f32_bf16 v134, s38, v43
    v_dot2c_f32_bf16 v135, s39, v43
    v_dot2c_f32_bf16 v128, s38, v44
    v_dot2c_f32_bf16 v129, s39, v44
    v_dot2c_f32_bf16 v130, s38, v45
    v_dot2c_f32_bf16 v131, s39, v45
    v_dot2c_f32_bf16 v132, s38, v46
    v_dot2c_f32_bf16 v133, s39, v46
    v_dot2c_f32_bf16 v134, s38, v47
    v_dot2c_f32_bf16 v135, s39, v47
    v_dot2c_f32_bf16 v128, s38, v48
    v_dot2c_f32_bf16 v129, s39, v48
    v_dot2c_f32_bf16 v130, s38, v49
    v_dot2c_f32_bf16 v131, s39, v49
    v_dot2c_f32_bf16 v132, s38, v50
    v_dot2c_f32_bf16 v133, s39, v50
    v_dot2c_f32_bf16 v134, s38, v51
    v_dot2c_f32_bf16 v135, s39, v51
    v_pk_mul_f32 v[224:225], v[128:129], s[40:41]
    v_pk_mul_f32 v[226:227], v[130:131], s[40:41]
    v_pk_mul_f32 v[228:229], v[132:133], s[40:41]
    v_pk_mul_f32 v[230:231], v[134:135], s[40:41]
    v_exp_f32 v224, v224
    v_exp_f32 v225, v225
    v_exp_f32 v226, v226
    v_exp_f32 v227, v227
    v_exp_f32 v228, v228
    v_exp_f32 v229, v229
    v_exp_f32 v230, v230
    v_exp_f32 v231, v231
    v_pk_add_f32 v[224:225], v[224:225], 1.0 op_sel_hi:[1,0]
    v_pk_add_f32 v[226:227], v[226:227], 1.0 op_sel_hi:[1,0]
    v_pk_add_f32 v[228:229], v[228:229], 1.0 op_sel_hi:[1,0]
    v_pk_add_f32 v[230:231], v[230:231], 1.0 op_sel_hi:[1,0]
    v_rcp_f32 v224, v224
    v_rcp_f32 v225, v225
    v_rcp_f32 v226, v226
    v_rcp_f32 v227, v227
    v_rcp_f32 v228, v228
    v_rcp_f32 v229, v229
    v_rcp_f32 v230, v230
    v_rcp_f32 v231, v231
    v_pk_mul_f32 v[128:129], v[128:129], v[224:225]
    v_pk_mul_f32 v[130:131], v[130:131], v[226:227]
    v_pk_mul_f32 v[132:133], v[132:133], v[228:229]
    v_pk_mul_f32 v[134:135], v[134:135], v[230:231]
    s_waitcnt vmcnt(0)
Lev:
    s_mov_b32 s46, s44
    s_cmp_eq_u32 s44, 3
    s_cbranch_scc1 Lev_c
    v_cmp_ne_u32 s[42:43], v183, v15
    s_add_u32 s85, s85, 1
    s_cmp_gt_u32 s85, 0x80000
    s_cselect_b64 s[42:43], 0, s[42:43]
    s_bfe_u32 s47, s42, 0x40010
    s_and_b32 s48, s44, 2
    s_or_b32 s47, s47, s48
    s_cmp_lg_u32 s47, 0
    s_cbranch_scc1 Lev_s
    s_or_b32 s44, s44, 2
    buffer_load_dwordx4 v[88:91], v181, s[8:11], s0 offen sc1
    buffer_load_dwordx4 v[92:95], v181, s[8:11], s1 offen sc1
    buffer_load_dwordx4 v[104:107], v181, s[8:11], s28 offen sc1
Lev_s:
    s_and_b32 s47, s44, 1
    s_and_b32 s48, s42, 0xfff0ffff
    s_or_b32 s47, s47, s48
    s_or_b32 s47, s47, s43
    s_cmp_lg_u32 s47, 0
    s_cbranch_scc1 Lev_p
    s_or_b32 s44, s44, 1
    buffer_load_dwordx4 v[112:115], v11, s[8:11], s29 offen sc1
    s_add_u32 s29, s29, 262144
    buffer_load_dwordx4 v[116:119], v11, s[8:11], s29 offen sc1
    s_add_u32 s29, s29, 262144
    s_cmp_ge_u32 s2, 128
    s_cbranch_scc1 Lfin_x
    buffer_load_dwordx4 v[120:123], v11, s[8:11], s29 offen sc1
    s_branch Lev_p
Lfin_x:
    buffer_load_short_d16_hi v32, v13, s[8:11], s59 offen sc1
    s_add_u32 s59, s59, 4096
    buffer_load_short_d16_hi v33, v13, s[8:11], s59 offen sc1
    s_add_u32 s59, s59, 4096
    buffer_load_short_d16_hi v34, v13, s[8:11], s59 offen sc1
    s_add_u32 s59, s59, 4096
    buffer_load_short_d16_hi v35, v13, s[8:11], s59 offen sc1
    s_add_u32 s59, s59, 53248
    buffer_load_short_d16_hi v36, v13, s[8:11], s59 offen sc1
    s_add_u32 s59, s59, 4096
    buffer_load_short_d16_hi v37, v13, s[8:11], s59 offen sc1
    s_add_u32 s59, s59, 4096
    buffer_load_short_d16_hi v38, v13, s[8:11], s59 offen sc1
    s_add_u32 s59, s59, 4096
    buffer_load_short_d16_hi v39, v13, s[8:11], s59 offen sc1
    s_add_u32 s59, s59, 4096
Lev_p:
    s_cmp_eq_u32 s44, 3
    s_cbranch_scc1 Lev_c
    s_mov_b64 exec, s[42:43]
    buffer_load_dword v183, v8, s[8:11], 0 offen sc1
    s_mov_b64 exec, -1
Lev_c:
    s_bitcmp1_b32 s45, 2
    s_cbranch_scc1 Lev_d
    s_or_b32 s45, s45, 4
    v_dot2c_f32_bf16 v136, s38, v52
    v_dot2c_f32_bf16 v137, s39, v52
    v_dot2c_f32_bf16 v138, s38, v53
    v_dot2c_f32_bf16 v139, s39, v53
    v_dot2c_f32_bf16 v140, s38, v54
    v_dot2c_f32_bf16 v141, s39, v54
    v_dot2c_f32_bf16 v142, s38, v55
    v_dot2c_f32_bf16 v143, s39, v55
    v_dot2c_f32_bf16 v136, s38, v72
    v_dot2c_f32_bf16 v137, s39, v72
    v_dot2c_f32_bf16 v138, s38, v73
    v_dot2c_f32_bf16 v139, s39, v73
    v_dot2c_f32_bf16 v140, s38, v74
    v_dot2c_f32_bf16 v141, s39, v74
    v_dot2c_f32_bf16 v142, s38, v75
    v_dot2c_f32_bf16 v143, s39, v75
    v_dot2c_f32_bf16 v136, s38, v76
    v_dot2c_f32_bf16 v137, s39, v76
    v_dot2c_f32_bf16 v138, s38, v77
    v_dot2c_f32_bf16 v139, s39, v77
    v_dot2c_f32_bf16 v140, s38, v78
    v_dot2c_f32_bf16 v141, s39, v78
    v_dot2c_f32_bf16 v142, s38, v79
    v_dot2c_f32_bf16 v143, s39, v79
    v_pk_mul_f32 v[224:225], v[136:137], s[40:41]
    v_pk_mul_f32 v[226:227], v[138:139], s[40:41]
    v_pk_mul_f32 v[228:229], v[140:141], s[40:41]
    v_pk_mul_f32 v[230:231], v[142:143], s[40:41]
    v_exp_f32 v224, v224
Lpad11:
    s_cbranch_execz Lwret5
    v_exp_f32 v225, v225
    v_exp_f32 v226, v226
    v_exp_f32 v227, v227
    v_exp_f32 v228, v228
    v_exp_f32 v229, v229
    v_exp_f32 v230, v230
    v_exp_f32 v231, v231
    v_pk_add_f32 v[224:225], v[224:225], 1.0 op_sel_hi:[1,0]
    v_pk_add_f32 v[226:227], v[226:227], 1.0 op_sel_hi:[1,0]
    v_pk_add_f32 v[228:229], v[228:229], 1.0 op_sel_hi:[1,0]
    v_pk_add_f32 v[230:231], v[230:231], 1.0 op_sel_hi:[1,0]
    v_rcp_f32 v224, v224
    v_rcp_f32 v225, v225
    v_rcp_f32 v226, v226
    v_rcp_f32 v227, v227
    v_rcp_f32 v228, v228
    v_rcp_f32 v229, v229
    v_rcp_f32 v230, v230
    v_rcp_f32 v231, v231
    v_pk_mul_f32 v[136:137], v[136:137], v[224:225]
    v_pk_mul_f32 v[138:139], v[138:139], v[226:227]
    v_pk_mul_f32 v[140:141], v[140:141], v[228:229]
    v_pk_mul_f32 v[142:143], v[142:143], v[230:231]
Lev_d:
    s_andn2_b32 s47, s46, s45
    s_or_b32 s45, s45, s46
    s_bitcmp1_b32 s47, 0
    s_cbranch_scc0 Lev_e
    v_permlane16_swap_b32 v112, v114
    v_permlane16_swap_b32 v113, v115
    v_permlane16_swap_b32 v116, v118
    v_permlane16_swap_b32 v117, v119
    v_permlane16_swap_b32 v120, v122
    v_permlane16_swap_b32 v121, v123
    v_lshlrev_b32 v16, 16, v112
    v_and_b32 v17, 0xffff0000, v112
    v_lshlrev_b32 v18, 16, v113
    v_and_b32 v19, 0xffff0000, v113
    v_lshlrev_b32 v20, 16, v114
    v_and_b32 v21, 0xffff0000, v114
    v_lshlrev_b32 v22, 16, v115
    v_and_b32 v23, 0xffff0000, v115
    v_lshlrev_b32 v24, 16, v116
    v_and_b32 v25, 0xffff0000, v116
    v_lshlrev_b32 v26, 16, v117
    v_and_b32 v27, 0xffff0000, v117
    v_lshlrev_b32 v28, 16, v118
    v_and_b32 v29, 0xffff0000, v118
    v_lshlrev_b32 v30, 16, v119
    v_and_b32 v31, 0xffff0000, v119
    v_pk_fma_f32 v[128:129], v[128:129], v[16:17], v[196:197]
    v_pk_fma_f32 v[130:131], v[130:131], v[18:19], v[198:199]
    v_pk_fma_f32 v[132:133], v[132:133], v[20:21], v[200:201]
    v_pk_fma_f32 v[134:135], v[134:135], v[22:23], v[202:203]
    v_cvt_pk_bf16_f32 v160, v128, v129
    v_cvt_pk_bf16_f32 v162, v132, v133
    v_cvt_pk_bf16_f32 v161, v130, v131
    v_cvt_pk_bf16_f32 v163, v134, v135
    v_permlane16_swap_b32 v160, v162
    s_nop 0
    v_permlane16_swap_b32 v161, v163
    buffer_store_dwordx4 v[160:163], v178, s[16:19], s78 offen offset:0
    v_pk_fma_f32 v[136:137], v[136:137], v[24:25], v[204:205]
    v_pk_fma_f32 v[138:139], v[138:139], v[26:27], v[206:207]
    v_pk_fma_f32 v[140:141], v[140:141], v[28:29], v[208:209]
    v_pk_fma_f32 v[142:143], v[142:143], v[30:31], v[210:211]
    v_cvt_pk_bf16_f32 v164, v136, v137
    v_cvt_pk_bf16_f32 v166, v140, v141
    v_cvt_pk_bf16_f32 v165, v138, v139
    v_cvt_pk_bf16_f32 v167, v142, v143
    v_permlane16_swap_b32 v164, v166
    s_nop 0
    v_permlane16_swap_b32 v165, v167
    buffer_store_dwordx4 v[164:167], v178, s[16:19], s78 offen offset:128
    s_cmp_ge_u32 s2, 128
    s_cbranch_scc1 Lev_e
    v_lshlrev_b32 v32, 16, v120
    v_and_b32 v33, 0xffff0000, v120
    v_lshlrev_b32 v34, 16, v121
    v_and_b32 v35, 0xffff0000, v121
    v_lshlrev_b32 v36, 16, v122
    v_and_b32 v37, 0xffff0000, v122
    v_lshlrev_b32 v38, 16, v123
    v_and_b32 v39, 0xffff0000, v123
Lev_e:
    s_bitcmp1_b32 s47, 1
    s_cbranch_scc0 Lev_f
    v_dot2c_f32_bf16 v144, s38, v88
    v_dot2c_f32_bf16 v145, s39, v88
    v_dot2c_f32_bf16 v146, s38, v89
    v_dot2c_f32_bf16 v147, s39, v89
    v_dot2c_f32_bf16 v148, s38, v90
    v_dot2c_f32_bf16 v149, s39, v90
    v_dot2c_f32_bf16 v150, s38, v91
    v_dot2c_f32_bf16 v151, s39, v91
    v_dot2c_f32_bf16 v144, s38, v92
    v_dot2c_f32_bf16 v145, s39, v92
    v_dot2c_f32_bf16 v146, s38, v93
    v_dot2c_f32_bf16 v147, s39, v93
    v_dot2c_f32_bf16 v148, s38, v94
    v_dot2c_f32_bf16 v149, s39, v94
    v_dot2c_f32_bf16 v150, s38, v95
    v_dot2c_f32_bf16 v151, s39, v95
    v_dot2c_f32_bf16 v144, s38, v104
    v_dot2c_f32_bf16 v145, s39, v104
    v_dot2c_f32_bf16 v146, s38, v105
    v_dot2c_f32_bf16 v147, s39, v105
    v_dot2c_f32_bf16 v148, s38, v106
    v_dot2c_f32_bf16 v149, s39, v106
    v_dot2c_f32_bf16 v150, s38, v107
    v_dot2c_f32_bf16 v151, s39, v107
    v_pk_mul_f32 v[224:225], v[144:145], s[40:41]
    v_pk_mul_f32 v[226:227], v[146:147], s[40:41]
    v_pk_mul_f32 v[228:229], v[148:149], s[40:41]
    v_pk_mul_f32 v[230:231], v[150:151], s[40:41]
    v_exp_f32 v224, v224
    v_exp_f32 v225, v225
    v_exp_f32 v226, v226
    v_exp_f32 v227, v227
    v_exp_f32 v228, v228
    v_exp_f32 v229, v229
    v_exp_f32 v230, v230
    v_exp_f32 v231, v231
    v_pk_add_f32 v[224:225], v[224:225], 1.0 op_sel_hi:[1,0]
    v_pk_add_f32 v[226:227], v[226:227], 1.0 op_sel_hi:[1,0]
    v_pk_add_f32 v[228:229], v[228:229], 1.0 op_sel_hi:[1,0]
    v_pk_add_f32 v[230:231], v[230:231], 1.0 op_sel_hi:[1,0]
    v_rcp_f32 v224, v224
    v_rcp_f32 v225, v225
    v_rcp_f32 v226, v226
    v_rcp_f32 v227, v227
    v_rcp_f32 v228, v228
    v_rcp_f32 v229, v229
    v_rcp_f32 v230, v230
    v_rcp_f32 v231, v231
    v_pk_mul_f32 v[144:145], v[144:145], v[224:225]
    v_pk_mul_f32 v[146:147], v[146:147], v[226:227]
    v_pk_mul_f32 v[148:149], v[148:149], v[228:229]
    v_pk_mul_f32 v[150:151], v[150:151], v[230:231]
Lev_f:
    s_cmp_eq_u32 s45, 7
    s_cbranch_scc1 Lev_x
    s_bitcmp1_b32 s47, 0
    s_cbranch_scc0 Lev_w
    s_waitcnt vmcnt(2)
    s_branch Lev
Lev_w:
    s_waitcnt vmcnt(0)
    s_branch Lev
Lev_x:
    v_pk_fma_f32 v[144:145], v[144:145], v[32:33], v[212:213]
    v_pk_fma_f32 v[146:147], v[146:147], v[34:35], v[214:215]
    v_pk_fma_f32 v[148:149], v[148:149], v[36:37], v[216:217]
    v_pk_fma_f32 v[150:151], v[150:151], v[38:39], v[218:219]
    v_cvt_pk_bf16_f32 v168, v144, v145
    v_cvt_pk_bf16_f32 v170, v148, v149
    v_cvt_pk_bf16_f32 v169, v146, v147
    v_cvt_pk_bf16_f32 v171, v150, v151
    v_permlane16_swap_b32 v168, v170
    s_nop 0
    v_permlane16_swap_b32 v169, v171
    buffer_store_dwordx4 v[168:171], v178, s[16:19], s78 offen offset:256
    s_endpgm
Lrole_ssm:
Lpad12:
    s_cbranch_execz Lwret1
    v_mfma_f32_16x16x32_bf16 v[160:163], v[16:19], a[0:3], 0
    ds_read_b64_tr_b16 v[32:33], v9 offset:4096
    ds_read_b64_tr_b16 v[34:35], v9 offset:4352
    s_lshl_b32 s32, s3, 13
    v_mfma_f32_16x16x32_bf16 v[160:163], v[20:23], a[16:19], v[160:163]
    s_lshl_b32 s33, s3, 10
    s_add_u32 m0, s32, 8192
    s_add_u32 s81, s70, 0
    v_mfma_f32_16x16x32_bf16 v[164:167], v[16:19], a[4:7], 0
    buffer_load_dwordx4 v62, s[8:11], s81 offen sc1 lds
    s_add_u32 m0, s32, 9216
    v_mfma_f32_16x16x32_bf16 v[164:167], v[20:23], a[20:23], v[164:167]
    s_add_u32 s81, s70, 73728
    buffer_load_dwordx4 v62, s[8:11], s81 offen sc1 lds
    v_mfma_f32_16x16x32_bf16 v[168:171], v[16:19], a[8:11], 0
    ds_read_b64_tr_b16 v[36:37], v9 offset:6144
    ds_read_b64_tr_b16 v[38:39], v9 offset:6400
    s_add_u32 m0, s32, 10240
    v_mfma_f32_16x16x32_bf16 v[168:171], v[20:23], a[24:27], v[168:171]
    s_add_u32 s81, s70, 147456
    buffer_load_dwordx4 v62, s[8:11], s81 offen sc1 lds
    v_mfma_f32_16x16x32_bf16 v[172:175], v[16:19], a[12:15], 0
    s_add_u32 m0, s32, 11264
    s_add_u32 s81, s70, 221184
    v_lshrrev_b32 v63, 1, v0
    v_mfma_f32_16x16x32_bf16 v[172:175], v[20:23], a[28:31], v[172:175]
    buffer_load_dwordx4 v62, s[8:11], s81 offen sc1 lds
    s_waitcnt lgkmcnt(4)
    v_mfma_f32_16x16x32_bf16 v[176:179], v[24:27], a[0:3], 0
    ds_read_b64_tr_b16 v[16:17], v9 offset:5120
    ds_read_b64_tr_b16 v[18:19], v9 offset:5376
    s_add_u32 m0, s32, 12288
    v_mfma_f32_16x16x32_bf16 v[176:179], v[28:31], a[16:19], v[176:179]
    s_add_u32 s81, s70, 294912
    buffer_load_dwordx4 v62, s[8:11], s81 offen sc1 lds
    v_mfma_f32_16x16x32_bf16 v[180:183], v[24:27], a[4:7], 0
    s_add_u32 m0, s32, 13312
    s_add_u32 s81, s70, 368640
    v_and_b32 v57, 1, v0
    v_mfma_f32_16x16x32_bf16 v[180:183], v[28:31], a[20:23], v[180:183]
    buffer_load_dwordx4 v62, s[8:11], s81 offen sc1 lds
    s_add_u32 m0, s32, 14336
    v_mfma_f32_16x16x32_bf16 v[184:187], v[24:27], a[8:11], 0
    ds_read_b64_tr_b16 v[20:21], v9 offset:7168
    ds_read_b64_tr_b16 v[22:23], v9 offset:7424
    s_add_u32 s81, s70, 442368
    v_mfma_f32_16x16x32_bf16 v[184:187], v[28:31], a[24:27], v[184:187]
    buffer_load_dwordx4 v62, s[8:11], s81 offen sc1 lds
    s_add_u32 m0, s32, 15360
    v_mfma_f32_16x16x32_bf16 v[188:191], v[24:27], a[12:15], 0
    s_add_u32 s81, s70, 516096
    buffer_load_dwordx4 v62, s[8:11], s81 offen sc1 lds
    v_mfma_f32_16x16x32_bf16 v[188:191], v[28:31], a[28:31], v[188:191]
    v_lshl_add_u32 v63, v57, 5, v63
    v_lshlrev_b32 v63, 4, v63
    s_waitcnt lgkmcnt(4)
    v_mfma_f32_16x16x32_bf16 v[160:163], v[32:35], a[32:35], v[160:163]
    ds_read_b64_tr_b16 v[24:25], v9 offset:8192
    ds_read_b64_tr_b16 v[26:27], v9 offset:8448
    s_mov_b32 m0, s74
    v_mfma_f32_16x16x32_bf16 v[160:163], v[36:39], a[48:51], v[160:163]
    buffer_load_dwordx4 v63, s[8:11], s72 offen offset:0 sc1 lds
    v_fma_f32 v12, -v102, v102, s58
    v_mfma_f32_16x16x32_bf16 v[164:167], v[32:35], a[36:39], v[164:167]
    buffer_load_dwordx4 v63, s[8:11], s72 offen offset:1024 sc1 lds
    v_fma_f32 v13, -v103, v103, s58
    v_mfma_f32_16x16x32_bf16 v[164:167], v[36:39], a[52:55], v[164:167]
    buffer_load_dwordx4 v63, s[8:11], s72 offen offset:2048 sc1 lds
    v_mul_f32 v118, v118, v102
    v_mfma_f32_16x16x32_bf16 v[168:171], v[32:35], a[40:43], v[168:171]
    ds_read_b64_tr_b16 v[28:29], v9 offset:10240
    ds_read_b64_tr_b16 v[30:31], v9 offset:10496
    v_mul_f32 v119, v119, v103
    v_mfma_f32_16x16x32_bf16 v[168:171], v[36:39], a[56:59], v[168:171]
    buffer_load_dwordx4 v63, s[8:11], s72 offen offset:3072 sc1 lds
    s_add_u32 m0, s33, 74016
    v_mfma_f32_16x16x32_bf16 v[172:175], v[32:35], a[44:47], v[172:175]
    buffer_load_dwordx4 v63, s[8:11], s73 offen offset:0 sc1 lds
    v_mul_f32 v102, v12, v102
    v_mfma_f32_16x16x32_bf16 v[172:175], v[36:39], a[60:63], v[172:175]
    v_exp_f32 v100, v100
    s_waitcnt lgkmcnt(4)
    v_mfma_f32_16x16x32_bf16 v[176:179], v[16:19], a[32:35], v[176:179]
    ds_read_b64_tr_b16 v[32:33], v9 offset:9216
    ds_read_b64_tr_b16 v[34:35], v9 offset:9472
    v_mul_f32 v103, v13, v103
    v_mfma_f32_16x16x32_bf16 v[176:179], v[20:23], a[48:51], v[176:179]
    v_exp_f32 v101, v101
    v_add_f32 v100, 1.0, v100
    v_mfma_f32_16x16x32_bf16 v[180:183], v[16:19], a[36:39], v[180:183]
    v_exp_f32 v102, v102
    v_add_f32 v101, 1.0, v101
    v_mfma_f32_16x16x32_bf16 v[180:183], v[20:23], a[52:55], v[180:183]
    v_exp_f32 v103, v103
    v_add_f32 v102, 1.0, v102
    v_mfma_f32_16x16x32_bf16 v[184:187], v[16:19], a[40:43], v[184:187]
    ds_read_b64_tr_b16 v[36:37], v9 offset:11264
    ds_read_b64_tr_b16 v[38:39], v9 offset:11520
    v_add_f32 v103, 1.0, v103
    v_mfma_f32_16x16x32_bf16 v[184:187], v[20:23], a[56:59], v[184:187]
    v_rcp_f32 v100, v100
    v_mul_f32 v124, v124, v108
    v_mfma_f32_16x16x32_bf16 v[188:191], v[16:19], a[44:47], v[188:191]
    v_rcp_f32 v101, v101
    v_mul_f32 v125, v125, v109
    v_mfma_f32_16x16x32_bf16 v[188:191], v[20:23], a[60:63], v[188:191]
    v_mul_f32 v126, v126, v110
    v_mul_f32 v127, v127, v111
    s_waitcnt lgkmcnt(4)
    v_mfma_f32_16x16x32_bf16 v[160:163], v[24:27], a[64:67], v[160:163]
    ds_read_b64_tr_b16 v[16:17], v9 offset:12288
    ds_read_b64_tr_b16 v[18:19], v9 offset:12544
    v_mfma_f32_16x16x32_bf16 v[160:163], v[28:31], a[80:83], v[160:163]
    v_rcp_f32 v102, v102
    v_rcp_f32 v103, v103
    v_pk_fma_f32 v[10:11], v[104:105], v[104:105], s[58:59] op_sel_hi:[1,1,0] neg_lo:[1,0,0] neg_hi:[1,0,0]
    v_pk_fma_f32 v[12:13], v[106:107], v[106:107], s[58:59] op_sel_hi:[1,1,0] neg_lo:[1,0,0] neg_hi:[1,0,0]
    v_pk_mul_f32 v[120:121], v[120:121], v[104:105]
    v_pk_mul_f32 v[122:123], v[122:123], v[106:107]
    v_pk_mul_f32 v[104:105], v[10:11], v[104:105]
    v_pk_mul_f32 v[106:107], v[12:13], v[106:107]
    v_pk_mul_f32 v[116:117], v[116:117], v[100:101]
    v_pk_mul_f32 v[118:119], v[118:119], v[102:103]
    v_mfma_f32_16x16x32_bf16 v[164:167], v[24:27], a[68:71], v[164:167]
    v_cvt_pk_bf16_f32 v44, v116, v117
    v_cvt_pk_bf16_f32 v45, v118, v119
    v_fma_f32 v10, -v108, v108, s58
    v_mfma_f32_16x16x32_bf16 v[164:167], v[28:31], a[84:87], v[164:167]
    v_exp_f32 v104, v104
    v_fma_f32 v11, -v109, v109, s58
    v_mfma_f32_16x16x32_bf16 v[168:171], v[24:27], a[72:75], v[168:171]
    ds_read_b64_tr_b16 v[20:21], v9 offset:14336
    ds_read_b64_tr_b16 v[22:23], v9 offset:14592
    v_add_f32 v104, 1.0, v104
    v_mfma_f32_16x16x32_bf16 v[168:171], v[28:31], a[88:91], v[168:171]
    v_exp_f32 v105, v105
    v_mul_f32 v108, v10, v108
    v_mfma_f32_16x16x32_bf16 v[172:175], v[24:27], a[76:79], v[172:175]
    v_exp_f32 v106, v106
    v_add_f32 v105, 1.0, v105
    v_mfma_f32_16x16x32_bf16 v[172:175], v[28:31], a[92:95], v[172:175]
    v_exp_f32 v107, v107
    v_add_f32 v106, 1.0, v106
    s_waitcnt lgkmcnt(4)
    v_mfma_f32_16x16x32_bf16 v[176:179], v[32:35], a[64:67], v[176:179]
    ds_read_b64_tr_b16 v[24:25], v9 offset:13312
    ds_read_b64_tr_b16 v[26:27], v9 offset:13568
    v_add_f32 v107, 1.0, v107
    v_mfma_f32_16x16x32_bf16 v[176:179], v[36:39], a[80:83], v[176:179]
    v_rcp_f32 v104, v104
    v_mul_f32 v109, v11, v109
    v_mfma_f32_16x16x32_bf16 v[180:183], v[32:35], a[68:71], v[180:183]
    v_rcp_f32 v105, v105
    v_mul_f32 v120, v120, v104
    v_mfma_f32_16x16x32_bf16 v[180:183], v[36:39], a[84:87], v[180:183]
    v_rcp_f32 v106, v106
    v_mul_f32 v121, v121, v105
    v_mfma_f32_16x16x32_bf16 v[184:187], v[32:35], a[72:75], v[184:187]
    ds_read_b64_tr_b16 v[28:29], v9 offset:15360
    ds_read_b64_tr_b16 v[30:31], v9 offset:15616
    v_mul_f32 v122, v122, v106
    v_mfma_f32_16x16x32_bf16 v[184:187], v[36:39], a[88:91], v[184:187]
    v_rcp_f32 v107, v107
    v_cvt_pk_bf16_f32 v48, v120, v121
    v_mfma_f32_16x16x32_bf16 v[188:191], v[32:35], a[76:79], v[188:191]
    v_mul_f32 v123, v123, v107
    v_cvt_pk_bf16_f32 v49, v122, v123
    v_fma_f32 v12, -v110, v110, s58
    v_mfma_f32_16x16x32_bf16 v[188:191], v[36:39], a[92:95], v[188:191]
    v_exp_f32 v108, v108
    s_waitcnt lgkmcnt(4)
    v_mfma_f32_16x16x32_bf16 v[160:163], v[16:19], a[96:99], v[160:163]
    ds_read_b64_tr_b16 v[32:33], v9 offset:16384
    ds_read_b64_tr_b16 v[34:35], v9 offset:16640
    v_fma_f32 v13, -v111, v111, s58
    v_mfma_f32_16x16x32_bf16 v[160:163], v[20:23], a[112:115], v[160:163]
    v_exp_f32 v109, v109
    v_mul_f32 v110, v12, v110
    v_mfma_f32_16x16x32_bf16 v[164:167], v[16:19], a[100:103], v[164:167]
    v_mul_f32 v111, v13, v111
    v_exp_f32 v110, v110
    v_mfma_f32_16x16x32_bf16 v[164:167], v[20:23], a[116:119], v[164:167]
    v_exp_f32 v111, v111
    v_add_f32 v108, 1.0, v108
    v_add_f32 v109, 1.0, v109
    v_mfma_f32_16x16x32_bf16 v[168:171], v[16:19], a[104:107], v[168:171]
    ds_read_b64_tr_b16 v[36:37], v9 offset:18432
    ds_read_b64_tr_b16 v[38:39], v9 offset:18688
    v_add_f32 v110, 1.0, v110
    v_mfma_f32_16x16x32_bf16 v[168:171], v[20:23], a[120:123], v[168:171]
    v_rcp_f32 v108, v108
    v_add_f32 v111, 1.0, v111
    v_mfma_f32_16x16x32_bf16 v[172:175], v[16:19], a[108:111], v[172:175]
    v_rcp_f32 v109, v109
    v_mul_f32 v124, v124, v108
    v_mfma_f32_16x16x32_bf16 v[172:175], v[20:23], a[124:127], v[172:175]
    v_rcp_f32 v110, v110
    s_waitcnt lgkmcnt(4)
    v_mfma_f32_16x16x32_bf16 v[176:179], v[24:27], a[96:99], v[176:179]
    ds_read_b64_tr_b16 v[16:17], v9 offset:17408
    ds_read_b64_tr_b16 v[18:19], v9 offset:17664
    v_mul_f32 v125, v125, v109
    v_mfma_f32_16x16x32_bf16 v[176:179], v[28:31], a[112:115], v[176:179]
    v_rcp_f32 v111, v111
    v_mul_f32 v126, v126, v110
    v_mfma_f32_16x16x32_bf16 v[180:183], v[24:27], a[100:103], v[180:183]
    v_mul_f32 v127, v127, v111
    v_cvt_pk_bf16_f32 v52, v124, v125
    v_cvt_pk_bf16_f32 v53, v126, v127
    v_mfma_f32_16x16x32_bf16 v[180:183], v[28:31], a[116:119], v[180:183]
    v_mov_b32 v4, 0
    v_mov_b32 v5, 0
    v_mov_b32 v6, 0
    v_mfma_f32_16x16x32_bf16 v[184:187], v[24:27], a[104:107], v[184:187]
    ds_read_b64_tr_b16 v[20:21], v9 offset:19456
    ds_read_b64_tr_b16 v[22:23], v9 offset:19712
    v_mov_b32 v7, 0
    v_mfma_f32_16x16x32_bf16 v[184:187], v[28:31], a[120:123], v[184:187]
    v_lshrrev_b32 v64, 3, v0
    v_and_b32 v65, 0x70, v1
    s_mul_i32 s36, s3, 1152
    v_mfma_f32_16x16x32_bf16 v[188:191], v[24:27], a[108:111], v[188:191]
    s_add_u32 s37, s36, 78112
    v_add_u32 v65, s37, v65
    v_mul_u32_u24 v64, 4624, v64
    v_mfma_f32_16x16x32_bf16 v[188:191], v[28:31], a[124:127], v[188:191]
    v_add_u32 v64, v64, v65
    v_lshrrev_b32 v66, 4, v0
    s_waitcnt lgkmcnt(4)
    v_mfma_f32_16x16x32_bf16 v[160:163], v[32:35], a[128:131], v[160:163]
    ds_read_b64_tr_b16 v[24:25], v9 offset:20480
    ds_read_b64_tr_b16 v[26:27], v9 offset:20736
    ds_write_b128 v64, v[4:7]
    v_mfma_f32_16x16x32_bf16 v[160:163], v[36:39], a[144:147], v[160:163]
    ds_write_b128 v65, v[4:7] offset:36992
    v_mfma_f32_16x16x32_bf16 v[164:167], v[32:35], a[132:135], v[164:167]
    v_mfma_f32_16x16x32_bf16 v[164:167], v[36:39], a[148:151], v[164:167]
    v_mfma_f32_16x16x32_bf16 v[168:171], v[32:35], a[136:139], v[168:171]
    ds_read_b64_tr_b16 v[28:29], v9 offset:22528
    ds_read_b64_tr_b16 v[30:31], v9 offset:22784
    v_mfma_f32_16x16x32_bf16 v[168:171], v[36:39], a[152:155], v[168:171]
    v_lshrrev_b32 v64, 1, v0
    v_mfma_f32_16x16x32_bf16 v[172:175], v[32:35], a[140:143], v[172:175]
    v_min_u32 v64, 8, v64
    v_mul_u32_u24 v64, 4128, v64
    v_mfma_f32_16x16x32_bf16 v[172:175], v[36:39], a[156:159], v[172:175]
    v_and_b32 v65, 16, v1
    v_add_u32 v64, v64, v65
    s_waitcnt lgkmcnt(6)
    v_mfma_f32_16x16x32_bf16 v[176:179], v[16:19], a[128:131], v[176:179]
    ds_read_b64_tr_b16 v[32:33], v9 offset:21504
    ds_read_b64_tr_b16 v[34:35], v9 offset:21760
    ds_write_b128 v64, v[4:7] offset:40960
    v_mfma_f32_16x16x32_bf16 v[176:179], v[20:23], a[144:147], v[176:179]
    v_mfma_f32_16x16x32_bf16 v[180:183], v[16:19], a[132:135], v[180:183]
    v_bfe_u32 v64, v0, 2, 2
    v_mfma_f32_16x16x32_bf16 v[180:183], v[20:23], a[148:151], v[180:183]
    v_and_b32 v65, 3, v0
    v_lshl_add_u32 v64, v66, 3, v64
    v_mfma_f32_16x16x32_bf16 v[184:187], v[16:19], a[136:139], v[184:187]
    ds_read_b64_tr_b16 v[36:37], v9 offset:23552
    ds_read_b64_tr_b16 v[38:39], v9 offset:23808
    v_mfma_f32_16x16x32_bf16 v[184:187], v[20:23], a[152:155], v[184:187]
    v_sub_u32 v64, v65, v64
    s_add_u32 s37, s74, 192
    v_lshl_add_u32 v2, v64, 3, s37
    v_mfma_f32_16x16x32_bf16 v[188:191], v[16:19], a[140:143], v[188:191]
    v_and_b32 v67, 15, v0
    v_lshl_add_u32 v64, v66, 1, v67
    s_mul_i32 s39, s3, 4624
    s_add_u32 s39, s39, 78120
    v_mfma_f32_16x16x32_bf16 v[188:191], v[20:23], a[156:159], v[188:191]
    v_lshl_add_u32 v3, v64, 3, s39
    v_fma_f32 v10, -v128, v128, s58
    s_waitcnt lgkmcnt(5)
    v_mfma_f32_16x16x32_bf16 v[160:163], v[24:27], a[160:163], v[160:163]
    ds_read_b64_tr_b16 v[16:17], v9 offset:24576
    ds_read_b64_tr_b16 v[18:19], v9 offset:24832
    v_fma_f32 v11, -v129, v129, s58
    v_mfma_f32_16x16x32_bf16 v[160:163], v[28:31], a[176:179], v[160:163]
    v_mul_f32 v144, v144, v128
    v_mul_f32 v145, v145, v129
    v_mul_f32 v128, v10, v128
    v_mfma_f32_16x16x32_bf16 v[164:167], v[24:27], a[164:167], v[164:167]
    v_mul_f32 v129, v11, v129
    v_exp_f32 v128, v128
    v_mfma_f32_16x16x32_bf16 v[164:167], v[28:31], a[180:183], v[164:167]
    v_exp_f32 v129, v129
    v_fma_f32 v12, -v130, v130, s58
    v_mfma_f32_16x16x32_bf16 v[168:171], v[24:27], a[168:171], v[168:171]
    ds_read_b64_tr_b16 v[20:21], v9 offset:26624
    ds_read_b64_tr_b16 v[22:23], v9 offset:26880
    v_fma_f32 v13, -v131, v131, s58
    v_mul_f32 v146, v146, v130
    v_mfma_f32_16x16x32_bf16 v[168:171], v[28:31], a[184:187], v[168:171]
    v_mul_f32 v147, v147, v131
    v_mul_f32 v130, v12, v130
    v_mul_f32 v131, v13, v131
    v_mfma_f32_16x16x32_bf16 v[172:175], v[24:27], a[172:175], v[172:175]
    v_exp_f32 v130, v130
    v_add_f32 v128, 1.0, v128
    v_mfma_f32_16x16x32_bf16 v[172:175], v[28:31], a[188:191], v[172:175]
    v_add_f32 v129, 1.0, v129
    s_waitcnt lgkmcnt(4)
    s_waitcnt vmcnt(0)
    v_mfma_f32_16x16x32_bf16 v[176:179], v[32:35], a[160:163], v[176:179]
    ds_read_b64_tr_b16 v[24:25], v9 offset:25600
    ds_read_b64_tr_b16 v[26:27], v9 offset:25856
    ds_read_b64_tr_b16 v[192:193], v56 offset:0
    v_mfma_f32_16x16x32_bf16 v[176:179], v[36:39], a[176:179], v[176:179]
    ds_read_b64_tr_b16 v[194:195], v56 offset:256
    ds_read_b64_tr_b16 v[196:197], v56 offset:1024
    ds_read_b64_tr_b16 v[198:199], v56 offset:1280
    ds_read_b64_tr_b16 v[200:201], v56 offset:2048
    v_mfma_f32_16x16x32_bf16 v[180:183], v[32:35], a[164:167], v[180:183]
    ds_read_b64_tr_b16 v[202:203], v56 offset:2304
    ds_read_b64_tr_b16 v[204:205], v56 offset:3072
    v_add_f32 v130, 1.0, v130
    v_mfma_f32_16x16x32_bf16 v[180:183], v[36:39], a[180:183], v[180:183]
    ds_read_b64_tr_b16 v[206:207], v56 offset:3328
    ds_read_b64_tr_b16 v[208:209], v56 offset:4096
    v_mfma_f32_16x16x32_bf16 v[184:187], v[32:35], a[168:171], v[184:187]
    ds_read_b64_tr_b16 v[28:29], v9 offset:27648
    ds_read_b64_tr_b16 v[30:31], v9 offset:27904
    ds_read_b64_tr_b16 v[210:211], v56 offset:4352
    ds_read_b64_tr_b16 v[212:213], v56 offset:5120
    v_mfma_f32_16x16x32_bf16 v[184:187], v[36:39], a[184:187], v[184:187]
    ds_read_b64_tr_b16 v[214:215], v56 offset:5376
    v_exp_f32 v131, v131
    v_mfma_f32_16x16x32_bf16 v[188:191], v[32:35], a[172:175], v[188:191]
    ds_read_b64_tr_b16 v[216:217], v56 offset:6144
    ds_read_b64_tr_b16 v[218:219], v56 offset:6400
    v_rcp_f32 v128, v128
    v_mfma_f32_16x16x32_bf16 v[188:191], v[36:39], a[188:191], v[188:191]
    ds_read_b64_tr_b16 v[220:221], v56 offset:7168
    ds_read_b64_tr_b16 v[222:223], v56 offset:7424
    s_waitcnt lgkmcnt(15)
    v_mfma_f32_16x16x32_bf16 v[160:163], v[16:19], a[192:195], v[160:163]
    ds_read_b64_tr_b16 v[32:33], v9 offset:28672
    ds_read_b64_tr_b16 v[34:35], v9 offset:28928
    ds_write_b128 v61, v[192:195] offset:0
    v_mfma_f32_16x16x32_bf16 v[160:163], v[20:23], a[208:211], v[160:163]
    v_mfma_f32_16x16x32_bf16 v[164:167], v[16:19], a[196:199], v[164:167]
    v_add_f32 v131, 1.0, v131
    v_mfma_f32_16x16x32_bf16 v[164:167], v[20:23], a[212:215], v[164:167]
    v_rcp_f32 v129, v129
    v_mfma_f32_16x16x32_bf16 v[168:171], v[16:19], a[200:203], v[168:171]
    ds_read_b64_tr_b16 v[36:37], v9 offset:30720
    ds_read_b64_tr_b16 v[38:39], v9 offset:30976
    s_waitcnt lgkmcnt(15)
    ds_write_b128 v61, v[196:199] offset:32
    v_mfma_f32_16x16x32_bf16 v[168:171], v[20:23], a[216:219], v[168:171]
    v_rcp_f32 v130, v130
    v_rcp_f32 v131, v131
    v_pk_fma_f32 v[10:11], v[132:133], v[132:133], s[58:59] op_sel_hi:[1,1,0] neg_lo:[1,0,0] neg_hi:[1,0,0]
    v_pk_fma_f32 v[12:13], v[134:135], v[134:135], s[58:59] op_sel_hi:[1,1,0] neg_lo:[1,0,0] neg_hi:[1,0,0]
    v_pk_mul_f32 v[148:149], v[148:149], v[132:133]
    v_pk_mul_f32 v[150:151], v[150:151], v[134:135]
    v_pk_mul_f32 v[132:133], v[10:11], v[132:133]
    v_pk_mul_f32 v[134:135], v[12:13], v[134:135]
    v_pk_mul_f32 v[144:145], v[144:145], v[128:129]
    v_pk_mul_f32 v[146:147], v[146:147], v[130:131]
    v_mfma_f32_16x16x32_bf16 v[172:175], v[16:19], a[204:207], v[172:175]
    v_cvt_pk_bf16_f32 v42, v144, v145
    v_mfma_f32_16x16x32_bf16 v[172:175], v[20:23], a[220:223], v[172:175]
    v_cvt_pk_bf16_f32 v43, v146, v147
    s_waitcnt lgkmcnt(13)
    v_mfma_f32_16x16x32_bf16 v[176:179], v[24:27], a[192:195], v[176:179]
    ds_read_b64_tr_b16 v[16:17], v9 offset:29696
    ds_read_b64_tr_b16 v[18:19], v9 offset:29952
    ds_write_b128 v61, v[200:203] offset:64
    v_mfma_f32_16x16x32_bf16 v[176:179], v[28:31], a[208:211], v[176:179]
    v_mfma_f32_16x16x32_bf16 v[180:183], v[24:27], a[196:199], v[180:183]
    v_mfma_f32_16x16x32_bf16 v[180:183], v[28:31], a[212:215], v[180:183]
    ds_write_b128 v61, v[204:207] offset:96
    v_mfma_f32_16x16x32_bf16 v[184:187], v[24:27], a[200:203], v[184:187]
    ds_read_b64_tr_b16 v[20:21], v9 offset:31744
    ds_read_b64_tr_b16 v[22:23], v9 offset:32000
    v_mfma_f32_16x16x32_bf16 v[184:187], v[28:31], a[216:219], v[184:187]
    buffer_store_dwordx4 v[40:43], v1, s[8:11], s56 offen offset:0 sc1
    v_mfma_f32_16x16x32_bf16 v[188:191], v[24:27], a[204:207], v[188:191]
    v_exp_f32 v132, v132
    v_mfma_f32_16x16x32_bf16 v[188:191], v[28:31], a[220:223], v[188:191]
    s_waitcnt lgkmcnt(12)
    ds_write_b128 v61, v[208:211] offset:128
    v_add_u32 v9, 4294836224, v9
    s_waitcnt lgkmcnt(8)
    v_mfma_f32_16x16x32_bf16 v[160:163], v[32:35], a[224:227], v[160:163]
    ds_read_b64_tr_b16 v[24:25], v9 offset:0
    ds_read_b64_tr_b16 v[26:27], v9 offset:256
    v_mfma_f32_16x16x32_bf16 v[160:163], v[36:39], a[240:243], v[160:163]
    v_exp_f32 v133, v133
    v_mfma_f32_16x16x32_bf16 v[164:167], v[32:35], a[228:231], v[164:167]
    v_exp_f32 v134, v134
    v_mfma_f32_16x16x32_bf16 v[164:167], v[36:39], a[244:247], v[164:167]
    ds_write_b128 v61, v[212:215] offset:160
    v_mfma_f32_16x16x32_bf16 v[168:171], v[32:35], a[232:235], v[168:171]
    ds_read_b64_tr_b16 v[28:29], v9 offset:2048
    ds_read_b64_tr_b16 v[30:31], v9 offset:2304
    v_mfma_f32_16x16x32_bf16 v[168:171], v[36:39], a[248:251], v[168:171]
    v_exp_f32 v135, v135
    v_add_f32 v132, 1.0, v132
    v_mfma_f32_16x16x32_bf16 v[172:175], v[32:35], a[236:239], v[172:175]
    v_add_f32 v133, 1.0, v133
    v_rcp_f32 v132, v132
    v_add_f32 v134, 1.0, v134
    v_mfma_f32_16x16x32_bf16 v[172:175], v[36:39], a[252:255], v[172:175]
    ds_write_b128 v61, v[216:219] offset:192
    s_waitcnt lgkmcnt(7)
    v_mfma_f32_16x16x32_bf16 v[176:179], v[16:19], a[224:227], v[176:179]
    ds_read_b64_tr_b16 v[32:33], v9 offset:1024
    ds_read_b64_tr_b16 v[34:35], v9 offset:1280
    v_mfma_f32_16x16x32_bf16 v[176:179], v[20:23], a[240:243], v[176:179]
    v_rcp_f32 v133, v133
    v_mfma_f32_16x16x32_bf16 v[180:183], v[16:19], a[228:231], v[180:183]
    v_add_f32 v135, 1.0, v135
    v_mfma_f32_16x16x32_bf16 v[180:183], v[20:23], a[244:247], v[180:183]
    ds_write_b128 v61, v[220:223] offset:224
    v_mfma_f32_16x16x32_bf16 v[184:187], v[16:19], a[232:235], v[184:187]
    ds_read_b64_tr_b16 v[36:37], v9 offset:3072
    ds_read_b64_tr_b16 v[38:39], v9 offset:3328
    v_mfma_f32_16x16x32_bf16 v[184:187], v[20:23], a[248:251], v[184:187]
    v_rcp_f32 v134, v134
    v_rcp_f32 v135, v135
    v_pk_fma_f32 v[10:11], v[136:137], v[136:137], s[58:59] op_sel_hi:[1,1,0] neg_lo:[1,0,0] neg_hi:[1,0,0]
    v_pk_fma_f32 v[12:13], v[138:139], v[138:139], s[58:59] op_sel_hi:[1,1,0] neg_lo:[1,0,0] neg_hi:[1,0,0]
    v_pk_mul_f32 v[152:153], v[152:153], v[136:137]
    v_pk_mul_f32 v[154:155], v[154:155], v[138:139]
    v_pk_mul_f32 v[136:137], v[10:11], v[136:137]
    v_pk_mul_f32 v[138:139], v[12:13], v[138:139]
    v_pk_mul_f32 v[148:149], v[148:149], v[132:133]
    v_pk_mul_f32 v[150:151], v[150:151], v[134:135]
    v_mfma_f32_16x16x32_bf16 v[188:191], v[16:19], a[236:239], v[188:191]
    v_cvt_pk_bf16_f32 v46, v148, v149
    v_cvt_pk_bf16_f32 v47, v150, v151
    buffer_store_dwordx4 v[44:47], v1, s[8:11], s56 offen offset:1024 sc1
    v_mfma_f32_16x16x32_bf16 v[188:191], v[20:23], a[252:255], v[188:191]
    s_waitcnt lgkmcnt(6)
    s_waitcnt lgkmcnt(2)
    s_barrier
    v_mfma_f32_16x16x32_bf16 v[160:163], v[24:27], v[224:227], v[160:163]
    ds_read_b64_tr_b16 a[0:1], v2 offset:32
    ds_read_b64_tr_b16 a[2:3], v2 offset:0
    ds_read_b64_tr_b16 a[4:5], v2 offset:288
    ds_read_b64_tr_b16 a[16:17], v2 offset:1056
    ds_read_b64_tr_b16 a[18:19], v2 offset:1024
    v_mfma_f32_16x16x32_bf16 v[160:163], v[28:31], v[240:243], v[160:163]
    ds_read_b64_tr_b16 a[6:7], v2 offset:256
    ds_read_b64_tr_b16 a[8:9], v2 offset:544
    ds_read_b64_tr_b16 a[20:21], v2 offset:1312
    v_mfma_f32_16x16x32_bf16 v[164:167], v[24:27], v[228:231], v[164:167]
    ds_read_b64_tr_b16 a[10:11], v2 offset:512
    ds_read_b64_tr_b16 a[22:23], v2 offset:1280
    v_exp_f32 v136, v136
    v_mfma_f32_16x16x32_bf16 v[164:167], v[28:31], v[244:247], v[164:167]
    ds_read_b64_tr_b16 a[12:13], v2 offset:800
    ds_read_b64_tr_b16 a[14:15], v2 offset:768
    ds_read_b64_tr_b16 a[24:25], v2 offset:1568
    v_mfma_f32_16x16x32_bf16 v[168:171], v[24:27], v[232:235], v[168:171]
    ds_read_b64 a[128:129], v3 offset:0
    ds_read_b64_tr_b16 a[26:27], v2 offset:1536
    v_exp_f32 v137, v137
    v_mfma_f32_16x16x32_bf16 v[168:171], v[28:31], v[248:251], v[168:171]
    ds_read_b64 a[130:131], v3 offset:8
    ds_read_b64 a[132:133], v3 offset:64
    ds_read_b64_tr_b16 a[28:29], v2 offset:1824
    v_mfma_f32_16x16x32_bf16 v[172:175], v[24:27], v[236:239], v[172:175]
    ds_read_b64 a[134:135], v3 offset:72
    ds_read_b64_tr_b16 a[30:31], v2 offset:1792
Lpad13:
    s_cbranch_execz Lwret2
    v_exp_f32 v138, v138
    v_mfma_f32_16x16x32_bf16 v[172:175], v[28:31], v[252:255], v[172:175]
    ds_read_b64 a[136:137], v3 offset:128
    ds_read_b64 a[138:139], v3 offset:136
    s_waitcnt lgkmcnt(15)
    v_mfma_f32_16x16x32_bf16 v[176:179], v[32:35], v[224:227], v[176:179]
    ds_read_b64 a[140:141], v3 offset:192
    ds_read_b64 a[144:145], v3 offset:256
    ds_read_b64 a[146:147], v3 offset:264
    v_add_f32 v136, 1.0, v136
    v_mfma_f32_16x16x32_bf16 v[176:179], v[36:39], v[240:243], v[176:179]
    ds_read_b64 a[142:143], v3 offset:200
    ds_read_b64 a[148:149], v3 offset:320
    v_add_f32 v137, 1.0, v137
    v_mfma_f32_16x16x32_bf16 v[180:183], v[32:35], v[228:231], v[180:183]
    ds_read_b64 a[150:151], v3 offset:328
    v_exp_f32 v139, v139
    v_add_f32 v138, 1.0, v138
    v_mfma_f32_16x16x32_bf16 v[180:183], v[36:39], v[244:247], v[180:183]
    ds_read_b64 a[152:153], v3 offset:384
    v_rcp_f32 v136, v136
    v_mfma_f32_16x16x32_bf16 v[184:187], v[32:35], v[232:235], v[184:187]
    ds_read_b64 a[154:155], v3 offset:392
    v_rcp_f32 v137, v137
    v_add_f32 v139, 1.0, v139
    v_mfma_f32_16x16x32_bf16 v[184:187], v[36:39], v[248:251], v[184:187]
    ds_read_b64 a[156:157], v3 offset:448
    ds_read_b64_tr_b16 a[32:33], v2 offset:2080
    ds_read_b64_tr_b16 a[34:35], v2 offset:2048
    v_mfma_f32_16x16x32_bf16 v[188:191], v[32:35], v[236:239], v[188:191]
    ds_read_b64 a[158:159], v3 offset:456
    ds_read_b64_tr_b16 a[36:37], v2 offset:2336
    ds_read_b64_tr_b16 a[38:39], v2 offset:2304
    ds_read_b64_tr_b16 a[40:41], v2 offset:2592
    v_mfma_f32_16x16x32_bf16 v[188:191], v[36:39], v[252:255], v[188:191]
    ds_read_b64_tr_b16 a[42:43], v2 offset:2560
    ds_read_b64_tr_b16 a[44:45], v2 offset:2848
    ds_read_b64_tr_b16 a[46:47], v2 offset:2816
    s_waitcnt lgkmcnt(14)
    v_mfma_f32_16x16x32_bf16 v[64:67], a[4:7], a[128:131], 0
    v_rcp_f32 v138, v138
    v_rcp_f32 v139, v139
    v_pk_fma_f32 v[10:11], v[140:141], v[140:141], s[58:59] op_sel_hi:[1,1,0] neg_lo:[1,0,0] neg_hi:[1,0,0]
    v_pk_fma_f32 v[12:13], v[142:143], v[142:143], s[58:59] op_sel_hi:[1,1,0] neg_lo:[1,0,0] neg_hi:[1,0,0]
    v_pk_mul_f32 v[156:157], v[156:157], v[140:141]
    v_pk_mul_f32 v[158:159], v[158:159], v[142:143]
    v_pk_mul_f32 v[140:141], v[10:11], v[140:141]
    v_pk_mul_f32 v[142:143], v[12:13], v[142:143]
    v_pk_mul_f32 v[152:153], v[152:153], v[136:137]
    v_pk_mul_f32 v[154:155], v[154:155], v[138:139]
    v_mfma_f32_16x16x32_bf16 v[64:67], a[0:3], a[132:135], v[64:67]
    v_cvt_pk_bf16_f32 v50, v152, v153
    v_cvt_pk_bf16_f32 v51, v154, v155
    buffer_store_dwordx4 v[48:51], v1, s[8:11], s56 offen offset:2048 sc1
    ds_read_b64 a[160:161], v3 offset:512
    v_mfma_f32_16x16x32_bf16 v[68:71], a[12:15], a[128:131], 0
    v_exp_f32 v140, v140
    v_exp_f32 v141, v141
    ds_read_b64 a[162:163], v3 offset:520
    v_mfma_f32_16x16x32_bf16 v[68:71], a[8:11], a[132:135], v[68:71]
    v_exp_f32 v142, v142
    v_exp_f32 v143, v143
    v_add_f32 v140, 1.0, v140
    v_mfma_f32_16x16x32_bf16 v[68:71], a[4:7], a[136:139], v[68:71]
    v_add_f32 v141, 1.0, v141
    v_rcp_f32 v140, v140
    v_rcp_f32 v141, v141
    v_mfma_f32_16x16x32_bf16 v[68:71], a[0:3], a[140:143], v[68:71]
    v_add_f32 v142, 1.0, v142
    v_add_f32 v143, 1.0, v143
    v_rcp_f32 v142, v142
    s_waitcnt lgkmcnt(8)
    v_mfma_f32_16x16x32_bf16 v[72:75], a[20:23], a[128:131], 0
    v_rcp_f32 v143, v143
    v_mul_f32 v156, v156, v140
    v_mul_f32 v157, v157, v141
    v_mul_f32 v158, v158, v142
    v_mfma_f32_16x16x32_bf16 v[72:75], a[16:19], a[132:135], v[72:75]
    v_mul_f32 v159, v159, v143
    v_cvt_pk_bf16_f32 v54, v156, v157
    v_cvt_pk_bf16_f32 v55, v158, v159
    buffer_store_dwordx4 v[52:55], v1, s[8:11], s56 offen offset:3072 sc1
    v_mfma_f32_16x16x32_bf16 v[72:75], a[12:15], a[136:139], v[72:75]
    ds_read_b64 a[164:165], v3 offset:576
    ds_read_b64 a[166:167], v3 offset:584
    v_mfma_f32_16x16x32_bf16 v[72:75], a[8:11], a[140:143], v[72:75]
    ds_read_b64 a[168:169], v3 offset:640
    ds_read_b64 a[170:171], v3 offset:648
    v_mfma_f32_16x16x32_bf16 v[72:75], a[4:7], a[144:147], v[72:75]
    ds_read_b64 a[172:173], v3 offset:704
    ds_read_b64_tr_b16 a[48:49], v2 offset:3104
    v_mfma_f32_16x16x32_bf16 v[72:75], a[0:3], a[148:151], v[72:75]
    ds_read_b64 a[174:175], v3 offset:712
    ds_read_b64_tr_b16 a[50:51], v2 offset:3072
    v_mfma_f32_16x16x32_bf16 v[76:79], a[28:31], a[128:131], 0
    ds_read_b64_tr_b16 a[52:53], v2 offset:3360
    ds_read_b64_tr_b16 a[54:55], v2 offset:3328
    v_mfma_f32_16x16x32_bf16 v[76:79], a[24:27], a[132:135], v[76:79]
    ds_read_b64_tr_b16 a[56:57], v2 offset:3616
    ds_read_b64_tr_b16 a[58:59], v2 offset:3584
    v_mfma_f32_16x16x32_bf16 v[76:79], a[20:23], a[136:139], v[76:79]
    ds_read_b64_tr_b16 a[60:61], v2 offset:3872
    ds_read_b64_tr_b16 a[62:63], v2 offset:3840
    v_mfma_f32_16x16x32_bf16 v[76:79], a[16:19], a[140:143], v[76:79]
    v_lshrrev_b32 v16, 4, v0
    v_mul_u32_u24 v16, 73728, v16
    v_mfma_f32_16x16x32_bf16 v[76:79], a[12:15], a[144:147], v[76:79]
    ds_read_b64 a[176:177], v3 offset:768
    v_bfe_u32 v17, v0, 2, 2
    v_mfma_f32_16x16x32_bf16 v[76:79], a[8:11], a[148:151], v[76:79]
    ds_read_b64 a[178:179], v3 offset:776
    v_lshl_add_u32 v16, v17, 10, v16
    v_mfma_f32_16x16x32_bf16 v[76:79], a[4:7], a[152:155], v[76:79]
    ds_read_b64 a[180:181], v3 offset:832
    v_and_b32 v17, 3, v0
    v_mfma_f32_16x16x32_bf16 v[76:79], a[0:3], a[156:159], v[76:79]
    ds_read_b64 a[182:183], v3 offset:840
    s_waitcnt lgkmcnt(11)
    v_mfma_f32_16x16x32_bf16 v[80:83], a[36:39], a[128:131], 0
    ds_read_b64 a[184:185], v3 offset:896
    ds_read_b64 a[186:187], v3 offset:904
    v_mfma_f32_16x16x32_bf16 v[80:83], a[32:35], a[132:135], v[80:83]
    ds_read_b64 a[188:189], v3 offset:960
    ds_read_b64 a[190:191], v3 offset:968
    v_mfma_f32_16x16x32_bf16 v[80:83], a[28:31], a[136:139], v[80:83]
    v_lshl_add_u32 v16, v17, 6, v16
    s_add_u32 s38, s36, 115232
    v_mfma_f32_16x16x32_bf16 v[80:83], a[24:27], a[140:143], v[80:83]
    v_lshl_add_u32 v17, v0, 1, s38
    v_cmp_eq_u32 s[42:43], 63, v0
    v_mfma_f32_16x16x32_bf16 v[80:83], a[20:23], a[144:147], v[80:83]
    s_sub_u32 s37, 74016, s74
    v_add_u32 v18, s37, v2
    v_mfma_f32_16x16x32_bf16 v[80:83], a[16:19], a[148:151], v[80:83]
    v_lshrrev_b32 v34, 4, v0
    v_and_b32 v35, 15, v0
    v_mfma_f32_16x16x32_bf16 v[80:83], a[12:15], a[152:155], v[80:83]
    v_lshl_add_u32 v32, v34, 1, v35
    s_add_u32 s37, s36, 115112
    v_mfma_f32_16x16x32_bf16 v[80:83], a[8:11], a[156:159], v[80:83]
    v_lshl_add_u32 v20, v32, 3, s37
    v_and_b32 v33, 2, v34
    v_mfma_f32_16x16x32_bf16 v[80:83], a[4:7], a[160:163], v[80:83]
    v_xor_b32 v32, v0, v33
    v_lshl_add_u32 v25, v32, 3, s74
    v_mfma_f32_16x16x32_bf16 v[80:83], a[0:3], a[164:167], v[80:83]
    v_lshlrev_b32 v33, 2, v33
    v_xor_b32 v32, v0, v33
    v_mfma_f32_16x16x32_bf16 v[84:87], a[44:47], a[128:131], 0
    s_mul_i32 s37, s3, 8208
    s_add_u32 s37, s37, 119744
    v_mfma_f32_16x16x32_bf16 v[84:87], a[40:43], a[132:135], v[84:87]
    v_lshl_add_u32 v26, v32, 4, s37
    v_subrev_u32 v29, 16, v26
    v_mfma_f32_16x16x32_bf16 v[84:87], a[36:39], a[136:139], v[84:87]
    v_subrev_u32 v32, 16, v0
    v_add_u32 v33, 47, v0
    v_mfma_f32_16x16x32_bf16 v[84:87], a[32:35], a[140:143], v[84:87]
    v_cmp_gt_u32 vcc, 16, v0
    s_movk_i32 s37, 252
    v_mfma_f32_16x16x32_bf16 v[84:87], a[28:31], a[144:147], v[84:87]
    v_add_u32 v3, 1152, v3
    ds_read_b64 a[192:193], v3 offset:0
    v_mfma_f32_16x16x32_bf16 v[84:87], a[24:27], a[148:151], v[84:87]
    ds_read_b64 a[194:195], v3 offset:8
    ds_read_b64 a[196:197], v3 offset:64
    v_mfma_f32_16x16x32_bf16 v[84:87], a[20:23], a[152:155], v[84:87]
    ds_read_b64 a[198:199], v3 offset:72
    ds_read_b64 a[200:201], v3 offset:128
    v_mfma_f32_16x16x32_bf16 v[84:87], a[16:19], a[156:159], v[84:87]
    ds_read_b64 a[202:203], v3 offset:136
    v_cndmask_b32 v32, v32, v33, vcc
    v_mfma_f32_16x16x32_bf16 v[84:87], a[12:15], a[160:163], v[84:87]
    ds_read_b64 a[204:205], v3 offset:192
    ds_read_b64 a[206:207], v3 offset:200
    v_mfma_f32_16x16x32_bf16 v[84:87], a[8:11], a[164:167], v[84:87]
    ds_read_b64 a[208:209], v3 offset:256
    v_lshlrev_b32 v27, 2, v32
    v_mfma_f32_16x16x32_bf16 v[84:87], a[4:7], a[168:171], v[84:87]
    ds_read_b64 a[210:211], v3 offset:264
    ds_read_b64 a[212:213], v3 offset:320
    v_mfma_f32_16x16x32_bf16 v[84:87], a[0:3], a[172:175], v[84:87]
    ds_read_b64 a[214:215], v3 offset:328
    s_waitcnt lgkmcnt(12)
    v_mfma_f32_16x16x32_bf16 v[88:91], a[52:55], a[128:131], 0
    ds_read_b64 a[216:217], v3 offset:384
    ds_read_b64 a[218:219], v3 offset:392
    v_mfma_f32_16x16x32_bf16 v[88:91], a[48:51], a[132:135], v[88:91]
    ds_read_b64 a[220:221], v3 offset:448
    v_writelane_b32 v27, s37, 0
    v_mfma_f32_16x16x32_bf16 v[88:91], a[44:47], a[136:139], v[88:91]
    ds_read_b64 a[222:223], v3 offset:456
    ds_read_b64 a[224:225], v3 offset:512
    v_mfma_f32_16x16x32_bf16 v[88:91], a[40:43], a[140:143], v[88:91]
    ds_read_b64 a[226:227], v3 offset:520
    s_lshl_b32 s37, s3, 6
    v_mfma_f32_16x16x32_bf16 v[88:91], a[36:39], a[144:147], v[88:91]
    ds_read_b64 a[228:229], v3 offset:576
    ds_read_b64 a[230:231], v3 offset:584
    v_mfma_f32_16x16x32_bf16 v[88:91], a[32:35], a[148:151], v[88:91]
    ds_read_b64 a[232:233], v3 offset:640
    v_add_u32 v35, s37, v0
    v_mfma_f32_16x16x32_bf16 v[88:91], a[28:31], a[152:155], v[88:91]
    ds_read_b64 a[234:235], v3 offset:648
    ds_read_b64 a[236:237], v3 offset:704
    v_mfma_f32_16x16x32_bf16 v[88:91], a[24:27], a[156:159], v[88:91]
    ds_read_b64 a[238:239], v3 offset:712
    v_bfe_u32 v32, v35, 1, 4
    v_mfma_f32_16x16x32_bf16 v[88:91], a[20:23], a[160:163], v[88:91]
    ds_read_b64 a[240:241], v3 offset:768
    ds_read_b64 a[242:243], v3 offset:776
    v_mfma_f32_16x16x32_bf16 v[88:91], a[16:19], a[164:167], v[88:91]
    ds_read_b64 a[244:245], v3 offset:832
    s_waitcnt vmcnt(0)
    v_mfma_f32_16x16x32_bf16 v[88:91], a[12:15], a[168:171], v[88:91]
    buffer_store_dword v15, v14, s[8:11], 0 offen offset:4 sc1
    v_mfma_f32_16x16x32_bf16 v[88:91], a[8:11], a[172:175], v[88:91]
    ds_read_b64 a[246:247], v3 offset:840
    ds_read_b64 a[248:249], v3 offset:896
    v_mfma_f32_16x16x32_bf16 v[88:91], a[4:7], a[176:179], v[88:91]
    ds_read_b64 a[250:251], v3 offset:904
    ds_read_b64 a[252:253], v3 offset:960
    v_mfma_f32_16x16x32_bf16 v[88:91], a[0:3], a[180:183], v[88:91]
    ds_read_b64 a[254:255], v3 offset:968
    v_and_b32 v33, 1, v35
    v_mfma_f32_16x16x32_bf16 v[92:95], a[60:63], a[128:131], 0
    buffer_load_ushort v36, v16, s[8:11], s71 offen
    v_mfma_f32_16x16x32_bf16 v[92:95], a[56:59], a[132:135], v[92:95]
    s_add_u32 s71, s71, 294912
    v_mul_u32_u24 v33, 40, v33
    v_mfma_f32_16x16x32_bf16 v[92:95], a[52:55], a[136:139], v[92:95]
    v_xor_b32 v32, v32, v33
    v_lshrrev_b32 v33, 5, v35
    v_mfma_f32_16x16x32_bf16 v[92:95], a[48:51], a[140:143], v[92:95]
    v_lshl_add_u32 v32, v33, 6, v32
    v_lshlrev_b32 v32, 4, v32
    v_mfma_f32_16x16x32_bf16 v[92:95], a[44:47], a[144:147], v[92:95]
    v_add_u32 v28, 119744, v32
    v_subrev_u32 v35, 1, v35
    v_mfma_f32_16x16x32_bf16 v[92:95], a[40:43], a[148:151], v[92:95]
    v_bfe_u32 v32, v35, 1, 4
    v_and_b32 v33, 1, v35
    v_mfma_f32_16x16x32_bf16 v[92:95], a[36:39], a[152:155], v[92:95]
    v_mul_u32_u24 v33, 40, v33
    v_xor_b32 v32, v32, v33
    v_mfma_f32_16x16x32_bf16 v[92:95], a[32:35], a[156:159], v[92:95]
    v_ashrrev_i32 v33, 5, v35
    v_lshl_add_u32 v32, v33, 6, v32
    v_mfma_f32_16x16x32_bf16 v[92:95], a[28:31], a[160:163], v[92:95]
    v_lshlrev_b32 v32, 4, v32
    v_add_u32 v32, 120000, v32
    v_mfma_f32_16x16x32_bf16 v[92:95], a[24:27], a[164:167], v[92:95]
    v_max_u32 v24, 119728, v32
    v_bfe_u32 v32, v0, 2, 2
    v_mfma_f32_16x16x32_bf16 v[92:95], a[20:23], a[168:171], v[92:95]
    v_mul_u32_u24 v32, 4128, v32
    v_and_b32 v33, 3, v0
    v_mfma_f32_16x16x32_bf16 v[92:95], a[16:19], a[172:175], v[92:95]
    v_lshl_add_u32 v32, v33, 7, v32
    v_and_b32 v33, 2, v0
    v_mfma_f32_16x16x32_bf16 v[92:95], a[12:15], a[176:179], v[92:95]
    buffer_load_ushort v37, v16, s[8:11], s71 offen
    v_mfma_f32_16x16x32_bf16 v[92:95], a[8:11], a[180:183], v[92:95]
    s_add_u32 s71, s71, 294912
    v_xor_b32 v33, v33, v34
    v_mfma_f32_16x16x32_bf16 v[92:95], a[4:7], a[184:187], v[92:95]
    v_lshl_add_u32 v32, v33, 3, v32
    s_lshl_b32 s37, s3, 5
    v_mfma_f32_16x16x32_bf16 v[92:95], a[0:3], a[188:191], v[92:95]
    s_add_u32 s37, s37, 40992
    s_waitcnt lgkmcnt(0)
    v_mfma_f32_16x16x32_bf16 v[96:99], a[4:7], a[192:195], 0
    v_add_u32 v30, s37, v32
    s_lshl_b32 s37, s78, 15
    v_mfma_f32_16x16x32_bf16 v[96:99], a[0:3], a[196:199], v[96:99]
    s_add_u32 s37, s37, s33
    s_add_u32 s70, s37, 2621440
    v_mfma_f32_16x16x32_bf16 v[100:103], a[12:15], a[192:195], 0
    v_mov_b32 v31, 2146435072
    v_writelane_b32 v31, s77, 0
    v_mfma_f32_16x16x32_bf16 v[100:103], a[8:11], a[196:199], v[100:103]
    v_add_u32 v3, 1152, v3
    ds_read_b64 a[128:129], v3 offset:0
    v_mfma_f32_16x16x32_bf16 v[100:103], a[4:7], a[200:203], v[100:103]
    ds_read_b64 a[130:131], v3 offset:8
    ds_read_b64 a[132:133], v3 offset:64
    v_mfma_f32_16x16x32_bf16 v[100:103], a[0:3], a[204:207], v[100:103]
    ds_read_b64 a[134:135], v3 offset:72
    ds_read_b64 a[136:137], v3 offset:128
    v_mfma_f32_16x16x32_bf16 v[104:107], a[20:23], a[192:195], 0
    ds_read_b64 a[138:139], v3 offset:136
    v_fma_f32 v10, -v160, v160, s58
    v_mfma_f32_16x16x32_bf16 v[104:107], a[16:19], a[196:199], v[104:107]
    ds_read_b64 a[140:141], v3 offset:192
    ds_read_b64 a[142:143], v3 offset:200
    v_mfma_f32_16x16x32_bf16 v[104:107], a[12:15], a[200:203], v[104:107]
    buffer_load_ushort v38, v16, s[8:11], s71 offen
    v_mfma_f32_16x16x32_bf16 v[104:107], a[8:11], a[204:207], v[104:107]
    s_add_u32 s71, s71, 294912
    ds_read_b64 a[144:145], v3 offset:256
    v_mfma_f32_16x16x32_bf16 v[104:107], a[4:7], a[208:211], v[104:107]
    ds_read_b64 a[146:147], v3 offset:264
    ds_read_b64 a[148:149], v3 offset:320
    v_mfma_f32_16x16x32_bf16 v[104:107], a[0:3], a[212:215], v[104:107]
    ds_read_b64 a[150:151], v3 offset:328
    ds_read_b64 a[152:153], v3 offset:384
    v_mfma_f32_16x16x32_bf16 v[108:111], a[28:31], a[192:195], 0
    ds_read_b64 a[154:155], v3 offset:392
    v_fma_f32 v11, -v161, v161, s58
    v_mfma_f32_16x16x32_bf16 v[108:111], a[24:27], a[196:199], v[108:111]
    ds_read_b64 a[156:157], v3 offset:448
    ds_read_b64 a[158:159], v3 offset:456
    v_mfma_f32_16x16x32_bf16 v[108:111], a[20:23], a[200:203], v[108:111]
    ds_read_b64 a[160:161], v3 offset:512
    v_mul_f32 v176, v176, v160
    v_mfma_f32_16x16x32_bf16 v[108:111], a[16:19], a[204:207], v[108:111]
    ds_read_b64 a[162:163], v3 offset:520
    ds_read_b64 a[164:165], v3 offset:576
    v_mfma_f32_16x16x32_bf16 v[108:111], a[12:15], a[208:211], v[108:111]
    ds_read_b64 a[166:167], v3 offset:584
    v_mul_f32 v177, v177, v161
    v_mfma_f32_16x16x32_bf16 v[108:111], a[8:11], a[212:215], v[108:111]
    ds_read_b64 a[168:169], v3 offset:640
    ds_read_b64 a[170:171], v3 offset:648
    v_mfma_f32_16x16x32_bf16 v[108:111], a[4:7], a[216:219], v[108:111]
    ds_read_b64 a[172:173], v3 offset:704
    v_mul_f32 v160, v10, v160
    v_mfma_f32_16x16x32_bf16 v[108:111], a[0:3], a[220:223], v[108:111]
    ds_read_b64 a[174:175], v3 offset:712
    ds_read_b64 a[176:177], v3 offset:768
    v_mfma_f32_16x16x32_bf16 v[112:115], a[36:39], a[192:195], 0
    buffer_load_ushort v39, v16, s[8:11], s71 offen
    v_mfma_f32_16x16x32_bf16 v[112:115], a[32:35], a[196:199], v[112:115]
    s_add_u32 s71, s71, 294912
    ds_read_b64 a[178:179], v3 offset:776
    v_mfma_f32_16x16x32_bf16 v[112:115], a[28:31], a[200:203], v[112:115]
    ds_read_b64 a[180:181], v3 offset:832
    ds_read_b64 a[182:183], v3 offset:840
    v_mfma_f32_16x16x32_bf16 v[112:115], a[24:27], a[204:207], v[112:115]
    ds_read_b64 a[184:185], v3 offset:896
    ds_read_b64 a[186:187], v3 offset:904
    v_mfma_f32_16x16x32_bf16 v[112:115], a[20:23], a[208:211], v[112:115]
    ds_read_b64 a[188:189], v3 offset:960
    v_mul_f32 v161, v11, v161
    v_mfma_f32_16x16x32_bf16 v[112:115], a[16:19], a[212:215], v[112:115]
    ds_read_b64 a[190:191], v3 offset:968
    v_fma_f32 v12, -v162, v162, s58
    v_mfma_f32_16x16x32_bf16 v[112:115], a[12:15], a[216:219], v[112:115]
    v_exp_f32 v160, v160
    v_mfma_f32_16x16x32_bf16 v[112:115], a[8:11], a[220:223], v[112:115]
    v_exp_f32 v161, v161
    v_mfma_f32_16x16x32_bf16 v[112:115], a[4:7], a[224:227], v[112:115]
    v_fma_f32 v13, -v163, v163, s58
    v_mul_f32 v178, v178, v162
    v_mfma_f32_16x16x32_bf16 v[112:115], a[0:3], a[228:231], v[112:115]
    v_mul_f32 v179, v179, v163
    v_mul_f32 v162, v12, v162
    v_mfma_f32_16x16x32_bf16 v[116:119], a[44:47], a[192:195], 0
    v_mul_f32 v163, v13, v163
    v_add_f32 v160, 1.0, v160
    v_mfma_f32_16x16x32_bf16 v[116:119], a[40:43], a[196:199], v[116:119]
    v_exp_f32 v162, v162
    v_mfma_f32_16x16x32_bf16 v[116:119], a[36:39], a[200:203], v[116:119]
    buffer_load_ushort v57, v16, s[8:11], s71 offen
    v_mfma_f32_16x16x32_bf16 v[116:119], a[32:35], a[204:207], v[116:119]
    s_add_u32 s71, s71, 294912
    v_add_f32 v161, 1.0, v161
    v_mfma_f32_16x16x32_bf16 v[116:119], a[28:31], a[208:211], v[116:119]
    v_exp_f32 v163, v163
    v_mfma_f32_16x16x32_bf16 v[116:119], a[24:27], a[212:215], v[116:119]
    v_rcp_f32 v160, v160
    v_mfma_f32_16x16x32_bf16 v[116:119], a[20:23], a[216:219], v[116:119]
    v_rcp_f32 v161, v161
    v_mfma_f32_16x16x32_bf16 v[116:119], a[16:19], a[220:223], v[116:119]
    v_add_f32 v162, 1.0, v162
    v_add_f32 v163, 1.0, v163
    v_mfma_f32_16x16x32_bf16 v[116:119], a[12:15], a[224:227], v[116:119]
    v_rcp_f32 v162, v162
    v_rcp_f32 v163, v163
    v_pk_fma_f32 v[10:11], v[164:165], v[164:165], s[58:59] op_sel_hi:[1,1,0] neg_lo:[1,0,0] neg_hi:[1,0,0]
    v_pk_fma_f32 v[12:13], v[166:167], v[166:167], s[58:59] op_sel_hi:[1,1,0] neg_lo:[1,0,0] neg_hi:[1,0,0]
    v_pk_mul_f32 v[180:181], v[180:181], v[164:165]
    v_pk_mul_f32 v[182:183], v[182:183], v[166:167]
    v_pk_mul_f32 v[164:165], v[10:11], v[164:165]
    v_pk_mul_f32 v[166:167], v[12:13], v[166:167]
    v_pk_mul_f32 v[176:177], v[176:177], v[160:161]
    v_pk_mul_f32 v[178:179], v[178:179], v[162:163]
    v_mfma_f32_16x16x32_bf16 v[116:119], a[8:11], a[228:231], v[116:119]
    v_cvt_pk_bf16_f32 v40, v176, v177
    v_cvt_pk_bf16_f32 v41, v178, v179
    v_mfma_f32_16x16x32_bf16 v[116:119], a[4:7], a[232:235], v[116:119]
    v_exp_f32 v164, v164
    v_mfma_f32_16x16x32_bf16 v[116:119], a[0:3], a[236:239], v[116:119]
    v_exp_f32 v165, v165
    v_mfma_f32_16x16x32_bf16 v[120:123], a[52:55], a[192:195], 0
    v_exp_f32 v166, v166
    v_mfma_f32_16x16x32_bf16 v[120:123], a[48:51], a[196:199], v[120:123]
    v_exp_f32 v167, v167
    v_mfma_f32_16x16x32_bf16 v[120:123], a[44:47], a[200:203], v[120:123]
    buffer_load_ushort v58, v16, s[8:11], s71 offen
    v_mfma_f32_16x16x32_bf16 v[120:123], a[40:43], a[204:207], v[120:123]
    s_add_u32 s71, s71, 294912
    v_add_f32 v164, 1.0, v164
    v_mfma_f32_16x16x32_bf16 v[120:123], a[36:39], a[208:211], v[120:123]
    v_add_f32 v165, 1.0, v165
    v_add_f32 v166, 1.0, v166
    v_mfma_f32_16x16x32_bf16 v[120:123], a[32:35], a[212:215], v[120:123]
    v_rcp_f32 v164, v164
    v_mfma_f32_16x16x32_bf16 v[120:123], a[28:31], a[216:219], v[120:123]
    v_rcp_f32 v165, v165
    v_mfma_f32_16x16x32_bf16 v[120:123], a[24:27], a[220:223], v[120:123]
    v_add_f32 v167, 1.0, v167
    v_mfma_f32_16x16x32_bf16 v[120:123], a[20:23], a[224:227], v[120:123]
    v_rcp_f32 v166, v166
    v_rcp_f32 v167, v167
    v_pk_fma_f32 v[10:11], v[168:169], v[168:169], s[58:59] op_sel_hi:[1,1,0] neg_lo:[1,0,0] neg_hi:[1,0,0]
    v_pk_fma_f32 v[12:13], v[170:171], v[170:171], s[58:59] op_sel_hi:[1,1,0] neg_lo:[1,0,0] neg_hi:[1,0,0]
    v_pk_mul_f32 v[184:185], v[184:185], v[168:169]
    v_pk_mul_f32 v[186:187], v[186:187], v[170:171]
    v_pk_mul_f32 v[168:169], v[10:11], v[168:169]
    v_pk_mul_f32 v[170:171], v[12:13], v[170:171]
    v_pk_mul_f32 v[180:181], v[180:181], v[164:165]
    v_pk_mul_f32 v[182:183], v[182:183], v[166:167]
    v_mfma_f32_16x16x32_bf16 v[120:123], a[16:19], a[228:231], v[120:123]
    v_cvt_pk_bf16_f32 v42, v180, v181
    v_cvt_pk_bf16_f32 v43, v182, v183
    v_mfma_f32_16x16x32_bf16 v[120:123], a[12:15], a[232:235], v[120:123]
    v_exp_f32 v168, v168
    v_mfma_f32_16x16x32_bf16 v[120:123], a[8:11], a[236:239], v[120:123]
    v_exp_f32 v169, v169
    v_mfma_f32_16x16x32_bf16 v[120:123], a[4:7], a[240:243], v[120:123]
    v_exp_f32 v170, v170
    v_mfma_f32_16x16x32_bf16 v[120:123], a[0:3], a[244:247], v[120:123]
    v_exp_f32 v171, v171
    v_mfma_f32_16x16x32_bf16 v[124:127], a[60:63], a[192:195], 0
    buffer_load_ushort v59, v16, s[8:11], s71 offen
    v_mfma_f32_16x16x32_bf16 v[124:127], a[56:59], a[196:199], v[124:127]
    s_add_u32 s71, s71, 294912
    v_add_f32 v168, 1.0, v168
    v_mfma_f32_16x16x32_bf16 v[124:127], a[52:55], a[200:203], v[124:127]
    v_add_f32 v169, 1.0, v169
    v_add_f32 v170, 1.0, v170
    v_mfma_f32_16x16x32_bf16 v[124:127], a[48:51], a[204:207], v[124:127]
    v_rcp_f32 v168, v168
    v_mfma_f32_16x16x32_bf16 v[124:127], a[44:47], a[208:211], v[124:127]
    v_rcp_f32 v169, v169
    v_mfma_f32_16x16x32_bf16 v[124:127], a[40:43], a[212:215], v[124:127]
    v_add_f32 v171, 1.0, v171
    v_mfma_f32_16x16x32_bf16 v[124:127], a[36:39], a[216:219], v[124:127]
    v_rcp_f32 v170, v170
    v_rcp_f32 v171, v171
    v_pk_fma_f32 v[10:11], v[172:173], v[172:173], s[58:59] op_sel_hi:[1,1,0] neg_lo:[1,0,0] neg_hi:[1,0,0]
    v_pk_fma_f32 v[12:13], v[174:175], v[174:175], s[58:59] op_sel_hi:[1,1,0] neg_lo:[1,0,0] neg_hi:[1,0,0]
    v_pk_mul_f32 v[188:189], v[188:189], v[172:173]
    v_pk_mul_f32 v[190:191], v[190:191], v[174:175]
    v_pk_mul_f32 v[172:173], v[10:11], v[172:173]
    v_pk_mul_f32 v[174:175], v[12:13], v[174:175]
    v_pk_mul_f32 v[184:185], v[184:185], v[168:169]
    v_pk_mul_f32 v[186:187], v[186:187], v[170:171]
    v_mfma_f32_16x16x32_bf16 v[124:127], a[32:35], a[220:223], v[124:127]
    v_cvt_pk_bf16_f32 v44, v184, v185
    v_cvt_pk_bf16_f32 v45, v186, v187
    v_mfma_f32_16x16x32_bf16 v[124:127], a[28:31], a[224:227], v[124:127]
    v_exp_f32 v172, v172
    v_mfma_f32_16x16x32_bf16 v[124:127], a[24:27], a[228:231], v[124:127]
    v_exp_f32 v173, v173
    v_mfma_f32_16x16x32_bf16 v[124:127], a[20:23], a[232:235], v[124:127]
    v_exp_f32 v174, v174
    v_mfma_f32_16x16x32_bf16 v[124:127], a[16:19], a[236:239], v[124:127]
    v_exp_f32 v175, v175
    v_mfma_f32_16x16x32_bf16 v[124:127], a[12:15], a[240:243], v[124:127]
    buffer_load_ushort v60, v16, s[8:11], s71 offen
    v_mfma_f32_16x16x32_bf16 v[124:127], a[8:11], a[244:247], v[124:127]
    v_add_f32 v172, 1.0, v172
    v_add_f32 v173, 1.0, v173
    v_mfma_f32_16x16x32_bf16 v[124:127], a[4:7], a[248:251], v[124:127]
    v_rcp_f32 v172, v172
    v_mfma_f32_16x16x32_bf16 v[124:127], a[0:3], a[252:255], v[124:127]
    v_add_f32 v174, 1.0, v174
    s_waitcnt lgkmcnt(0)
    v_mfma_f32_16x16x32_bf16 v[192:195], a[4:7], a[128:131], 0
    v_rcp_f32 v173, v173
    v_mfma_f32_16x16x32_bf16 v[192:195], a[0:3], a[132:135], v[192:195]
    v_add_f32 v175, 1.0, v175
    v_mul_f32 v188, v188, v172
    v_mfma_f32_16x16x32_bf16 v[196:199], a[12:15], a[128:131], 0
    v_rcp_f32 v174, v174
    v_mfma_f32_16x16x32_bf16 v[196:199], a[8:11], a[132:135], v[196:199]
    v_rcp_f32 v175, v175
    v_mfma_f32_16x16x32_bf16 v[196:199], a[4:7], a[136:139], v[196:199]
    v_mul_f32 v189, v189, v173
    v_mul_f32 v190, v190, v174
    v_mfma_f32_16x16x32_bf16 v[196:199], a[0:3], a[140:143], v[196:199]
    v_add_f32 v65, v65, v96
    v_add_f32 v66, v66, v97
    v_mfma_f32_16x16x32_bf16 v[200:203], a[20:23], a[128:131], 0
    v_add_f32 v67, v67, v98
    v_add_f32 v69, v69, v100
    v_mfma_f32_16x16x32_bf16 v[200:203], a[16:19], a[132:135], v[200:203]
    v_add_f32 v70, v70, v101
    v_add_f32 v71, v71, v102
    v_mfma_f32_16x16x32_bf16 v[200:203], a[12:15], a[136:139], v[200:203]
    s_add_u32 m0, s74, 16512
    s_add_u32 s72, s72, 16384
    v_mfma_f32_16x16x32_bf16 v[200:203], a[8:11], a[140:143], v[200:203]
    buffer_load_dwordx4 v63, s[8:11], s72 offen offset:0 sc1 lds
    v_mfma_f32_16x16x32_bf16 v[200:203], a[4:7], a[144:147], v[200:203]
    buffer_load_dwordx4 v63, s[8:11], s72 offen offset:1024 sc1 lds
    v_mfma_f32_16x16x32_bf16 v[200:203], a[0:3], a[148:151], v[200:203]
    buffer_load_dwordx4 v63, s[8:11], s72 offen offset:2048 sc1 lds
    v_mfma_f32_16x16x32_bf16 v[204:207], a[28:31], a[128:131], 0
    buffer_load_dwordx4 v63, s[8:11], s72 offen offset:3072 sc1 lds
    v_mfma_f32_16x16x32_bf16 v[204:207], a[24:27], a[132:135], v[204:207]
    v_add_f32 v73, v73, v104
    v_add_f32 v74, v74, v105
    v_mfma_f32_16x16x32_bf16 v[204:207], a[20:23], a[136:139], v[204:207]
    v_add_f32 v75, v75, v106
    v_add_f32 v77, v77, v108
    v_mfma_f32_16x16x32_bf16 v[204:207], a[16:19], a[140:143], v[204:207]
    v_add_f32 v78, v78, v109
    v_add_f32 v79, v79, v110
    v_mfma_f32_16x16x32_bf16 v[204:207], a[12:15], a[144:147], v[204:207]
    v_add_f32 v81, v81, v112
    v_add_f32 v82, v82, v113
    v_mfma_f32_16x16x32_bf16 v[204:207], a[8:11], a[148:151], v[204:207]
    v_add_f32 v83, v83, v114
    v_add_f32 v85, v85, v116
    v_mfma_f32_16x16x32_bf16 v[204:207], a[4:7], a[152:155], v[204:207]
    v_add_f32 v86, v86, v117
    v_add_f32 v87, v87, v118
    v_mfma_f32_16x16x32_bf16 v[204:207], a[0:3], a[156:159], v[204:207]
    v_add_f32 v89, v89, v120
    v_add_f32 v90, v90, v121
    v_mfma_f32_16x16x32_bf16 v[208:211], a[36:39], a[128:131], 0
    v_add_f32 v91, v91, v122
    v_add_f32 v93, v93, v124
    v_mfma_f32_16x16x32_bf16 v[208:211], a[32:35], a[132:135], v[208:211]
    v_add_f32 v94, v94, v125
    v_add_f32 v95, v95, v126
    v_mfma_f32_16x16x32_bf16 v[208:211], a[28:31], a[136:139], v[208:211]
    v_mul_f32 v191, v191, v175
    v_cvt_pk_bf16_f32 v46, v188, v189
    v_mfma_f32_16x16x32_bf16 v[208:211], a[24:27], a[140:143], v[208:211]
    v_cvt_pk_bf16_f32 v47, v190, v191
    v_add_u32 v3, 1152, v3
    v_mfma_f32_16x16x32_bf16 v[208:211], a[20:23], a[144:147], v[208:211]
    ds_read_b64 a[192:193], v3 offset:0
    ds_read_b64 a[194:195], v3 offset:8
    v_mfma_f32_16x16x32_bf16 v[208:211], a[16:19], a[148:151], v[208:211]
    ds_read_b64 a[196:197], v3 offset:64
    ds_read_b64 a[198:199], v3 offset:72
    v_mfma_f32_16x16x32_bf16 v[208:211], a[12:15], a[152:155], v[208:211]
    ds_read_b64 a[200:201], v3 offset:128
    ds_read_b64 a[202:203], v3 offset:136
    v_mfma_f32_16x16x32_bf16 v[208:211], a[8:11], a[156:159], v[208:211]
    ds_read_b64 a[204:205], v3 offset:192
    ds_read_b64 a[206:207], v3 offset:200
    v_mfma_f32_16x16x32_bf16 v[208:211], a[4:7], a[160:163], v[208:211]
    ds_read_b64 a[208:209], v3 offset:256
    ds_read_b64 a[210:211], v3 offset:264
    v_mfma_f32_16x16x32_bf16 v[208:211], a[0:3], a[164:167], v[208:211]
    ds_read_b64 a[212:213], v3 offset:320
    ds_read_b64 a[214:215], v3 offset:328
    v_mfma_f32_16x16x32_bf16 v[212:215], a[44:47], a[128:131], 0
    ds_read_b64 a[216:217], v3 offset:384
    ds_read_b64 a[218:219], v3 offset:392
    v_mfma_f32_16x16x32_bf16 v[212:215], a[40:43], a[132:135], v[212:215]
    ds_read_b64 a[220:221], v3 offset:448
    ds_read_b64 a[222:223], v3 offset:456
    v_mfma_f32_16x16x32_bf16 v[212:215], a[36:39], a[136:139], v[212:215]
    ds_read_b64 a[224:225], v3 offset:512
    ds_read_b64_tr_b16 a[64:65], v18 offset:32
    v_mfma_f32_16x16x32_bf16 v[212:215], a[32:35], a[140:143], v[212:215]
    ds_read_b64_tr_b16 a[66:67], v18 offset:0
    v_mfma_f32_16x16x32_bf16 v[212:215], a[28:31], a[144:147], v[212:215]
    ds_read_b64 a[226:227], v3 offset:520
    v_mfma_f32_16x16x32_bf16 v[212:215], a[24:27], a[148:151], v[212:215]
    ds_read_b64_tr_b16 a[68:69], v18 offset:288
    v_mfma_f32_16x16x32_bf16 v[212:215], a[20:23], a[152:155], v[212:215]
    ds_read_b64 a[228:229], v3 offset:576
    v_mfma_f32_16x16x32_bf16 v[212:215], a[16:19], a[156:159], v[212:215]
    v_mfma_f32_16x16x32_bf16 v[212:215], a[12:15], a[160:163], v[212:215]
    ds_read_b64 a[230:231], v3 offset:584
    ds_read_b64_tr_b16 a[70:71], v18 offset:256
    v_mfma_f32_16x16x32_bf16 v[212:215], a[8:11], a[164:167], v[212:215]
    ds_read_b64 a[232:233], v3 offset:640
    v_mfma_f32_16x16x32_bf16 v[212:215], a[4:7], a[168:171], v[212:215]
    ds_read_b64 a[234:235], v3 offset:648
Lpad14:
    s_cbranch_execz Lpad15
    v_mfma_f32_16x16x32_bf16 v[212:215], a[0:3], a[172:175], v[212:215]
    ds_read_b64 a[236:237], v3 offset:704
    ds_read_b64 a[238:239], v3 offset:712
    v_mfma_f32_16x16x32_bf16 v[216:219], a[52:55], a[128:131], 0
    ds_read_b64 a[240:241], v3 offset:768
    ds_read_b64_tr_b16 a[72:73], v18 offset:544
    v_mfma_f32_16x16x32_bf16 v[216:219], a[48:51], a[132:135], v[216:219]
    ds_read_b64 a[242:243], v3 offset:776
    v_mfma_f32_16x16x32_bf16 v[216:219], a[44:47], a[136:139], v[216:219]
    ds_read_b64 a[244:245], v3 offset:832
    v_mfma_f32_16x16x32_bf16 v[216:219], a[40:43], a[140:143], v[216:219]
    ds_read_b64 a[246:247], v3 offset:840
    ds_read_b64 a[248:249], v3 offset:896
    v_mfma_f32_16x16x32_bf16 v[216:219], a[36:39], a[144:147], v[216:219]
    ds_read_b64 a[250:251], v3 offset:904
    ds_read_b64_tr_b16 a[74:75], v18 offset:512
    v_mfma_f32_16x16x32_bf16 v[216:219], a[32:35], a[148:151], v[216:219]
    ds_read_b64 a[252:253], v3 offset:960
    v_mfma_f32_16x16x32_bf16 v[216:219], a[28:31], a[152:155], v[216:219]
    ds_read_b64 a[254:255], v3 offset:968
    ds_read_b64_tr_b16 a[76:77], v18 offset:800
    v_mfma_f32_16x16x32_bf16 v[216:219], a[24:27], a[156:159], v[216:219]
    ds_read_b64_tr_b16 a[78:79], v18 offset:768
    v_mfma_f32_16x16x32_bf16 v[216:219], a[20:23], a[160:163], v[216:219]
    ds_read_b64_tr_b16 a[80:81], v18 offset:1056
    v_mfma_f32_16x16x32_bf16 v[216:219], a[16:19], a[164:167], v[216:219]
    buffer_store_dwordx4 v[40:43], v1, s[8:11], s57 offen offset:0 sc1
    v_mfma_f32_16x16x32_bf16 v[216:219], a[12:15], a[168:171], v[216:219]
    ds_read_b64_tr_b16 a[82:83], v18 offset:1024
    ds_read_b64_tr_b16 a[84:85], v18 offset:1312
    v_mfma_f32_16x16x32_bf16 v[216:219], a[8:11], a[172:175], v[216:219]
    ds_read_b64_tr_b16 a[86:87], v18 offset:1280
    ds_read_b64_tr_b16 a[88:89], v18 offset:1568
    v_mfma_f32_16x16x32_bf16 v[216:219], a[4:7], a[176:179], v[216:219]
    ds_read_b64_tr_b16 a[90:91], v18 offset:1536
    v_mfma_f32_16x16x32_bf16 v[216:219], a[0:3], a[180:183], v[216:219]
    ds_read_b64_tr_b16 a[92:93], v18 offset:1824
    ds_read_b64_tr_b16 a[94:95], v18 offset:1792
    v_mfma_f32_16x16x32_bf16 v[220:223], a[60:63], a[128:131], 0
    buffer_store_dwordx4 v[44:47], v1, s[8:11], s57 offen offset:2048 sc1
    v_mfma_f32_16x16x32_bf16 v[220:223], a[56:59], a[132:135], v[220:223]
    ds_read_b64_tr_b16 a[96:97], v18 offset:2080
    ds_read_b64_tr_b16 a[98:99], v18 offset:2048
    v_mfma_f32_16x16x32_bf16 v[220:223], a[52:55], a[136:139], v[220:223]
    ds_read_b64_tr_b16 a[100:101], v18 offset:2336
    ds_read_b64_tr_b16 a[102:103], v18 offset:2304
    v_mfma_f32_16x16x32_bf16 v[220:223], a[48:51], a[140:143], v[220:223]
    ds_read_b64_tr_b16 a[104:105], v18 offset:2592
    v_mfma_f32_16x16x32_bf16 v[220:223], a[44:47], a[144:147], v[220:223]
    ds_read_b64_tr_b16 a[106:107], v18 offset:2560
    ds_read_b64_tr_b16 a[108:109], v18 offset:2848
    v_mfma_f32_16x16x32_bf16 v[220:223], a[40:43], a[148:151], v[220:223]
    ds_read_b64_tr_b16 a[110:111], v18 offset:2816
    v_mfma_f32_16x16x32_bf16 v[220:223], a[36:39], a[152:155], v[220:223]
    ds_read_b64_tr_b16 a[112:113], v18 offset:3104
    ds_read_b64_tr_b16 a[114:115], v18 offset:3072
    v_mfma_f32_16x16x32_bf16 v[220:223], a[32:35], a[156:159], v[220:223]
    ds_read_b64_tr_b16 a[116:117], v18 offset:3360
    v_mfma_f32_16x16x32_bf16 v[220:223], a[28:31], a[160:163], v[220:223]
    ds_read_b64_tr_b16 a[118:119], v18 offset:3328
    ds_read_b64_tr_b16 a[120:121], v18 offset:3616
    v_mfma_f32_16x16x32_bf16 v[220:223], a[24:27], a[164:167], v[220:223]
    ds_read_b64_tr_b16 a[122:123], v18 offset:3584
    v_mfma_f32_16x16x32_bf16 v[220:223], a[20:23], a[168:171], v[220:223]
    ds_read_b64_tr_b16 a[124:125], v18 offset:3872
    ds_read_b64_tr_b16 a[126:127], v18 offset:3840
    v_mfma_f32_16x16x32_bf16 v[220:223], a[16:19], a[172:175], v[220:223]
    v_mfma_f32_16x16x32_bf16 v[220:223], a[12:15], a[176:179], v[220:223]
    v_mfma_f32_16x16x32_bf16 v[220:223], a[8:11], a[180:183], v[220:223]
    v_mfma_f32_16x16x32_bf16 v[220:223], a[4:7], a[184:187], v[220:223]
    v_mfma_f32_16x16x32_bf16 v[220:223], a[0:3], a[188:191], v[220:223]
    s_waitcnt lgkmcnt(15)
    v_mfma_f32_16x16x32_bf16 v[224:227], a[4:7], a[192:195], 0
    v_mfma_f32_16x16x32_bf16 v[224:227], a[0:3], a[196:199], v[224:227]
    v_mfma_f32_16x16x32_bf16 v[228:231], a[12:15], a[192:195], 0
    v_mfma_f32_16x16x32_bf16 v[228:231], a[8:11], a[196:199], v[228:231]
    v_mfma_f32_16x16x32_bf16 v[228:231], a[4:7], a[200:203], v[228:231]
    v_mfma_f32_16x16x32_bf16 v[228:231], a[0:3], a[204:207], v[228:231]
    v_mfma_f32_16x16x32_bf16 v[232:235], a[20:23], a[192:195], 0
    v_mfma_f32_16x16x32_bf16 v[232:235], a[16:19], a[196:199], v[232:235]
    v_mfma_f32_16x16x32_bf16 v[232:235], a[12:15], a[200:203], v[232:235]
    v_mfma_f32_16x16x32_bf16 v[232:235], a[8:11], a[204:207], v[232:235]
    s_waitcnt vmcnt(6)
    v_mfma_f32_16x16x32_bf16 v[232:235], a[4:7], a[208:211], v[232:235]
    ds_write_b16 v17, v36 offset:0
    v_mfma_f32_16x16x32_bf16 v[232:235], a[0:3], a[212:215], v[232:235]
    ds_write_b16 v17, v37 offset:128
    v_mfma_f32_16x16x32_bf16 v[236:239], a[28:31], a[192:195], 0
    ds_write_b16 v17, v38 offset:256
    v_mfma_f32_16x16x32_bf16 v[236:239], a[24:27], a[196:199], v[236:239]
    ds_write_b16 v17, v39 offset:384
    v_mfma_f32_16x16x32_bf16 v[236:239], a[20:23], a[200:203], v[236:239]
    v_mfma_f32_16x16x32_bf16 v[236:239], a[16:19], a[204:207], v[236:239]
    ds_write_b16 v17, v57 offset:512
    v_mfma_f32_16x16x32_bf16 v[236:239], a[12:15], a[208:211], v[236:239]
    ds_write_b16 v17, v58 offset:640
    v_mfma_f32_16x16x32_bf16 v[236:239], a[8:11], a[212:215], v[236:239]
    ds_write_b16 v17, v59 offset:768
    v_mfma_f32_16x16x32_bf16 v[236:239], a[4:7], a[216:219], v[236:239]
    v_mfma_f32_16x16x32_bf16 v[236:239], a[0:3], a[220:223], v[236:239]
    ds_write_b16 v17, v60 offset:896
    v_mfma_f32_16x16x32_bf16 v[240:243], a[36:39], a[192:195], 0
    v_mfma_f32_16x16x32_bf16 v[240:243], a[32:35], a[196:199], v[240:243]
    v_mfma_f32_16x16x32_bf16 v[240:243], a[28:31], a[200:203], v[240:243]
    ds_read_b64 a[128:129], v20 offset:0
    ds_read_b64 a[130:131], v20 offset:8
    v_mfma_f32_16x16x32_bf16 v[240:243], a[24:27], a[204:207], v[240:243]
    ds_read_b64 a[132:133], v20 offset:64
    ds_read_b64 a[134:135], v20 offset:72
    v_mfma_f32_16x16x32_bf16 v[240:243], a[20:23], a[208:211], v[240:243]
    ds_read_b64 a[136:137], v20 offset:128
    v_mfma_f32_16x16x32_bf16 v[240:243], a[16:19], a[212:215], v[240:243]
    ds_read_b64 a[138:139], v20 offset:136
    ds_read_b64 a[140:141], v20 offset:192
    v_mfma_f32_16x16x32_bf16 v[240:243], a[12:15], a[216:219], v[240:243]
    ds_read_b64 a[142:143], v20 offset:200
    v_mfma_f32_16x16x32_bf16 v[240:243], a[8:11], a[220:223], v[240:243]
    ds_read_b64 a[144:145], v20 offset:256
    s_waitcnt vmcnt(0)
    v_mfma_f32_16x16x32_bf16 v[240:243], a[4:7], a[224:227], v[240:243]
    buffer_store_dword v15, v14, s[8:11], 0 offen offset:8 sc1
    v_mfma_f32_16x16x32_bf16 v[240:243], a[0:3], a[228:231], v[240:243]
    ds_read_b64 a[146:147], v20 offset:264
    ds_read_b64 a[148:149], v20 offset:320
    v_mfma_f32_16x16x32_bf16 v[244:247], a[44:47], a[192:195], 0
    ds_read_b64 a[150:151], v20 offset:328
    ds_read_b64 a[152:153], v20 offset:384
    v_mfma_f32_16x16x32_bf16 v[244:247], a[40:43], a[196:199], v[244:247]
    ds_read_b64 a[154:155], v20 offset:392
    v_mfma_f32_16x16x32_bf16 v[244:247], a[36:39], a[200:203], v[244:247]
    ds_read_b64 a[156:157], v20 offset:448
    ds_read_b64 a[158:159], v20 offset:456
    v_mfma_f32_16x16x32_bf16 v[244:247], a[32:35], a[204:207], v[244:247]
    ds_read_b64 a[160:161], v20 offset:512
    v_mfma_f32_16x16x32_bf16 v[244:247], a[28:31], a[208:211], v[244:247]
    ds_read_b64 a[162:163], v20 offset:520
    ds_read_b64 a[164:165], v20 offset:576
    v_mfma_f32_16x16x32_bf16 v[244:247], a[24:27], a[212:215], v[244:247]
    ds_read_b64 a[166:167], v20 offset:584
    v_mfma_f32_16x16x32_bf16 v[244:247], a[20:23], a[216:219], v[244:247]
    ds_read_b64 a[168:169], v20 offset:640
    ds_read_b64 a[170:171], v20 offset:648
    v_mfma_f32_16x16x32_bf16 v[244:247], a[16:19], a[220:223], v[244:247]
    ds_read_b64 a[172:173], v20 offset:704
    v_mfma_f32_16x16x32_bf16 v[244:247], a[12:15], a[224:227], v[244:247]
    ds_read_b64 a[174:175], v20 offset:712
    ds_read_b64 a[176:177], v20 offset:768
    v_mfma_f32_16x16x32_bf16 v[244:247], a[8:11], a[228:231], v[244:247]
    ds_read_b64 a[178:179], v20 offset:776
    v_mfma_f32_16x16x32_bf16 v[244:247], a[4:7], a[232:235], v[244:247]
    ds_read_b64 a[180:181], v20 offset:832
    ds_read_b64 a[182:183], v20 offset:840
    v_mfma_f32_16x16x32_bf16 v[244:247], a[0:3], a[236:239], v[244:247]
    ds_read_b64 a[184:185], v20 offset:896
    v_mfma_f32_16x16x32_bf16 v[248:251], a[52:55], a[192:195], 0
    ds_read_b64 a[186:187], v20 offset:904
    ds_read_b64 a[188:189], v20 offset:960
    v_mfma_f32_16x16x32_bf16 v[248:251], a[48:51], a[196:199], v[248:251]
    ds_read_b64 a[190:191], v20 offset:968
    v_mfma_f32_16x16x32_bf16 v[248:251], a[44:47], a[200:203], v[248:251]
    v_mfma_f32_16x16x32_bf16 v[248:251], a[40:43], a[204:207], v[248:251]
    v_mfma_f32_16x16x32_bf16 v[248:251], a[36:39], a[208:211], v[248:251]
    v_mfma_f32_16x16x32_bf16 v[248:251], a[32:35], a[212:215], v[248:251]
    v_mfma_f32_16x16x32_bf16 v[248:251], a[28:31], a[216:219], v[248:251]
    v_mfma_f32_16x16x32_bf16 v[248:251], a[24:27], a[220:223], v[248:251]
    v_mfma_f32_16x16x32_bf16 v[248:251], a[20:23], a[224:227], v[248:251]
    v_mfma_f32_16x16x32_bf16 v[248:251], a[16:19], a[228:231], v[248:251]
    v_mfma_f32_16x16x32_bf16 v[248:251], a[12:15], a[232:235], v[248:251]
    v_mfma_f32_16x16x32_bf16 v[248:251], a[8:11], a[236:239], v[248:251]
    v_mfma_f32_16x16x32_bf16 v[248:251], a[4:7], a[240:243], v[248:251]
    v_mfma_f32_16x16x32_bf16 v[248:251], a[0:3], a[244:247], v[248:251]
    v_mfma_f32_16x16x32_bf16 v[252:255], a[60:63], a[192:195], 0
    v_mfma_f32_16x16x32_bf16 v[252:255], a[56:59], a[196:199], v[252:255]
    v_mfma_f32_16x16x32_bf16 v[252:255], a[52:55], a[200:203], v[252:255]
    v_mfma_f32_16x16x32_bf16 v[252:255], a[48:51], a[204:207], v[252:255]
    v_mfma_f32_16x16x32_bf16 v[252:255], a[44:47], a[208:211], v[252:255]
    v_mfma_f32_16x16x32_bf16 v[252:255], a[40:43], a[212:215], v[252:255]
    v_mfma_f32_16x16x32_bf16 v[252:255], a[36:39], a[216:219], v[252:255]
    v_mfma_f32_16x16x32_bf16 v[252:255], a[32:35], a[220:223], v[252:255]
    v_mfma_f32_16x16x32_bf16 v[252:255], a[28:31], a[224:227], v[252:255]
    v_mfma_f32_16x16x32_bf16 v[252:255], a[24:27], a[228:231], v[252:255]
    v_mfma_f32_16x16x32_bf16 v[252:255], a[20:23], a[232:235], v[252:255]
    v_mfma_f32_16x16x32_bf16 v[252:255], a[16:19], a[236:239], v[252:255]
    v_mfma_f32_16x16x32_bf16 v[252:255], a[12:15], a[240:243], v[252:255]
    v_mfma_f32_16x16x32_bf16 v[252:255], a[8:11], a[244:247], v[252:255]
    v_mfma_f32_16x16x32_bf16 v[252:255], a[4:7], a[248:251], v[252:255]
    v_mfma_f32_16x16x32_bf16 v[252:255], a[0:3], a[252:255], v[252:255]
    s_waitcnt lgkmcnt(0)
    v_mfma_f32_16x16x32_bf16 v[128:131], a[68:71], a[128:131], 0
    v_mfma_f32_16x16x32_bf16 v[128:131], a[64:67], a[132:135], v[128:131]
    ds_read_b64_tr_b16 a[0:1], v2 offset:16544
    ds_read_b64_tr_b16 a[2:3], v2 offset:16512
    v_mfma_f32_16x16x32_bf16 v[132:135], a[76:79], a[128:131], 0
    ds_read_b64_tr_b16 a[4:5], v2 offset:16800
    ds_read_b64_tr_b16 a[6:7], v2 offset:16768
    v_mfma_f32_16x16x32_bf16 v[132:135], a[72:75], a[132:135], v[132:135]
    v_add_u32 v3, 15040, v3
    ds_read_b64 a[192:193], v3 offset:0
    v_mfma_f32_16x16x32_bf16 v[132:135], a[68:71], a[136:139], v[132:135]
    ds_read_b64 a[194:195], v3 offset:8
    ds_read_b64 a[196:197], v3 offset:64
    v_mfma_f32_16x16x32_bf16 v[132:135], a[64:67], a[140:143], v[132:135]
    ds_read_b64 a[198:199], v3 offset:72
    v_add_f32 v66, v66, v192
    v_mfma_f32_16x16x32_bf16 v[136:139], a[84:87], a[128:131], 0
    ds_read_b64 a[200:201], v3 offset:128
    ds_read_b64 a[202:203], v3 offset:136
    v_mfma_f32_16x16x32_bf16 v[136:139], a[80:83], a[132:135], v[136:139]
    ds_read_b64 a[204:205], v3 offset:192
    ds_read_b64_tr_b16 a[8:9], v2 offset:17056
    v_mfma_f32_16x16x32_bf16 v[136:139], a[76:79], a[136:139], v[136:139]
    ds_read_b64 a[206:207], v3 offset:200
    v_add_f32 v67, v67, v193
    v_add_f32 v99, v99, v194
    v_mfma_f32_16x16x32_bf16 v[136:139], a[72:75], a[140:143], v[136:139]
    ds_read_b64 a[208:209], v3 offset:256
    ds_read_b64_tr_b16 a[10:11], v2 offset:17024
    v_mfma_f32_16x16x32_bf16 v[136:139], a[68:71], a[144:147], v[136:139]
    ds_read_b64 a[210:211], v3 offset:264
    v_add_f32 v67, v67, v224
    v_mfma_f32_16x16x32_bf16 v[136:139], a[64:67], a[148:151], v[136:139]
    ds_read_b64 a[212:213], v3 offset:320
    ds_read_b64_tr_b16 a[12:13], v2 offset:17312
    v_mfma_f32_16x16x32_bf16 v[140:143], a[92:95], a[128:131], 0
    ds_read_b64 a[214:215], v3 offset:328
    v_add_f32 v99, v99, v225
    v_mfma_f32_16x16x32_bf16 v[140:143], a[88:91], a[132:135], v[140:143]
    ds_read_b64 a[216:217], v3 offset:384
    ds_read_b64_tr_b16 a[14:15], v2 offset:17280
    v_mfma_f32_16x16x32_bf16 v[140:143], a[84:87], a[136:139], v[140:143]
    ds_read_b64 a[218:219], v3 offset:392
    v_add_f32 v195, v195, v226
    v_mfma_f32_16x16x32_bf16 v[140:143], a[80:83], a[140:143], v[140:143]
    ds_read_b64 a[220:221], v3 offset:448
    ds_read_b64_tr_b16 a[16:17], v2 offset:17568
    v_mfma_f32_16x16x32_bf16 v[140:143], a[76:79], a[144:147], v[140:143]
    ds_read_b64 a[222:223], v3 offset:456
    v_cndmask_b32 v96, v99, 0, s[42:43]
    v_mfma_f32_16x16x32_bf16 v[140:143], a[72:75], a[148:151], v[140:143]
    ds_read_b64 a[224:225], v3 offset:512
    ds_read_b64_tr_b16 a[18:19], v2 offset:17536
    v_cndmask_b32 v97, v195, 0, s[42:43]
    v_mfma_f32_16x16x32_bf16 v[140:143], a[68:71], a[152:155], v[140:143]
    ds_read_b64 a[226:227], v3 offset:520
    v_cndmask_b32 v98, v227, 0, s[42:43]
    v_mfma_f32_16x16x32_bf16 v[140:143], a[64:67], a[156:159], v[140:143]
    ds_read_b64 a[228:229], v3 offset:576
    ds_read_b64 a[230:231], v3 offset:584
    v_mfma_f32_16x16x32_bf16 v[144:147], a[100:103], a[128:131], 0
    ds_read_b64 a[232:233], v3 offset:640
    ds_read_b64_tr_b16 a[20:21], v2 offset:17824
    v_mfma_f32_16x16x32_bf16 v[144:147], a[96:99], a[132:135], v[144:147]
    ds_read_b64 a[234:235], v3 offset:648
    ds_read_b64_tr_b16 a[22:23], v2 offset:17792
    v_mfma_f32_16x16x32_bf16 v[144:147], a[92:95], a[136:139], v[144:147]
    ds_bpermute_b32 v192, v27, v96
    v_mfma_f32_16x16x32_bf16 v[144:147], a[88:91], a[140:143], v[144:147]
    ds_read_b64_tr_b16 a[24:25], v2 offset:18080
    v_add_f32 v70, v70, v196
    v_mfma_f32_16x16x32_bf16 v[144:147], a[84:87], a[144:147], v[144:147]
    ds_bpermute_b32 v193, v27, v97
    v_mfma_f32_16x16x32_bf16 v[144:147], a[80:83], a[148:151], v[144:147]
    ds_read_b64_tr_b16 a[26:27], v2 offset:18048
    v_add_f32 v71, v71, v197
    v_mfma_f32_16x16x32_bf16 v[144:147], a[76:79], a[152:155], v[144:147]
    ds_bpermute_b32 v194, v27, v98
    v_add_f32 v103, v103, v198
    v_mfma_f32_16x16x32_bf16 v[144:147], a[72:75], a[156:159], v[144:147]
    ds_read_b64_tr_b16 a[28:29], v2 offset:18336
    v_add_f32 v71, v71, v228
    v_mfma_f32_16x16x32_bf16 v[144:147], a[68:71], a[160:163], v[144:147]
    ds_read_b64 a[236:237], v3 offset:704
    v_add_f32 v103, v103, v229
    v_mfma_f32_16x16x32_bf16 v[144:147], a[64:67], a[164:167], v[144:147]
    ds_read_b64 a[238:239], v3 offset:712
    ds_read_b64_tr_b16 a[30:31], v2 offset:18304
    v_mfma_f32_16x16x32_bf16 v[148:151], a[108:111], a[128:131], 0
    ds_read_b64 a[240:241], v3 offset:768
    v_add_f32 v199, v199, v230
    v_mfma_f32_16x16x32_bf16 v[148:151], a[104:107], a[132:135], v[148:151]
    ds_read_b64 a[242:243], v3 offset:776
    ds_read_b64_tr_b16 a[32:33], v2 offset:18592
    v_mfma_f32_16x16x32_bf16 v[148:151], a[100:103], a[136:139], v[148:151]
    ds_read_b64 a[244:245], v3 offset:832
    v_cndmask_b32 v100, v103, v99, s[42:43]
    v_mfma_f32_16x16x32_bf16 v[148:151], a[96:99], a[140:143], v[148:151]
    ds_read_b64 a[246:247], v3 offset:840
    ds_read_b64_tr_b16 a[34:35], v2 offset:18560
    v_mfma_f32_16x16x32_bf16 v[148:151], a[92:95], a[144:147], v[148:151]
    ds_read_b64 a[248:249], v3 offset:896
    v_cndmask_b32 v101, v199, v195, s[42:43]
    v_mfma_f32_16x16x32_bf16 v[148:151], a[88:91], a[148:151], v[148:151]
    ds_read_b64 a[250:251], v3 offset:904
    ds_read_b64_tr_b16 a[36:37], v2 offset:18848
    v_cndmask_b32 v102, v231, v227, s[42:43]
    v_mfma_f32_16x16x32_bf16 v[148:151], a[84:87], a[152:155], v[148:151]
    ds_read_b64 a[252:253], v3 offset:960
    s_waitcnt lgkmcnt(15)
    v_add_f32 v64, v64, v192
    v_mfma_f32_16x16x32_bf16 v[148:151], a[80:83], a[156:159], v[148:151]
    ds_read_b64 a[254:255], v3 offset:968
    ds_read_b64_tr_b16 a[38:39], v2 offset:18816
    v_mfma_f32_16x16x32_bf16 v[148:151], a[76:79], a[160:163], v[148:151]
    ds_read_b64_tr_b16 a[40:41], v2 offset:19104
    v_add_f32 v65, v65, v193
    v_mfma_f32_16x16x32_bf16 v[148:151], a[72:75], a[164:167], v[148:151]
    ds_read_b64_tr_b16 a[42:43], v2 offset:19072
    ds_read_b64_tr_b16 a[44:45], v2 offset:19360
    v_mfma_f32_16x16x32_bf16 v[148:151], a[68:71], a[168:171], v[148:151]
    ds_read_b64_tr_b16 a[46:47], v2 offset:19328
    s_waitcnt lgkmcnt(15)
    v_add_f32 v66, v66, v194
    v_mfma_f32_16x16x32_bf16 v[148:151], a[64:67], a[172:175], v[148:151]
    ds_read_b64_tr_b16 a[48:49], v2 offset:19616
    ds_read_b64_tr_b16 a[50:51], v2 offset:19584
    v_mfma_f32_16x16x32_bf16 v[152:155], a[116:119], a[128:131], 0
    ds_read_b64_tr_b16 a[52:53], v2 offset:19872
    v_cvt_pk_bf16_f32 v224, v64, v65
    v_mfma_f32_16x16x32_bf16 v[152:155], a[112:115], a[132:135], v[152:155]
    ds_read_b64_tr_b16 a[54:55], v2 offset:19840
    ds_read_b64_tr_b16 a[56:57], v2 offset:20128
    v_cvt_pk_bf16_f32 v225, v66, v67
    v_mfma_f32_16x16x32_bf16 v[152:155], a[108:111], a[136:139], v[152:155]
    ds_read_b64_tr_b16 a[58:59], v2 offset:20096
    v_add_f32 v74, v74, v200
    v_mfma_f32_16x16x32_bf16 v[152:155], a[104:107], a[140:143], v[152:155]
    ds_read_b64_tr_b16 a[60:61], v2 offset:20384
    ds_read_b64_tr_b16 a[62:63], v2 offset:20352
    v_mfma_f32_16x16x32_bf16 v[152:155], a[100:103], a[144:147], v[152:155]
    ds_bpermute_b32 v196, v27, v100
    v_mfma_f32_16x16x32_bf16 v[152:155], a[96:99], a[148:151], v[152:155]
    ds_bpermute_b32 v197, v27, v101
    v_mfma_f32_16x16x32_bf16 v[152:155], a[92:95], a[152:155], v[152:155]
    ds_bpermute_b32 v198, v27, v102
    v_mfma_f32_16x16x32_bf16 v[152:155], a[88:91], a[156:159], v[152:155]
    ds_write_b64 v25, v[224:225] offset:0
    v_mfma_f32_16x16x32_bf16 v[152:155], a[84:87], a[160:163], v[152:155]
    v_add_f32 v75, v75, v201
    v_add_f32 v107, v107, v202
    v_mfma_f32_16x16x32_bf16 v[152:155], a[80:83], a[164:167], v[152:155]
    v_add_f32 v75, v75, v232
    v_add_f32 v107, v107, v233
    v_mfma_f32_16x16x32_bf16 v[152:155], a[76:79], a[168:171], v[152:155]
    v_add_f32 v203, v203, v234
    v_cndmask_b32 v104, v107, v103, s[42:43]
    v_mfma_f32_16x16x32_bf16 v[152:155], a[72:75], a[172:175], v[152:155]
    v_cndmask_b32 v105, v203, v199, s[42:43]
    v_cndmask_b32 v106, v235, v231, s[42:43]
    v_mfma_f32_16x16x32_bf16 v[152:155], a[68:71], a[176:179], v[152:155]
    ds_bpermute_b32 v200, v27, v104
    v_mfma_f32_16x16x32_bf16 v[152:155], a[64:67], a[180:183], v[152:155]
    ds_bpermute_b32 v201, v27, v105
    v_mfma_f32_16x16x32_bf16 v[156:159], a[124:127], a[128:131], 0
    ds_bpermute_b32 v202, v27, v106
    v_mfma_f32_16x16x32_bf16 v[156:159], a[120:123], a[132:135], v[156:159]
    s_waitcnt lgkmcnt(4)
    v_add_f32 v68, v68, v196
    v_add_f32 v69, v69, v197
    v_mfma_f32_16x16x32_bf16 v[156:159], a[116:119], a[136:139], v[156:159]
    v_add_f32 v70, v70, v198
    v_cvt_pk_bf16_f32 v228, v68, v69
    v_mfma_f32_16x16x32_bf16 v[156:159], a[112:115], a[140:143], v[156:159]
    v_cvt_pk_bf16_f32 v229, v70, v71
    v_add_f32 v78, v78, v204
    v_mfma_f32_16x16x32_bf16 v[156:159], a[108:111], a[144:147], v[156:159]
    ds_write_b64 v25, v[228:229] offset:512
    v_mfma_f32_16x16x32_bf16 v[156:159], a[104:107], a[148:151], v[156:159]
    v_add_f32 v79, v79, v205
    v_add_f32 v111, v111, v206
    v_mfma_f32_16x16x32_bf16 v[156:159], a[100:103], a[152:155], v[156:159]
    v_add_f32 v79, v79, v236
    v_add_f32 v111, v111, v237
    v_mfma_f32_16x16x32_bf16 v[156:159], a[96:99], a[156:159], v[156:159]
    v_add_f32 v207, v207, v238
    v_cndmask_b32 v108, v111, v107, s[42:43]
    v_mfma_f32_16x16x32_bf16 v[156:159], a[92:95], a[160:163], v[156:159]
    v_cndmask_b32 v109, v207, v203, s[42:43]
    v_cndmask_b32 v110, v239, v235, s[42:43]
    v_mfma_f32_16x16x32_bf16 v[156:159], a[88:91], a[164:167], v[156:159]
    ds_bpermute_b32 v204, v27, v108
    v_mfma_f32_16x16x32_bf16 v[156:159], a[84:87], a[168:171], v[156:159]
    ds_bpermute_b32 v205, v27, v109
    v_mfma_f32_16x16x32_bf16 v[156:159], a[80:83], a[172:175], v[156:159]
    ds_bpermute_b32 v206, v27, v110
    v_mfma_f32_16x16x32_bf16 v[156:159], a[76:79], a[176:179], v[156:159]
    s_waitcnt lgkmcnt(4)
    v_add_f32 v72, v72, v200
    v_add_f32 v73, v73, v201
    v_mfma_f32_16x16x32_bf16 v[156:159], a[72:75], a[180:183], v[156:159]
    v_add_f32 v74, v74, v202
    v_cvt_pk_bf16_f32 v232, v72, v73
    v_mfma_f32_16x16x32_bf16 v[156:159], a[68:71], a[184:187], v[156:159]
    v_cvt_pk_bf16_f32 v233, v74, v75
    v_add_f32 v82, v82, v208
    v_add_f32 v83, v83, v209
    v_mfma_f32_16x16x32_bf16 v[156:159], a[64:67], a[188:191], v[156:159]
    v_add_f32 v115, v115, v210
    v_mfma_f32_16x16x32_bf16 v[160:163], a[4:7], a[192:195], 0
    ds_write_b64 v25, v[232:233] offset:1024
    v_mfma_f32_16x16x32_bf16 v[160:163], a[0:3], a[196:199], v[160:163]
    v_add_f32 v83, v83, v240
    v_add_f32 v115, v115, v241
    v_mfma_f32_16x16x32_bf16 v[164:167], a[12:15], a[192:195], 0
    v_add_f32 v211, v211, v242
    v_cndmask_b32 v112, v115, v111, s[42:43]
    v_mfma_f32_16x16x32_bf16 v[164:167], a[8:11], a[196:199], v[164:167]
    v_add_u32 v3, 1152, v3
    ds_read_b64 a[128:129], v3 offset:0
    v_mfma_f32_16x16x32_bf16 v[164:167], a[4:7], a[200:203], v[164:167]
    ds_read_b64 a[130:131], v3 offset:8
    ds_read_b64 a[132:133], v3 offset:64
    v_mfma_f32_16x16x32_bf16 v[164:167], a[0:3], a[204:207], v[164:167]
    ds_read_b64 a[134:135], v3 offset:72
    ds_read_b64 a[136:137], v3 offset:128
    v_mfma_f32_16x16x32_bf16 v[168:171], a[20:23], a[192:195], 0
    ds_read_b64 a[138:139], v3 offset:136
    v_cndmask_b32 v113, v211, v207, s[42:43]
    v_mfma_f32_16x16x32_bf16 v[168:171], a[16:19], a[196:199], v[168:171]
    ds_read_b64 a[140:141], v3 offset:192
    ds_read_b64 a[142:143], v3 offset:200
    v_mfma_f32_16x16x32_bf16 v[168:171], a[12:15], a[200:203], v[168:171]
    ds_read_b64 a[144:145], v3 offset:256
    v_cndmask_b32 v114, v243, v239, s[42:43]
    v_mfma_f32_16x16x32_bf16 v[168:171], a[8:11], a[204:207], v[168:171]
    ds_read_b64 a[146:147], v3 offset:264
    ds_read_b64 a[148:149], v3 offset:320
    v_mfma_f32_16x16x32_bf16 v[168:171], a[4:7], a[208:211], v[168:171]
    ds_read_b64 a[150:151], v3 offset:328
    s_waitcnt lgkmcnt(13)
    v_add_f32 v76, v76, v204
    v_mfma_f32_16x16x32_bf16 v[168:171], a[0:3], a[212:215], v[168:171]
    ds_read_b64 a[152:153], v3 offset:384
    ds_read_b64 a[154:155], v3 offset:392
    v_mfma_f32_16x16x32_bf16 v[172:175], a[28:31], a[192:195], 0
    ds_read_b64 a[156:157], v3 offset:448
    v_add_f32 v77, v77, v205
    v_mfma_f32_16x16x32_bf16 v[172:175], a[24:27], a[196:199], v[172:175]
    ds_read_b64 a[158:159], v3 offset:456
    ds_read_b64 a[160:161], v3 offset:512
    v_mfma_f32_16x16x32_bf16 v[172:175], a[20:23], a[200:203], v[172:175]
    ds_read_b64 a[162:163], v3 offset:520
    v_add_f32 v78, v78, v206
    v_mfma_f32_16x16x32_bf16 v[172:175], a[16:19], a[204:207], v[172:175]
    ds_read_b64 a[164:165], v3 offset:576
    ds_read_b64 a[166:167], v3 offset:584
    v_mfma_f32_16x16x32_bf16 v[172:175], a[12:15], a[208:211], v[172:175]
    ds_read_b64 a[168:169], v3 offset:640
    v_cvt_pk_bf16_f32 v236, v76, v77
    v_mfma_f32_16x16x32_bf16 v[172:175], a[8:11], a[212:215], v[172:175]
    ds_read_b64 a[170:171], v3 offset:648
    ds_read_b64 a[172:173], v3 offset:704
    v_cvt_pk_bf16_f32 v237, v78, v79
    v_mfma_f32_16x16x32_bf16 v[172:175], a[4:7], a[216:219], v[172:175]
    ds_read_b64 a[174:175], v3 offset:712
    v_add_f32 v86, v86, v212
    v_mfma_f32_16x16x32_bf16 v[172:175], a[0:3], a[220:223], v[172:175]
    ds_read_b64 a[176:177], v3 offset:768
    ds_read_b64 a[178:179], v3 offset:776
    v_mfma_f32_16x16x32_bf16 v[176:179], a[36:39], a[192:195], 0
    ds_read_b64 a[180:181], v3 offset:832
    v_add_f32 v87, v87, v213
    v_mfma_f32_16x16x32_bf16 v[176:179], a[32:35], a[196:199], v[176:179]
    ds_read_b64 a[182:183], v3 offset:840
    ds_read_b64 a[184:185], v3 offset:896
    v_mfma_f32_16x16x32_bf16 v[176:179], a[28:31], a[200:203], v[176:179]
    ds_read_b64 a[186:187], v3 offset:904
    v_add_f32 v119, v119, v214
    v_mfma_f32_16x16x32_bf16 v[176:179], a[24:27], a[204:207], v[176:179]
    ds_read_b64 a[188:189], v3 offset:960
    ds_read_b64 a[190:191], v3 offset:968
    v_mfma_f32_16x16x32_bf16 v[176:179], a[20:23], a[208:211], v[176:179]
    s_mov_b64 exec, 1
    ds_write_b128 v29, v[4:7]
    s_mov_b64 exec, -1
    v_mfma_f32_16x16x32_bf16 v[176:179], a[16:19], a[212:215], v[176:179]
    ds_write_b128 v26, v[128:131] offset:0
    v_mfma_f32_16x16x32_bf16 v[176:179], a[12:15], a[216:219], v[176:179]
    ds_write_b128 v26, v[132:135] offset:1024
    v_mfma_f32_16x16x32_bf16 v[176:179], a[8:11], a[220:223], v[176:179]
    ds_write_b128 v26, v[136:139] offset:2048
    v_mfma_f32_16x16x32_bf16 v[176:179], a[4:7], a[224:227], v[176:179]
    ds_bpermute_b32 v208, v27, v112
    v_mfma_f32_16x16x32_bf16 v[176:179], a[0:3], a[228:231], v[176:179]
    ds_bpermute_b32 v209, v27, v113
    v_mfma_f32_16x16x32_bf16 v[180:183], a[44:47], a[192:195], 0
    ds_bpermute_b32 v210, v27, v114
    v_mfma_f32_16x16x32_bf16 v[180:183], a[40:43], a[196:199], v[180:183]
    ds_write_b64 v25, v[236:237] offset:1536
    v_mfma_f32_16x16x32_bf16 v[180:183], a[36:39], a[200:203], v[180:183]
    ds_write_b128 v26, v[140:143] offset:3072
    v_mfma_f32_16x16x32_bf16 v[180:183], a[32:35], a[204:207], v[180:183]
    v_add_f32 v87, v87, v244
    v_add_f32 v119, v119, v245
    v_mfma_f32_16x16x32_bf16 v[180:183], a[28:31], a[208:211], v[180:183]
    v_add_f32 v215, v215, v246
    v_cndmask_b32 v116, v119, v115, s[42:43]
    v_mfma_f32_16x16x32_bf16 v[180:183], a[24:27], a[212:215], v[180:183]
    v_cndmask_b32 v117, v215, v211, s[42:43]
    v_cndmask_b32 v118, v247, v243, s[42:43]
    v_mfma_f32_16x16x32_bf16 v[180:183], a[20:23], a[216:219], v[180:183]
    ds_bpermute_b32 v212, v27, v116
    v_mfma_f32_16x16x32_bf16 v[180:183], a[16:19], a[220:223], v[180:183]
    ds_bpermute_b32 v213, v27, v117
    v_mfma_f32_16x16x32_bf16 v[180:183], a[12:15], a[224:227], v[180:183]
    ds_bpermute_b32 v214, v27, v118
    v_mfma_f32_16x16x32_bf16 v[180:183], a[8:11], a[228:231], v[180:183]
    ds_write_b128 v26, v[144:147] offset:4096
    v_mfma_f32_16x16x32_bf16 v[180:183], a[4:7], a[232:235], v[180:183]
    s_getpc_b64 s[60:61]
    s_bfe_u32 s62, s2, 0x30003
    v_mfma_f32_16x16x32_bf16 v[180:183], a[0:3], a[236:239], v[180:183]
    s_waitcnt lgkmcnt(6)
    v_add_f32 v80, v80, v208
    v_add_f32 v81, v81, v209
    v_mfma_f32_16x16x32_bf16 v[184:187], a[52:55], a[192:195], 0
    s_add_u32 s60, s60, 0xffffb6dc
    s_addc_u32 s61, s61, -1
    v_mfma_f32_16x16x32_bf16 v[184:187], a[48:51], a[196:199], v[184:187]
    v_add_f32 v82, v82, v210
    v_cvt_pk_bf16_f32 v240, v80, v81
    v_mfma_f32_16x16x32_bf16 v[184:187], a[44:47], a[200:203], v[184:187]
    s_lshl_b32 s62, s62, 2
    s_add_u32 s62, s62, s3
    v_mfma_f32_16x16x32_bf16 v[184:187], a[40:43], a[204:207], v[184:187]
    v_cvt_pk_bf16_f32 v241, v82, v83
    v_add_f32 v90, v90, v216
    v_mfma_f32_16x16x32_bf16 v[184:187], a[36:39], a[208:211], v[184:187]
    s_mul_i32 s62, s62, 736
    v_min_u32 v21, 5, v0
    v_mfma_f32_16x16x32_bf16 v[184:187], a[32:35], a[212:215], v[184:187]
    ds_write_b128 v26, v[148:151] offset:5120
    v_mfma_f32_16x16x32_bf16 v[184:187], a[28:31], a[216:219], v[184:187]
    v_lshl_add_u32 v21, v21, 7, s62
    v_add_f32 v91, v91, v217
    v_mfma_f32_16x16x32_bf16 v[184:187], a[24:27], a[220:223], v[184:187]
    ds_write_b64 v25, v[240:241] offset:2048
    v_mfma_f32_16x16x32_bf16 v[184:187], a[20:23], a[224:227], v[184:187]
    global_load_dword v22, v21, s[60:61]
    v_mfma_f32_16x16x32_bf16 v[184:187], a[16:19], a[228:231], v[184:187]
    v_add_f32 v123, v123, v218
    v_add_f32 v91, v91, v248
    v_mfma_f32_16x16x32_bf16 v[184:187], a[12:15], a[232:235], v[184:187]
    v_add_f32 v123, v123, v249
    v_add_f32 v219, v219, v250
    v_mfma_f32_16x16x32_bf16 v[184:187], a[8:11], a[236:239], v[184:187]
    ds_write_b128 v26, v[152:155] offset:6144
    v_mfma_f32_16x16x32_bf16 v[184:187], a[4:7], a[240:243], v[184:187]
    v_cndmask_b32 v120, v123, v119, s[42:43]
    v_cndmask_b32 v121, v219, v215, s[42:43]
Lpad15:
    s_cbranch_execz Lwret6
    v_mfma_f32_16x16x32_bf16 v[184:187], a[0:3], a[244:247], v[184:187]
    v_cndmask_b32 v122, v251, v247, s[42:43]
    s_waitcnt lgkmcnt(4)
    v_add_f32 v84, v84, v212
    v_mfma_f32_16x16x32_bf16 v[188:191], a[60:63], a[192:195], 0
    ds_bpermute_b32 v216, v27, v120
    v_mfma_f32_16x16x32_bf16 v[188:191], a[56:59], a[196:199], v[188:191]
    ds_bpermute_b32 v217, v27, v121
    v_mfma_f32_16x16x32_bf16 v[188:191], a[52:55], a[200:203], v[188:191]
    ds_bpermute_b32 v218, v27, v122
    v_mfma_f32_16x16x32_bf16 v[188:191], a[48:51], a[204:207], v[188:191]
    v_add_f32 v85, v85, v213
    v_add_f32 v86, v86, v214
    v_mfma_f32_16x16x32_bf16 v[188:191], a[44:47], a[208:211], v[188:191]
    ds_write_b128 v26, v[156:159] offset:7168
    v_mfma_f32_16x16x32_bf16 v[188:191], a[40:43], a[212:215], v[188:191]
    v_cvt_pk_bf16_f32 v244, v84, v85
    v_cvt_pk_bf16_f32 v245, v86, v87
    v_mfma_f32_16x16x32_bf16 v[188:191], a[36:39], a[216:219], v[188:191]
    ds_write_b64 v25, v[244:245] offset:2560
    v_mfma_f32_16x16x32_bf16 v[188:191], a[32:35], a[220:223], v[188:191]
    v_add_f32 v94, v94, v220
    v_add_f32 v95, v95, v221
    v_mfma_f32_16x16x32_bf16 v[188:191], a[28:31], a[224:227], v[188:191]
    v_add_f32 v127, v127, v222
    v_add_f32 v95, v95, v252
    v_mfma_f32_16x16x32_bf16 v[188:191], a[24:27], a[228:231], v[188:191]
    v_add_f32 v127, v127, v253
    v_add_f32 v223, v223, v254
    v_mfma_f32_16x16x32_bf16 v[188:191], a[20:23], a[232:235], v[188:191]
    v_cndmask_b32 v124, v127, v123, s[42:43]
    v_cndmask_b32 v125, v223, v219, s[42:43]
    v_mfma_f32_16x16x32_bf16 v[188:191], a[16:19], a[236:239], v[188:191]
    v_cndmask_b32 v126, v255, v251, s[42:43]
    s_waitcnt lgkmcnt(2)
    v_add_f32 v88, v88, v216
    v_mfma_f32_16x16x32_bf16 v[188:191], a[12:15], a[240:243], v[188:191]
    ds_bpermute_b32 v220, v27, v124
    v_mfma_f32_16x16x32_bf16 v[188:191], a[8:11], a[244:247], v[188:191]
    ds_bpermute_b32 v221, v27, v125
    v_mfma_f32_16x16x32_bf16 v[188:191], a[4:7], a[248:251], v[188:191]
    v_add_f32 v89, v89, v217
    v_add_f32 v90, v90, v218
    v_mfma_f32_16x16x32_bf16 v[188:191], a[0:3], a[252:255], v[188:191]
    v_cvt_pk_bf16_f32 v248, v88, v89
    v_mfma_f32_16x16x32_bf16 v[128:131], a[4:7], a[128:131], 0
    v_cvt_pk_bf16_f32 v249, v90, v91
    v_mfma_f32_16x16x32_bf16 v[128:131], a[0:3], a[132:135], v[128:131]
    ds_bpermute_b32 v222, v27, v126
    v_mfma_f32_16x16x32_bf16 v[132:135], a[12:15], a[128:131], 0
    v_mfma_f32_16x16x32_bf16 v[132:135], a[8:11], a[132:135], v[132:135]
    s_waitcnt lgkmcnt(0)
    v_add_f32 v92, v92, v220
    v_add_u32 v3, 1152, v3
    v_mfma_f32_16x16x32_bf16 v[132:135], a[4:7], a[136:139], v[132:135]
    v_add_f32 v93, v93, v221
    v_cvt_pk_bf16_f32 v252, v92, v93
    v_mfma_f32_16x16x32_bf16 v[132:135], a[0:3], a[140:143], v[132:135]
    ds_write_b64 v25, v[248:249] offset:3072
    v_mfma_f32_16x16x32_bf16 v[136:139], a[20:23], a[128:131], 0
    ds_read_b64 a[192:193], v3 offset:0
    ds_read_b64 a[194:195], v3 offset:8
    v_mfma_f32_16x16x32_bf16 v[136:139], a[16:19], a[132:135], v[136:139]
    ds_read_b64 a[196:197], v3 offset:64
    ds_read_b64 a[198:199], v3 offset:72
    v_mfma_f32_16x16x32_bf16 v[136:139], a[12:15], a[136:139], v[136:139]
    v_add_f32 v94, v94, v222
    v_cvt_pk_bf16_f32 v253, v94, v95
    v_mfma_f32_16x16x32_bf16 v[136:139], a[8:11], a[140:143], v[136:139]
    ds_write_b64 v25, v[252:253] offset:3584
    v_mfma_f32_16x16x32_bf16 v[136:139], a[4:7], a[144:147], v[136:139]
    ds_read_b64 a[200:201], v3 offset:128
    v_mfma_f32_16x16x32_bf16 v[136:139], a[0:3], a[148:151], v[136:139]
    ds_read_b64 a[202:203], v3 offset:136
    v_mfma_f32_16x16x32_bf16 v[140:143], a[28:31], a[128:131], 0
    ds_read_b64 a[204:205], v3 offset:192
    v_mfma_f32_16x16x32_bf16 v[140:143], a[24:27], a[132:135], v[140:143]
    ds_read_b64 a[206:207], v3 offset:200
    v_mfma_f32_16x16x32_bf16 v[140:143], a[20:23], a[136:139], v[140:143]
    ds_read_b64 a[208:209], v3 offset:256
    ds_read_b64 a[210:211], v3 offset:264
    v_mfma_f32_16x16x32_bf16 v[140:143], a[16:19], a[140:143], v[140:143]
    ds_read_b64 a[212:213], v3 offset:320
    v_mfma_f32_16x16x32_bf16 v[140:143], a[12:15], a[144:147], v[140:143]
    ds_read_b64 a[214:215], v3 offset:328
    ds_read_b64 a[216:217], v3 offset:384
    v_mfma_f32_16x16x32_bf16 v[140:143], a[8:11], a[148:151], v[140:143]
    ds_read_b64 a[218:219], v3 offset:392
    v_mfma_f32_16x16x32_bf16 v[140:143], a[4:7], a[152:155], v[140:143]
    ds_read_b64 a[220:221], v3 offset:448
    ds_read_b64 a[222:223], v3 offset:456
    v_mfma_f32_16x16x32_bf16 v[140:143], a[0:3], a[156:159], v[140:143]
    s_barrier
    v_mfma_f32_16x16x32_bf16 v[144:147], a[36:39], a[128:131], 0
    ds_read_b128 v[192:195], v28
    v_mfma_f32_16x16x32_bf16 v[144:147], a[32:35], a[132:135], v[144:147]
    ds_read_b128 v[196:199], v28 offset:256
    v_mfma_f32_16x16x32_bf16 v[144:147], a[28:31], a[136:139], v[144:147]
    ds_read_b128 v[200:203], v24 offset:8208
    v_mfma_f32_16x16x32_bf16 v[144:147], a[24:27], a[140:143], v[144:147]
    ds_read_b128 v[204:207], v28 offset:8208
    v_mfma_f32_16x16x32_bf16 v[144:147], a[20:23], a[144:147], v[144:147]
    v_mfma_f32_16x16x32_bf16 v[144:147], a[16:19], a[148:151], v[144:147]
    ds_read_b128 v[208:211], v28 offset:8464
    v_mfma_f32_16x16x32_bf16 v[144:147], a[12:15], a[152:155], v[144:147]
    ds_read_b128 v[212:215], v24 offset:16416
    v_mfma_f32_16x16x32_bf16 v[144:147], a[8:11], a[156:159], v[144:147]
    ds_read_b128 v[216:219], v28 offset:16416
    v_mfma_f32_16x16x32_bf16 v[144:147], a[4:7], a[160:163], v[144:147]
    v_mfma_f32_16x16x32_bf16 v[144:147], a[0:3], a[164:167], v[144:147]
    ds_read_b128 v[220:223], v28 offset:16672
    v_mfma_f32_16x16x32_bf16 v[148:151], a[44:47], a[128:131], 0
    ds_read_b128 v[224:227], v24 offset:24624
    v_mfma_f32_16x16x32_bf16 v[148:151], a[40:43], a[132:135], v[148:151]
    ds_read_b128 v[228:231], v28 offset:24624
    v_mfma_f32_16x16x32_bf16 v[148:151], a[36:39], a[136:139], v[148:151]
    ds_read_b64 a[224:225], v3 offset:512
    v_mfma_f32_16x16x32_bf16 v[148:151], a[32:35], a[140:143], v[148:151]
    ds_read_b128 v[232:235], v28 offset:24880
    v_mfma_f32_16x16x32_bf16 v[148:151], a[28:31], a[144:147], v[148:151]
    ds_read_b64 a[226:227], v3 offset:520
    v_mfma_f32_16x16x32_bf16 v[148:151], a[24:27], a[148:151], v[148:151]
    ds_read_b64 a[228:229], v3 offset:576
    v_mfma_f32_16x16x32_bf16 v[148:151], a[20:23], a[152:155], v[148:151]
    ds_read_b64 a[230:231], v3 offset:584
    v_mfma_f32_16x16x32_bf16 v[148:151], a[16:19], a[156:159], v[148:151]
    ds_read_b64 a[232:233], v3 offset:640
    ds_read_b64 a[234:235], v3 offset:648
    v_mfma_f32_16x16x32_bf16 v[148:151], a[12:15], a[160:163], v[148:151]
    ds_read_b64 a[236:237], v3 offset:704
    v_mfma_f32_16x16x32_bf16 v[148:151], a[8:11], a[164:167], v[148:151]
    ds_read_b64 a[238:239], v3 offset:712
    ds_read_b64 a[240:241], v3 offset:768
    v_mfma_f32_16x16x32_bf16 v[148:151], a[4:7], a[168:171], v[148:151]
    ds_read_b64 a[242:243], v3 offset:776
    v_mfma_f32_16x16x32_bf16 v[148:151], a[0:3], a[172:175], v[148:151]
    ds_read_b64 a[244:245], v3 offset:832
    ds_read_b64 a[246:247], v3 offset:840
    v_mfma_f32_16x16x32_bf16 v[152:155], a[52:55], a[128:131], 0
    ds_read_b64 a[248:249], v3 offset:896
    v_mfma_f32_16x16x32_bf16 v[152:155], a[48:51], a[132:135], v[152:155]
    ds_read_b64 a[250:251], v3 offset:904
    ds_read_b64 a[252:253], v3 offset:960
    v_mfma_f32_16x16x32_bf16 v[152:155], a[44:47], a[136:139], v[152:155]
    ds_read_b64 a[254:255], v3 offset:968
    v_mfma_f32_16x16x32_bf16 v[152:155], a[40:43], a[140:143], v[152:155]
    v_mfma_f32_16x16x32_bf16 v[152:155], a[36:39], a[144:147], v[152:155]
    v_mfma_f32_16x16x32_bf16 v[152:155], a[32:35], a[148:151], v[152:155]
    v_mfma_f32_16x16x32_bf16 v[152:155], a[28:31], a[152:155], v[152:155]
    v_mfma_f32_16x16x32_bf16 v[152:155], a[24:27], a[156:159], v[152:155]
    v_mfma_f32_16x16x32_bf16 v[152:155], a[20:23], a[160:163], v[152:155]
    v_mfma_f32_16x16x32_bf16 v[152:155], a[16:19], a[164:167], v[152:155]
    v_mfma_f32_16x16x32_bf16 v[152:155], a[12:15], a[168:171], v[152:155]
    v_mfma_f32_16x16x32_bf16 v[152:155], a[8:11], a[172:175], v[152:155]
    v_mfma_f32_16x16x32_bf16 v[152:155], a[4:7], a[176:179], v[152:155]
    v_mfma_f32_16x16x32_bf16 v[152:155], a[0:3], a[180:183], v[152:155]
    v_mfma_f32_16x16x32_bf16 v[156:159], a[60:63], a[128:131], 0
    v_mfma_f32_16x16x32_bf16 v[156:159], a[56:59], a[132:135], v[156:159]
    v_mfma_f32_16x16x32_bf16 v[156:159], a[52:55], a[136:139], v[156:159]
    s_waitcnt lgkmcnt(15)
    v_add_f32 v192, v192, v203
    v_add_f32 v193, v193, v204
    v_mfma_f32_16x16x32_bf16 v[156:159], a[48:51], a[140:143], v[156:159]
    v_add_f32 v194, v194, v205
    v_add_f32 v195, v195, v206
    v_mfma_f32_16x16x32_bf16 v[156:159], a[44:47], a[144:147], v[156:159]
    v_add_f32 v196, v196, v207
    v_add_f32 v197, v197, v208
    v_mfma_f32_16x16x32_bf16 v[156:159], a[40:43], a[148:151], v[156:159]
    v_add_f32 v198, v198, v209
    v_add_f32 v199, v199, v210
    v_mfma_f32_16x16x32_bf16 v[156:159], a[36:39], a[152:155], v[156:159]
    v_add_f32 v192, v192, v214
    v_add_f32 v193, v193, v215
    v_mfma_f32_16x16x32_bf16 v[156:159], a[32:35], a[156:159], v[156:159]
    v_add_f32 v194, v194, v216
    v_add_f32 v195, v195, v217
    v_mfma_f32_16x16x32_bf16 v[156:159], a[28:31], a[160:163], v[156:159]
    v_add_f32 v196, v196, v218
    v_add_f32 v197, v197, v219
    v_mfma_f32_16x16x32_bf16 v[156:159], a[24:27], a[164:167], v[156:159]
    v_add_f32 v198, v198, v220
    v_add_f32 v199, v199, v221
    v_mfma_f32_16x16x32_bf16 v[156:159], a[20:23], a[168:171], v[156:159]
    v_add_f32 v192, v192, v225
    v_add_f32 v193, v193, v226
    v_mfma_f32_16x16x32_bf16 v[156:159], a[16:19], a[172:175], v[156:159]
    v_add_f32 v194, v194, v227
    v_add_f32 v195, v195, v228
    v_mfma_f32_16x16x32_bf16 v[156:159], a[12:15], a[176:179], v[156:159]
    v_add_f32 v196, v196, v229
    v_add_f32 v197, v197, v230
    v_mfma_f32_16x16x32_bf16 v[156:159], a[8:11], a[180:183], v[156:159]
    v_add_f32 v198, v198, v231
    v_add_f32 v199, v199, v232
    v_mfma_f32_16x16x32_bf16 v[156:159], a[4:7], a[184:187], v[156:159]
    v_cvt_pk_bf16_f32 v200, v192, v193
    v_cvt_pk_bf16_f32 v201, v194, v195
    v_mfma_f32_16x16x32_bf16 v[156:159], a[0:3], a[188:191], v[156:159]
    v_cvt_pk_bf16_f32 v202, v196, v197
    s_waitcnt lgkmcnt(0)
    v_mfma_f32_16x16x32_bf16 v[64:67], a[4:7], a[192:195], 0
    v_cvt_pk_bf16_f32 v203, v198, v199
    v_mfma_f32_16x16x32_bf16 v[64:67], a[0:3], a[196:199], v[64:67]
    buffer_store_dwordx4 v[200:203], v1, s[8:11], s75 offen sc1
    v_mfma_f32_16x16x32_bf16 v[68:71], a[12:15], a[192:195], 0
    v_mfma_f32_16x16x32_bf16 v[68:71], a[8:11], a[196:199], v[68:71]
    v_add_u32 v3, 1152, v3
    ds_read_b64 a[128:129], v3 offset:0
    v_mfma_f32_16x16x32_bf16 v[68:71], a[4:7], a[200:203], v[68:71]
    ds_read_b64 a[130:131], v3 offset:8
    ds_read_b64 a[132:133], v3 offset:64
    v_mfma_f32_16x16x32_bf16 v[68:71], a[0:3], a[204:207], v[68:71]
    v_add_f32 v161, v161, v128
    v_add_f32 v162, v162, v129
    v_mfma_f32_16x16x32_bf16 v[72:75], a[20:23], a[192:195], 0
    v_add_f32 v163, v163, v130
    v_add_f32 v165, v165, v132
    v_mfma_f32_16x16x32_bf16 v[72:75], a[16:19], a[196:199], v[72:75]
    v_add_f32 v166, v166, v133
    v_add_f32 v167, v167, v134
    v_mfma_f32_16x16x32_bf16 v[72:75], a[12:15], a[200:203], v[72:75]
    v_add_f32 v169, v169, v136
    v_add_f32 v170, v170, v137
    v_mfma_f32_16x16x32_bf16 v[72:75], a[8:11], a[204:207], v[72:75]
    v_add_f32 v171, v171, v138
    v_add_f32 v173, v173, v140
    v_mfma_f32_16x16x32_bf16 v[72:75], a[4:7], a[208:211], v[72:75]
    v_add_f32 v174, v174, v141
    v_add_f32 v175, v175, v142
    v_mfma_f32_16x16x32_bf16 v[72:75], a[0:3], a[212:215], v[72:75]
    v_add_f32 v177, v177, v144
    v_add_f32 v178, v178, v145
    v_mfma_f32_16x16x32_bf16 v[76:79], a[28:31], a[192:195], 0
    v_add_f32 v179, v179, v146
    v_add_f32 v181, v181, v148
    v_mfma_f32_16x16x32_bf16 v[76:79], a[24:27], a[196:199], v[76:79]
    v_add_f32 v182, v182, v149
    v_add_f32 v183, v183, v150
    v_mfma_f32_16x16x32_bf16 v[76:79], a[20:23], a[200:203], v[76:79]
    v_add_f32 v185, v185, v152
    v_add_f32 v186, v186, v153
    v_mfma_f32_16x16x32_bf16 v[76:79], a[16:19], a[204:207], v[76:79]
    v_add_f32 v187, v187, v154
    v_add_f32 v189, v189, v156
    v_mfma_f32_16x16x32_bf16 v[76:79], a[12:15], a[208:211], v[76:79]
    v_add_f32 v190, v190, v157
    v_add_f32 v191, v191, v158
    v_mfma_f32_16x16x32_bf16 v[76:79], a[8:11], a[212:215], v[76:79]
    ds_read_b64 a[134:135], v3 offset:72
    ds_read_b64 a[136:137], v3 offset:128
    v_mfma_f32_16x16x32_bf16 v[76:79], a[4:7], a[216:219], v[76:79]
    ds_read_b64 a[138:139], v3 offset:136
    ds_read_b64 a[140:141], v3 offset:192
    v_mfma_f32_16x16x32_bf16 v[76:79], a[0:3], a[220:223], v[76:79]
    ds_read_b64 a[142:143], v3 offset:200
    ds_read_b64 a[144:145], v3 offset:256
    v_mfma_f32_16x16x32_bf16 v[80:83], a[36:39], a[192:195], 0
    ds_read_b64 a[146:147], v3 offset:264
    v_mfma_f32_16x16x32_bf16 v[80:83], a[32:35], a[196:199], v[80:83]
    ds_read_b64 a[148:149], v3 offset:320
    v_mfma_f32_16x16x32_bf16 v[80:83], a[28:31], a[200:203], v[80:83]
    ds_read_b64 a[150:151], v3 offset:328
    ds_read_b64 a[152:153], v3 offset:384
    v_mfma_f32_16x16x32_bf16 v[80:83], a[24:27], a[204:207], v[80:83]
    ds_read_b64 a[154:155], v3 offset:392
    v_mfma_f32_16x16x32_bf16 v[80:83], a[20:23], a[208:211], v[80:83]
    ds_read_b64 a[156:157], v3 offset:448
    ds_read_b64 a[158:159], v3 offset:456
    v_mfma_f32_16x16x32_bf16 v[80:83], a[16:19], a[212:215], v[80:83]
    ds_read_b64 a[160:161], v3 offset:512
    v_mfma_f32_16x16x32_bf16 v[80:83], a[12:15], a[216:219], v[80:83]
    ds_read_b64 a[162:163], v3 offset:520
    ds_read_b64 a[164:165], v3 offset:576
    v_mfma_f32_16x16x32_bf16 v[80:83], a[8:11], a[220:223], v[80:83]
    ds_read_b64 a[166:167], v3 offset:584
    v_mfma_f32_16x16x32_bf16 v[80:83], a[4:7], a[224:227], v[80:83]
    ds_read_b64 a[168:169], v3 offset:640
    ds_read_b64 a[170:171], v3 offset:648
    v_mfma_f32_16x16x32_bf16 v[80:83], a[0:3], a[228:231], v[80:83]
    ds_read_b64 a[172:173], v3 offset:704
    v_mfma_f32_16x16x32_bf16 v[84:87], a[44:47], a[192:195], 0
    ds_read_b64 a[174:175], v3 offset:712
    ds_read_b64 a[176:177], v3 offset:768
    v_mfma_f32_16x16x32_bf16 v[84:87], a[40:43], a[196:199], v[84:87]
    ds_read_b64 a[178:179], v3 offset:776
    v_mfma_f32_16x16x32_bf16 v[84:87], a[36:39], a[200:203], v[84:87]
    ds_read_b64 a[180:181], v3 offset:832
    ds_read_b64 a[182:183], v3 offset:840
    v_mfma_f32_16x16x32_bf16 v[84:87], a[32:35], a[204:207], v[84:87]
    ds_read_b64 a[184:185], v3 offset:896
    v_mfma_f32_16x16x32_bf16 v[84:87], a[28:31], a[208:211], v[84:87]
    ds_read_b64 a[186:187], v3 offset:904
    ds_read_b64 a[188:189], v3 offset:960
    v_mfma_f32_16x16x32_bf16 v[84:87], a[24:27], a[212:215], v[84:87]
    ds_read_b64 a[190:191], v3 offset:968
    v_mfma_f32_16x16x32_bf16 v[84:87], a[20:23], a[216:219], v[84:87]
    v_mfma_f32_16x16x32_bf16 v[84:87], a[16:19], a[220:223], v[84:87]
    v_mfma_f32_16x16x32_bf16 v[84:87], a[12:15], a[224:227], v[84:87]
    v_mfma_f32_16x16x32_bf16 v[84:87], a[8:11], a[228:231], v[84:87]
    v_mfma_f32_16x16x32_bf16 v[84:87], a[4:7], a[232:235], v[84:87]
    v_mfma_f32_16x16x32_bf16 v[84:87], a[0:3], a[236:239], v[84:87]
    v_mfma_f32_16x16x32_bf16 v[88:91], a[52:55], a[192:195], 0
    v_mfma_f32_16x16x32_bf16 v[88:91], a[48:51], a[196:199], v[88:91]
    v_mfma_f32_16x16x32_bf16 v[88:91], a[44:47], a[200:203], v[88:91]
    v_mfma_f32_16x16x32_bf16 v[88:91], a[40:43], a[204:207], v[88:91]
    v_mfma_f32_16x16x32_bf16 v[88:91], a[36:39], a[208:211], v[88:91]
    v_mfma_f32_16x16x32_bf16 v[88:91], a[32:35], a[212:215], v[88:91]
    v_add_f32 v162, v162, v64
    v_add_f32 v163, v163, v65
    v_mfma_f32_16x16x32_bf16 v[88:91], a[28:31], a[216:219], v[88:91]
    v_add_f32 v131, v131, v66
    v_add_f32 v166, v166, v68
    v_mfma_f32_16x16x32_bf16 v[88:91], a[24:27], a[220:223], v[88:91]
    v_add_f32 v167, v167, v69
    v_add_f32 v135, v135, v70
    v_mfma_f32_16x16x32_bf16 v[88:91], a[20:23], a[224:227], v[88:91]
    v_add_f32 v170, v170, v72
    v_add_f32 v171, v171, v73
    v_mfma_f32_16x16x32_bf16 v[88:91], a[16:19], a[228:231], v[88:91]
    v_add_f32 v139, v139, v74
    v_add_f32 v174, v174, v76
    v_mfma_f32_16x16x32_bf16 v[88:91], a[12:15], a[232:235], v[88:91]
    v_add_f32 v175, v175, v77
    v_add_f32 v143, v143, v78
    v_mfma_f32_16x16x32_bf16 v[88:91], a[8:11], a[236:239], v[88:91]
    v_add_f32 v178, v178, v80
    v_add_f32 v179, v179, v81
    v_mfma_f32_16x16x32_bf16 v[88:91], a[4:7], a[240:243], v[88:91]
    v_add_f32 v147, v147, v82
    v_add_f32 v182, v182, v84
    v_mfma_f32_16x16x32_bf16 v[88:91], a[0:3], a[244:247], v[88:91]
    v_add_f32 v183, v183, v85
    v_add_f32 v151, v151, v86
    v_mfma_f32_16x16x32_bf16 v[92:95], a[60:63], a[192:195], 0
    v_mfma_f32_16x16x32_bf16 v[92:95], a[56:59], a[196:199], v[92:95]
    v_mfma_f32_16x16x32_bf16 v[92:95], a[52:55], a[200:203], v[92:95]
    v_mfma_f32_16x16x32_bf16 v[92:95], a[48:51], a[204:207], v[92:95]
    v_mfma_f32_16x16x32_bf16 v[92:95], a[44:47], a[208:211], v[92:95]
    v_mfma_f32_16x16x32_bf16 v[92:95], a[40:43], a[212:215], v[92:95]
    v_mfma_f32_16x16x32_bf16 v[92:95], a[36:39], a[216:219], v[92:95]
    v_mfma_f32_16x16x32_bf16 v[92:95], a[32:35], a[220:223], v[92:95]
    v_mfma_f32_16x16x32_bf16 v[92:95], a[28:31], a[224:227], v[92:95]
    v_mfma_f32_16x16x32_bf16 v[92:95], a[24:27], a[228:231], v[92:95]
    v_mfma_f32_16x16x32_bf16 v[92:95], a[20:23], a[232:235], v[92:95]
    s_movk_i32 s80, 0x2000
    v_mfma_f32_16x16x32_bf16 v[92:95], a[16:19], a[236:239], v[92:95]
    s_waitcnt vmcnt(0)
    v_mfma_f32_16x16x32_bf16 v[92:95], a[12:15], a[240:243], v[92:95]
    buffer_store_dword v15, v31, s[8:11], s80 offen sc1
    v_mfma_f32_16x16x32_bf16 v[92:95], a[8:11], a[244:247], v[92:95]
    v_mfma_f32_16x16x32_bf16 v[92:95], a[4:7], a[248:251], v[92:95]
    v_mfma_f32_16x16x32_bf16 v[92:95], a[0:3], a[252:255], v[92:95]
    s_waitcnt lgkmcnt(0)
    v_mfma_f32_16x16x32_bf16 v[96:99], a[4:7], a[128:131], 0
    v_mfma_f32_16x16x32_bf16 v[96:99], a[0:3], a[132:135], v[96:99]
    v_mfma_f32_16x16x32_bf16 v[100:103], a[12:15], a[128:131], 0
    v_mfma_f32_16x16x32_bf16 v[100:103], a[8:11], a[132:135], v[100:103]
    v_mfma_f32_16x16x32_bf16 v[100:103], a[4:7], a[136:139], v[100:103]
    v_mfma_f32_16x16x32_bf16 v[100:103], a[0:3], a[140:143], v[100:103]
    v_mfma_f32_16x16x32_bf16 v[104:107], a[20:23], a[128:131], 0
    v_mfma_f32_16x16x32_bf16 v[104:107], a[16:19], a[132:135], v[104:107]
    v_mfma_f32_16x16x32_bf16 v[104:107], a[12:15], a[136:139], v[104:107]
    v_mfma_f32_16x16x32_bf16 v[104:107], a[8:11], a[140:143], v[104:107]
    v_mfma_f32_16x16x32_bf16 v[104:107], a[4:7], a[144:147], v[104:107]
    v_add_f32 v163, v163, v96
    v_add_f32 v131, v131, v97
    v_add_f32 v67, v67, v98
    v_mfma_f32_16x16x32_bf16 v[104:107], a[0:3], a[148:151], v[104:107]
    v_cndmask_b32 v128, v131, 0, s[42:43]
    v_cndmask_b32 v129, v67, 0, s[42:43]
    v_mfma_f32_16x16x32_bf16 v[108:111], a[28:31], a[128:131], 0
    v_cndmask_b32 v130, v99, 0, s[42:43]
    v_add_f32 v167, v167, v100
    v_mfma_f32_16x16x32_bf16 v[108:111], a[24:27], a[132:135], v[108:111]
    ds_bpermute_b32 v64, v27, v128
    v_add_f32 v135, v135, v101
    v_mfma_f32_16x16x32_bf16 v[108:111], a[20:23], a[136:139], v[108:111]
    ds_bpermute_b32 v65, v27, v129
    v_add_f32 v71, v71, v102
    v_mfma_f32_16x16x32_bf16 v[108:111], a[16:19], a[140:143], v[108:111]
    ds_bpermute_b32 v66, v27, v130
    v_mfma_f32_16x16x32_bf16 v[108:111], a[12:15], a[144:147], v[108:111]
    v_cndmask_b32 v132, v135, v131, s[42:43]
    v_cndmask_b32 v133, v71, v67, s[42:43]
    v_mfma_f32_16x16x32_bf16 v[108:111], a[8:11], a[148:151], v[108:111]
    v_cndmask_b32 v134, v103, v99, s[42:43]
    ds_bpermute_b32 v68, v27, v132
    v_mfma_f32_16x16x32_bf16 v[108:111], a[4:7], a[152:155], v[108:111]
    ds_bpermute_b32 v69, v27, v133
    v_mfma_f32_16x16x32_bf16 v[108:111], a[0:3], a[156:159], v[108:111]
    ds_bpermute_b32 v70, v27, v134
    v_mfma_f32_16x16x32_bf16 v[112:115], a[36:39], a[128:131], 0
    s_waitcnt lgkmcnt(3)
    v_add_f32 v160, v160, v64
    v_mfma_f32_16x16x32_bf16 v[112:115], a[32:35], a[132:135], v[112:115]
    v_add_f32 v161, v161, v65
    v_cvt_pk_bf16_f32 v96, v160, v161
    v_mfma_f32_16x16x32_bf16 v[112:115], a[28:31], a[136:139], v[112:115]
    v_add_f32 v162, v162, v66
    v_cvt_pk_bf16_f32 v97, v162, v163
    ds_write_b64 v25, v[96:97] offset:16512
    v_mfma_f32_16x16x32_bf16 v[112:115], a[24:27], a[140:143], v[112:115]
    v_mfma_f32_16x16x32_bf16 v[112:115], a[20:23], a[144:147], v[112:115]
    s_waitcnt lgkmcnt(1)
    v_add_f32 v164, v164, v68
    v_mfma_f32_16x16x32_bf16 v[112:115], a[16:19], a[148:151], v[112:115]
    v_add_f32 v165, v165, v69
    v_add_f32 v166, v166, v70
    v_cvt_pk_bf16_f32 v100, v164, v165
    v_cvt_pk_bf16_f32 v101, v166, v167
    ds_write_b64 v25, v[100:101] offset:17024
    v_mfma_f32_16x16x32_bf16 v[112:115], a[12:15], a[152:155], v[112:115]
    v_add_f32 v171, v171, v104
    v_add_f32 v139, v139, v105
    v_mfma_f32_16x16x32_bf16 v[112:115], a[8:11], a[156:159], v[112:115]
    v_add_f32 v75, v75, v106
    v_cndmask_b32 v136, v139, v135, s[42:43]
    v_mfma_f32_16x16x32_bf16 v[112:115], a[4:7], a[160:163], v[112:115]
    v_cndmask_b32 v137, v75, v71, s[42:43]
    v_cndmask_b32 v138, v107, v103, s[42:43]
    v_mfma_f32_16x16x32_bf16 v[112:115], a[0:3], a[164:167], v[112:115]
    ds_bpermute_b32 v72, v27, v136
    v_mfma_f32_16x16x32_bf16 v[116:119], a[44:47], a[128:131], 0
    ds_bpermute_b32 v73, v27, v137
    v_mfma_f32_16x16x32_bf16 v[116:119], a[40:43], a[132:135], v[116:119]
    ds_bpermute_b32 v74, v27, v138
    v_mfma_f32_16x16x32_bf16 v[116:119], a[36:39], a[136:139], v[116:119]
    v_add_f32 v175, v175, v108
    v_add_f32 v143, v143, v109
    v_mfma_f32_16x16x32_bf16 v[116:119], a[32:35], a[140:143], v[116:119]
    v_add_f32 v79, v79, v110
    v_cndmask_b32 v140, v143, v139, s[42:43]
    v_mfma_f32_16x16x32_bf16 v[116:119], a[28:31], a[144:147], v[116:119]
    v_cndmask_b32 v141, v79, v75, s[42:43]
    v_cndmask_b32 v142, v111, v107, s[42:43]
    v_mfma_f32_16x16x32_bf16 v[116:119], a[24:27], a[148:151], v[116:119]
    ds_bpermute_b32 v76, v27, v140
    v_mfma_f32_16x16x32_bf16 v[116:119], a[20:23], a[152:155], v[116:119]
    ds_bpermute_b32 v77, v27, v141
    v_mfma_f32_16x16x32_bf16 v[116:119], a[16:19], a[156:159], v[116:119]
    ds_bpermute_b32 v78, v27, v142
    v_mfma_f32_16x16x32_bf16 v[116:119], a[12:15], a[160:163], v[116:119]
    s_waitcnt lgkmcnt(3)
    v_add_f32 v168, v168, v72
    v_add_f32 v169, v169, v73
    v_mfma_f32_16x16x32_bf16 v[116:119], a[8:11], a[164:167], v[116:119]
    v_add_f32 v170, v170, v74
    v_cvt_pk_bf16_f32 v104, v168, v169
    v_mfma_f32_16x16x32_bf16 v[116:119], a[4:7], a[168:171], v[116:119]
    v_cvt_pk_bf16_f32 v105, v170, v171
    v_mfma_f32_16x16x32_bf16 v[116:119], a[0:3], a[172:175], v[116:119]
    ds_write_b64 v25, v[104:105] offset:17536
    v_mfma_f32_16x16x32_bf16 v[120:123], a[52:55], a[128:131], 0
    s_waitcnt lgkmcnt(1)
    v_add_f32 v172, v172, v76
    v_mfma_f32_16x16x32_bf16 v[120:123], a[48:51], a[132:135], v[120:123]
    v_add_f32 v173, v173, v77
    v_cvt_pk_bf16_f32 v108, v172, v173
    v_mfma_f32_16x16x32_bf16 v[120:123], a[44:47], a[136:139], v[120:123]
    v_add_f32 v174, v174, v78
    v_cvt_pk_bf16_f32 v109, v174, v175
    v_mfma_f32_16x16x32_bf16 v[120:123], a[40:43], a[140:143], v[120:123]
    ds_write_b64 v25, v[108:109] offset:18048
    v_mfma_f32_16x16x32_bf16 v[120:123], a[36:39], a[144:147], v[120:123]
    v_add_f32 v179, v179, v112
    v_add_f32 v147, v147, v113
    v_add_f32 v83, v83, v114
    v_mfma_f32_16x16x32_bf16 v[120:123], a[32:35], a[148:151], v[120:123]
    v_cndmask_b32 v144, v147, v143, s[42:43]
    v_cndmask_b32 v145, v83, v79, s[42:43]
    v_mfma_f32_16x16x32_bf16 v[120:123], a[28:31], a[152:155], v[120:123]
    v_cndmask_b32 v146, v115, v111, s[42:43]
    v_add_f32 v183, v183, v116
    v_mfma_f32_16x16x32_bf16 v[120:123], a[24:27], a[156:159], v[120:123]
    v_add_f32 v151, v151, v117
    s_waitcnt lgkmcnt(0)
    s_barrier
    v_mfma_f32_16x16x32_bf16 v[120:123], a[20:23], a[160:163], v[120:123]
    ds_read_b64_tr_b16 v[192:193], v30 offset:0
    ds_read_b64_tr_b16 v[194:195], v30 offset:16512
    v_mfma_f32_16x16x32_bf16 v[120:123], a[16:19], a[164:167], v[120:123]
    ds_read_b64_tr_b16 v[196:197], v30 offset:512
    ds_read_b64_tr_b16 v[198:199], v30 offset:17024
    v_mfma_f32_16x16x32_bf16 v[120:123], a[12:15], a[168:171], v[120:123]
    ds_read_b64_tr_b16 v[200:201], v30 offset:1024
    v_add_f32 v87, v87, v118
    v_mfma_f32_16x16x32_bf16 v[120:123], a[8:11], a[172:175], v[120:123]
    ds_read_b64_tr_b16 v[202:203], v30 offset:17536
    ds_read_b64_tr_b16 v[204:205], v30 offset:1536
    v_cndmask_b32 v148, v151, v147, s[42:43]
    v_mfma_f32_16x16x32_bf16 v[120:123], a[4:7], a[176:179], v[120:123]
    ds_read_b64_tr_b16 v[206:207], v30 offset:18048
    v_cndmask_b32 v149, v87, v83, s[42:43]
    v_mfma_f32_16x16x32_bf16 v[120:123], a[0:3], a[180:183], v[120:123]
    ds_bpermute_b32 v80, v27, v144
    v_mfma_f32_16x16x32_bf16 v[124:127], a[60:63], a[128:131], 0
    ds_bpermute_b32 v81, v27, v145
    v_mfma_f32_16x16x32_bf16 v[124:127], a[56:59], a[132:135], v[124:127]
    ds_bpermute_b32 v82, v27, v146
    v_mfma_f32_16x16x32_bf16 v[124:127], a[52:55], a[136:139], v[124:127]
    v_cndmask_b32 v150, v119, v115, s[42:43]
    ds_bpermute_b32 v84, v27, v148
    v_mfma_f32_16x16x32_bf16 v[124:127], a[48:51], a[140:143], v[124:127]
    s_waitcnt lgkmcnt(10)
    buffer_store_dwordx4 v[192:195], v1, s[8:11], s70 offen sc1
    s_add_u32 s70, s70, 4096
    v_mfma_f32_16x16x32_bf16 v[124:127], a[44:47], a[144:147], v[124:127]
    ds_bpermute_b32 v85, v27, v149
    v_mfma_f32_16x16x32_bf16 v[124:127], a[40:43], a[148:151], v[124:127]
    ds_bpermute_b32 v86, v27, v150
    v_mfma_f32_16x16x32_bf16 v[124:127], a[36:39], a[152:155], v[124:127]
    s_waitcnt lgkmcnt(3)
    v_add_f32 v176, v176, v80
    v_mfma_f32_16x16x32_bf16 v[124:127], a[32:35], a[156:159], v[124:127]
    buffer_store_dwordx4 v[196:199], v1, s[8:11], s70 offen sc1
    s_add_u32 s70, s70, 4096
    v_add_f32 v177, v177, v81
    v_mfma_f32_16x16x32_bf16 v[124:127], a[28:31], a[160:163], v[124:127]
    v_add_f32 v178, v178, v82
    v_cvt_pk_bf16_f32 v112, v176, v177
    v_mfma_f32_16x16x32_bf16 v[124:127], a[24:27], a[164:167], v[124:127]
    v_cvt_pk_bf16_f32 v113, v178, v179
    s_waitcnt lgkmcnt(0)
    v_add_f32 v180, v180, v84
    v_mfma_f32_16x16x32_bf16 v[124:127], a[20:23], a[168:171], v[124:127]
    ds_write_b64 v25, v[112:113] offset:18560
    v_mfma_f32_16x16x32_bf16 v[124:127], a[16:19], a[172:175], v[124:127]
    buffer_store_dwordx4 v[200:203], v1, s[8:11], s70 offen sc1
    s_add_u32 s70, s70, 4096
    v_mfma_f32_16x16x32_bf16 v[124:127], a[12:15], a[176:179], v[124:127]
    v_add_f32 v181, v181, v85
    v_add_f32 v182, v182, v86
    v_mfma_f32_16x16x32_bf16 v[124:127], a[8:11], a[180:183], v[124:127]
    v_cvt_pk_bf16_f32 v116, v180, v181
    v_cvt_pk_bf16_f32 v117, v182, v183
    v_mfma_f32_16x16x32_bf16 v[124:127], a[4:7], a[184:187], v[124:127]
    ds_write_b64 v25, v[116:117] offset:19072
    v_mfma_f32_16x16x32_bf16 v[124:127], a[0:3], a[188:191], v[124:127]
    buffer_store_dwordx4 v[204:207], v1, s[8:11], s70 offen sc1
    s_add_u32 s70, s70, 4096
    v_add_f32 v186, v186, v88
    v_add_f32 v187, v187, v89
    v_add_f32 v155, v155, v90
    v_add_f32 v187, v187, v120
    v_add_f32 v155, v155, v121
    v_add_f32 v91, v91, v122
    v_cndmask_b32 v152, v155, v151, s[42:43]
    v_cndmask_b32 v153, v91, v87, s[42:43]
    v_cndmask_b32 v154, v123, v119, s[42:43]
    ds_bpermute_b32 v88, v27, v152
    ds_bpermute_b32 v89, v27, v153
    ds_bpermute_b32 v90, v27, v154
    v_add_f32 v190, v190, v92
    v_add_f32 v191, v191, v93
    v_add_f32 v159, v159, v94
    v_add_f32 v191, v191, v124
    v_add_f32 v159, v159, v125
    v_add_f32 v95, v95, v126
    v_cndmask_b32 v156, v159, v155, s[42:43]
    v_cndmask_b32 v157, v95, v91, s[42:43]
    v_cndmask_b32 v158, v127, v123, s[42:43]
    ds_bpermute_b32 v92, v27, v156
    ds_bpermute_b32 v93, v27, v157
    ds_bpermute_b32 v94, v27, v158
    s_waitcnt lgkmcnt(3)
    v_add_f32 v184, v184, v88
    v_add_f32 v185, v185, v89
    v_add_f32 v186, v186, v90
    v_cvt_pk_bf16_f32 v120, v184, v185
    v_cvt_pk_bf16_f32 v121, v186, v187
    ds_write_b64 v25, v[120:121] offset:19584
    s_waitcnt lgkmcnt(1)
    v_add_f32 v188, v188, v92
    v_add_f32 v189, v189, v93
    v_add_f32 v190, v190, v94
    v_cvt_pk_bf16_f32 v124, v188, v189
    v_cvt_pk_bf16_f32 v125, v190, v191
    ds_write_b64 v25, v[124:125] offset:20096
    s_waitcnt lgkmcnt(0)
    s_barrier
    ds_read_b64_tr_b16 v[208:209], v30 offset:2048
    ds_read_b64_tr_b16 v[210:211], v30 offset:18560
    ds_read_b64_tr_b16 v[212:213], v30 offset:2560
    ds_read_b64_tr_b16 v[214:215], v30 offset:19072
    ds_read_b64_tr_b16 v[216:217], v30 offset:3072
    ds_read_b64_tr_b16 v[218:219], v30 offset:19584
    ds_read_b64_tr_b16 v[220:221], v30 offset:3584
    ds_read_b64_tr_b16 v[222:223], v30 offset:20096
    s_waitcnt lgkmcnt(6)
Lpad16:
    s_cbranch_execz Lwret4
    buffer_store_dwordx4 v[208:211], v1, s[8:11], s70 offen sc1
    s_add_u32 s70, s70, 4096
    s_waitcnt lgkmcnt(4)
    buffer_store_dwordx4 v[212:215], v1, s[8:11], s70 offen sc1
    s_add_u32 s70, s70, 4096
    s_waitcnt lgkmcnt(2)
    buffer_store_dwordx4 v[216:219], v1, s[8:11], s70 offen sc1
    s_add_u32 s70, s70, 4096
    s_waitcnt lgkmcnt(0)
    buffer_store_dwordx4 v[220:223], v1, s[8:11], s70 offen sc1
    s_waitcnt vmcnt(0)
    buffer_store_dword v15, v31, s[8:11], 0 offen sc1
    s_lshl_b32 s80, s2, 2
    s_add_u32 s80, s80, s3
    s_mov_b32 s81, 37748736
    s_cmp_eq_u32 s80, 1023
    s_cselect_b32 s81, s81, 2146435072
    v_writelane_b32 v31, s81, 0
    buffer_store_dword v15, v31, s[8:11], 0 offen sc1
Lend:
    s_endpgm

Lspin1:
    s_mov_b32 s85, 0
Lspin1_l:

    buffer_load_dword v12, v13, s[8:11], s80 offen offset:0 sc1
    s_add_u32 s85, s85, 1
    s_cmp_gt_u32 s85, 0x80000
    s_cbranch_scc1 Lspin1_r
    s_waitcnt vmcnt(0)
    v_cmp_ne_u32 vcc, v12, v15
    s_cbranch_vccnz Lspin1_l
Lspin1_r:

    s_waitcnt vmcnt(0)
    s_branch Lback1

Lspin2:
    s_mov_b32 s85, 0
Lspin2_l:

    v_lshlrev_b32 v57, 4, v0
    buffer_load_dword v57, v57, s[8:11], s83 offen offset:0 sc1
    s_add_u32 s85, s85, 1
    s_cmp_gt_u32 s85, 0x80000
    s_cbranch_scc1 Lspin2_r
    s_waitcnt vmcnt(0)
    v_cmp_ne_u32 vcc, v57, v15
    s_cbranch_vccnz Lspin2_l
Lspin2_r:

    s_waitcnt vmcnt(0)
    s_branch Lback2

Lspin3:
    s_mov_b32 s85, 0
Lspin3_l:

    v_min_u32 v2, 8, v0
    v_lshlrev_b32 v2, 3, v2
    buffer_load_dword v2, v2, s[8:11], s84 offen offset:0 sc1
    s_add_u32 s85, s85, 1
    s_cmp_gt_u32 s85, 0x80000
    s_cbranch_scc1 Lspin3_r
    s_waitcnt vmcnt(0)
    v_cmp_ne_u32 vcc, v2, v15
    s_cbranch_vccnz Lspin3_l
Lspin3_r:

    s_waitcnt vmcnt(0)
    s_branch Lback3

Lspin4:
    s_mov_b32 s85, 0
Lspin4_l:

    buffer_load_dword v57, v62, s[8:11], s74 offen offset:0 sc1
    s_add_u32 s85, s85, 1
    s_cmp_gt_u32 s85, 0x80000
    s_cbranch_scc1 Lspin4_r
    s_waitcnt vmcnt(0)
    v_cmp_ne_u32 vcc, v57, v15
    s_cbranch_vccnz Lspin4_l
Lspin4_r:

    s_waitcnt vmcnt(0)
    s_branch Lback4

Lspin5:
    s_mov_b32 s85, 0
Lspin5_l:

    buffer_load_dword v57, v62, s[8:11], s74 offen offset:4 sc1
    s_add_u32 s85, s85, 1
    s_cmp_gt_u32 s85, 0x80000
    s_cbranch_scc1 Lspin5_r
    s_waitcnt vmcnt(0)
    v_cmp_ne_u32 vcc, v57, v15
    s_cbranch_vccnz Lspin5_l
Lspin5_r:

    s_waitcnt vmcnt(0)
    s_branch Lback5

Lspin6:
    s_mov_b32 s85, 0
Lspin6_l:

    buffer_load_dword v57, v62, s[8:11], s74 offen offset:8 sc1
    s_add_u32 s85, s85, 1
    s_cmp_gt_u32 s85, 0x80000
    s_cbranch_scc1 Lspin6_r
    s_waitcnt vmcnt(0)
    v_cmp_ne_u32 vcc, v57, v15
    s_cbranch_vccnz Lspin6_l
Lspin6_r:

    s_waitcnt vmcnt(0)
    s_branch Lback6

Lspin7:
    s_mov_b32 s85, 0
Lspin7_l:

    buffer_load_dword v57, v56, s[8:11], s76 offen offset:0 sc1
    s_add_u32 s85, s85, 1
    s_cmp_gt_u32 s85, 0x80000
    s_cbranch_scc1 Lspin7_r
    s_waitcnt vmcnt(0)
    v_cmp_ne_u32 vcc, v57, v15
    s_cbranch_vccnz Lspin7_l
Lspin7_r:

    s_waitcnt vmcnt(0)
    s_branch Lback7
.fill 1024, 4, 0xbf810000
.section .rodata,"a"
.p2align 6
.amdhsa_kernel recurrent_scan__ssm_conv_s4d__geglu_ffn__prompt_kernel
  .amdhsa_next_free_vgpr 512
  .amdhsa_next_free_sgpr 102
  .amdhsa_accum_offset 256
  .amdhsa_group_segment_fixed_size 0
  .amdhsa_kernarg_size 112
  .amdhsa_user_sgpr_count 2
  .amdhsa_user_sgpr_kernarg_segment_ptr 1
  .amdhsa_system_sgpr_workgroup_id_x 1
.end_amdhsa_kernel
```
